```python
import torch

def _softmax(x, axis=-1):
    return torch.softmax(x, dim=axis)

def _gelu(x):
    return torch.nn.functional.gelu(x, approximate='tanh')

def _silu(x):
    return torch.nn.functional.silu(x)

def _sigmoid(x):
    return torch.sigmoid(x)

def _layernorm(x, axis=-1, eps=1e-05):
    m = x.mean(dim=axis, keepdim=True)
    v = x.var(dim=axis, keepdim=True, unbiased=False)
    return (x - m) / torch.sqrt(v + eps)

def _scatter_add(tgt, idx, src, axis=0):
    return tgt.clone().index_add_(axis, idx, src)

def _segment_sum(src, seg, n):
    out = torch.zeros((n,) + src.shape[1:], dtype=src.dtype)
    return out.index_add_(0, seg, src)

def _pad(x, pw):
    flat = tuple((v for pair in reversed(pw) for v in pair))
    return torch.nn.functional.pad(x, flat)
kernel_name = 'parallel_sum__memory_aug_recurrent_mem_tr__dense_activation_silu__prompt'

def setup_inputs():

    _w = lambda a: (lambda t: t.to(torch.bfloat16) if t.is_floating_point() else t)(torch.as_tensor(a))

    def _A_setup():
        B, S, Dm = (1, 2048, 1024)
        H, Dh = (32, 128)
        M, seg = (8, 32)
        seg = min(seg, S)
        S = S // seg * seg
        return {'x': _w((lambda *s: torch.randn(*s, dtype=torch.bfloat16) * 0.05)(B, S, Dm)), 'mem0': _w((lambda *s: torch.randn(*s, dtype=torch.bfloat16) * 0.2)(B, M, Dm)), 'Wq': _w((lambda *s: torch.randn(*s, dtype=torch.bfloat16) * 1.6)(Dm, H, Dh) * Dm ** (-0.5)), 'Wk': _w((lambda *s: torch.randn(*s, dtype=torch.bfloat16) * 1.6)(Dm, H, Dh) * Dm ** (-0.5)), 'Wv': _w((lambda *s: torch.randn(*s, dtype=torch.bfloat16) * 0.2)(Dm, H, Dh) * Dm ** (-0.5)), 'Wo': _w((lambda *s: torch.randn(*s, dtype=torch.bfloat16) * 0.2)(H, Dh, Dm) * (H * Dh) ** (-0.5)), 'seg_len': seg}
    _A_in = _A_setup()

    def _B_setup():
        B, S, D, F = (1, 2048, 1024, 3584)
        return {'x': _w((lambda *s: torch.randn(*s, dtype=torch.bfloat16) * 0.05)(B, S, D)), 'w1': _w((lambda *s: torch.randn(*s, dtype=torch.bfloat16) * 0.8)(D, F) * D ** (-0.5)), 'w2': _w((lambda *s: torch.randn(*s, dtype=torch.bfloat16) * 0.1)(F, D) * F ** (-0.5))}
    _B_in = _B_setup()
    return {'A_x': _A_in['x'], 'A_mem0': _A_in['mem0'], 'A_Wq': _A_in['Wq'], 'A_Wk': _A_in['Wk'], 'A_Wv': _A_in['Wv'], 'A_Wo': _A_in['Wo'], 'A_seg_len': _A_in['seg_len'], 'B_x': _B_in['x'], 'B_w1': _B_in['w1'], 'B_w2': _B_in['w2']}

def reference(A_x, A_mem0, A_Wq, A_Wk, A_Wv, A_Wo, A_seg_len, B_x, B_w1, B_w2):

    def _A_ref(x, mem0, Wq, Wk, Wv, Wo, seg_len):
        B, S, Dm = x.shape
        H, Dh = (Wq.shape[1], Wq.shape[2])
        M = mem0.shape[1]
        scale = Dh ** (-0.5)
        n_seg = S // seg_len
        L = M + seg_len
        idx = torch.arange(L)
        mask = (idx[:, None] < M) | (idx[:, None] >= idx[None, :])
        mem = mem0
        outs = []
        for s in range(n_seg):
            xs = x[:, s * seg_len:(s + 1) * seg_len, :].clone()
            h = torch.concatenate([mem, xs], axis=1)
            q = torch.einsum('btd,dhe->bhte', h, Wq)
            k = torch.einsum('btd,dhe->bhte', h, Wk)
            v = torch.einsum('btd,dhe->bhte', h, Wv)
            scores = torch.einsum('bhqe,bhke->bhqk', q, k) * scale
            scores = torch.where(mask[None, None], scores, -1000000000.0)
            p = _softmax(scores, axis=-1)
            o = torch.einsum('bhqk,bhke->bhqe', p, v)
            o = torch.einsum('bhte,hed->btd', o, Wo)
            mem = o[:, :M, :].clone()
            outs.append(o[:, M:, :])
        return torch.concatenate(outs, axis=1)

    def _B_ref(x, w1, w2):
        h = torch.einsum('bsd,df->bsf', x, w1)
        h = _silu(h)
        out = torch.einsum('bsf,fd->bsd', h, w2)
        return out
    x = A_x
    xn = _layernorm(x, axis=-1)
    return x + _A_ref(xn, A_mem0, A_Wq, A_Wk, A_Wv, A_Wo, A_seg_len) + _B_ref(xn, B_w1, B_w2)
```

```asm
; @launch grid=(256,1,1) block=(256,1,1) lds=163840
.amdgcn_target "amdgcn-amd-amdhsa--gfx950"
.text
.globl parallel_sum__memory_aug_recurrent_mem_tr__dense_activation_silu__prompt_kernel
.p2align 8
.type parallel_sum__memory_aug_recurrent_mem_tr__dense_activation_silu__prompt_kernel,@function
parallel_sum__memory_aug_recurrent_mem_tr__dense_activation_silu__prompt_kernel:
s_cmp_ge_u32 s2, 256
s_cbranch_scc1 m_end
s_load_dwordx2 s[72:73], s[0:1], 88
s_mov_b32 s74, 256
s_mov_b32 s75, 0x20000
s_load_dwordx2 s[4:5], s[0:1], 96
s_mov_b32 s6, 268435456
s_mov_b32 s7, 0x20000
s_load_dwordx2 s[8:9], s[0:1], 0
s_mov_b32 s10, 4194304
s_mov_b32 s11, 0x20000
v_lshrrev_b32 v2, 6, v0
v_and_b32 v0, 63, v0
s_getreg_b32 s56, hwreg(HW_REG_XCC_ID, 0, 4)
v_readfirstlane_b32 s14, v2
v_mov_b32 v97, 1
s_lshl_b32 s24, s56, 4
s_cmp_lt_u32 s56, 8
s_cselect_b32 s24, s24, 2147483648
s_waitcnt lgkmcnt(0)
s_and_b32 s31, s72, 127
s_cselect_b32 s24, 2147483648, s24
s_cmp_eq_u32 s14, 0
s_cselect_b32 s24, s24, 2147483648
v_mov_b32 v96, 2147483648
v_writelane_b32 v96, s24, 0
buffer_atomic_add v97, v96, s[72:75], 0 offen sc0
s_load_dwordx2 s[40:41], s[0:1], 24
s_mov_b32 s42, 8388608
s_mov_b32 s43, 0x20000
s_load_dwordx2 s[44:45], s[0:1], 32
s_mov_b32 s46, 8388608
s_mov_b32 s47, 0x20000
s_load_dwordx2 s[48:49], s[0:1], 16
s_mov_b32 s50, 8388608
s_mov_b32 s51, 0x20000
s_load_dwordx2 s[52:53], s[0:1], 40
s_mov_b32 s54, 8388608
s_mov_b32 s55, 0x20000
s_load_dwordx2 s[96:97], s[0:1], 8
s_mov_b32 s98, 16384
s_mov_b32 s99, 0x20000
v_mov_b32 v8, -1
v_mov_b32 v9, -1
v_mov_b32 v10, -1
v_mov_b32 v11, -1
v_mov_b32 v12, -1
v_mov_b32 v255, -1
s_mov_b32 s17, 0x100000
s_lshr_b32 s24, s2, 3
s_lshl_b32 s24, s24, 1
s_xor_b32 s25, s2, s14
s_and_b32 s25, s25, 1
s_add_u32 s24, s24, s25
s_lshl_b32 s24, s24, 3
s_and_b32 s25, s2, 7
s_add_u32 s24, s24, s25
s_add_u32 s24, s24, 165888
s_add_u32 s25, s2, 163840
s_cmp_eq_u32 s14, 0
s_cselect_b32 s24, s25, s24
s_add_u32 s25, s2, 164352
s_cmp_eq_u32 s14, 3
s_cselect_b32 s24, s25, s24
s_lshl_b32 s38, s24, 10
v_lshlrev_b32 v13, 4, v0
buffer_store_dwordx4 v[8:11], v13, s[4:7], s38 offen sc1
s_cmp_eq_u32 s14, 3
s_cbranch_scc0 m_c1
v_bfe_u32 v14, v0, 3, 1
v_lshlrev_b32 v14, 19, v14
v_and_b32 v15, 7, v0
v_lshl_add_u32 v14, v15, 4, v14
s_lshl_b32 s24, s2, 7
s_add_u32 s24, s24, 168034304
v_add_u32 v14, s24, v14
s_lshl_b32 s24, s2, 9
s_add_u32 s24, s24, 170917632
v_add_u32 v15, s24, v13
v_cmp_gt_u32 vcc, 16, v0
s_nop 1
v_cndmask_b32 v14, v15, v14, vcc
v_cndmask_b32 v16, 0, v8, vcc
v_mov_b32 v15, 2147483648
v_mov_b32 v17, v16
v_mov_b32 v18, v16
v_mov_b32 v19, v16
v_cmp_gt_u32 vcc, 48, v0
s_nop 1
v_cndmask_b32 v14, v15, v14, vcc
buffer_store_dwordx4 v[16:19], v14, s[4:7], 0 offen sc1
m_c1:
v_mov_b32 v98, 131584
v_lshl_add_u32 v99, v2, 2, v98
s_waitcnt vmcnt(0)
v_readfirstlane_b32 s24, v97
s_nop 1
v_mov_b32 v97, s24
ds_write_b32 v99, v97
s_waitcnt lgkmcnt(0)
s_barrier
ds_read_b32 v100, v98
s_and_b32 s12, s56, 3
s_lshl_b32 s16, s12, 5
s_mov_b32 s58, 0
s_mov_b32 s57, 1
s_waitcnt lgkmcnt(0)
v_readfirstlane_b32 s13, v100
s_add_u32 s16, s16, s13
s_cmp_lt_u32 s56, 4
s_cselect_b32 s16, -1, s16
s_lshr_b32 s24, s56, 3
s_or_b32 s24, s24, s31
s_cselect_b32 s13, 32, s13
s_cmp_ge_u32 s56, 8
s_cselect_b32 s24, 31, 32
s_cmp_lt_u32 s13, s24
s_cbranch_scc1 m_role
s_mov_b32 s24, 160
v_mov_b32 v97, 1
s_cmp_eq_u32 s14, 0
s_cselect_b32 s24, s24, 2147483648
v_mov_b32 v96, 2147483648
v_writelane_b32 v96, s24, 0
buffer_store_dword v97, v96, s[72:75], 0 offen sc1
m_fb:
s_load_dwordx2 s[48:49], s[0:1], 16
s_waitcnt vmcnt(0) lgkmcnt(0)
s_barrier
s_mov_b32 s24, 164
v_mov_b32 v97, 1
s_cmp_eq_u32 s14, 0
s_cselect_b32 s24, s24, 2147483648
v_mov_b32 v96, 2147483648
v_writelane_b32 v96, s24, 0
buffer_atomic_add v97, v96, s[72:75], 0 offen sc0 sc1
v_mov_b32 v98, 131584
s_waitcnt vmcnt(0)
s_cmp_lg_u32 s14, 0
s_cbranch_scc1 m_fb1
v_readfirstlane_b32 s24, v97
s_nop 1
v_mov_b32 v97, s24
ds_write_b32 v98, v97
s_waitcnt lgkmcnt(0)
m_fb1:
s_barrier
ds_read_b32 v97, v98
s_mov_b32 s58, 1
s_waitcnt lgkmcnt(0)
v_readfirstlane_b32 s24, v97
s_bfe_u32 s12, s24, 0x20005
s_and_b32 s13, s24, 31
s_and_b32 s24, s24, 255
s_sub_u32 s16, s24, 128
s_cselect_b32 s16, -1, s16
m_role:
s_lshl_b32 s24, s56, 5
s_add_u32 s24, s24, s13
s_lshl_b32 s24, s24, 7
s_add_u32 s24, s24, 171048960
s_cmp_eq_u32 s58, 0
s_cselect_b32 s24, s24, 2147483648
v_mov_b32 v99, 0
s_cmp_eq_u32 s14, 3
s_cselect_b32 s24, s24, 2147483648
v_mov_b32 v98, 2147483648
v_writelane_b32 v98, s24, 0
buffer_store_dword v99, v98, s[4:7], 0 offen
v_and_b32 v3, 15, v0
v_lshrrev_b32 v4, 4, v0
s_not_b32 s25, s13
s_lshl_b32 s25, s25, 31
s_lshr_b32 s24, s13, 1
s_cmp_eq_u32 s16, -1
s_cselect_b32 s24, s24, s16
s_cselect_b32 s25, s25, 0
s_lshl_b32 s24, s24, 4
v_add_u32 v5, s24, v3
s_lshl_b32 s24, s14, 9
s_or_b32 s24, s24, s25
v_lshl_add_u32 v6, v5, 11, s24
v_lshl_add_u32 v6, v4, 4, v6
s_cmp_eq_u32 s16, -1
s_cbranch_scc1 m_x0
s_cmp_lg_u32 s58, 0
s_cbranch_scc1 m_x
s_memtime s[34:35]
s_waitcnt lgkmcnt(0)
buffer_store_dwordx4 v[8:11], v13, s[4:7], s38 offen sc1
s_branch m_x
m_x0:
s_lshl_b32 s24, s56, 4
s_add_u32 s24, s24, 4
s_cmp_eq_u32 s58, 0
s_cselect_b32 s24, s24, 2147483648
v_mov_b32 v97, s57
s_cmp_eq_u32 s14, 3
s_cselect_b32 s24, s24, 2147483648
v_mov_b32 v96, 2147483648
v_writelane_b32 v96, s24, 0
buffer_atomic_add v97, v96, s[72:75], 0 offen sc0
m_x:
buffer_load_dwordx4 v[16:19], v6, s[8:11], 0 offen offset:0
buffer_load_dwordx4 v[20:23], v6, s[8:11], 0 offen offset:64
buffer_load_dwordx4 v[24:27], v6, s[8:11], 0 offen offset:128
buffer_load_dwordx4 v[28:31], v6, s[8:11], 0 offen offset:192
buffer_load_dwordx4 v[32:35], v6, s[8:11], 0 offen offset:256
buffer_load_dwordx4 v[36:39], v6, s[8:11], 0 offen offset:320
buffer_load_dwordx4 v[40:43], v6, s[8:11], 0 offen offset:384
buffer_load_dwordx4 v[44:47], v6, s[8:11], 0 offen offset:448
v_lshrrev_b32 v7, 5, v5
v_lshlrev_b32 v7, 16, v7
v_and_b32 v15, 31, v5
v_lshl_add_u32 v7, v15, 4, v7
s_lshl_b32 s24, s14, 14
s_or_b32 s24, s24, s25
v_add_u32 v7, s24, v7
s_cmp_lg_u32 s16, -1
s_cbranch_scc1 m_xw
s_lshl_b32 s24, s12, 5
s_add_u32 s24, s24, s13
s_lshl_b32 s33, s14, 15
s_lshl_b32 s32, s14, 21
s_lshl_b32 s24, s24, 6
s_add_u32 s32, s32, s24
s_lshr_b32 s24, s13, 1
s_lshl_b32 s24, s24, 2
s_add_u32 s24, s24, s14
s_lshl_b32 s64, s24, 17
s_lshl_b32 s68, s24, 15
s_lshl_b32 s24, s12, 11
s_add_u32 s64, s64, s24
s_lshl_b32 s24, s12, 21
s_add_u32 s68, s68, s24
v_and_b32 v8, 3, v0
v_lshlrev_b32 v8, 9, v8
v_add_u32 v8, 384, v8
s_lshl_b32 s24, s13, 31
v_or_b32 v8, s24, v8
v_lshrrev_b32 v9, 2, v0
v_lshl_add_u32 v12, v9, 13, v8
v_lshl_add_u32 v255, v9, 11, v8
v_lshrrev_b32 v8, 2, v0
v_and_b32 v9, 3, v0
v_lshlrev_b32 v9, 4, v9
v_lshl_add_u32 v10, v8, 13, v9
v_lshl_add_u32 v11, v8, 11, v9
s_lshl_b32 s24, s12, 21
s_lshl_b32 s63, s14, 19
s_add_u32 s63, s63, s24
s_lshl_b32 s24, s13, 6
s_add_u32 s63, s63, s24
s_and_b32 s24, s13, 1
s_or_b32 s24, s24, s58
s_cbranch_scc1 m_rows
s_cmp_lg_u32 s14, 3
s_cbranch_scc1 m_dt
s_waitcnt vmcnt(8)
v_readfirstlane_b32 s28, v97
s_lshl_b32 s29, s56, 2
s_add_u32 s29, s29, 128
s_add_u32 s28, s28, s57
s_and_b32 s30, s28, 255
s_lshr_b32 s28, s28, 8
s_add_u32 s28, s28, 256
s_lshl_b32 s31, s58, 8
s_or_b32 s30, s30, s31
s_cmp_eq_u32 s30, 32
s_cselect_b32 s29, s29, 2147483648
v_mov_b32 v97, s28
s_cmp_eq_u32 s14, 3
s_cselect_b32 s29, s29, 2147483648
v_mov_b32 v96, 2147483648
v_writelane_b32 v96, s29, 0
buffer_store_dword v97, v96, s[72:75], 0 offen sc1
s_lshl_b32 s30, s56, 4
s_add_u32 s30, s30, 8
v_mov_b32 v97, 1
v_mov_b32 v96, 2147483648
v_writelane_b32 v96, s30, 0
buffer_atomic_add v97, v96, s[72:75], 0 offen sc0
s_waitcnt vmcnt(0)
v_readfirstlane_b32 s28, v97
v_mov_b32 v97, 1
s_cmp_lg_u32 s28, 31
s_cbranch_scc1 m_dt
s_lshl_b32 s30, s56, 5
s_lshl_b32 s30, s30, 7
s_add_u32 s30, s30, 171048960
v_lshl_add_u32 v96, v0, 7, s30
v_mov_b32 v98, 2147483648
v_cmp_gt_u32 vcc, 32, v0
s_nop 1
v_cndmask_b32 v96, v98, v96, vcc
buffer_store_dword v97, v96, s[4:7], 0 offen
m_dt:
s_branch m_dma
m_rows:
s_waitcnt vmcnt(8)
v_readfirstlane_b32 s28, v97
s_lshl_b32 s29, s56, 2
s_add_u32 s29, s29, 128
s_add_u32 s28, s28, s57
s_and_b32 s30, s28, 255
s_lshr_b32 s28, s28, 8
s_add_u32 s28, s28, 256
s_lshl_b32 s31, s58, 8
s_or_b32 s30, s30, s31
s_cmp_eq_u32 s30, 32
s_cselect_b32 s29, s29, 2147483648
v_mov_b32 v97, s28
s_cmp_eq_u32 s14, 3
s_cselect_b32 s29, s29, 2147483648
v_mov_b32 v96, 2147483648
v_writelane_b32 v96, s29, 0
buffer_store_dword v97, v96, s[72:75], 0 offen sc1
s_bitcmp0_b32 s13, 0
s_cbranch_scc1 m_noln
s_waitcnt vmcnt(1)
s_branch m_xi
m_xw:
v_mov_b32 v98, 131600
s_lshl_b32 s24, s14, 2
v_add_u32 v99, s24, v98
s_waitcnt vmcnt(8)
s_memtime s[36:37]
s_waitcnt lgkmcnt(0)
s_sub_u32 s36, s36, s34
v_mov_b32 v97, s36
ds_write_b32 v99, v97
s_sub_u32 s24, s14, 0
s_cmp_ge_u32 s24, 2
s_cbranch_scc1 m_xa
s_lshl_b32 s25, s16, 1
s_add_u32 s24, s24, s25
s_lshl_b32 s24, s24, 15
v_lshlrev_b32 v200, 7, v0
buffer_load_dword v201, v200, s[48:51], s24 offen
s_add_u32 s24, s24, 8192
buffer_load_dword v201, v200, s[48:51], s24 offen
s_add_u32 s24, s24, 8192
buffer_load_dword v201, v200, s[48:51], s24 offen
s_add_u32 s24, s24, 8192
buffer_load_dword v201, v200, s[48:51], s24 offen
s_waitcnt vmcnt(4)
s_branch m_xi
m_xa:
s_waitcnt vmcnt(0)
m_xi:
v_lshlrev_b32 v64, 16, v16
v_and_b32 v65, 0xffff0000, v16
v_lshlrev_b32 v66, 16, v17
v_and_b32 v67, 0xffff0000, v17
v_lshlrev_b32 v68, 16, v18
v_and_b32 v69, 0xffff0000, v18
v_lshlrev_b32 v70, 16, v19
v_and_b32 v71, 0xffff0000, v19
v_lshlrev_b32 v72, 16, v20
v_and_b32 v73, 0xffff0000, v20
v_lshlrev_b32 v74, 16, v21
v_and_b32 v75, 0xffff0000, v21
v_lshlrev_b32 v76, 16, v22
v_and_b32 v77, 0xffff0000, v22
v_lshlrev_b32 v78, 16, v23
v_and_b32 v79, 0xffff0000, v23
v_lshlrev_b32 v80, 16, v24
v_and_b32 v81, 0xffff0000, v24
v_lshlrev_b32 v82, 16, v25
v_and_b32 v83, 0xffff0000, v25
v_lshlrev_b32 v84, 16, v26
v_and_b32 v85, 0xffff0000, v26
v_lshlrev_b32 v86, 16, v27
v_and_b32 v87, 0xffff0000, v27
v_lshlrev_b32 v88, 16, v28
v_and_b32 v89, 0xffff0000, v28
v_lshlrev_b32 v90, 16, v29
v_and_b32 v91, 0xffff0000, v29
v_lshlrev_b32 v92, 16, v30
v_and_b32 v93, 0xffff0000, v30
v_lshlrev_b32 v94, 16, v31
v_and_b32 v95, 0xffff0000, v31
v_lshlrev_b32 v96, 16, v32
v_and_b32 v97, 0xffff0000, v32
v_lshlrev_b32 v98, 16, v33
v_and_b32 v99, 0xffff0000, v33
v_lshlrev_b32 v100, 16, v34
v_and_b32 v101, 0xffff0000, v34
v_lshlrev_b32 v102, 16, v35
v_and_b32 v103, 0xffff0000, v35
v_lshlrev_b32 v104, 16, v36
v_and_b32 v105, 0xffff0000, v36
v_lshlrev_b32 v106, 16, v37
v_and_b32 v107, 0xffff0000, v37
v_lshlrev_b32 v108, 16, v38
v_and_b32 v109, 0xffff0000, v38
v_lshlrev_b32 v110, 16, v39
v_and_b32 v111, 0xffff0000, v39
v_lshlrev_b32 v112, 16, v40
v_and_b32 v113, 0xffff0000, v40
v_lshlrev_b32 v114, 16, v41
v_and_b32 v115, 0xffff0000, v41
v_lshlrev_b32 v116, 16, v42
v_and_b32 v117, 0xffff0000, v42
v_lshlrev_b32 v118, 16, v43
v_and_b32 v119, 0xffff0000, v43
v_lshlrev_b32 v120, 16, v44
v_and_b32 v121, 0xffff0000, v44
v_lshlrev_b32 v122, 16, v45
v_and_b32 v123, 0xffff0000, v45
v_lshlrev_b32 v124, 16, v46
v_and_b32 v125, 0xffff0000, v46
v_lshlrev_b32 v126, 16, v47
v_and_b32 v127, 0xffff0000, v47
v_pk_add_f32 v[48:49], v[64:65], v[66:67]
v_pk_add_f32 v[50:51], v[68:69], v[70:71]
v_pk_add_f32 v[48:49], v[48:49], v[72:73]
v_pk_add_f32 v[50:51], v[50:51], v[74:75]
v_pk_add_f32 v[48:49], v[48:49], v[76:77]
v_pk_add_f32 v[50:51], v[50:51], v[78:79]
v_pk_add_f32 v[48:49], v[48:49], v[80:81]
v_pk_add_f32 v[50:51], v[50:51], v[82:83]
v_pk_add_f32 v[48:49], v[48:49], v[84:85]
v_pk_add_f32 v[50:51], v[50:51], v[86:87]
v_pk_add_f32 v[48:49], v[48:49], v[88:89]
v_pk_add_f32 v[50:51], v[50:51], v[90:91]
v_pk_add_f32 v[48:49], v[48:49], v[92:93]
v_pk_add_f32 v[50:51], v[50:51], v[94:95]
v_pk_add_f32 v[48:49], v[48:49], v[96:97]
v_pk_add_f32 v[50:51], v[50:51], v[98:99]
v_pk_add_f32 v[48:49], v[48:49], v[100:101]
v_pk_add_f32 v[50:51], v[50:51], v[102:103]
v_pk_add_f32 v[48:49], v[48:49], v[104:105]
v_pk_add_f32 v[50:51], v[50:51], v[106:107]
v_pk_add_f32 v[48:49], v[48:49], v[108:109]
v_pk_add_f32 v[50:51], v[50:51], v[110:111]
v_pk_add_f32 v[48:49], v[48:49], v[112:113]
v_pk_add_f32 v[50:51], v[50:51], v[114:115]
v_pk_add_f32 v[48:49], v[48:49], v[116:117]
v_pk_add_f32 v[50:51], v[50:51], v[118:119]
v_pk_add_f32 v[48:49], v[48:49], v[120:121]
v_pk_add_f32 v[50:51], v[50:51], v[122:123]
v_pk_add_f32 v[48:49], v[48:49], v[124:125]
v_pk_add_f32 v[50:51], v[50:51], v[126:127]
v_pk_add_f32 v[48:49], v[48:49], v[50:51]
v_add_f32 v48, v48, v49
v_lshlrev_b32 v62, 4, v3
v_add_u32 v62, 131072, v62
s_lshl_b32 s24, s14, 2
v_add_u32 v63, s24, v62
v_mov_b32 v49, v48
s_nop 1
v_permlane16_swap_b32 v48, v49
v_add_f32 v48, v48, v49
v_mov_b32 v49, v48
s_nop 1
v_permlane32_swap_b32 v48, v49
v_add_f32 v48, v48, v49
ds_write_b32 v63, v48 offset:0
s_waitcnt lgkmcnt(0)
s_barrier
ds_read_b128 v[52:55], v62 offset:0
s_waitcnt lgkmcnt(0)
v_add_f32 v52, v52, v53
v_add_f32 v54, v54, v55
v_add_f32 v48, v52, v54
s_cmp_eq_u32 s16, -1
s_cbranch_scc1 m_nv
v_mov_b32 v128, 131604
ds_read2_b32 v[128:129], v128 offset0:0 offset1:1
s_waitcnt lgkmcnt(0)
v_readfirstlane_b32 s26, v128
v_readfirstlane_b32 s27, v129
s_sub_u32 s25, s26, s27
s_sub_u32 s28, 0, s25
s_bitcmp1_b32 s2, 0
s_cselect_b32 s25, s25, s28
s_mov_b32 s57, 0x101
s_cmp_gt_i32 s25, 128
s_cselect_b32 s57, 0x201, s57
s_cmp_lt_i32 s25, -128
s_cselect_b32 s57, 1, s57
s_lshl_b32 s30, s56, 4
s_add_u32 s30, s30, 4
s_cmp_eq_u32 s58, 0
s_cselect_b32 s30, s30, 2147483648
v_mov_b32 v131, s57
s_cmp_lg_u32 s14, 3
s_cbranch_scc1 m_nv
v_mov_b32 v130, 2147483648
v_writelane_b32 v130, s30, 0
buffer_atomic_add v131, v130, s[72:75], 0 offen sc0
m_nv:
v_mul_f32 v48, 0x3a800000, v48
v_pk_add_f32 v[56:57], v[64:65], v[48:49] op_sel_hi:[1,0] neg_lo:[0,1] neg_hi:[0,1]
v_pk_add_f32 v[50:51], v[66:67], v[48:49] op_sel_hi:[1,0] neg_lo:[0,1] neg_hi:[0,1]
v_pk_mul_f32 v[58:59], v[56:57], v[56:57]
v_pk_mul_f32 v[60:61], v[50:51], v[50:51]
v_pk_add_f32 v[56:57], v[68:69], v[48:49] op_sel_hi:[1,0] neg_lo:[0,1] neg_hi:[0,1]
v_pk_add_f32 v[50:51], v[70:71], v[48:49] op_sel_hi:[1,0] neg_lo:[0,1] neg_hi:[0,1]
v_pk_fma_f32 v[58:59], v[56:57], v[56:57], v[58:59]
v_pk_fma_f32 v[60:61], v[50:51], v[50:51], v[60:61]
v_pk_add_f32 v[56:57], v[72:73], v[48:49] op_sel_hi:[1,0] neg_lo:[0,1] neg_hi:[0,1]
v_pk_add_f32 v[50:51], v[74:75], v[48:49] op_sel_hi:[1,0] neg_lo:[0,1] neg_hi:[0,1]
v_pk_fma_f32 v[58:59], v[56:57], v[56:57], v[58:59]
v_pk_fma_f32 v[60:61], v[50:51], v[50:51], v[60:61]
v_pk_add_f32 v[56:57], v[76:77], v[48:49] op_sel_hi:[1,0] neg_lo:[0,1] neg_hi:[0,1]
v_pk_add_f32 v[50:51], v[78:79], v[48:49] op_sel_hi:[1,0] neg_lo:[0,1] neg_hi:[0,1]
v_pk_fma_f32 v[58:59], v[56:57], v[56:57], v[58:59]
v_pk_fma_f32 v[60:61], v[50:51], v[50:51], v[60:61]
v_pk_add_f32 v[56:57], v[80:81], v[48:49] op_sel_hi:[1,0] neg_lo:[0,1] neg_hi:[0,1]
v_pk_add_f32 v[50:51], v[82:83], v[48:49] op_sel_hi:[1,0] neg_lo:[0,1] neg_hi:[0,1]
v_pk_fma_f32 v[58:59], v[56:57], v[56:57], v[58:59]
v_pk_fma_f32 v[60:61], v[50:51], v[50:51], v[60:61]
v_pk_add_f32 v[56:57], v[84:85], v[48:49] op_sel_hi:[1,0] neg_lo:[0,1] neg_hi:[0,1]
v_pk_add_f32 v[50:51], v[86:87], v[48:49] op_sel_hi:[1,0] neg_lo:[0,1] neg_hi:[0,1]
v_pk_fma_f32 v[58:59], v[56:57], v[56:57], v[58:59]
v_pk_fma_f32 v[60:61], v[50:51], v[50:51], v[60:61]
v_pk_add_f32 v[56:57], v[88:89], v[48:49] op_sel_hi:[1,0] neg_lo:[0,1] neg_hi:[0,1]
v_pk_add_f32 v[50:51], v[90:91], v[48:49] op_sel_hi:[1,0] neg_lo:[0,1] neg_hi:[0,1]
v_pk_fma_f32 v[58:59], v[56:57], v[56:57], v[58:59]
v_pk_fma_f32 v[60:61], v[50:51], v[50:51], v[60:61]
v_pk_add_f32 v[56:57], v[92:93], v[48:49] op_sel_hi:[1,0] neg_lo:[0,1] neg_hi:[0,1]
v_pk_add_f32 v[50:51], v[94:95], v[48:49] op_sel_hi:[1,0] neg_lo:[0,1] neg_hi:[0,1]
v_pk_fma_f32 v[58:59], v[56:57], v[56:57], v[58:59]
v_pk_fma_f32 v[60:61], v[50:51], v[50:51], v[60:61]
v_pk_add_f32 v[56:57], v[96:97], v[48:49] op_sel_hi:[1,0] neg_lo:[0,1] neg_hi:[0,1]
v_pk_add_f32 v[50:51], v[98:99], v[48:49] op_sel_hi:[1,0] neg_lo:[0,1] neg_hi:[0,1]
v_pk_fma_f32 v[58:59], v[56:57], v[56:57], v[58:59]
v_pk_fma_f32 v[60:61], v[50:51], v[50:51], v[60:61]
v_pk_add_f32 v[56:57], v[100:101], v[48:49] op_sel_hi:[1,0] neg_lo:[0,1] neg_hi:[0,1]
v_pk_add_f32 v[50:51], v[102:103], v[48:49] op_sel_hi:[1,0] neg_lo:[0,1] neg_hi:[0,1]
v_pk_fma_f32 v[58:59], v[56:57], v[56:57], v[58:59]
v_pk_fma_f32 v[60:61], v[50:51], v[50:51], v[60:61]
v_pk_add_f32 v[56:57], v[104:105], v[48:49] op_sel_hi:[1,0] neg_lo:[0,1] neg_hi:[0,1]
v_pk_add_f32 v[50:51], v[106:107], v[48:49] op_sel_hi:[1,0] neg_lo:[0,1] neg_hi:[0,1]
v_pk_fma_f32 v[58:59], v[56:57], v[56:57], v[58:59]
v_pk_fma_f32 v[60:61], v[50:51], v[50:51], v[60:61]
v_pk_add_f32 v[56:57], v[108:109], v[48:49] op_sel_hi:[1,0] neg_lo:[0,1] neg_hi:[0,1]
v_pk_add_f32 v[50:51], v[110:111], v[48:49] op_sel_hi:[1,0] neg_lo:[0,1] neg_hi:[0,1]
v_pk_fma_f32 v[58:59], v[56:57], v[56:57], v[58:59]
v_pk_fma_f32 v[60:61], v[50:51], v[50:51], v[60:61]
v_pk_add_f32 v[56:57], v[112:113], v[48:49] op_sel_hi:[1,0] neg_lo:[0,1] neg_hi:[0,1]
v_pk_add_f32 v[50:51], v[114:115], v[48:49] op_sel_hi:[1,0] neg_lo:[0,1] neg_hi:[0,1]
v_pk_fma_f32 v[58:59], v[56:57], v[56:57], v[58:59]
v_pk_fma_f32 v[60:61], v[50:51], v[50:51], v[60:61]
v_pk_add_f32 v[56:57], v[116:117], v[48:49] op_sel_hi:[1,0] neg_lo:[0,1] neg_hi:[0,1]
v_pk_add_f32 v[50:51], v[118:119], v[48:49] op_sel_hi:[1,0] neg_lo:[0,1] neg_hi:[0,1]
v_pk_fma_f32 v[58:59], v[56:57], v[56:57], v[58:59]
v_pk_fma_f32 v[60:61], v[50:51], v[50:51], v[60:61]
v_pk_add_f32 v[56:57], v[120:121], v[48:49] op_sel_hi:[1,0] neg_lo:[0,1] neg_hi:[0,1]
v_pk_add_f32 v[50:51], v[122:123], v[48:49] op_sel_hi:[1,0] neg_lo:[0,1] neg_hi:[0,1]
v_pk_fma_f32 v[58:59], v[56:57], v[56:57], v[58:59]
v_pk_fma_f32 v[60:61], v[50:51], v[50:51], v[60:61]
v_pk_add_f32 v[56:57], v[124:125], v[48:49] op_sel_hi:[1,0] neg_lo:[0,1] neg_hi:[0,1]
v_pk_add_f32 v[50:51], v[126:127], v[48:49] op_sel_hi:[1,0] neg_lo:[0,1] neg_hi:[0,1]
v_pk_fma_f32 v[58:59], v[56:57], v[56:57], v[58:59]
v_pk_fma_f32 v[60:61], v[50:51], v[50:51], v[60:61]
v_pk_add_f32 v[58:59], v[58:59], v[60:61]
v_add_f32 v58, v58, v59
v_mov_b32 v49, v58
s_nop 1
v_permlane16_swap_b32 v58, v49
v_add_f32 v58, v58, v49
v_mov_b32 v49, v58
s_nop 1
v_permlane32_swap_b32 v58, v49
v_add_f32 v58, v58, v49
ds_write_b32 v63, v58 offset:256
s_waitcnt lgkmcnt(0)
s_barrier
ds_read_b128 v[52:55], v62 offset:256
s_waitcnt lgkmcnt(0)
v_add_f32 v52, v52, v53
v_add_f32 v54, v54, v55
v_add_f32 v58, v52, v54
v_mul_f32 v58, 0x3a800000, v58
v_cvt_pk_bf16_f32 v58, v58, v48
v_and_b32 v48, 0xffff0000, v58
v_lshlrev_b32 v58, 16, v58
v_add_f32 v58, 0x3727c5ac, v58
v_cvt_pk_bf16_f32 v58, v58, v58
v_lshlrev_b32 v58, 16, v58
v_sqrt_f32 v58, v58
s_nop 0
v_cvt_pk_bf16_f32 v58, v58, v58
v_lshlrev_b32 v58, 16, v58
v_rcp_f32 v58, v58
v_pk_add_f32 v[64:65], v[64:65], v[48:49] op_sel_hi:[1,0] neg_lo:[0,1] neg_hi:[0,1]
v_cvt_pk_bf16_f32 v65, v64, v65
v_lshlrev_b32 v64, 16, v65
v_and_b32 v65, 0xffff0000, v65
v_pk_mul_f32 v[64:65], v[64:65], v[58:59] op_sel_hi:[1,0]
v_pk_add_f32 v[66:67], v[66:67], v[48:49] op_sel_hi:[1,0] neg_lo:[0,1] neg_hi:[0,1]
v_cvt_pk_bf16_f32 v67, v66, v67
v_lshlrev_b32 v66, 16, v67
v_and_b32 v67, 0xffff0000, v67
v_pk_mul_f32 v[66:67], v[66:67], v[58:59] op_sel_hi:[1,0]
v_pk_add_f32 v[68:69], v[68:69], v[48:49] op_sel_hi:[1,0] neg_lo:[0,1] neg_hi:[0,1]
v_cvt_pk_bf16_f32 v69, v68, v69
v_lshlrev_b32 v68, 16, v69
v_and_b32 v69, 0xffff0000, v69
v_pk_mul_f32 v[68:69], v[68:69], v[58:59] op_sel_hi:[1,0]
v_pk_add_f32 v[70:71], v[70:71], v[48:49] op_sel_hi:[1,0] neg_lo:[0,1] neg_hi:[0,1]
v_cvt_pk_bf16_f32 v71, v70, v71
v_lshlrev_b32 v70, 16, v71
v_and_b32 v71, 0xffff0000, v71
v_pk_mul_f32 v[70:71], v[70:71], v[58:59] op_sel_hi:[1,0]
v_pk_add_f32 v[72:73], v[72:73], v[48:49] op_sel_hi:[1,0] neg_lo:[0,1] neg_hi:[0,1]
v_cvt_pk_bf16_f32 v73, v72, v73
v_lshlrev_b32 v72, 16, v73
v_and_b32 v73, 0xffff0000, v73
v_pk_mul_f32 v[72:73], v[72:73], v[58:59] op_sel_hi:[1,0]
v_pk_add_f32 v[74:75], v[74:75], v[48:49] op_sel_hi:[1,0] neg_lo:[0,1] neg_hi:[0,1]
v_cvt_pk_bf16_f32 v75, v74, v75
v_lshlrev_b32 v74, 16, v75
v_and_b32 v75, 0xffff0000, v75
v_pk_mul_f32 v[74:75], v[74:75], v[58:59] op_sel_hi:[1,0]
v_pk_add_f32 v[76:77], v[76:77], v[48:49] op_sel_hi:[1,0] neg_lo:[0,1] neg_hi:[0,1]
v_cvt_pk_bf16_f32 v77, v76, v77
v_lshlrev_b32 v76, 16, v77
v_and_b32 v77, 0xffff0000, v77
v_pk_mul_f32 v[76:77], v[76:77], v[58:59] op_sel_hi:[1,0]
v_pk_add_f32 v[78:79], v[78:79], v[48:49] op_sel_hi:[1,0] neg_lo:[0,1] neg_hi:[0,1]
v_cvt_pk_bf16_f32 v79, v78, v79
v_lshlrev_b32 v78, 16, v79
v_and_b32 v79, 0xffff0000, v79
v_pk_mul_f32 v[78:79], v[78:79], v[58:59] op_sel_hi:[1,0]
v_pk_add_f32 v[80:81], v[80:81], v[48:49] op_sel_hi:[1,0] neg_lo:[0,1] neg_hi:[0,1]
v_cvt_pk_bf16_f32 v81, v80, v81
v_lshlrev_b32 v80, 16, v81
v_and_b32 v81, 0xffff0000, v81
v_pk_mul_f32 v[80:81], v[80:81], v[58:59] op_sel_hi:[1,0]
v_pk_add_f32 v[82:83], v[82:83], v[48:49] op_sel_hi:[1,0] neg_lo:[0,1] neg_hi:[0,1]
v_cvt_pk_bf16_f32 v83, v82, v83
v_lshlrev_b32 v82, 16, v83
v_and_b32 v83, 0xffff0000, v83
v_pk_mul_f32 v[82:83], v[82:83], v[58:59] op_sel_hi:[1,0]
v_pk_add_f32 v[84:85], v[84:85], v[48:49] op_sel_hi:[1,0] neg_lo:[0,1] neg_hi:[0,1]
v_cvt_pk_bf16_f32 v85, v84, v85
v_lshlrev_b32 v84, 16, v85
v_and_b32 v85, 0xffff0000, v85
v_pk_mul_f32 v[84:85], v[84:85], v[58:59] op_sel_hi:[1,0]
v_pk_add_f32 v[86:87], v[86:87], v[48:49] op_sel_hi:[1,0] neg_lo:[0,1] neg_hi:[0,1]
v_cvt_pk_bf16_f32 v87, v86, v87
v_lshlrev_b32 v86, 16, v87
v_and_b32 v87, 0xffff0000, v87
v_pk_mul_f32 v[86:87], v[86:87], v[58:59] op_sel_hi:[1,0]
v_pk_add_f32 v[88:89], v[88:89], v[48:49] op_sel_hi:[1,0] neg_lo:[0,1] neg_hi:[0,1]
v_cvt_pk_bf16_f32 v89, v88, v89
v_lshlrev_b32 v88, 16, v89
v_and_b32 v89, 0xffff0000, v89
v_pk_mul_f32 v[88:89], v[88:89], v[58:59] op_sel_hi:[1,0]
v_pk_add_f32 v[90:91], v[90:91], v[48:49] op_sel_hi:[1,0] neg_lo:[0,1] neg_hi:[0,1]
v_cvt_pk_bf16_f32 v91, v90, v91
v_lshlrev_b32 v90, 16, v91
v_and_b32 v91, 0xffff0000, v91
v_pk_mul_f32 v[90:91], v[90:91], v[58:59] op_sel_hi:[1,0]
v_pk_add_f32 v[92:93], v[92:93], v[48:49] op_sel_hi:[1,0] neg_lo:[0,1] neg_hi:[0,1]
v_cvt_pk_bf16_f32 v93, v92, v93
v_lshlrev_b32 v92, 16, v93
v_and_b32 v93, 0xffff0000, v93
v_pk_mul_f32 v[92:93], v[92:93], v[58:59] op_sel_hi:[1,0]
v_pk_add_f32 v[94:95], v[94:95], v[48:49] op_sel_hi:[1,0] neg_lo:[0,1] neg_hi:[0,1]
v_cvt_pk_bf16_f32 v95, v94, v95
v_lshlrev_b32 v94, 16, v95
v_and_b32 v95, 0xffff0000, v95
v_pk_mul_f32 v[94:95], v[94:95], v[58:59] op_sel_hi:[1,0]
v_pk_add_f32 v[96:97], v[96:97], v[48:49] op_sel_hi:[1,0] neg_lo:[0,1] neg_hi:[0,1]
v_cvt_pk_bf16_f32 v97, v96, v97
v_lshlrev_b32 v96, 16, v97
v_and_b32 v97, 0xffff0000, v97
v_pk_mul_f32 v[96:97], v[96:97], v[58:59] op_sel_hi:[1,0]
v_pk_add_f32 v[98:99], v[98:99], v[48:49] op_sel_hi:[1,0] neg_lo:[0,1] neg_hi:[0,1]
v_cvt_pk_bf16_f32 v99, v98, v99
v_lshlrev_b32 v98, 16, v99
v_and_b32 v99, 0xffff0000, v99
v_pk_mul_f32 v[98:99], v[98:99], v[58:59] op_sel_hi:[1,0]
v_pk_add_f32 v[100:101], v[100:101], v[48:49] op_sel_hi:[1,0] neg_lo:[0,1] neg_hi:[0,1]
v_cvt_pk_bf16_f32 v101, v100, v101
v_lshlrev_b32 v100, 16, v101
v_and_b32 v101, 0xffff0000, v101
v_pk_mul_f32 v[100:101], v[100:101], v[58:59] op_sel_hi:[1,0]
v_pk_add_f32 v[102:103], v[102:103], v[48:49] op_sel_hi:[1,0] neg_lo:[0,1] neg_hi:[0,1]
v_cvt_pk_bf16_f32 v103, v102, v103
v_lshlrev_b32 v102, 16, v103
v_and_b32 v103, 0xffff0000, v103
v_pk_mul_f32 v[102:103], v[102:103], v[58:59] op_sel_hi:[1,0]
v_pk_add_f32 v[104:105], v[104:105], v[48:49] op_sel_hi:[1,0] neg_lo:[0,1] neg_hi:[0,1]
v_cvt_pk_bf16_f32 v105, v104, v105
v_lshlrev_b32 v104, 16, v105
v_and_b32 v105, 0xffff0000, v105
v_pk_mul_f32 v[104:105], v[104:105], v[58:59] op_sel_hi:[1,0]
v_pk_add_f32 v[106:107], v[106:107], v[48:49] op_sel_hi:[1,0] neg_lo:[0,1] neg_hi:[0,1]
v_cvt_pk_bf16_f32 v107, v106, v107
v_lshlrev_b32 v106, 16, v107
v_and_b32 v107, 0xffff0000, v107
v_pk_mul_f32 v[106:107], v[106:107], v[58:59] op_sel_hi:[1,0]
v_pk_add_f32 v[108:109], v[108:109], v[48:49] op_sel_hi:[1,0] neg_lo:[0,1] neg_hi:[0,1]
v_cvt_pk_bf16_f32 v109, v108, v109
v_lshlrev_b32 v108, 16, v109
v_and_b32 v109, 0xffff0000, v109
v_pk_mul_f32 v[108:109], v[108:109], v[58:59] op_sel_hi:[1,0]
v_pk_add_f32 v[110:111], v[110:111], v[48:49] op_sel_hi:[1,0] neg_lo:[0,1] neg_hi:[0,1]
v_cvt_pk_bf16_f32 v111, v110, v111
v_lshlrev_b32 v110, 16, v111
v_and_b32 v111, 0xffff0000, v111
v_pk_mul_f32 v[110:111], v[110:111], v[58:59] op_sel_hi:[1,0]
v_pk_add_f32 v[112:113], v[112:113], v[48:49] op_sel_hi:[1,0] neg_lo:[0,1] neg_hi:[0,1]
v_cvt_pk_bf16_f32 v113, v112, v113
v_lshlrev_b32 v112, 16, v113
v_and_b32 v113, 0xffff0000, v113
v_pk_mul_f32 v[112:113], v[112:113], v[58:59] op_sel_hi:[1,0]
v_pk_add_f32 v[114:115], v[114:115], v[48:49] op_sel_hi:[1,0] neg_lo:[0,1] neg_hi:[0,1]
v_cvt_pk_bf16_f32 v115, v114, v115
v_lshlrev_b32 v114, 16, v115
v_and_b32 v115, 0xffff0000, v115
v_pk_mul_f32 v[114:115], v[114:115], v[58:59] op_sel_hi:[1,0]
v_pk_add_f32 v[116:117], v[116:117], v[48:49] op_sel_hi:[1,0] neg_lo:[0,1] neg_hi:[0,1]
v_cvt_pk_bf16_f32 v117, v116, v117
v_lshlrev_b32 v116, 16, v117
v_and_b32 v117, 0xffff0000, v117
v_pk_mul_f32 v[116:117], v[116:117], v[58:59] op_sel_hi:[1,0]
v_pk_add_f32 v[118:119], v[118:119], v[48:49] op_sel_hi:[1,0] neg_lo:[0,1] neg_hi:[0,1]
v_cvt_pk_bf16_f32 v119, v118, v119
v_lshlrev_b32 v118, 16, v119
v_and_b32 v119, 0xffff0000, v119
v_pk_mul_f32 v[118:119], v[118:119], v[58:59] op_sel_hi:[1,0]
v_pk_add_f32 v[120:121], v[120:121], v[48:49] op_sel_hi:[1,0] neg_lo:[0,1] neg_hi:[0,1]
v_cvt_pk_bf16_f32 v121, v120, v121
v_lshlrev_b32 v120, 16, v121
v_and_b32 v121, 0xffff0000, v121
v_pk_mul_f32 v[120:121], v[120:121], v[58:59] op_sel_hi:[1,0]
v_pk_add_f32 v[122:123], v[122:123], v[48:49] op_sel_hi:[1,0] neg_lo:[0,1] neg_hi:[0,1]
v_cvt_pk_bf16_f32 v123, v122, v123
v_lshlrev_b32 v122, 16, v123
v_and_b32 v123, 0xffff0000, v123
v_pk_mul_f32 v[122:123], v[122:123], v[58:59] op_sel_hi:[1,0]
v_pk_add_f32 v[124:125], v[124:125], v[48:49] op_sel_hi:[1,0] neg_lo:[0,1] neg_hi:[0,1]
v_cvt_pk_bf16_f32 v125, v124, v125
v_lshlrev_b32 v124, 16, v125
v_and_b32 v125, 0xffff0000, v125
v_pk_mul_f32 v[124:125], v[124:125], v[58:59] op_sel_hi:[1,0]
v_pk_add_f32 v[126:127], v[126:127], v[48:49] op_sel_hi:[1,0] neg_lo:[0,1] neg_hi:[0,1]
v_cvt_pk_bf16_f32 v127, v126, v127
v_lshlrev_b32 v126, 16, v127
v_and_b32 v127, 0xffff0000, v127
v_pk_mul_f32 v[126:127], v[126:127], v[58:59] op_sel_hi:[1,0]
s_cmp_lg_u32 s16, -1
s_cbranch_scc1 m_gemm
v_lshrrev_b32 v15, 1, v4
v_and_b32 v4, 1, v4
v_lshl_add_u32 v4, v4, 1, v15
s_lshl_b32 s24, s58, 2
s_add_u32 s24, s24, s12
s_lshl_b32 s24, s24, 19
s_add_u32 s24, s24, 171966464
v_lshl_add_u32 v7, v4, 9, v7
v_cvt_pk_bf16_f32 v16, v64, v65
v_cvt_pk_bf16_f32 v18, v66, v67
v_cvt_pk_bf16_f32 v17, v68, v69
v_cvt_pk_bf16_f32 v19, v70, v71
s_nop 0
v_permlane32_swap_b32 v16, v17
v_permlane32_swap_b32 v18, v19
v_cvt_pk_bf16_f32 v20, v72, v73
v_cvt_pk_bf16_f32 v22, v74, v75
v_cvt_pk_bf16_f32 v21, v76, v77
v_cvt_pk_bf16_f32 v23, v78, v79
s_nop 0
v_permlane32_swap_b32 v20, v21
v_permlane32_swap_b32 v22, v23
v_cvt_pk_bf16_f32 v24, v80, v81
v_cvt_pk_bf16_f32 v26, v82, v83
v_cvt_pk_bf16_f32 v25, v84, v85
v_cvt_pk_bf16_f32 v27, v86, v87
s_nop 0
v_permlane32_swap_b32 v24, v25
v_permlane32_swap_b32 v26, v27
v_cvt_pk_bf16_f32 v28, v88, v89
v_cvt_pk_bf16_f32 v30, v90, v91
v_cvt_pk_bf16_f32 v29, v92, v93
v_cvt_pk_bf16_f32 v31, v94, v95
s_nop 0
v_permlane32_swap_b32 v28, v29
v_permlane32_swap_b32 v30, v31
v_cvt_pk_bf16_f32 v32, v96, v97
v_cvt_pk_bf16_f32 v34, v98, v99
v_cvt_pk_bf16_f32 v33, v100, v101
v_cvt_pk_bf16_f32 v35, v102, v103
s_nop 0
v_permlane32_swap_b32 v32, v33
v_permlane32_swap_b32 v34, v35
v_cvt_pk_bf16_f32 v36, v104, v105
v_cvt_pk_bf16_f32 v38, v106, v107
v_cvt_pk_bf16_f32 v37, v108, v109
v_cvt_pk_bf16_f32 v39, v110, v111
s_nop 0
v_permlane32_swap_b32 v36, v37
v_permlane32_swap_b32 v38, v39
v_cvt_pk_bf16_f32 v40, v112, v113
v_cvt_pk_bf16_f32 v42, v114, v115
v_cvt_pk_bf16_f32 v41, v116, v117
v_cvt_pk_bf16_f32 v43, v118, v119
s_nop 0
v_permlane32_swap_b32 v40, v41
v_permlane32_swap_b32 v42, v43
v_cvt_pk_bf16_f32 v44, v120, v121
v_cvt_pk_bf16_f32 v46, v122, v123
v_cvt_pk_bf16_f32 v45, v124, v125
v_cvt_pk_bf16_f32 v47, v126, v127
s_nop 0
v_permlane32_swap_b32 v44, v45
v_permlane32_swap_b32 v46, v47
s_cmp_lg_u32 s58, 0
s_cbranch_scc1 m_xs
buffer_store_dwordx4 v[16:19], v7, s[4:7], s24 offen offset:0
buffer_store_dwordx4 v[20:23], v7, s[4:7], s24 offen offset:2048
s_add_u32 s24, s24, 4096
buffer_store_dwordx4 v[24:27], v7, s[4:7], s24 offen offset:0
buffer_store_dwordx4 v[28:31], v7, s[4:7], s24 offen offset:2048
s_add_u32 s24, s24, 4096
buffer_store_dwordx4 v[32:35], v7, s[4:7], s24 offen offset:0
buffer_store_dwordx4 v[36:39], v7, s[4:7], s24 offen offset:2048
s_add_u32 s24, s24, 4096
buffer_store_dwordx4 v[40:43], v7, s[4:7], s24 offen offset:0
buffer_store_dwordx4 v[44:47], v7, s[4:7], s24 offen offset:2048
s_add_u32 s24, s24, 4096
s_branch m_xd
m_xs:
buffer_store_dwordx4 v[16:19], v7, s[4:7], s24 offen offset:0 sc1
buffer_store_dwordx4 v[20:23], v7, s[4:7], s24 offen offset:2048 sc1
s_add_u32 s24, s24, 4096
buffer_store_dwordx4 v[24:27], v7, s[4:7], s24 offen offset:0 sc1
buffer_store_dwordx4 v[28:31], v7, s[4:7], s24 offen offset:2048 sc1
s_add_u32 s24, s24, 4096
buffer_store_dwordx4 v[32:35], v7, s[4:7], s24 offen offset:0 sc1
buffer_store_dwordx4 v[36:39], v7, s[4:7], s24 offen offset:2048 sc1
s_add_u32 s24, s24, 4096
buffer_store_dwordx4 v[40:43], v7, s[4:7], s24 offen offset:0 sc1
buffer_store_dwordx4 v[44:47], v7, s[4:7], s24 offen offset:2048 sc1
s_add_u32 s24, s24, 4096
m_xd:
m_noln:
s_waitcnt vmcnt(0)
s_barrier
s_cmp_lg_u32 s14, 3
s_cbranch_scc1 m_ra
s_cmp_eq_u32 s58, 0
s_cbranch_scc1 m_ra_f
s_mov_b32 s30, 168
v_mov_b32 v97, 1
v_mov_b32 v96, 2147483648
v_writelane_b32 v96, s30, 0
buffer_atomic_add v97, v96, s[72:75], 0 offen sc1
s_branch m_ra
m_ra_f:
s_lshl_b32 s30, s56, 4
s_add_u32 s30, s30, 8
v_mov_b32 v97, 1
v_mov_b32 v96, 2147483648
v_writelane_b32 v96, s30, 0
buffer_atomic_add v97, v96, s[72:75], 0 offen sc0
s_waitcnt vmcnt(0)
v_readfirstlane_b32 s28, v97
v_mov_b32 v97, 1
s_cmp_lg_u32 s28, 31
s_cbranch_scc1 m_ra
s_lshl_b32 s30, s56, 5
s_lshl_b32 s30, s30, 7
s_add_u32 s30, s30, 171048960
v_lshl_add_u32 v96, v0, 7, s30
v_mov_b32 v98, 2147483648
v_cmp_gt_u32 vcc, 32, v0
s_nop 1
v_cndmask_b32 v96, v98, v96, vcc
buffer_store_dword v97, v96, s[4:7], 0 offen
m_ra:
m_dma:
buffer_load_dword v245, v12, s[40:43], s64 offen
buffer_load_dword v245, v12, s[44:47], s64 offen
s_add_u32 m0, s33, 0
s_mov_b32 s26, s32
buffer_load_dwordx4 v10, s[40:43], s26 offen lds
s_add_u32 m0, m0, 1024
s_add_u32 s26, s26, 131072
buffer_load_dwordx4 v10, s[40:43], s26 offen lds
s_add_u32 m0, m0, 1024
s_add_u32 s26, s26, 131072
buffer_load_dwordx4 v10, s[40:43], s26 offen lds
s_add_u32 m0, m0, 1024
s_add_u32 s26, s26, 131072
buffer_load_dwordx4 v10, s[40:43], s26 offen lds
s_add_u32 m0, m0, 1024
s_add_u32 s26, s26, 131072
buffer_load_dwordx4 v10, s[40:43], s26 offen lds
s_add_u32 m0, m0, 1024
s_add_u32 s26, s26, 131072
buffer_load_dwordx4 v10, s[40:43], s26 offen lds
s_add_u32 m0, m0, 1024
s_add_u32 s26, s26, 131072
buffer_load_dwordx4 v10, s[40:43], s26 offen lds
s_add_u32 m0, m0, 1024
s_add_u32 s26, s26, 131072
buffer_load_dwordx4 v10, s[40:43], s26 offen lds
s_add_u32 m0, m0, 1024
s_add_u32 s26, s26, 131072
buffer_load_dwordx4 v10, s[40:43], s26 offen lds
s_add_u32 m0, m0, 1024
s_add_u32 s26, s26, 131072
buffer_load_dwordx4 v10, s[40:43], s26 offen lds
s_add_u32 m0, m0, 1024
s_add_u32 s26, s26, 131072
buffer_load_dwordx4 v10, s[40:43], s26 offen lds
s_add_u32 m0, m0, 1024
s_add_u32 s26, s26, 131072
buffer_load_dwordx4 v10, s[40:43], s26 offen lds
s_add_u32 m0, m0, 1024
s_add_u32 s26, s26, 131072
buffer_load_dwordx4 v10, s[40:43], s26 offen lds
s_add_u32 m0, m0, 1024
s_add_u32 s26, s26, 131072
buffer_load_dwordx4 v10, s[40:43], s26 offen lds
s_add_u32 m0, m0, 1024
s_add_u32 s26, s26, 131072
buffer_load_dwordx4 v10, s[40:43], s26 offen lds
s_add_u32 m0, m0, 1024
s_add_u32 s26, s26, 131072
buffer_load_dwordx4 v10, s[40:43], s26 offen lds
s_add_u32 m0, s33, 16384
s_mov_b32 s26, s32
buffer_load_dwordx4 v10, s[44:47], s26 offen lds
s_add_u32 m0, m0, 1024
s_add_u32 s26, s26, 131072
buffer_load_dwordx4 v10, s[44:47], s26 offen lds
s_add_u32 m0, m0, 1024
s_add_u32 s26, s26, 131072
buffer_load_dwordx4 v10, s[44:47], s26 offen lds
s_add_u32 m0, m0, 1024
s_add_u32 s26, s26, 131072
buffer_load_dwordx4 v10, s[44:47], s26 offen lds
s_add_u32 m0, m0, 1024
s_add_u32 s26, s26, 131072
buffer_load_dwordx4 v10, s[44:47], s26 offen lds
s_add_u32 m0, m0, 1024
s_add_u32 s26, s26, 131072
buffer_load_dwordx4 v10, s[44:47], s26 offen lds
s_add_u32 m0, m0, 1024
s_add_u32 s26, s26, 131072
buffer_load_dwordx4 v10, s[44:47], s26 offen lds
s_add_u32 m0, m0, 1024
s_add_u32 s26, s26, 131072
buffer_load_dwordx4 v10, s[44:47], s26 offen lds
s_add_u32 m0, m0, 1024
s_add_u32 s26, s26, 131072
buffer_load_dwordx4 v10, s[44:47], s26 offen lds
s_add_u32 m0, m0, 1024
s_add_u32 s26, s26, 131072
buffer_load_dwordx4 v10, s[44:47], s26 offen lds
s_add_u32 m0, m0, 1024
s_add_u32 s26, s26, 131072
buffer_load_dwordx4 v10, s[44:47], s26 offen lds
s_add_u32 m0, m0, 1024
s_add_u32 s26, s26, 131072
buffer_load_dwordx4 v10, s[44:47], s26 offen lds
s_add_u32 m0, m0, 1024
s_add_u32 s26, s26, 131072
buffer_load_dwordx4 v10, s[44:47], s26 offen lds
s_add_u32 m0, m0, 1024
s_add_u32 s26, s26, 131072
buffer_load_dwordx4 v10, s[44:47], s26 offen lds
s_add_u32 m0, m0, 1024
s_add_u32 s26, s26, 131072
buffer_load_dwordx4 v10, s[44:47], s26 offen lds
s_add_u32 m0, m0, 1024
s_add_u32 s26, s26, 131072
buffer_load_dwordx4 v10, s[44:47], s26 offen lds
v_and_b32 v1, 15, v0
v_lshrrev_b32 v2, 4, v0
s_lshl_b32 s24, s12, 5
s_add_u32 s24, s24, s13
v_and_b32 v13, 3, v0
v_lshlrev_b32 v13, 3, v13
v_add_u32 v13, s33, v13
v_bfe_u32 v48, v0, 3, 1
v_bfe_u32 v49, v0, 2, 1
v_lshl_add_u32 v14, v48, 4, v49
v_lshl_add_u32 v14, v2, 2, v14
v_lshl_add_u32 v14, v14, 6, v13
v_lshl_add_u32 v15, v48, 2, v49
v_and_b32 v50, 1, v2
v_lshl_add_u32 v15, v50, 4, v15
v_lshrrev_b32 v50, 1, v2
v_lshl_add_u32 v15, v50, 3, v15
v_lshl_add_u32 v15, v15, 6, v13
v_lshrrev_b32 v48, 2, v1
v_and_b32 v49, 1, v0
v_lshl_add_u32 v48, v48, 1, v49
v_lshlrev_b32 v48, 11, v48
v_lshl_add_u32 v48, v50, 6, v48
v_and_b32 v49, 1, v2
v_lshl_add_u32 v48, v49, 4, v48
v_bfe_u32 v49, v0, 1, 1
v_lshl_add_u32 v48, v49, 5, v48
s_lshl_b32 s29, s14, 9
buffer_load_dwordx4 v[128:131], v48, s[96:99], s29 offen offset:0
buffer_load_dwordx4 v[132:135], v48, s[96:99], s29 offen offset:128
buffer_load_dwordx4 v[136:139], v48, s[96:99], s29 offen offset:256
buffer_load_dwordx4 v[140:143], v48, s[96:99], s29 offen offset:384
v_lshlrev_b32 v241, 9, v2
v_lshl_add_u32 v241, v1, 4, v241
s_lshl_b32 s29, s14, 11
s_add_u32 s29, s29, 131072
v_lshl_add_u32 v242, v0, 4, s29
s_lshl_b32 s29, s14, 13
s_add_u32 s29, s29, 131072
v_lshl_add_u32 v243, v0, 4, s29
s_lshr_b32 s29, s24, 2
s_lshl_b32 s29, s29, 14
s_and_b32 s30, s24, 3
s_lshl_b32 s30, s30, 11
s_add_u32 s29, s29, s30
v_add_u32 v244, s29, v241
s_mov_b32 s61, 25165824
s_lshl_b32 s60, s58, 2
s_add_u32 s60, s60, s12
s_lshl_b32 s60, s60, 5
s_add_u32 s60, s60, s14
s_lshl_b32 s60, s60, 14
s_add_u32 s60, s60, 171966464
s_waitcnt vmcnt(20)
ds_read_b64_tr_b16 a[64:65], v14 offset:0
ds_read_b64_tr_b16 a[66:67], v14 offset:128
ds_read_b64_tr_b16 a[68:69], v14 offset:2048
ds_read_b64_tr_b16 a[70:71], v14 offset:2176
s_waitcnt lgkmcnt(4)
ds_read_b64_tr_b16 a[72:73], v14 offset:4096
ds_read_b64_tr_b16 a[74:75], v14 offset:4224
ds_read_b64_tr_b16 a[76:77], v14 offset:6144
ds_read_b64_tr_b16 a[78:79], v14 offset:6272
s_waitcnt lgkmcnt(4)
ds_read_b64_tr_b16 a[80:81], v14 offset:8192
ds_read_b64_tr_b16 a[82:83], v14 offset:8320
ds_read_b64_tr_b16 a[84:85], v14 offset:10240
ds_read_b64_tr_b16 a[86:87], v14 offset:10368
s_waitcnt lgkmcnt(4)
ds_read_b64_tr_b16 a[88:89], v14 offset:12288
ds_read_b64_tr_b16 a[90:91], v14 offset:12416
ds_read_b64_tr_b16 a[92:93], v14 offset:14336
ds_read_b64_tr_b16 a[94:95], v14 offset:14464
s_waitcnt lgkmcnt(4)
ds_read_b64_tr_b16 a[96:97], v14 offset:32
ds_read_b64_tr_b16 a[98:99], v14 offset:160
ds_read_b64_tr_b16 a[100:101], v14 offset:2080
ds_read_b64_tr_b16 a[102:103], v14 offset:2208
s_waitcnt lgkmcnt(4)
ds_read_b64_tr_b16 a[104:105], v14 offset:4128
ds_read_b64_tr_b16 a[106:107], v14 offset:4256
ds_read_b64_tr_b16 a[108:109], v14 offset:6176
ds_read_b64_tr_b16 a[110:111], v14 offset:6304
s_waitcnt lgkmcnt(4)
ds_read_b64_tr_b16 a[112:113], v14 offset:8224
ds_read_b64_tr_b16 a[114:115], v14 offset:8352
ds_read_b64_tr_b16 a[116:117], v14 offset:10272
ds_read_b64_tr_b16 a[118:119], v14 offset:10400
s_waitcnt lgkmcnt(4)
ds_read_b64_tr_b16 a[120:121], v14 offset:12320
ds_read_b64_tr_b16 a[122:123], v14 offset:12448
ds_read_b64_tr_b16 a[124:125], v14 offset:14368
ds_read_b64_tr_b16 a[126:127], v14 offset:14496
s_waitcnt lgkmcnt(4)
s_waitcnt lgkmcnt(0)
buffer_load_dword v245, v12, s[48:51], s64 offen
v_lshlrev_b32 v16, 2, v0
v_add_u32 v16, 128, v16
v_mov_b32 v17, 2147483648
v_cmp_gt_u32 vcc, 16, v0
s_nop 1
v_cndmask_b32 v16, v17, v16, vcc
v_mov_b32 v98, 131648
s_cmp_lg_u32 s14, 3
s_cbranch_scc1 m_rm_w
s_lshl_b32 s31, s56, 5
s_add_u32 s31, s31, s13
s_lshl_b32 s31, s31, 7
s_add_u32 s31, s31, 171048960
s_cmp_eq_u32 s58, 0
s_cbranch_scc0 m_rm_l
m_rm_k:
s_mov_b32 s30, 8
m_rm_q:
s_load_dword s29, s[4:5], s31 glc
s_mov_b32 s59, 0
s_waitcnt lgkmcnt(0)
s_cmp_lg_u32 s29, 0
s_cbranch_scc1 m_rm_d
s_sub_u32 s30, s30, 1
s_cbranch_scc0 m_rm_q
m_rm_l:
v_mov_b32 v96, 160
buffer_load_dwordx3 v[100:102], v96, s[72:75], 0 offen sc1
s_waitcnt vmcnt(0)
v_readfirstlane_b32 s29, v100
v_readfirstlane_b32 s30, v102
s_cmp_eq_u32 s58, 0
s_cselect_b32 s59, 3, 0
s_cselect_b32 s29, s29, 0
s_cselect_b32 s30, 0, s30
s_lshr_b32 s30, s30, 8
s_or_b32 s29, s29, s30
s_cbranch_scc1 m_rm_d
s_mov_b32 s59, 0
s_cmp_eq_u32 s17, 0
s_cbranch_scc1 m_rm_d
s_sub_u32 s17, s17, 1
s_cmp_eq_u32 s58, 0
s_cbranch_scc1 m_rm_k
s_branch m_rm_l
m_rm_d:
v_mov_b32 v97, s59
ds_write_b32 v98, v97
s_waitcnt lgkmcnt(0)
m_rm_w:
s_barrier
ds_read_b32 v97, v98
s_xor_b32 s15, s58, 1
s_waitcnt lgkmcnt(0)
v_readfirstlane_b32 s59, v97
s_cmp_eq_u32 s59, 3
s_cbranch_scc1 m_fb
s_add_u32 m0, s33, 0
s_mov_b32 s26, s32
buffer_load_dwordx4 v10, s[48:51], s26 offen lds
s_add_u32 m0, m0, 1024
s_add_u32 s26, s26, 131072
buffer_load_dwordx4 v[144:147], v241, s[4:7], s60 offen offset:0
buffer_load_dwordx4 v[148:151], v241, s[4:7], s60 offen offset:256
buffer_load_dwordx4 v10, s[48:51], s26 offen lds
s_add_u32 m0, m0, 1024
s_add_u32 s26, s26, 131072
buffer_load_dwordx4 v[152:155], v241, s[4:7], s60 offen offset:2048
buffer_load_dwordx4 v[156:159], v241, s[4:7], s60 offen offset:2304
s_add_u32 s60, s60, 4096
buffer_load_dwordx4 v10, s[48:51], s26 offen lds
s_add_u32 m0, m0, 1024
s_add_u32 s26, s26, 131072
buffer_load_dwordx4 v[160:163], v241, s[4:7], s60 offen offset:0
buffer_load_dwordx4 v[164:167], v241, s[4:7], s60 offen offset:256
buffer_load_dwordx4 v10, s[48:51], s26 offen lds
s_add_u32 m0, m0, 1024
s_add_u32 s26, s26, 131072
buffer_load_dwordx4 v[168:171], v241, s[4:7], s60 offen offset:2048
buffer_load_dwordx4 v[172:175], v241, s[4:7], s60 offen offset:2304
s_add_u32 s60, s60, 4096
buffer_load_dwordx4 v10, s[48:51], s26 offen lds
s_add_u32 m0, m0, 1024
s_add_u32 s26, s26, 131072
buffer_load_dwordx4 v[176:179], v241, s[4:7], s60 offen offset:0
buffer_load_dwordx4 v[180:183], v241, s[4:7], s60 offen offset:256
buffer_load_dwordx4 v10, s[48:51], s26 offen lds
s_add_u32 m0, m0, 1024
s_add_u32 s26, s26, 131072
buffer_load_dwordx4 v[184:187], v241, s[4:7], s60 offen offset:2048
buffer_load_dwordx4 v[188:191], v241, s[4:7], s60 offen offset:2304
s_add_u32 s60, s60, 4096
buffer_load_dwordx4 v10, s[48:51], s26 offen lds
s_add_u32 m0, m0, 1024
s_add_u32 s26, s26, 131072
buffer_load_dwordx4 v[192:195], v241, s[4:7], s60 offen offset:0
buffer_load_dwordx4 v[196:199], v241, s[4:7], s60 offen offset:256
buffer_load_dwordx4 v10, s[48:51], s26 offen lds
s_add_u32 m0, m0, 1024
s_add_u32 s26, s26, 131072
buffer_load_dwordx4 v[200:203], v241, s[4:7], s60 offen offset:2048
buffer_load_dwordx4 v[204:207], v241, s[4:7], s60 offen offset:2304
s_add_u32 s60, s60, 53248
s_waitcnt vmcnt(29)
ds_read_b64_tr_b16 a[128:129], v14 offset:16384
ds_read_b64_tr_b16 a[130:131], v14 offset:16512
ds_read_b64_tr_b16 a[132:133], v14 offset:18432
ds_read_b64_tr_b16 a[134:135], v14 offset:18560
s_waitcnt lgkmcnt(4)
ds_read_b64_tr_b16 a[136:137], v14 offset:20480
ds_read_b64_tr_b16 a[138:139], v14 offset:20608
ds_read_b64_tr_b16 a[140:141], v14 offset:22528
ds_read_b64_tr_b16 a[142:143], v14 offset:22656
s_waitcnt lgkmcnt(4)
ds_read_b64_tr_b16 a[144:145], v14 offset:24576
ds_read_b64_tr_b16 a[146:147], v14 offset:24704
ds_read_b64_tr_b16 a[148:149], v14 offset:26624
ds_read_b64_tr_b16 a[150:151], v14 offset:26752
s_waitcnt lgkmcnt(4)
ds_read_b64_tr_b16 a[152:153], v14 offset:28672
ds_read_b64_tr_b16 a[154:155], v14 offset:28800
ds_read_b64_tr_b16 a[156:157], v14 offset:30720
ds_read_b64_tr_b16 a[158:159], v14 offset:30848
s_waitcnt lgkmcnt(4)
ds_read_b64_tr_b16 a[160:161], v14 offset:16416
ds_read_b64_tr_b16 a[162:163], v14 offset:16544
ds_read_b64_tr_b16 a[164:165], v14 offset:18464
ds_read_b64_tr_b16 a[166:167], v14 offset:18592
s_waitcnt lgkmcnt(4)
ds_read_b64_tr_b16 a[168:169], v14 offset:20512
ds_read_b64_tr_b16 a[170:171], v14 offset:20640
ds_read_b64_tr_b16 a[172:173], v14 offset:22560
ds_read_b64_tr_b16 a[174:175], v14 offset:22688
s_waitcnt lgkmcnt(4)
ds_read_b64_tr_b16 a[176:177], v14 offset:24608
ds_read_b64_tr_b16 a[178:179], v14 offset:24736
ds_read_b64_tr_b16 a[180:181], v14 offset:26656
ds_read_b64_tr_b16 a[182:183], v14 offset:26784
s_waitcnt lgkmcnt(4)
ds_read_b64_tr_b16 a[184:185], v14 offset:28704
ds_read_b64_tr_b16 a[186:187], v14 offset:28832
ds_read_b64_tr_b16 a[188:189], v14 offset:30752
ds_read_b64_tr_b16 a[190:191], v14 offset:30880
s_waitcnt lgkmcnt(4)
s_waitcnt lgkmcnt(0)
buffer_load_dwordx4 v10, s[48:51], s26 offen lds
s_add_u32 m0, m0, 1024
s_add_u32 s26, s26, 131072
buffer_load_dwordx4 v[24:27], v241, s[4:7], s60 offen offset:0
buffer_load_dwordx4 v[28:31], v241, s[4:7], s60 offen offset:256
buffer_load_dwordx4 v10, s[48:51], s26 offen lds
s_add_u32 m0, m0, 1024
s_add_u32 s26, s26, 131072
buffer_load_dwordx4 v[32:35], v241, s[4:7], s60 offen offset:2048
buffer_load_dwordx4 v[36:39], v241, s[4:7], s60 offen offset:2304
s_add_u32 s60, s60, 4096
buffer_load_dwordx4 v10, s[48:51], s26 offen lds
s_add_u32 m0, m0, 1024
s_add_u32 s26, s26, 131072
buffer_load_dwordx4 v[40:43], v241, s[4:7], s60 offen offset:0
buffer_load_dwordx4 v[44:47], v241, s[4:7], s60 offen offset:256
buffer_load_dwordx4 v10, s[48:51], s26 offen lds
s_add_u32 m0, m0, 1024
s_add_u32 s26, s26, 131072
buffer_load_dwordx4 v[48:51], v241, s[4:7], s60 offen offset:2048
buffer_load_dwordx4 v[52:55], v241, s[4:7], s60 offen offset:2304
s_add_u32 s60, s60, 4096
buffer_load_dwordx4 v10, s[48:51], s26 offen lds
s_add_u32 m0, m0, 1024
s_add_u32 s26, s26, 131072
buffer_load_dwordx4 v[56:59], v241, s[4:7], s60 offen offset:0
buffer_load_dwordx4 v[60:63], v241, s[4:7], s60 offen offset:256
buffer_load_dwordx4 v10, s[48:51], s26 offen lds
s_add_u32 m0, m0, 1024
s_add_u32 s26, s26, 131072
buffer_load_dwordx4 v[64:67], v241, s[4:7], s60 offen offset:2048
buffer_load_dwordx4 v[68:71], v241, s[4:7], s60 offen offset:2304
s_add_u32 s60, s60, 4096
buffer_load_dwordx4 v10, s[48:51], s26 offen lds
s_add_u32 m0, m0, 1024
s_add_u32 s26, s26, 131072
buffer_load_dwordx4 v[72:75], v241, s[4:7], s60 offen offset:0
buffer_load_dwordx4 v[76:79], v241, s[4:7], s60 offen offset:256
buffer_load_dwordx4 v10, s[48:51], s26 offen lds
buffer_load_dwordx4 v[80:83], v241, s[4:7], s60 offen offset:2048
buffer_load_dwordx4 v[84:87], v241, s[4:7], s60 offen offset:2304
s_add_u32 s60, s60, 53248
buffer_load_dword v245, v255, s[52:55], s68 offen
s_add_u32 m0, s33, 16384
s_mov_b32 s26, s63
buffer_load_dwordx4 v11, s[52:55], s26 offen lds
s_add_u32 m0, m0, 1024
s_add_u32 s26, s26, 32768
buffer_load_dwordx4 v11, s[52:55], s26 offen lds
s_add_u32 m0, m0, 1024
s_add_u32 s26, s26, 32768
buffer_load_dwordx4 v11, s[52:55], s26 offen lds
s_add_u32 m0, m0, 1024
s_add_u32 s26, s26, 32768
buffer_load_dwordx4 v11, s[52:55], s26 offen lds
s_add_u32 m0, m0, 1024
s_add_u32 s26, s26, 32768
buffer_load_dwordx4 v11, s[52:55], s26 offen lds
s_add_u32 m0, m0, 1024
s_add_u32 s26, s26, 32768
buffer_load_dwordx4 v11, s[52:55], s26 offen lds
s_add_u32 m0, m0, 1024
s_add_u32 s26, s26, 32768
buffer_load_dwordx4 v11, s[52:55], s26 offen lds
s_add_u32 m0, m0, 1024
s_add_u32 s26, s26, 32768
buffer_load_dwordx4 v11, s[52:55], s26 offen lds
s_add_u32 m0, m0, 1024
s_add_u32 s26, s26, 32768
buffer_load_dwordx4 v11, s[52:55], s26 offen lds
s_add_u32 m0, m0, 1024
s_add_u32 s26, s26, 32768
buffer_load_dwordx4 v11, s[52:55], s26 offen lds
s_add_u32 m0, m0, 1024
s_add_u32 s26, s26, 32768
buffer_load_dwordx4 v11, s[52:55], s26 offen lds
s_add_u32 m0, m0, 1024
s_add_u32 s26, s26, 32768
buffer_load_dwordx4 v11, s[52:55], s26 offen lds
s_add_u32 m0, m0, 1024
s_add_u32 s26, s26, 32768
buffer_load_dwordx4 v11, s[52:55], s26 offen lds
s_add_u32 m0, m0, 1024
s_add_u32 s26, s26, 32768
buffer_load_dwordx4 v11, s[52:55], s26 offen lds
s_add_u32 m0, m0, 1024
s_add_u32 s26, s26, 32768
buffer_load_dwordx4 v11, s[52:55], s26 offen lds
s_add_u32 m0, m0, 1024
s_add_u32 s26, s26, 32768
buffer_load_dwordx4 v11, s[52:55], s26 offen lds
s_waitcnt vmcnt(41)
v_mfma_f32_16x16x32_bf16 v[208:211], a[64:67], v[144:147], 0
v_mfma_f32_16x16x32_bf16 v[224:227], v[144:147], a[128:131], 0
v_mfma_f32_16x16x32_bf16 v[212:215], a[96:99], v[144:147], 0
v_mfma_f32_16x16x32_bf16 v[232:235], v[144:147], a[160:163], 0
v_mfma_f32_16x16x32_bf16 v[216:219], a[64:67], v[148:151], 0
v_mfma_f32_16x16x32_bf16 v[228:231], v[148:151], a[128:131], 0
v_mfma_f32_16x16x32_bf16 v[220:223], a[96:99], v[148:151], 0
v_mfma_f32_16x16x32_bf16 v[236:239], v[148:151], a[160:163], 0
buffer_load_dwordx4 v[144:147], v241, s[4:7], s60 offen offset:0
v_mfma_f32_16x16x32_bf16 v[208:211], a[68:71], v[152:155], v[208:211]
v_mfma_f32_16x16x32_bf16 v[224:227], v[152:155], a[132:135], v[224:227]
v_mfma_f32_16x16x32_bf16 v[212:215], a[100:103], v[152:155], v[212:215]
v_mfma_f32_16x16x32_bf16 v[232:235], v[152:155], a[164:167], v[232:235]
buffer_load_dwordx4 v[148:151], v241, s[4:7], s60 offen offset:256
v_mfma_f32_16x16x32_bf16 v[216:219], a[68:71], v[156:159], v[216:219]
v_mfma_f32_16x16x32_bf16 v[228:231], v[156:159], a[132:135], v[228:231]
v_mfma_f32_16x16x32_bf16 v[220:223], a[100:103], v[156:159], v[220:223]
v_mfma_f32_16x16x32_bf16 v[236:239], v[156:159], a[164:167], v[236:239]
buffer_load_dwordx4 v[152:155], v241, s[4:7], s60 offen offset:2048
v_mfma_f32_16x16x32_bf16 v[208:211], a[72:75], v[160:163], v[208:211]
v_mfma_f32_16x16x32_bf16 v[224:227], v[160:163], a[136:139], v[224:227]
v_mfma_f32_16x16x32_bf16 v[212:215], a[104:107], v[160:163], v[212:215]
v_mfma_f32_16x16x32_bf16 v[232:235], v[160:163], a[168:171], v[232:235]
buffer_load_dwordx4 v[156:159], v241, s[4:7], s60 offen offset:2304
s_add_u32 s60, s60, 4096
v_mfma_f32_16x16x32_bf16 v[216:219], a[72:75], v[164:167], v[216:219]
v_mfma_f32_16x16x32_bf16 v[228:231], v[164:167], a[136:139], v[228:231]
v_mfma_f32_16x16x32_bf16 v[220:223], a[104:107], v[164:167], v[220:223]
v_mfma_f32_16x16x32_bf16 v[236:239], v[164:167], a[168:171], v[236:239]
buffer_load_dwordx4 v[160:163], v241, s[4:7], s60 offen offset:0
v_mfma_f32_16x16x32_bf16 v[208:211], a[76:79], v[168:171], v[208:211]
v_mfma_f32_16x16x32_bf16 v[224:227], v[168:171], a[140:143], v[224:227]
v_mfma_f32_16x16x32_bf16 v[212:215], a[108:111], v[168:171], v[212:215]
v_mfma_f32_16x16x32_bf16 v[232:235], v[168:171], a[172:175], v[232:235]
buffer_load_dwordx4 v[164:167], v241, s[4:7], s60 offen offset:256
v_mfma_f32_16x16x32_bf16 v[216:219], a[76:79], v[172:175], v[216:219]
v_mfma_f32_16x16x32_bf16 v[228:231], v[172:175], a[140:143], v[228:231]
v_mfma_f32_16x16x32_bf16 v[220:223], a[108:111], v[172:175], v[220:223]
v_mfma_f32_16x16x32_bf16 v[236:239], v[172:175], a[172:175], v[236:239]
buffer_load_dwordx4 v[168:171], v241, s[4:7], s60 offen offset:2048
v_mfma_f32_16x16x32_bf16 v[208:211], a[80:83], v[176:179], v[208:211]
v_mfma_f32_16x16x32_bf16 v[224:227], v[176:179], a[144:147], v[224:227]
v_mfma_f32_16x16x32_bf16 v[212:215], a[112:115], v[176:179], v[212:215]
v_mfma_f32_16x16x32_bf16 v[232:235], v[176:179], a[176:179], v[232:235]
buffer_load_dwordx4 v[172:175], v241, s[4:7], s60 offen offset:2304
s_add_u32 s60, s60, 4096
v_mfma_f32_16x16x32_bf16 v[216:219], a[80:83], v[180:183], v[216:219]
v_mfma_f32_16x16x32_bf16 v[228:231], v[180:183], a[144:147], v[228:231]
v_mfma_f32_16x16x32_bf16 v[220:223], a[112:115], v[180:183], v[220:223]
v_mfma_f32_16x16x32_bf16 v[236:239], v[180:183], a[176:179], v[236:239]
buffer_load_dwordx4 v[176:179], v241, s[4:7], s60 offen offset:0
v_mfma_f32_16x16x32_bf16 v[208:211], a[84:87], v[184:187], v[208:211]
v_mfma_f32_16x16x32_bf16 v[224:227], v[184:187], a[148:151], v[224:227]
v_mfma_f32_16x16x32_bf16 v[212:215], a[116:119], v[184:187], v[212:215]
v_mfma_f32_16x16x32_bf16 v[232:235], v[184:187], a[180:183], v[232:235]
buffer_load_dwordx4 v[180:183], v241, s[4:7], s60 offen offset:256
v_mfma_f32_16x16x32_bf16 v[216:219], a[84:87], v[188:191], v[216:219]
v_mfma_f32_16x16x32_bf16 v[228:231], v[188:191], a[148:151], v[228:231]
v_mfma_f32_16x16x32_bf16 v[220:223], a[116:119], v[188:191], v[220:223]
v_mfma_f32_16x16x32_bf16 v[236:239], v[188:191], a[180:183], v[236:239]
buffer_load_dwordx4 v[184:187], v241, s[4:7], s60 offen offset:2048
v_mfma_f32_16x16x32_bf16 v[208:211], a[88:91], v[192:195], v[208:211]
v_mfma_f32_16x16x32_bf16 v[224:227], v[192:195], a[152:155], v[224:227]
v_mfma_f32_16x16x32_bf16 v[212:215], a[120:123], v[192:195], v[212:215]
v_mfma_f32_16x16x32_bf16 v[232:235], v[192:195], a[184:187], v[232:235]
buffer_load_dwordx4 v[188:191], v241, s[4:7], s60 offen offset:2304
s_add_u32 s60, s60, 4096
v_mfma_f32_16x16x32_bf16 v[216:219], a[88:91], v[196:199], v[216:219]
v_mfma_f32_16x16x32_bf16 v[228:231], v[196:199], a[152:155], v[228:231]
v_mfma_f32_16x16x32_bf16 v[220:223], a[120:123], v[196:199], v[220:223]
v_mfma_f32_16x16x32_bf16 v[236:239], v[196:199], a[184:187], v[236:239]
buffer_load_dwordx4 v[192:195], v241, s[4:7], s60 offen offset:0
v_mfma_f32_16x16x32_bf16 v[208:211], a[92:95], v[200:203], v[208:211]
v_mfma_f32_16x16x32_bf16 v[224:227], v[200:203], a[156:159], v[224:227]
v_mfma_f32_16x16x32_bf16 v[212:215], a[124:127], v[200:203], v[212:215]
v_mfma_f32_16x16x32_bf16 v[232:235], v[200:203], a[188:191], v[232:235]
buffer_load_dwordx4 v[196:199], v241, s[4:7], s60 offen offset:256
v_mfma_f32_16x16x32_bf16 v[216:219], a[92:95], v[204:207], v[216:219]
v_mfma_f32_16x16x32_bf16 v[228:231], v[204:207], a[156:159], v[228:231]
v_mfma_f32_16x16x32_bf16 v[220:223], a[124:127], v[204:207], v[220:223]
v_mfma_f32_16x16x32_bf16 v[236:239], v[204:207], a[188:191], v[236:239]
buffer_load_dwordx4 v[200:203], v241, s[4:7], s60 offen offset:2048
buffer_load_dwordx4 v[204:207], v241, s[4:7], s60 offen offset:2304
s_add_u32 s60, s60, 53248
s_barrier
ds_write_b128 v242, v[208:211] offset:0
ds_write_b128 v242, v[212:215] offset:1024
ds_write_b128 v242, v[224:227] offset:16384
ds_write_b128 v242, v[228:231] offset:17408
ds_write_b128 v242, v[216:219] offset:8192
ds_write_b128 v242, v[220:223] offset:9216
ds_write_b128 v242, v[232:235] offset:24576
ds_write_b128 v242, v[236:239] offset:25600
s_waitcnt lgkmcnt(0)
s_barrier
ds_read_b128 v[88:91], v243 offset:0
ds_read_b128 v[92:95], v243 offset:1024
ds_read_b128 v[96:99], v243 offset:2048
ds_read_b128 v[100:103], v243 offset:3072
ds_read_b128 v[104:107], v243 offset:4096
ds_read_b128 v[108:111], v243 offset:5120
ds_read_b128 v[112:115], v243 offset:6144
ds_read_b128 v[116:119], v243 offset:7168
s_waitcnt vmcnt(33)
v_mfma_f32_16x16x32_bf16 v[208:211], a[64:67], v[24:27], 0
v_mfma_f32_16x16x32_bf16 v[224:227], v[24:27], a[128:131], 0
v_mfma_f32_16x16x32_bf16 v[212:215], a[96:99], v[24:27], 0
v_mfma_f32_16x16x32_bf16 v[232:235], v[24:27], a[160:163], 0
v_mfma_f32_16x16x32_bf16 v[216:219], a[64:67], v[28:31], 0
v_mfma_f32_16x16x32_bf16 v[228:231], v[28:31], a[128:131], 0
v_mfma_f32_16x16x32_bf16 v[220:223], a[96:99], v[28:31], 0
v_mfma_f32_16x16x32_bf16 v[236:239], v[28:31], a[160:163], 0
v_mfma_f32_16x16x32_bf16 v[208:211], a[68:71], v[32:35], v[208:211]
v_mfma_f32_16x16x32_bf16 v[224:227], v[32:35], a[132:135], v[224:227]
v_mfma_f32_16x16x32_bf16 v[212:215], a[100:103], v[32:35], v[212:215]
v_mfma_f32_16x16x32_bf16 v[232:235], v[32:35], a[164:167], v[232:235]
v_mfma_f32_16x16x32_bf16 v[216:219], a[68:71], v[36:39], v[216:219]
s_waitcnt lgkmcnt(4)
v_mfma_f32_16x16x32_bf16 v[228:231], v[36:39], a[132:135], v[228:231]
v_pk_add_f32 v[88:89], v[88:89], v[96:97]
v_mfma_f32_16x16x32_bf16 v[220:223], a[100:103], v[36:39], v[220:223]
v_pk_add_f32 v[90:91], v[90:91], v[98:99]
v_mfma_f32_16x16x32_bf16 v[236:239], v[36:39], a[164:167], v[236:239]
v_pk_add_f32 v[92:93], v[92:93], v[100:101]
v_mfma_f32_16x16x32_bf16 v[208:211], a[72:75], v[40:43], v[208:211]
v_pk_add_f32 v[94:95], v[94:95], v[102:103]
v_mfma_f32_16x16x32_bf16 v[224:227], v[40:43], a[136:139], v[224:227]
s_waitcnt lgkmcnt(2)
v_mfma_f32_16x16x32_bf16 v[212:215], a[104:107], v[40:43], v[212:215]
v_pk_add_f32 v[88:89], v[88:89], v[104:105]
v_mfma_f32_16x16x32_bf16 v[232:235], v[40:43], a[168:171], v[232:235]
v_pk_add_f32 v[90:91], v[90:91], v[106:107]
v_mfma_f32_16x16x32_bf16 v[216:219], a[72:75], v[44:47], v[216:219]
v_pk_add_f32 v[92:93], v[92:93], v[108:109]
v_mfma_f32_16x16x32_bf16 v[228:231], v[44:47], a[136:139], v[228:231]
v_pk_add_f32 v[94:95], v[94:95], v[110:111]
v_mfma_f32_16x16x32_bf16 v[220:223], a[104:107], v[44:47], v[220:223]
s_waitcnt lgkmcnt(0)
v_mfma_f32_16x16x32_bf16 v[236:239], v[44:47], a[168:171], v[236:239]
v_pk_add_f32 v[88:89], v[88:89], v[112:113]
v_mfma_f32_16x16x32_bf16 v[208:211], a[76:79], v[48:51], v[208:211]
v_pk_add_f32 v[90:91], v[90:91], v[114:115]
v_mfma_f32_16x16x32_bf16 v[224:227], v[48:51], a[140:143], v[224:227]
v_pk_add_f32 v[92:93], v[92:93], v[116:117]
v_mfma_f32_16x16x32_bf16 v[212:215], a[108:111], v[48:51], v[212:215]
v_pk_add_f32 v[94:95], v[94:95], v[118:119]
v_mfma_f32_16x16x32_bf16 v[232:235], v[48:51], a[172:175], v[232:235]
v_cvt_pk_bf16_f32 v120, v88, v89
v_mfma_f32_16x16x32_bf16 v[216:219], a[76:79], v[52:55], v[216:219]
v_cvt_pk_bf16_f32 v121, v90, v91
v_mfma_f32_16x16x32_bf16 v[228:231], v[52:55], a[140:143], v[228:231]
v_cvt_pk_bf16_f32 v122, v92, v93
v_mfma_f32_16x16x32_bf16 v[220:223], a[108:111], v[52:55], v[220:223]
v_cvt_pk_bf16_f32 v123, v94, v95
v_mfma_f32_16x16x32_bf16 v[236:239], v[52:55], a[172:175], v[236:239]
v_mfma_f32_16x16x32_bf16 v[208:211], a[80:83], v[56:59], v[208:211]
v_mfma_f32_16x16x32_bf16 v[224:227], v[56:59], a[144:147], v[224:227]
v_mfma_f32_16x16x32_bf16 v[212:215], a[112:115], v[56:59], v[212:215]
v_mfma_f32_16x16x32_bf16 v[232:235], v[56:59], a[176:179], v[232:235]
v_mfma_f32_16x16x32_bf16 v[216:219], a[80:83], v[60:63], v[216:219]
v_mfma_f32_16x16x32_bf16 v[228:231], v[60:63], a[144:147], v[228:231]
v_mfma_f32_16x16x32_bf16 v[220:223], a[112:115], v[60:63], v[220:223]
v_mfma_f32_16x16x32_bf16 v[236:239], v[60:63], a[176:179], v[236:239]
v_mfma_f32_16x16x32_bf16 v[208:211], a[84:87], v[64:67], v[208:211]
v_mfma_f32_16x16x32_bf16 v[224:227], v[64:67], a[148:151], v[224:227]
v_mfma_f32_16x16x32_bf16 v[212:215], a[116:119], v[64:67], v[212:215]
v_mfma_f32_16x16x32_bf16 v[232:235], v[64:67], a[180:183], v[232:235]
v_mfma_f32_16x16x32_bf16 v[216:219], a[84:87], v[68:71], v[216:219]
v_mfma_f32_16x16x32_bf16 v[228:231], v[68:71], a[148:151], v[228:231]
v_mfma_f32_16x16x32_bf16 v[220:223], a[116:119], v[68:71], v[220:223]
v_mfma_f32_16x16x32_bf16 v[236:239], v[68:71], a[180:183], v[236:239]
v_mfma_f32_16x16x32_bf16 v[208:211], a[88:91], v[72:75], v[208:211]
v_mfma_f32_16x16x32_bf16 v[224:227], v[72:75], a[152:155], v[224:227]
v_mfma_f32_16x16x32_bf16 v[212:215], a[120:123], v[72:75], v[212:215]
v_mfma_f32_16x16x32_bf16 v[232:235], v[72:75], a[184:187], v[232:235]
v_mfma_f32_16x16x32_bf16 v[216:219], a[88:91], v[76:79], v[216:219]
v_mfma_f32_16x16x32_bf16 v[228:231], v[76:79], a[152:155], v[228:231]
v_mfma_f32_16x16x32_bf16 v[220:223], a[120:123], v[76:79], v[220:223]
v_mfma_f32_16x16x32_bf16 v[236:239], v[76:79], a[184:187], v[236:239]
v_mfma_f32_16x16x32_bf16 v[208:211], a[92:95], v[80:83], v[208:211]
v_mfma_f32_16x16x32_bf16 v[224:227], v[80:83], a[156:159], v[224:227]
v_mfma_f32_16x16x32_bf16 v[212:215], a[124:127], v[80:83], v[212:215]
v_mfma_f32_16x16x32_bf16 v[232:235], v[80:83], a[188:191], v[232:235]
v_mfma_f32_16x16x32_bf16 v[216:219], a[92:95], v[84:87], v[216:219]
v_mfma_f32_16x16x32_bf16 v[228:231], v[84:87], a[156:159], v[228:231]
v_mfma_f32_16x16x32_bf16 v[220:223], a[124:127], v[84:87], v[220:223]
v_mfma_f32_16x16x32_bf16 v[236:239], v[84:87], a[188:191], v[236:239]
s_cmp_ge_u32 s14, 2
s_cbranch_scc1 m_kvs
v_permlane32_swap_b32 v120, v122
v_permlane32_swap_b32 v121, v123
m_kvs:
ds_read_b64_tr_b16 a[0:1], v14 offset:0
ds_read_b64_tr_b16 a[2:3], v14 offset:128
ds_read_b64_tr_b16 a[4:5], v14 offset:2048
ds_read_b64_tr_b16 a[6:7], v14 offset:2176
s_waitcnt lgkmcnt(4)
ds_read_b64_tr_b16 a[8:9], v14 offset:4096
ds_read_b64_tr_b16 a[10:11], v14 offset:4224
ds_read_b64_tr_b16 a[12:13], v14 offset:6144
ds_read_b64_tr_b16 a[14:15], v14 offset:6272
s_waitcnt lgkmcnt(4)
ds_read_b64_tr_b16 a[16:17], v14 offset:8192
ds_read_b64_tr_b16 a[18:19], v14 offset:8320
ds_read_b64_tr_b16 a[20:21], v14 offset:10240
ds_read_b64_tr_b16 a[22:23], v14 offset:10368
s_waitcnt lgkmcnt(4)
ds_read_b64_tr_b16 a[24:25], v14 offset:12288
ds_read_b64_tr_b16 a[26:27], v14 offset:12416
ds_read_b64_tr_b16 a[28:29], v14 offset:14336
ds_read_b64_tr_b16 a[30:31], v14 offset:14464
s_waitcnt lgkmcnt(4)
ds_read_b64_tr_b16 a[32:33], v14 offset:32
ds_read_b64_tr_b16 a[34:35], v14 offset:160
ds_read_b64_tr_b16 a[36:37], v14 offset:2080
ds_read_b64_tr_b16 a[38:39], v14 offset:2208
s_waitcnt lgkmcnt(4)
ds_read_b64_tr_b16 a[40:41], v14 offset:4128
ds_read_b64_tr_b16 a[42:43], v14 offset:4256
ds_read_b64_tr_b16 a[44:45], v14 offset:6176
ds_read_b64_tr_b16 a[46:47], v14 offset:6304
s_waitcnt lgkmcnt(4)
ds_read_b64_tr_b16 a[48:49], v14 offset:8224
ds_read_b64_tr_b16 a[50:51], v14 offset:8352
ds_read_b64_tr_b16 a[52:53], v14 offset:10272
ds_read_b64_tr_b16 a[54:55], v14 offset:10400
s_waitcnt lgkmcnt(4)
ds_read_b64_tr_b16 a[56:57], v14 offset:12320
ds_read_b64_tr_b16 a[58:59], v14 offset:12448
ds_read_b64_tr_b16 a[60:61], v14 offset:14368
ds_read_b64_tr_b16 a[62:63], v14 offset:14496
s_waitcnt lgkmcnt(4)
s_waitcnt lgkmcnt(0)
buffer_load_dword v17, v16, s[72:75], 0 offen sc1
s_waitcnt vmcnt(17)
ds_read_b64_tr_b16 a[192:193], v15 offset:16384
ds_read_b64_tr_b16 a[194:195], v15 offset:16512
ds_read_b64_tr_b16 a[196:197], v15 offset:18432
ds_read_b64_tr_b16 a[198:199], v15 offset:18560
s_waitcnt lgkmcnt(4)
ds_read_b64_tr_b16 a[200:201], v15 offset:20480
ds_read_b64_tr_b16 a[202:203], v15 offset:20608
ds_read_b64_tr_b16 a[204:205], v15 offset:22528
ds_read_b64_tr_b16 a[206:207], v15 offset:22656
s_waitcnt lgkmcnt(4)
ds_read_b64_tr_b16 a[208:209], v15 offset:24576
ds_read_b64_tr_b16 a[210:211], v15 offset:24704
ds_read_b64_tr_b16 a[212:213], v15 offset:26624
ds_read_b64_tr_b16 a[214:215], v15 offset:26752
s_waitcnt lgkmcnt(4)
ds_read_b64_tr_b16 a[216:217], v15 offset:28672
ds_read_b64_tr_b16 a[218:219], v15 offset:28800
ds_read_b64_tr_b16 a[220:221], v15 offset:30720
ds_read_b64_tr_b16 a[222:223], v15 offset:30848
s_waitcnt lgkmcnt(4)
ds_read_b64_tr_b16 a[224:225], v15 offset:16416
ds_read_b64_tr_b16 a[226:227], v15 offset:16544
ds_read_b64_tr_b16 a[228:229], v15 offset:18464
ds_read_b64_tr_b16 a[230:231], v15 offset:18592
s_waitcnt lgkmcnt(4)
ds_read_b64_tr_b16 a[232:233], v15 offset:20512
ds_read_b64_tr_b16 a[234:235], v15 offset:20640
ds_read_b64_tr_b16 a[236:237], v15 offset:22560
ds_read_b64_tr_b16 a[238:239], v15 offset:22688
s_waitcnt lgkmcnt(4)
ds_read_b64_tr_b16 a[240:241], v15 offset:24608
ds_read_b64_tr_b16 a[242:243], v15 offset:24736
ds_read_b64_tr_b16 a[244:245], v15 offset:26656
ds_read_b64_tr_b16 a[246:247], v15 offset:26784
s_waitcnt lgkmcnt(4)
ds_read_b64_tr_b16 a[248:249], v15 offset:28704
ds_read_b64_tr_b16 a[250:251], v15 offset:28832
ds_read_b64_tr_b16 a[252:253], v15 offset:30752
ds_read_b64_tr_b16 a[254:255], v15 offset:30880
s_waitcnt lgkmcnt(4)
s_waitcnt lgkmcnt(0)
s_waitcnt vmcnt(0)
s_mov_b32 s59, 1
s_cmp_lg_u32 s58, 0
s_cbranch_scc1 m_rv_d
m_rv_l:
v_cmp_ne_u32 vcc, 0, v17
s_bitcmp1_b32 vcc_lo, 8
s_cbranch_scc1 m_fb
s_and_b32 s29, vcc_lo, 255
s_cmp_eq_u32 s29, 255
s_cbranch_scc1 m_rv_v
s_cmp_eq_u32 s17, 0
s_cbranch_scc1 m_rv_d
s_sub_u32 s17, s17, 1
buffer_load_dword v17, v16, s[72:75], 0 offen sc1
s_waitcnt vmcnt(0)
s_branch m_rv_l
m_rv_v:
v_add_u32_dpp v17, v17, v17 row_shr:1 row_mask:0xf bank_mask:0xf bound_ctrl:0
s_nop 1
v_add_u32_dpp v17, v17, v17 row_shr:2 row_mask:0xf bank_mask:0xf bound_ctrl:0
s_nop 1
v_add_u32_dpp v17, v17, v17 row_shr:4 row_mask:0xf bank_mask:0xf bound_ctrl:0
s_nop 0
v_readlane_b32 s29, v17, 7
s_mov_b32 s57, s29
s_cmp_gt_u32 s29, 2176
s_cselect_b32 s59, 2, 1
m_rv_d:
s_and_b32 s65, s59, 2
s_lshl_b32 s65, s65, 12
s_lshr_b32 s29, s61, 8
s_xnor_b32 s29, s29, s65
s_and_b32 s29, s29, 8192
s_add_u32 s29, s29, s61
s_lshr_b32 s30, s14, 1
s_lshl_b32 s30, s30, 17
s_and_b32 s31, s14, 1
s_or_b32 s30, s30, s31
s_lshl_b32 s30, s30, 8
s_add_u32 s29, s29, s30
buffer_store_dwordx4 v[120:123], v244, s[4:7], s29 offen sc1
s_add_u32 s61, s61, 524288
v_mov_b32 v80, v120
v_mov_b32 v81, v121
v_mov_b32 v82, v122
v_mov_b32 v83, v123
v_mov_b64 v[8:9], v[128:129]
v_mov_b64 v[10:11], v[130:131]
v_mov_b64 v[12:13], v[132:133]
v_mov_b64 v[14:15], v[134:135]
v_mov_b64 v[16:17], v[136:137]
v_mov_b64 v[18:19], v[138:139]
v_mov_b64 v[20:21], v[140:141]
v_mov_b64 v[22:23], v[142:143]
s_lshl_b32 s24, s12, 5
s_add_u32 s24, s24, s13
v_lshrrev_b32 v79, 1, v2
v_and_b32 v78, 1, v2
v_bfe_u32 v77, v0, 1, 1
v_mov_b32 v3, 0x4444
v_mov_b32 v76, 0xeeee
v_cmp_eq_u32 s[66:67], 1, v77
s_nop 1
v_cndmask_b32 v3, v3, v76, s[66:67]
v_mov_b32 v4, -1
v_mov_b32 v128, 0x3f803f80
v_mov_b32 v116, 0
v_mov_b32 v120, 0
v_mov_b32 v124, 0
v_mov_b32 v5, -1
v_mov_b32 v129, 0x3f803f80
v_mov_b32 v117, 0
v_mov_b32 v121, 0
v_mov_b32 v125, 0
v_mov_b32 v6, -1
v_mov_b32 v130, 0x3f803f80
v_mov_b32 v118, 0
v_mov_b32 v122, 0
v_mov_b32 v126, 0
v_mov_b32 v7, -1
v_mov_b32 v131, 0x3f803f80
v_mov_b32 v119, 0
v_mov_b32 v123, 0
v_mov_b32 v127, 0
v_mov_b32 v24, 0
v_mov_b32 v25, 0
v_mov_b32 v26, 0
v_mov_b32 v27, 0
v_mov_b32 v28, 0
v_mov_b32 v29, 0
v_mov_b32 v30, 0
v_mov_b32 v31, 0
v_mov_b32 v32, 0
v_mov_b32 v33, 0
v_mov_b32 v34, 0
v_mov_b32 v35, 0
v_mov_b32 v36, 0
v_mov_b32 v37, 0
v_mov_b32 v38, 0
v_mov_b32 v39, 0
v_mov_b32 v40, 0
v_mov_b32 v41, 0
v_mov_b32 v42, 0
v_mov_b32 v43, 0
v_mov_b32 v44, 0
v_mov_b32 v45, 0
v_mov_b32 v46, 0
v_mov_b32 v47, 0
v_mov_b32 v48, 0
v_mov_b32 v49, 0
v_mov_b32 v50, 0
v_mov_b32 v51, 0
v_mov_b32 v52, 0
v_mov_b32 v53, 0
v_mov_b32 v54, 0
v_mov_b32 v55, 0
v_lshlrev_b32 v59, 4, v0
s_movk_i32 s30, 288
s_movk_i32 s31, 640
s_lshl_b32 s25, s12, 14
s_lshl_b32 s26, s14, 12
s_add_u32 s26, s26, s25
v_add_u32 v56, s26, v59
v_add_u32 v57, 65536, v56
v_mul_u32_u24 v76, 640, v2
v_lshl_add_u32 v76, v1, 2, v76
s_mul_i32 s26, s14, 2560
v_add_u32 v58, s26, v76
s_lshl_b32 s28, s13, 9
s_add_u32 s28, s28, s25
v_lshl_add_u32 v65, v0, 3, s28
s_mul_i32 s26, s14, 1280
s_add_u32 s26, s26, 16384
v_lshl_add_u32 v240, v0, 2, s26
v_and_b32 v60, 1, v0
v_lshlrev_b32 v60, 4, v60
v_bfe_u32 v76, v0, 1, 1
v_mad_u32_u24 v60, v76, s30, v60
v_bfe_u32 v76, v0, 2, 1
v_mad_u32_u24 v60, v76, s31, v60
v_bfe_u32 v76, v0, 3, 2
v_lshl_add_u32 v60, v76, 6, v60
v_lshl_add_u32 v60, v79, 5, v60
s_lshr_b32 s26, s13, 1
s_lshl_b32 s26, s26, 14
s_and_b32 s27, s13, 1
s_lshl_b32 s27, s27, 12
s_add_u32 s29, s26, s27
v_add_u32 v76, s29, v59
s_add_u32 s26, s12, 0
s_and_b32 s26, s26, 3
s_lshl_b32 s26, s26, 10
v_add_u32 v61, s26, v76
s_add_u32 s26, s12, 1
s_and_b32 s26, s26, 3
s_lshl_b32 s26, s26, 10
v_add_u32 v62, s26, v76
s_add_u32 s26, s12, 2
s_and_b32 s26, s26, 3
s_lshl_b32 s26, s26, 10
v_add_u32 v63, s26, v76
s_add_u32 s26, s12, 3
s_and_b32 s26, s26, 3
s_lshl_b32 s26, s26, 10
v_add_u32 v64, s26, v76
s_mov_b32 s18, 0
s_mov_b32 s23, 0
s_mov_b32 s32, 0
s_mov_b32 s33, 1040356334
s_mov_b32 s19, 167772160
s_mov_b32 s20, 168820736
s_mov_b32 s21, 169869312
s_mov_b32 s22, 170393600
s_cmp_eq_u32 s14, 0
s_cbranch_scc1 m_rp0
s_cmp_eq_u32 s14, 1
s_cbranch_scc1 m_rp1
s_cmp_eq_u32 s14, 2
s_cbranch_scc1 m_rp2
s_lshl_b32 s30, s24, 10
s_add_u32 s30, s30, 131072
s_lshr_b32 s31, s24, 2
s_lshl_b32 s31, s31, 10
s_add_u32 s31, s31, 262144
s_and_b32 s27, s24, 3
s_lshl_b32 s27, s27, 2
s_lshr_b32 s26, s24, 2
s_lshl_b32 s26, s26, 14
s_and_b32 s27, s24, 3
s_lshl_b32 s27, s27, 11
s_add_u32 s26, s26, s27
v_lshlrev_b32 v66, 9, v2
v_lshl_add_u32 v66, v1, 4, v66
v_add_u32 v66, s26, v66
s_mov_b32 s62, 33554432
s_lshl_b32 s26, s12, 8
s_add_u32 s26, s26, 170921988
v_mov_b32 v68, s26
v_mov_b32 v76, 2147483648
v_cmp_eq_u32 vcc, 0, v0
s_nop 1
v_cndmask_b32 v68, v76, v68, vcc
s_barrier
ds_write_b128 v59, v[80:83] offset:27648
v_add_u32 v242, 4294868992, v242
ds_write_b128 v242, v[208:211] offset:0
ds_write_b128 v242, v[212:215] offset:1024
ds_write_b128 v242, v[224:227] offset:16384
ds_write_b128 v242, v[228:231] offset:17408
ds_write_b128 v242, v[216:219] offset:8192
ds_write_b128 v242, v[220:223] offset:9216
ds_write_b128 v242, v[232:235] offset:24576
ds_write_b128 v242, v[236:239] offset:25600
v_add_u32 v74, 4096, v59
s_mov_b32 s69, 81920
s_sub_u32 s59, s60, 65536
s_lshr_b32 s64, s24, 3
s_lshl_b32 s64, s64, 6
s_add_u32 s64, s64, 170927104
s_mov_b32 s63, 0
s_mov_b32 s68, 24576
v_mov_b32 v75, 0
s_add_u32 s63, s60, 16384
s_lshl_b32 s30, s13, 11
v_lshl_add_u32 v67, v0, 7, s30
v_mov_b32 v76, 2147483648
v_cmp_gt_u32 vcc, 16, v0
s_nop 1
v_cndmask_b32 v67, v76, v67, vcc
s_mov_b64 s[8:9], s[72:73]
s_mov_b64 s[10:11], s[74:75]
v_lshlrev_b32 v69, 2, v0
v_add_u32 v69, 128, v69
v_mov_b32 v70, 2147483648
v_cmp_gt_u32 vcc, 16, v0
s_nop 1
v_cndmask_b32 v69, v70, v69, vcc
buffer_load_dword v70, v69, s[8:11], 0 offen sc1
s_xor_b32 s30, s65, 8192
s_waitcnt lgkmcnt(0)
s_barrier
v_add_u32 v61, s30, v61
v_add_u32 v62, s30, v62
v_add_u32 v63, s30, v63
v_add_u32 v64, s30, v64
s_cmp_eq_u32 s15, 0
s_cbranch_scc1 m_safe3
m_f3_top:
s_waitcnt vmcnt(3)
v_cmp_eq_u32 vcc, -1, v8
s_cbranch_vccnz m_f3_am0
v_smfmac_f32_16x16x64_bf16 v[24:27], v[8:11], a[0:7], v3
v_smfmac_f32_16x16x64_bf16 v[28:31], v[8:11], a[32:39], v3
s_waitcnt vmcnt(2)
v_cmp_eq_u32 vcc, -1, v12
v_smfmac_f32_16x16x64_bf16 v[32:35], v[8:11], a[64:71], v3
s_cbranch_vccnz m_f3_am1
v_smfmac_f32_16x16x64_bf16 v[36:39], v[8:11], a[96:103], v3
v_smfmac_f32_16x16x64_bf16 v[24:27], v[12:15], a[8:15], v3
v_smfmac_f32_16x16x64_bf16 v[28:31], v[12:15], a[40:47], v3
s_waitcnt vmcnt(1)
v_cmp_eq_u32 vcc, -1, v16
v_smfmac_f32_16x16x64_bf16 v[32:35], v[12:15], a[72:79], v3
s_cbranch_vccnz m_f3_am2
v_smfmac_f32_16x16x64_bf16 v[36:39], v[12:15], a[104:111], v3
v_smfmac_f32_16x16x64_bf16 v[24:27], v[16:19], a[16:23], v3
v_smfmac_f32_16x16x64_bf16 v[28:31], v[16:19], a[48:55], v3
s_waitcnt vmcnt(0)
v_cmp_eq_u32 vcc, -1, v20
v_smfmac_f32_16x16x64_bf16 v[32:35], v[16:19], a[80:87], v3
s_cbranch_vccnz m_f3_am3
v_smfmac_f32_16x16x64_bf16 v[36:39], v[16:19], a[112:119], v3
v_smfmac_f32_16x16x64_bf16 v[24:27], v[20:23], a[24:31], v3
v_smfmac_f32_16x16x64_bf16 v[28:31], v[20:23], a[56:63], v3
v_smfmac_f32_16x16x64_bf16 v[32:35], v[20:23], a[88:95], v3
v_smfmac_f32_16x16x64_bf16 v[36:39], v[20:23], a[120:127], v3
m_f3_ab:
v_smfmac_f32_16x16x64_bf16 v[40:43], v[8:11], a[128:135], v3
v_pk_add_f32 v[24:25], v[24:25], v[26:27]
v_pk_add_f32 v[28:29], v[28:29], v[30:31]
ds_write2_b32 v58, v24, v25 offset0:80 offset1:120
ds_write2_b32 v58, v28, v29 offset0:96 offset1:136
v_smfmac_f32_16x16x64_bf16 v[44:47], v[8:11], a[160:167], v3
v_pk_add_f32 v[32:33], v[32:33], v[34:35]
v_pk_add_f32 v[36:37], v[36:37], v[38:39]
ds_write2_b32 v58, v32, v33 offset0:0 offset1:40
ds_write2_b32 v58, v36, v37 offset0:16 offset1:56
s_and_b32 s30, s18, 3
s_lshl_b32 s19, s30, 19
s_add_u32 s19, s19, 167772160
v_smfmac_f32_16x16x64_bf16 v[40:43], v[12:15], a[136:143], v3
v_smfmac_f32_16x16x64_bf16 v[44:47], v[12:15], a[168:175], v3
s_waitcnt lgkmcnt(0)
s_barrier
v_smfmac_f32_16x16x64_bf16 v[40:43], v[16:19], a[144:151], v3
v_smfmac_f32_16x16x64_bf16 v[44:47], v[16:19], a[176:183], v3
v_smfmac_f32_16x16x64_bf16 v[40:43], v[20:23], a[152:159], v3
v_smfmac_f32_16x16x64_bf16 v[44:47], v[20:23], a[184:191], v3
s_nop 4
v_pk_add_f32 v[96:97], v[40:41], v[42:43]
s_nop 1
v_pk_add_f32 v[98:99], v[44:45], v[46:47]
ds_write_b128 v59, v[96:99] offset:15360
s_waitcnt lgkmcnt(0)
s_barrier
s_cmp_eq_u32 s18, 63
s_cbranch_scc1 m_f3_fin
v_mov_b64 v[24:25], 0
v_mov_b64 v[26:27], 0
v_mov_b64 v[28:29], 0
v_mov_b64 v[30:31], 0
v_mov_b64 v[32:33], 0
v_mov_b64 v[34:35], 0
v_mov_b64 v[36:37], 0
v_mov_b64 v[38:39], 0
v_mov_b64 v[40:41], 0
v_mov_b64 v[42:43], 0
v_mov_b64 v[44:45], 0
v_mov_b64 v[46:47], 0
s_cmp_ge_u32 s18, 15
s_cbranch_scc1 m_f3_ow0
ds_read_b128 v[104:107], v59 offset:40960
ds_read_b128 v[108:111], v59 offset:41984
ds_read_b128 v[112:115], v59 offset:43008
ds_read_b128 v[116:119], v59 offset:44032
ds_read_b128 v[120:123], v59 offset:45056
ds_read_b128 v[124:127], v59 offset:46080
ds_read_b128 v[128:131], v59 offset:47104
ds_read_b128 v[132:135], v59 offset:48128
v_mfma_f32_16x16x32_bf16 v[208:211], a[64:67], v[144:147], 0
v_mfma_f32_16x16x32_bf16 v[224:227], v[144:147], a[128:131], 0
v_mfma_f32_16x16x32_bf16 v[212:215], a[96:99], v[144:147], 0
v_mfma_f32_16x16x32_bf16 v[232:235], v[144:147], a[160:163], 0
v_mfma_f32_16x16x32_bf16 v[216:219], a[64:67], v[148:151], 0
v_mfma_f32_16x16x32_bf16 v[228:231], v[148:151], a[128:131], 0
v_mfma_f32_16x16x32_bf16 v[220:223], a[96:99], v[148:151], 0
s_waitcnt lgkmcnt(4)
v_pk_add_f32 v[104:105], v[104:105], v[112:113]
v_pk_add_f32 v[106:107], v[106:107], v[114:115]
v_mfma_f32_16x16x32_bf16 v[236:239], v[148:151], a[160:163], 0
v_pk_add_f32 v[108:109], v[108:109], v[116:117]
v_pk_add_f32 v[110:111], v[110:111], v[118:119]
s_waitcnt lgkmcnt(2)
v_mfma_f32_16x16x32_bf16 v[208:211], a[68:71], v[152:155], v[208:211]
v_pk_add_f32 v[104:105], v[104:105], v[120:121]
v_pk_add_f32 v[106:107], v[106:107], v[122:123]
v_pk_add_f32 v[108:109], v[108:109], v[124:125]
v_mfma_f32_16x16x32_bf16 v[224:227], v[152:155], a[132:135], v[224:227]
v_pk_add_f32 v[110:111], v[110:111], v[126:127]
s_waitcnt lgkmcnt(0)
v_pk_add_f32 v[104:105], v[104:105], v[128:129]
v_mfma_f32_16x16x32_bf16 v[212:215], a[100:103], v[152:155], v[212:215]
v_pk_add_f32 v[106:107], v[106:107], v[130:131]
v_pk_add_f32 v[108:109], v[108:109], v[132:133]
v_pk_add_f32 v[110:111], v[110:111], v[134:135]
v_mfma_f32_16x16x32_bf16 v[232:235], v[152:155], a[164:167], v[232:235]
v_cvt_pk_bf16_f32 v136, v104, v105
v_cvt_pk_bf16_f32 v137, v106, v107
v_cvt_pk_bf16_f32 v138, v108, v109
v_cvt_pk_bf16_f32 v139, v110, v111
s_nop 0
v_permlane32_swap_b32 v136, v138
v_permlane32_swap_b32 v137, v139
ds_write_b128 v74, v[136:139] offset:25600
ds_read_b128 v[104:107], v59 offset:57344
ds_read_b128 v[108:111], v59 offset:58368
ds_read_b128 v[112:115], v59 offset:59392
ds_read_b128 v[116:119], v59 offset:60416
ds_read_b128 v[120:123], v59 offset:61440
ds_read_b128 v[124:127], v59 offset:62464
ds_read_b128 v[128:131], v59 offset:63488
ds_read_b128 v[132:135], v59 offset:64512
v_mfma_f32_16x16x32_bf16 v[216:219], a[68:71], v[156:159], v[216:219]
v_mfma_f32_16x16x32_bf16 v[228:231], v[156:159], a[132:135], v[228:231]
v_mfma_f32_16x16x32_bf16 v[220:223], a[100:103], v[156:159], v[220:223]
v_mfma_f32_16x16x32_bf16 v[236:239], v[156:159], a[164:167], v[236:239]
v_mfma_f32_16x16x32_bf16 v[208:211], a[72:75], v[160:163], v[208:211]
v_mfma_f32_16x16x32_bf16 v[224:227], v[160:163], a[136:139], v[224:227]
v_mfma_f32_16x16x32_bf16 v[212:215], a[104:107], v[160:163], v[212:215]
s_waitcnt lgkmcnt(4)
v_pk_add_f32 v[104:105], v[104:105], v[112:113]
v_pk_add_f32 v[106:107], v[106:107], v[114:115]
v_mfma_f32_16x16x32_bf16 v[232:235], v[160:163], a[168:171], v[232:235]
v_pk_add_f32 v[108:109], v[108:109], v[116:117]
v_pk_add_f32 v[110:111], v[110:111], v[118:119]
s_waitcnt lgkmcnt(2)
v_mfma_f32_16x16x32_bf16 v[216:219], a[72:75], v[164:167], v[216:219]
v_pk_add_f32 v[104:105], v[104:105], v[120:121]
v_pk_add_f32 v[106:107], v[106:107], v[122:123]
v_pk_add_f32 v[108:109], v[108:109], v[124:125]
v_mfma_f32_16x16x32_bf16 v[228:231], v[164:167], a[136:139], v[228:231]
v_pk_add_f32 v[110:111], v[110:111], v[126:127]
s_waitcnt lgkmcnt(0)
v_pk_add_f32 v[104:105], v[104:105], v[128:129]
v_mfma_f32_16x16x32_bf16 v[220:223], a[104:107], v[164:167], v[220:223]
v_pk_add_f32 v[106:107], v[106:107], v[130:131]
v_pk_add_f32 v[108:109], v[108:109], v[132:133]
v_pk_add_f32 v[110:111], v[110:111], v[134:135]
v_mfma_f32_16x16x32_bf16 v[236:239], v[164:167], a[168:171], v[236:239]
v_cvt_pk_bf16_f32 v140, v104, v105
v_cvt_pk_bf16_f32 v141, v106, v107
v_cvt_pk_bf16_f32 v142, v108, v109
v_cvt_pk_bf16_f32 v143, v110, v111
ds_write_b128 v74, v[140:143] offset:27648
m_f3_ow0:
v_xor_b32 v74, 4096, v74
s_barrier
buffer_load_dwordx4 v[8:11], v57, s[4:7], s19 offen offset:0 sc1
buffer_load_dwordx4 v[12:15], v57, s[4:7], s19 offen offset:1024 sc1
buffer_load_dwordx4 v[16:19], v57, s[4:7], s19 offen offset:2048 sc1
buffer_load_dwordx4 v[20:23], v57, s[4:7], s19 offen offset:3072 sc1
s_waitcnt vmcnt(3)
v_cmp_eq_u32 vcc, -1, v8
s_cbranch_vccnz m_f3_om0
v_smfmac_f32_16x16x64_bf16 v[48:51], v[8:11], a[192:199], v3
s_waitcnt vmcnt(2)
v_cmp_eq_u32 vcc, -1, v12
s_cbranch_vccnz m_f3_om1
v_smfmac_f32_16x16x64_bf16 v[52:55], v[8:11], a[224:231], v3
v_smfmac_f32_16x16x64_bf16 v[48:51], v[12:15], a[200:207], v3
s_waitcnt vmcnt(1)
v_cmp_eq_u32 vcc, -1, v16
s_cbranch_vccnz m_f3_om2
v_smfmac_f32_16x16x64_bf16 v[52:55], v[12:15], a[232:239], v3
v_smfmac_f32_16x16x64_bf16 v[48:51], v[16:19], a[208:215], v3
s_waitcnt vmcnt(0)
v_cmp_eq_u32 vcc, -1, v20
s_cbranch_vccnz m_f3_om3
v_smfmac_f32_16x16x64_bf16 v[52:55], v[16:19], a[240:247], v3
v_smfmac_f32_16x16x64_bf16 v[48:51], v[20:23], a[216:223], v3
v_smfmac_f32_16x16x64_bf16 v[52:55], v[20:23], a[248:255], v3
m_f3_ob:
s_nop 4
v_pk_add_f32 v[96:97], v[48:49], v[50:51]
s_nop 1
v_pk_add_f32 v[98:99], v[52:53], v[54:55]
ds_write2_b32 v240, v96, v97 offset0:0 offset1:72
ds_write2_b32 v240, v98, v99 offset0:160 offset1:232
s_cmp_ge_u32 s18, 15
s_cbranch_scc1 m_f3_ow1
s_lshr_b32 s29, s61, 8
s_xnor_b32 s29, s29, s65
s_and_b32 s29, s29, 8192
s_add_u32 s29, s29, s61
s_add_u32 s28, s29, 33554432
s_add_u32 s61, s61, 524288
buffer_store_dwordx4 v[136:139], v244, s[4:7], s29 offen offset:256 sc1
buffer_store_dwordx4 v[140:143], v244, s[4:7], s28 offen offset:256 sc1
s_cmp_eq_u32 s18, 3
s_cbranch_scc1 m_f3_rw
m_f3_rwd:
buffer_load_dword v245, v67, s[4:7], s63 offen
s_add_u32 s63, s63, 65536
s_cmp_eq_u32 s18, 3
s_cselect_b32 s63, 176685056, s63
m_f3_ow1:
s_sub_u32 s30, s18, 13
s_cmp_ge_u32 s30, 49
s_cbranch_scc1 m_f3_ntk
s_cmp_eq_u32 s30, 0
s_cbranch_scc1 m_f3_kvf
v_readfirstlane_b32 s30, v75
s_cmp_lt_u32 s30, 16
s_cbranch_scc1 m_f3_kvw
m_f3_kv_d:
s_lshr_b32 s29, s62, 8
s_xor_b32 s29, s29, s65
s_and_b32 s29, s29, 8192
s_add_u32 s29, s29, s62
s_add_u32 s28, s29, 33554432
s_add_u32 m0, s68, 0
s_nop 0
buffer_load_dwordx4 v66, s[4:7], s29 offen offset:0 sc1 lds
s_add_u32 m0, s68, 768
s_nop 0
buffer_load_dwordx4 v66, s[4:7], s29 offen offset:256 sc1 lds
s_add_u32 m0, s68, 2048
s_nop 0
buffer_load_dwordx4 v66, s[4:7], s28 offen offset:0 sc1 lds
s_add_u32 m0, s68, 2816
s_nop 0
buffer_load_dwordx4 v66, s[4:7], s28 offen offset:256 sc1 lds
s_add_u32 s62, s62, 524288
s_xor_b32 s68, s68, 4096
m_f3_kvf:
s_add_u32 s30, s18, 3
s_and_b32 s30, s30, 7
s_cbranch_scc1 m_f3_ntk
s_cselect_b32 s30, 0, 1024
s_add_u32 s64, s64, s30
v_mov_b32 v77, 0
buffer_load_dword v75, v77, s[4:7], s64 offen sc1
m_f3_ntk:
s_waitcnt lgkmcnt(0)
s_barrier
v_mov_b64 v[48:49], 0
v_mov_b64 v[50:51], 0
v_mov_b64 v[52:53], 0
v_mov_b64 v[54:55], 0
s_cmp_ge_u32 s18, 15
s_cbranch_scc1 m_f3_ow2
v_mfma_f32_16x16x32_bf16 v[208:211], a[76:79], v[168:171], v[208:211]
v_mfma_f32_16x16x32_bf16 v[224:227], v[168:171], a[140:143], v[224:227]
s_add_u32 s28, s60, 0
buffer_load_dwordx4 v[144:147], v241, s[4:7], s28 offen offset:0
v_mfma_f32_16x16x32_bf16 v[212:215], a[108:111], v[168:171], v[212:215]
s_add_u32 s28, s60, 4294918144
s_add_u32 m0, s69, 0
s_nop 0
buffer_load_dwordx4 v241, s[4:7], s28 offen offset:0 lds
v_mfma_f32_16x16x32_bf16 v[232:235], v[168:171], a[172:175], v[232:235]
s_add_u32 s28, s60, 4294918144
s_add_u32 m0, s69, 768
s_nop 0
buffer_load_dwordx4 v241, s[4:7], s28 offen offset:256 lds
v_mfma_f32_16x16x32_bf16 v[216:219], a[76:79], v[172:175], v[216:219]
v_mfma_f32_16x16x32_bf16 v[228:231], v[172:175], a[140:143], v[228:231]
s_add_u32 s28, s60, 4096
buffer_load_dwordx4 v[168:171], v241, s[4:7], s28 offen offset:2048
s_add_u32 s28, s60, 0
buffer_load_dwordx4 v[148:151], v241, s[4:7], s28 offen offset:256
v_mfma_f32_16x16x32_bf16 v[220:223], a[108:111], v[172:175], v[220:223]
s_add_u32 s28, s60, 4294918144
s_add_u32 m0, s69, 0
s_nop 0
buffer_load_dwordx4 v241, s[4:7], s28 offen offset:2048 lds
v_mfma_f32_16x16x32_bf16 v[236:239], v[172:175], a[172:175], v[236:239]
s_add_u32 s28, s60, 4294918144
s_add_u32 m0, s69, 768
s_nop 0
buffer_load_dwordx4 v241, s[4:7], s28 offen offset:2304 lds
v_mfma_f32_16x16x32_bf16 v[208:211], a[80:83], v[176:179], v[208:211]
v_mfma_f32_16x16x32_bf16 v[224:227], v[176:179], a[144:147], v[224:227]
s_add_u32 s28, s60, 4096
buffer_load_dwordx4 v[172:175], v241, s[4:7], s28 offen offset:2304
s_add_u32 s28, s60, 0
buffer_load_dwordx4 v[152:155], v241, s[4:7], s28 offen offset:2048
v_mfma_f32_16x16x32_bf16 v[212:215], a[112:115], v[176:179], v[212:215]
s_add_u32 s28, s60, 4294922240
s_add_u32 m0, s69, 4096
s_nop 0
buffer_load_dwordx4 v241, s[4:7], s28 offen offset:0 lds
v_mfma_f32_16x16x32_bf16 v[232:235], v[176:179], a[176:179], v[232:235]
s_add_u32 s28, s60, 4294922240
s_add_u32 m0, s69, 4864
s_nop 0
buffer_load_dwordx4 v241, s[4:7], s28 offen offset:256 lds
v_mfma_f32_16x16x32_bf16 v[216:219], a[80:83], v[180:183], v[216:219]
v_mfma_f32_16x16x32_bf16 v[228:231], v[180:183], a[144:147], v[228:231]
s_add_u32 s28, s60, 8192
buffer_load_dwordx4 v[176:179], v241, s[4:7], s28 offen offset:0
s_add_u32 s28, s60, 0
buffer_load_dwordx4 v[156:159], v241, s[4:7], s28 offen offset:2304
v_mfma_f32_16x16x32_bf16 v[220:223], a[112:115], v[180:183], v[220:223]
s_add_u32 s28, s60, 4294922240
s_add_u32 m0, s69, 4096
s_nop 0
buffer_load_dwordx4 v241, s[4:7], s28 offen offset:2048 lds
v_mfma_f32_16x16x32_bf16 v[236:239], v[180:183], a[176:179], v[236:239]
s_add_u32 s28, s60, 4294922240
s_add_u32 m0, s69, 4864
s_nop 0
buffer_load_dwordx4 v241, s[4:7], s28 offen offset:2304 lds
v_mfma_f32_16x16x32_bf16 v[208:211], a[84:87], v[184:187], v[208:211]
v_mfma_f32_16x16x32_bf16 v[224:227], v[184:187], a[148:151], v[224:227]
s_add_u32 s28, s60, 8192
buffer_load_dwordx4 v[180:183], v241, s[4:7], s28 offen offset:256
s_add_u32 s28, s60, 4096
buffer_load_dwordx4 v[160:163], v241, s[4:7], s28 offen offset:0
v_mfma_f32_16x16x32_bf16 v[212:215], a[116:119], v[184:187], v[212:215]
s_add_u32 s28, s60, 4294926336
s_add_u32 m0, s69, 8192
s_nop 0
buffer_load_dwordx4 v241, s[4:7], s28 offen offset:0 lds
v_mfma_f32_16x16x32_bf16 v[232:235], v[184:187], a[180:183], v[232:235]
s_add_u32 s28, s60, 4294926336
s_add_u32 m0, s69, 8960
s_nop 0
buffer_load_dwordx4 v241, s[4:7], s28 offen offset:256 lds
v_mfma_f32_16x16x32_bf16 v[216:219], a[84:87], v[188:191], v[216:219]
v_mfma_f32_16x16x32_bf16 v[228:231], v[188:191], a[148:151], v[228:231]
s_add_u32 s28, s60, 8192
buffer_load_dwordx4 v[184:187], v241, s[4:7], s28 offen offset:2048
s_add_u32 s28, s60, 4096
buffer_load_dwordx4 v[164:167], v241, s[4:7], s28 offen offset:256
v_mfma_f32_16x16x32_bf16 v[220:223], a[116:119], v[188:191], v[220:223]
s_add_u32 s28, s60, 4294926336
s_add_u32 m0, s69, 8192
s_nop 0
buffer_load_dwordx4 v241, s[4:7], s28 offen offset:2048 lds
v_mfma_f32_16x16x32_bf16 v[236:239], v[188:191], a[180:183], v[236:239]
s_add_u32 s28, s60, 4294926336
s_add_u32 m0, s69, 8960
s_nop 0
buffer_load_dwordx4 v241, s[4:7], s28 offen offset:2304 lds
v_mfma_f32_16x16x32_bf16 v[208:211], a[88:91], v[192:195], v[208:211]
v_mfma_f32_16x16x32_bf16 v[224:227], v[192:195], a[152:155], v[224:227]
s_add_u32 s28, s60, 8192
buffer_load_dwordx4 v[188:191], v241, s[4:7], s28 offen offset:2304
v_mfma_f32_16x16x32_bf16 v[212:215], a[120:123], v[192:195], v[212:215]
s_add_u32 s28, s60, 4294930432
s_add_u32 m0, s69, 12288
s_nop 0
buffer_load_dwordx4 v241, s[4:7], s28 offen offset:0 lds
v_mfma_f32_16x16x32_bf16 v[232:235], v[192:195], a[184:187], v[232:235]
s_add_u32 s28, s60, 4294930432
s_add_u32 m0, s69, 13056
s_nop 0
buffer_load_dwordx4 v241, s[4:7], s28 offen offset:256 lds
v_mfma_f32_16x16x32_bf16 v[216:219], a[88:91], v[196:199], v[216:219]
v_mfma_f32_16x16x32_bf16 v[228:231], v[196:199], a[152:155], v[228:231]
s_add_u32 s28, s60, 12288
buffer_load_dwordx4 v[192:195], v241, s[4:7], s28 offen offset:0
v_mfma_f32_16x16x32_bf16 v[220:223], a[120:123], v[196:199], v[220:223]
s_add_u32 s28, s60, 4294930432
s_add_u32 m0, s69, 12288
s_nop 0
buffer_load_dwordx4 v241, s[4:7], s28 offen offset:2048 lds
v_mfma_f32_16x16x32_bf16 v[236:239], v[196:199], a[184:187], v[236:239]
s_add_u32 s28, s60, 4294930432
s_add_u32 m0, s69, 13056
s_nop 0
buffer_load_dwordx4 v241, s[4:7], s28 offen offset:2304 lds
v_mfma_f32_16x16x32_bf16 v[208:211], a[92:95], v[200:203], v[208:211]
v_mfma_f32_16x16x32_bf16 v[224:227], v[200:203], a[156:159], v[224:227]
s_add_u32 s28, s60, 12288
buffer_load_dwordx4 v[196:199], v241, s[4:7], s28 offen offset:256
v_mfma_f32_16x16x32_bf16 v[212:215], a[124:127], v[200:203], v[212:215]
v_mfma_f32_16x16x32_bf16 v[232:235], v[200:203], a[188:191], v[232:235]
v_mfma_f32_16x16x32_bf16 v[216:219], a[92:95], v[204:207], v[216:219]
v_mfma_f32_16x16x32_bf16 v[228:231], v[204:207], a[156:159], v[228:231]
s_add_u32 s28, s60, 12288
buffer_load_dwordx4 v[200:203], v241, s[4:7], s28 offen offset:2048
v_mfma_f32_16x16x32_bf16 v[220:223], a[124:127], v[204:207], v[220:223]
v_mfma_f32_16x16x32_bf16 v[236:239], v[204:207], a[188:191], v[236:239]
s_add_u32 s28, s60, 12288
buffer_load_dwordx4 v[204:207], v241, s[4:7], s28 offen offset:2304
ds_write_b128 v242, v[208:211] offset:0
ds_write_b128 v242, v[212:215] offset:1024
ds_write_b128 v242, v[224:227] offset:16384
ds_write_b128 v242, v[228:231] offset:17408
ds_write_b128 v242, v[216:219] offset:8192
ds_write_b128 v242, v[220:223] offset:9216
ds_write_b128 v242, v[232:235] offset:24576
ds_write_b128 v242, v[236:239] offset:25600
s_mov_b32 s59, s60
s_add_u32 s60, s60, 65536
s_cmp_eq_u32 s18, 4
s_cselect_b32 s60, 176734208, s60
s_xor_b32 s69, s69, 16384
m_f3_ow2:
s_add_u32 s18, s18, 1
s_mov_b32 s31, s21
s_and_b32 s30, s18, 3
s_lshl_b32 s21, s30, 18
s_xor_b32 s22, s21, 524288
s_add_u32 s21, s21, 169869312
s_add_u32 s22, s22, 169869312
s_xor_b32 s30, s30, 2
s_lshl_b32 s20, s30, 19
s_add_u32 s20, s20, 167772160
s_waitcnt lgkmcnt(0)
s_barrier
buffer_load_dwordx4 v[8:11], v56, s[4:7], s19 offen offset:0 sc1
buffer_load_dwordx4 v[12:15], v56, s[4:7], s19 offen offset:1024 sc1
buffer_load_dwordx4 v[16:19], v56, s[4:7], s19 offen offset:2048 sc1
buffer_load_dwordx4 v[20:23], v56, s[4:7], s19 offen offset:3072 sc1
s_branch m_f3_top
m_f3_am0:
s_mov_b32 s32, 15
s_cmp_eq_u32 s17, 0
s_cbranch_scc1 m_f3_ah40
s_sub_u32 s17, s17, 1
buffer_load_dwordx4 v[8:11], v56, s[4:7], s19 offen offset:0 sc1
s_branch m_f3_al41
m_f3_am1:
v_smfmac_f32_16x16x64_bf16 v[36:39], v[8:11], a[96:103], v3
s_mov_b32 s32, 14
s_cmp_eq_u32 s17, 0
s_cbranch_scc1 m_f3_ah31
s_sub_u32 s17, s17, 1
buffer_load_dwordx4 v[12:15], v56, s[4:7], s19 offen offset:1024 sc1
s_branch m_f3_al32
m_f3_am2:
v_smfmac_f32_16x16x64_bf16 v[36:39], v[12:15], a[104:111], v3
s_mov_b32 s32, 12
s_cmp_eq_u32 s17, 0
s_cbranch_scc1 m_f3_ah22
s_sub_u32 s17, s17, 1
buffer_load_dwordx4 v[16:19], v56, s[4:7], s19 offen offset:2048 sc1
s_branch m_f3_al23
m_f3_am3:
v_smfmac_f32_16x16x64_bf16 v[36:39], v[16:19], a[112:119], v3
s_mov_b32 s32, 8
s_cmp_eq_u32 s17, 0
s_cbranch_scc1 m_f3_ah13
s_sub_u32 s17, s17, 1
buffer_load_dwordx4 v[20:23], v56, s[4:7], s19 offen offset:3072 sc1
s_branch m_f3_al10
m_f3_al10:
s_bitcmp1_b32 s32, 0
s_cbranch_scc0 m_f3_al11
s_waitcnt vmcnt(0)
v_cmp_eq_u32 vcc, -1, v8
s_cbranch_vccz m_f3_ah10
s_cmp_eq_u32 s17, 0
s_cbranch_scc1 m_f3_ah10
s_sub_u32 s17, s17, 1
buffer_load_dwordx4 v[8:11], v56, s[4:7], s19 offen offset:0 sc1
m_f3_al11:
s_bitcmp1_b32 s32, 1
s_cbranch_scc0 m_f3_al12
s_waitcnt vmcnt(0)
v_cmp_eq_u32 vcc, -1, v12
s_cbranch_vccz m_f3_ah11
s_cmp_eq_u32 s17, 0
s_cbranch_scc1 m_f3_ah11
s_sub_u32 s17, s17, 1
buffer_load_dwordx4 v[12:15], v56, s[4:7], s19 offen offset:1024 sc1
m_f3_al12:
s_bitcmp1_b32 s32, 2
s_cbranch_scc0 m_f3_al13
s_waitcnt vmcnt(0)
v_cmp_eq_u32 vcc, -1, v16
s_cbranch_vccz m_f3_ah12
s_cmp_eq_u32 s17, 0
s_cbranch_scc1 m_f3_ah12
s_sub_u32 s17, s17, 1
buffer_load_dwordx4 v[16:19], v56, s[4:7], s19 offen offset:2048 sc1
m_f3_al13:
s_bitcmp1_b32 s32, 3
s_cbranch_scc0 m_f3_al10
s_waitcnt vmcnt(0)
v_cmp_eq_u32 vcc, -1, v20
s_cbranch_vccz m_f3_ah13
s_cmp_eq_u32 s17, 0
s_cbranch_scc1 m_f3_ah13
s_sub_u32 s17, s17, 1
buffer_load_dwordx4 v[20:23], v56, s[4:7], s19 offen offset:3072 sc1
s_branch m_f3_al10
m_f3_ah10:
v_smfmac_f32_16x16x64_bf16 v[24:27], v[8:11], a[0:7], v3
v_smfmac_f32_16x16x64_bf16 v[28:31], v[8:11], a[32:39], v3
v_smfmac_f32_16x16x64_bf16 v[32:35], v[8:11], a[64:71], v3
v_smfmac_f32_16x16x64_bf16 v[36:39], v[8:11], a[96:103], v3
s_branch m_f3_ab
m_f3_ah11:
v_smfmac_f32_16x16x64_bf16 v[24:27], v[12:15], a[8:15], v3
v_smfmac_f32_16x16x64_bf16 v[28:31], v[12:15], a[40:47], v3
v_smfmac_f32_16x16x64_bf16 v[32:35], v[12:15], a[72:79], v3
v_smfmac_f32_16x16x64_bf16 v[36:39], v[12:15], a[104:111], v3
s_branch m_f3_ab
m_f3_ah12:
v_smfmac_f32_16x16x64_bf16 v[24:27], v[16:19], a[16:23], v3
v_smfmac_f32_16x16x64_bf16 v[28:31], v[16:19], a[48:55], v3
v_smfmac_f32_16x16x64_bf16 v[32:35], v[16:19], a[80:87], v3
v_smfmac_f32_16x16x64_bf16 v[36:39], v[16:19], a[112:119], v3
s_branch m_f3_ab
m_f3_ah13:
v_smfmac_f32_16x16x64_bf16 v[24:27], v[20:23], a[24:31], v3
v_smfmac_f32_16x16x64_bf16 v[28:31], v[20:23], a[56:63], v3
v_smfmac_f32_16x16x64_bf16 v[32:35], v[20:23], a[88:95], v3
v_smfmac_f32_16x16x64_bf16 v[36:39], v[20:23], a[120:127], v3
s_branch m_f3_ab
m_f3_al20:
s_bitcmp1_b32 s32, 0
s_cbranch_scc0 m_f3_al21
s_waitcnt vmcnt(1)
v_cmp_eq_u32 vcc, -1, v8
s_cbranch_vccz m_f3_ah20
s_cmp_eq_u32 s17, 0
s_cbranch_scc1 m_f3_ah20
s_sub_u32 s17, s17, 1
buffer_load_dwordx4 v[8:11], v56, s[4:7], s19 offen offset:0 sc1
m_f3_al21:
s_bitcmp1_b32 s32, 1
s_cbranch_scc0 m_f3_al22
s_waitcnt vmcnt(1)
v_cmp_eq_u32 vcc, -1, v12
s_cbranch_vccz m_f3_ah21
s_cmp_eq_u32 s17, 0
s_cbranch_scc1 m_f3_ah21
s_sub_u32 s17, s17, 1
buffer_load_dwordx4 v[12:15], v56, s[4:7], s19 offen offset:1024 sc1
m_f3_al22:
s_bitcmp1_b32 s32, 2
s_cbranch_scc0 m_f3_al23
s_waitcnt vmcnt(1)
v_cmp_eq_u32 vcc, -1, v16
s_cbranch_vccz m_f3_ah22
s_cmp_eq_u32 s17, 0
s_cbranch_scc1 m_f3_ah22
s_sub_u32 s17, s17, 1
buffer_load_dwordx4 v[16:19], v56, s[4:7], s19 offen offset:2048 sc1
m_f3_al23:
s_bitcmp1_b32 s32, 3
s_cbranch_scc0 m_f3_al20
s_waitcnt vmcnt(1)
v_cmp_eq_u32 vcc, -1, v20
s_cbranch_vccz m_f3_ah23
s_cmp_eq_u32 s17, 0
s_cbranch_scc1 m_f3_ah23
s_sub_u32 s17, s17, 1
buffer_load_dwordx4 v[20:23], v56, s[4:7], s19 offen offset:3072 sc1
s_branch m_f3_al20
m_f3_ah20:
v_smfmac_f32_16x16x64_bf16 v[24:27], v[8:11], a[0:7], v3
v_smfmac_f32_16x16x64_bf16 v[28:31], v[8:11], a[32:39], v3
v_smfmac_f32_16x16x64_bf16 v[32:35], v[8:11], a[64:71], v3
v_smfmac_f32_16x16x64_bf16 v[36:39], v[8:11], a[96:103], v3
s_bitset0_b32 s32, 0
s_branch m_f3_al11
m_f3_ah21:
v_smfmac_f32_16x16x64_bf16 v[24:27], v[12:15], a[8:15], v3
v_smfmac_f32_16x16x64_bf16 v[28:31], v[12:15], a[40:47], v3
v_smfmac_f32_16x16x64_bf16 v[32:35], v[12:15], a[72:79], v3
v_smfmac_f32_16x16x64_bf16 v[36:39], v[12:15], a[104:111], v3
s_bitset0_b32 s32, 1
s_branch m_f3_al12
m_f3_ah22:
v_smfmac_f32_16x16x64_bf16 v[24:27], v[16:19], a[16:23], v3
v_smfmac_f32_16x16x64_bf16 v[28:31], v[16:19], a[48:55], v3
v_smfmac_f32_16x16x64_bf16 v[32:35], v[16:19], a[80:87], v3
v_smfmac_f32_16x16x64_bf16 v[36:39], v[16:19], a[112:119], v3
s_bitset0_b32 s32, 2
s_branch m_f3_al13
m_f3_ah23:
v_smfmac_f32_16x16x64_bf16 v[24:27], v[20:23], a[24:31], v3
v_smfmac_f32_16x16x64_bf16 v[28:31], v[20:23], a[56:63], v3
v_smfmac_f32_16x16x64_bf16 v[32:35], v[20:23], a[88:95], v3
v_smfmac_f32_16x16x64_bf16 v[36:39], v[20:23], a[120:127], v3
s_bitset0_b32 s32, 3
s_branch m_f3_al10
m_f3_al30:
s_bitcmp1_b32 s32, 0
s_cbranch_scc0 m_f3_al31
s_waitcnt vmcnt(2)
v_cmp_eq_u32 vcc, -1, v8
s_cbranch_vccz m_f3_ah30
s_cmp_eq_u32 s17, 0
s_cbranch_scc1 m_f3_ah30
s_sub_u32 s17, s17, 1
buffer_load_dwordx4 v[8:11], v56, s[4:7], s19 offen offset:0 sc1
m_f3_al31:
s_bitcmp1_b32 s32, 1
s_cbranch_scc0 m_f3_al32
s_waitcnt vmcnt(2)
v_cmp_eq_u32 vcc, -1, v12
s_cbranch_vccz m_f3_ah31
s_cmp_eq_u32 s17, 0
s_cbranch_scc1 m_f3_ah31
s_sub_u32 s17, s17, 1
buffer_load_dwordx4 v[12:15], v56, s[4:7], s19 offen offset:1024 sc1
m_f3_al32:
s_bitcmp1_b32 s32, 2
s_cbranch_scc0 m_f3_al33
s_waitcnt vmcnt(2)
v_cmp_eq_u32 vcc, -1, v16
s_cbranch_vccz m_f3_ah32
s_cmp_eq_u32 s17, 0
s_cbranch_scc1 m_f3_ah32
s_sub_u32 s17, s17, 1
buffer_load_dwordx4 v[16:19], v56, s[4:7], s19 offen offset:2048 sc1
m_f3_al33:
s_bitcmp1_b32 s32, 3
s_cbranch_scc0 m_f3_al30
s_waitcnt vmcnt(2)
v_cmp_eq_u32 vcc, -1, v20
s_cbranch_vccz m_f3_ah33
s_cmp_eq_u32 s17, 0
s_cbranch_scc1 m_f3_ah33
s_sub_u32 s17, s17, 1
buffer_load_dwordx4 v[20:23], v56, s[4:7], s19 offen offset:3072 sc1
s_branch m_f3_al30
m_f3_ah30:
v_smfmac_f32_16x16x64_bf16 v[24:27], v[8:11], a[0:7], v3
v_smfmac_f32_16x16x64_bf16 v[28:31], v[8:11], a[32:39], v3
v_smfmac_f32_16x16x64_bf16 v[32:35], v[8:11], a[64:71], v3
v_smfmac_f32_16x16x64_bf16 v[36:39], v[8:11], a[96:103], v3
s_bitset0_b32 s32, 0
s_branch m_f3_al21
m_f3_ah31:
v_smfmac_f32_16x16x64_bf16 v[24:27], v[12:15], a[8:15], v3
v_smfmac_f32_16x16x64_bf16 v[28:31], v[12:15], a[40:47], v3
v_smfmac_f32_16x16x64_bf16 v[32:35], v[12:15], a[72:79], v3
v_smfmac_f32_16x16x64_bf16 v[36:39], v[12:15], a[104:111], v3
s_bitset0_b32 s32, 1
s_branch m_f3_al22
m_f3_ah32:
v_smfmac_f32_16x16x64_bf16 v[24:27], v[16:19], a[16:23], v3
v_smfmac_f32_16x16x64_bf16 v[28:31], v[16:19], a[48:55], v3
v_smfmac_f32_16x16x64_bf16 v[32:35], v[16:19], a[80:87], v3
v_smfmac_f32_16x16x64_bf16 v[36:39], v[16:19], a[112:119], v3
s_bitset0_b32 s32, 2
s_branch m_f3_al23
m_f3_ah33:
v_smfmac_f32_16x16x64_bf16 v[24:27], v[20:23], a[24:31], v3
v_smfmac_f32_16x16x64_bf16 v[28:31], v[20:23], a[56:63], v3
v_smfmac_f32_16x16x64_bf16 v[32:35], v[20:23], a[88:95], v3
v_smfmac_f32_16x16x64_bf16 v[36:39], v[20:23], a[120:127], v3
s_bitset0_b32 s32, 3
s_branch m_f3_al20
m_f3_al40:
s_waitcnt vmcnt(3)
v_cmp_eq_u32 vcc, -1, v8
s_cbranch_vccz m_f3_ah40
s_cmp_eq_u32 s17, 0
s_cbranch_scc1 m_f3_ah40
s_sub_u32 s17, s17, 1
buffer_load_dwordx4 v[8:11], v56, s[4:7], s19 offen offset:0 sc1
m_f3_al41:
s_waitcnt vmcnt(3)
v_cmp_eq_u32 vcc, -1, v12
s_cbranch_vccz m_f3_ah41
s_cmp_eq_u32 s17, 0
s_cbranch_scc1 m_f3_ah41
s_sub_u32 s17, s17, 1
buffer_load_dwordx4 v[12:15], v56, s[4:7], s19 offen offset:1024 sc1
m_f3_al42:
s_waitcnt vmcnt(3)
v_cmp_eq_u32 vcc, -1, v16
s_cbranch_vccz m_f3_ah42
s_cmp_eq_u32 s17, 0
s_cbranch_scc1 m_f3_ah42
s_sub_u32 s17, s17, 1
buffer_load_dwordx4 v[16:19], v56, s[4:7], s19 offen offset:2048 sc1
m_f3_al43:
s_waitcnt vmcnt(3)
v_cmp_eq_u32 vcc, -1, v20
s_cbranch_vccz m_f3_ah43
s_cmp_eq_u32 s17, 0
s_cbranch_scc1 m_f3_ah43
s_sub_u32 s17, s17, 1
buffer_load_dwordx4 v[20:23], v56, s[4:7], s19 offen offset:3072 sc1
s_branch m_f3_al40
m_f3_ah40:
v_smfmac_f32_16x16x64_bf16 v[24:27], v[8:11], a[0:7], v3
v_smfmac_f32_16x16x64_bf16 v[28:31], v[8:11], a[32:39], v3
v_smfmac_f32_16x16x64_bf16 v[32:35], v[8:11], a[64:71], v3
v_smfmac_f32_16x16x64_bf16 v[36:39], v[8:11], a[96:103], v3
s_bitset0_b32 s32, 0
s_branch m_f3_al31
m_f3_ah41:
v_smfmac_f32_16x16x64_bf16 v[24:27], v[12:15], a[8:15], v3
v_smfmac_f32_16x16x64_bf16 v[28:31], v[12:15], a[40:47], v3
v_smfmac_f32_16x16x64_bf16 v[32:35], v[12:15], a[72:79], v3
v_smfmac_f32_16x16x64_bf16 v[36:39], v[12:15], a[104:111], v3
s_bitset0_b32 s32, 1
s_branch m_f3_al32
m_f3_ah42:
v_smfmac_f32_16x16x64_bf16 v[24:27], v[16:19], a[16:23], v3
v_smfmac_f32_16x16x64_bf16 v[28:31], v[16:19], a[48:55], v3
v_smfmac_f32_16x16x64_bf16 v[32:35], v[16:19], a[80:87], v3
v_smfmac_f32_16x16x64_bf16 v[36:39], v[16:19], a[112:119], v3
s_bitset0_b32 s32, 2
s_branch m_f3_al33
m_f3_ah43:
v_smfmac_f32_16x16x64_bf16 v[24:27], v[20:23], a[24:31], v3
v_smfmac_f32_16x16x64_bf16 v[28:31], v[20:23], a[56:63], v3
v_smfmac_f32_16x16x64_bf16 v[32:35], v[20:23], a[88:95], v3
v_smfmac_f32_16x16x64_bf16 v[36:39], v[20:23], a[120:127], v3
s_bitset0_b32 s32, 3
s_branch m_f3_al30
m_f3_om0:
s_mov_b32 s32, 15
s_cmp_eq_u32 s17, 0
s_cbranch_scc1 m_f3_oh40
s_sub_u32 s17, s17, 1
buffer_load_dwordx4 v[8:11], v57, s[4:7], s19 offen offset:0 sc1
s_branch m_f3_ol41
m_f3_om1:
v_smfmac_f32_16x16x64_bf16 v[52:55], v[8:11], a[224:231], v3
s_mov_b32 s32, 14
s_cmp_eq_u32 s17, 0
s_cbranch_scc1 m_f3_oh31
s_sub_u32 s17, s17, 1
buffer_load_dwordx4 v[12:15], v57, s[4:7], s19 offen offset:1024 sc1
s_branch m_f3_ol32
m_f3_om2:
v_smfmac_f32_16x16x64_bf16 v[52:55], v[12:15], a[232:239], v3
s_mov_b32 s32, 12
s_cmp_eq_u32 s17, 0
s_cbranch_scc1 m_f3_oh22
s_sub_u32 s17, s17, 1
buffer_load_dwordx4 v[16:19], v57, s[4:7], s19 offen offset:2048 sc1
s_branch m_f3_ol23
m_f3_om3:
v_smfmac_f32_16x16x64_bf16 v[52:55], v[16:19], a[240:247], v3
s_mov_b32 s32, 8
s_cmp_eq_u32 s17, 0
s_cbranch_scc1 m_f3_oh13
s_sub_u32 s17, s17, 1
buffer_load_dwordx4 v[20:23], v57, s[4:7], s19 offen offset:3072 sc1
s_branch m_f3_ol10
m_f3_ol10:
s_bitcmp1_b32 s32, 0
s_cbranch_scc0 m_f3_ol11
s_waitcnt vmcnt(0)
v_cmp_eq_u32 vcc, -1, v8
s_cbranch_vccz m_f3_oh10
s_cmp_eq_u32 s17, 0
s_cbranch_scc1 m_f3_oh10
s_sub_u32 s17, s17, 1
buffer_load_dwordx4 v[8:11], v57, s[4:7], s19 offen offset:0 sc1
m_f3_ol11:
s_bitcmp1_b32 s32, 1
s_cbranch_scc0 m_f3_ol12
s_waitcnt vmcnt(0)
v_cmp_eq_u32 vcc, -1, v12
s_cbranch_vccz m_f3_oh11
s_cmp_eq_u32 s17, 0
s_cbranch_scc1 m_f3_oh11
s_sub_u32 s17, s17, 1
buffer_load_dwordx4 v[12:15], v57, s[4:7], s19 offen offset:1024 sc1
m_f3_ol12:
s_bitcmp1_b32 s32, 2
s_cbranch_scc0 m_f3_ol13
s_waitcnt vmcnt(0)
v_cmp_eq_u32 vcc, -1, v16
s_cbranch_vccz m_f3_oh12
s_cmp_eq_u32 s17, 0
s_cbranch_scc1 m_f3_oh12
s_sub_u32 s17, s17, 1
buffer_load_dwordx4 v[16:19], v57, s[4:7], s19 offen offset:2048 sc1
m_f3_ol13:
s_bitcmp1_b32 s32, 3
s_cbranch_scc0 m_f3_ol10
s_waitcnt vmcnt(0)
v_cmp_eq_u32 vcc, -1, v20
s_cbranch_vccz m_f3_oh13
s_cmp_eq_u32 s17, 0
s_cbranch_scc1 m_f3_oh13
s_sub_u32 s17, s17, 1
buffer_load_dwordx4 v[20:23], v57, s[4:7], s19 offen offset:3072 sc1
s_branch m_f3_ol10
m_f3_oh10:
v_smfmac_f32_16x16x64_bf16 v[48:51], v[8:11], a[192:199], v3
v_smfmac_f32_16x16x64_bf16 v[52:55], v[8:11], a[224:231], v3
s_branch m_f3_ob
m_f3_oh11:
v_smfmac_f32_16x16x64_bf16 v[48:51], v[12:15], a[200:207], v3
v_smfmac_f32_16x16x64_bf16 v[52:55], v[12:15], a[232:239], v3
s_branch m_f3_ob
m_f3_oh12:
v_smfmac_f32_16x16x64_bf16 v[48:51], v[16:19], a[208:215], v3
v_smfmac_f32_16x16x64_bf16 v[52:55], v[16:19], a[240:247], v3
s_branch m_f3_ob
m_f3_oh13:
v_smfmac_f32_16x16x64_bf16 v[48:51], v[20:23], a[216:223], v3
v_smfmac_f32_16x16x64_bf16 v[52:55], v[20:23], a[248:255], v3
s_branch m_f3_ob
m_f3_ol20:
s_bitcmp1_b32 s32, 0
s_cbranch_scc0 m_f3_ol21
s_waitcnt vmcnt(1)
v_cmp_eq_u32 vcc, -1, v8
s_cbranch_vccz m_f3_oh20
s_cmp_eq_u32 s17, 0
s_cbranch_scc1 m_f3_oh20
s_sub_u32 s17, s17, 1
buffer_load_dwordx4 v[8:11], v57, s[4:7], s19 offen offset:0 sc1
m_f3_ol21:
s_bitcmp1_b32 s32, 1
s_cbranch_scc0 m_f3_ol22
s_waitcnt vmcnt(1)
v_cmp_eq_u32 vcc, -1, v12
s_cbranch_vccz m_f3_oh21
s_cmp_eq_u32 s17, 0
s_cbranch_scc1 m_f3_oh21
s_sub_u32 s17, s17, 1
buffer_load_dwordx4 v[12:15], v57, s[4:7], s19 offen offset:1024 sc1
m_f3_ol22:
s_bitcmp1_b32 s32, 2
s_cbranch_scc0 m_f3_ol23
s_waitcnt vmcnt(1)
v_cmp_eq_u32 vcc, -1, v16
s_cbranch_vccz m_f3_oh22
s_cmp_eq_u32 s17, 0
s_cbranch_scc1 m_f3_oh22
s_sub_u32 s17, s17, 1
buffer_load_dwordx4 v[16:19], v57, s[4:7], s19 offen offset:2048 sc1
m_f3_ol23:
s_bitcmp1_b32 s32, 3
s_cbranch_scc0 m_f3_ol20
s_waitcnt vmcnt(1)
v_cmp_eq_u32 vcc, -1, v20
s_cbranch_vccz m_f3_oh23
s_cmp_eq_u32 s17, 0
s_cbranch_scc1 m_f3_oh23
s_sub_u32 s17, s17, 1
buffer_load_dwordx4 v[20:23], v57, s[4:7], s19 offen offset:3072 sc1
s_branch m_f3_ol20
m_f3_oh20:
v_smfmac_f32_16x16x64_bf16 v[48:51], v[8:11], a[192:199], v3
v_smfmac_f32_16x16x64_bf16 v[52:55], v[8:11], a[224:231], v3
s_bitset0_b32 s32, 0
s_branch m_f3_ol11
m_f3_oh21:
v_smfmac_f32_16x16x64_bf16 v[48:51], v[12:15], a[200:207], v3
v_smfmac_f32_16x16x64_bf16 v[52:55], v[12:15], a[232:239], v3
s_bitset0_b32 s32, 1
s_branch m_f3_ol12
m_f3_oh22:
v_smfmac_f32_16x16x64_bf16 v[48:51], v[16:19], a[208:215], v3
v_smfmac_f32_16x16x64_bf16 v[52:55], v[16:19], a[240:247], v3
s_bitset0_b32 s32, 2
s_branch m_f3_ol13
m_f3_oh23:
v_smfmac_f32_16x16x64_bf16 v[48:51], v[20:23], a[216:223], v3
v_smfmac_f32_16x16x64_bf16 v[52:55], v[20:23], a[248:255], v3
s_bitset0_b32 s32, 3
s_branch m_f3_ol10
m_f3_ol30:
s_bitcmp1_b32 s32, 0
s_cbranch_scc0 m_f3_ol31
s_waitcnt vmcnt(2)
v_cmp_eq_u32 vcc, -1, v8
s_cbranch_vccz m_f3_oh30
s_cmp_eq_u32 s17, 0
s_cbranch_scc1 m_f3_oh30
s_sub_u32 s17, s17, 1
buffer_load_dwordx4 v[8:11], v57, s[4:7], s19 offen offset:0 sc1
m_f3_ol31:
s_bitcmp1_b32 s32, 1
s_cbranch_scc0 m_f3_ol32
s_waitcnt vmcnt(2)
v_cmp_eq_u32 vcc, -1, v12
s_cbranch_vccz m_f3_oh31
s_cmp_eq_u32 s17, 0
s_cbranch_scc1 m_f3_oh31
s_sub_u32 s17, s17, 1
buffer_load_dwordx4 v[12:15], v57, s[4:7], s19 offen offset:1024 sc1
m_f3_ol32:
s_bitcmp1_b32 s32, 2
s_cbranch_scc0 m_f3_ol33
s_waitcnt vmcnt(2)
v_cmp_eq_u32 vcc, -1, v16
s_cbranch_vccz m_f3_oh32
s_cmp_eq_u32 s17, 0
s_cbranch_scc1 m_f3_oh32
s_sub_u32 s17, s17, 1
buffer_load_dwordx4 v[16:19], v57, s[4:7], s19 offen offset:2048 sc1
m_f3_ol33:
s_bitcmp1_b32 s32, 3
s_cbranch_scc0 m_f3_ol30
s_waitcnt vmcnt(2)
v_cmp_eq_u32 vcc, -1, v20
s_cbranch_vccz m_f3_oh33
s_cmp_eq_u32 s17, 0
s_cbranch_scc1 m_f3_oh33
s_sub_u32 s17, s17, 1
buffer_load_dwordx4 v[20:23], v57, s[4:7], s19 offen offset:3072 sc1
s_branch m_f3_ol30
m_f3_oh30:
v_smfmac_f32_16x16x64_bf16 v[48:51], v[8:11], a[192:199], v3
v_smfmac_f32_16x16x64_bf16 v[52:55], v[8:11], a[224:231], v3
s_bitset0_b32 s32, 0
s_branch m_f3_ol21
m_f3_oh31:
v_smfmac_f32_16x16x64_bf16 v[48:51], v[12:15], a[200:207], v3
v_smfmac_f32_16x16x64_bf16 v[52:55], v[12:15], a[232:239], v3
s_bitset0_b32 s32, 1
s_branch m_f3_ol22
m_f3_oh32:
v_smfmac_f32_16x16x64_bf16 v[48:51], v[16:19], a[208:215], v3
v_smfmac_f32_16x16x64_bf16 v[52:55], v[16:19], a[240:247], v3
s_bitset0_b32 s32, 2
s_branch m_f3_ol23
m_f3_oh33:
v_smfmac_f32_16x16x64_bf16 v[48:51], v[20:23], a[216:223], v3
v_smfmac_f32_16x16x64_bf16 v[52:55], v[20:23], a[248:255], v3
s_bitset0_b32 s32, 3
s_branch m_f3_ol20
m_f3_ol40:
s_waitcnt vmcnt(3)
v_cmp_eq_u32 vcc, -1, v8
s_cbranch_vccz m_f3_oh40
s_cmp_eq_u32 s17, 0
s_cbranch_scc1 m_f3_oh40
s_sub_u32 s17, s17, 1
buffer_load_dwordx4 v[8:11], v57, s[4:7], s19 offen offset:0 sc1
m_f3_ol41:
s_waitcnt vmcnt(3)
v_cmp_eq_u32 vcc, -1, v12
s_cbranch_vccz m_f3_oh41
s_cmp_eq_u32 s17, 0
s_cbranch_scc1 m_f3_oh41
s_sub_u32 s17, s17, 1
buffer_load_dwordx4 v[12:15], v57, s[4:7], s19 offen offset:1024 sc1
m_f3_ol42:
s_waitcnt vmcnt(3)
v_cmp_eq_u32 vcc, -1, v16
s_cbranch_vccz m_f3_oh42
s_cmp_eq_u32 s17, 0
s_cbranch_scc1 m_f3_oh42
s_sub_u32 s17, s17, 1
buffer_load_dwordx4 v[16:19], v57, s[4:7], s19 offen offset:2048 sc1
m_f3_ol43:
s_waitcnt vmcnt(3)
v_cmp_eq_u32 vcc, -1, v20
s_cbranch_vccz m_f3_oh43
s_cmp_eq_u32 s17, 0
s_cbranch_scc1 m_f3_oh43
s_sub_u32 s17, s17, 1
buffer_load_dwordx4 v[20:23], v57, s[4:7], s19 offen offset:3072 sc1
s_branch m_f3_ol40
m_f3_oh40:
v_smfmac_f32_16x16x64_bf16 v[48:51], v[8:11], a[192:199], v3
v_smfmac_f32_16x16x64_bf16 v[52:55], v[8:11], a[224:231], v3
s_bitset0_b32 s32, 0
s_branch m_f3_ol31
m_f3_oh41:
v_smfmac_f32_16x16x64_bf16 v[48:51], v[12:15], a[200:207], v3
v_smfmac_f32_16x16x64_bf16 v[52:55], v[12:15], a[232:239], v3
s_bitset0_b32 s32, 1
s_branch m_f3_ol32
m_f3_oh42:
v_smfmac_f32_16x16x64_bf16 v[48:51], v[16:19], a[208:215], v3
v_smfmac_f32_16x16x64_bf16 v[52:55], v[16:19], a[240:247], v3
s_bitset0_b32 s32, 2
s_branch m_f3_ol33
m_f3_oh43:
v_smfmac_f32_16x16x64_bf16 v[48:51], v[20:23], a[216:223], v3
v_smfmac_f32_16x16x64_bf16 v[52:55], v[20:23], a[248:255], v3
s_bitset0_b32 s32, 3
s_branch m_f3_ol30
m_f3_rw:
v_cmp_ne_u32 vcc, 0, v70
s_and_b32 s30, vcc_lo, 30720
s_cmp_eq_u32 s30, 30720
s_cbranch_scc1 m_f3_rwd
s_cmp_eq_u32 s17, 0
s_cbranch_scc1 m_f3_rwd
s_sub_u32 s17, s17, 1
buffer_load_dword v70, v69, s[8:11], 0 offen sc1
s_waitcnt vmcnt(0)
s_branch m_f3_rw
m_f3_kvw:
v_mov_b32 v77, 0
m_f3_kv:
buffer_load_dword v75, v77, s[4:7], s64 offen sc1
s_waitcnt vmcnt(0)
v_readfirstlane_b32 s30, v75
s_cmp_ge_u32 s30, 16
s_cbranch_scc1 m_f3_kv_d
s_cmp_eq_u32 s17, 0
s_cbranch_scc1 m_f3_kv_d
s_sub_u32 s17, s17, 1
s_branch m_f3_kv
m_f3_fin:
s_waitcnt vmcnt(0)
s_barrier
v_mov_b32 v76, 1
buffer_atomic_add v76, v68, s[4:7], 0 offen sc0
s_and_b32 s26, s12, 1
s_lshr_b32 s27, s12, 1
s_lshl_b32 s27, s27, 2
s_add_u32 s26, s26, s27
s_lshl_b32 s26, s26, 12
s_xor_b32 s27, s65, 8192
s_add_u32 s26, s26, s27
s_add_u32 s26, s26, 170983424
v_mov_b32 v77, 2147483648
v_cmp_gt_u32 vcc, 32, v0
s_waitcnt vmcnt(0)
v_readfirstlane_b32 s27, v76
v_mov_b32 v76, 64
s_cmp_eq_u32 s27, 31
s_cselect_b32 s26, s26, 2147483648
v_lshl_add_u32 v68, v0, 7, s26
v_cndmask_b32 v68, v77, v68, vcc
buffer_store_dword v76, v68, s[4:7], 0 offen sc1
s_branch m_recdone
m_safe3:
m_s3_top:
s_waitcnt vmcnt(3)
v_cmp_eq_u32 vcc, -1, v8
s_cbranch_vccnz m_s3_am0
v_smfmac_f32_16x16x64_bf16 v[24:27], v[8:11], a[0:7], v3
v_smfmac_f32_16x16x64_bf16 v[28:31], v[8:11], a[32:39], v3
s_waitcnt vmcnt(2)
v_cmp_eq_u32 vcc, -1, v12
v_smfmac_f32_16x16x64_bf16 v[32:35], v[8:11], a[64:71], v3
s_cbranch_vccnz m_s3_am1
v_smfmac_f32_16x16x64_bf16 v[36:39], v[8:11], a[96:103], v3
v_smfmac_f32_16x16x64_bf16 v[24:27], v[12:15], a[8:15], v3
v_smfmac_f32_16x16x64_bf16 v[28:31], v[12:15], a[40:47], v3
s_waitcnt vmcnt(1)
v_cmp_eq_u32 vcc, -1, v16
v_smfmac_f32_16x16x64_bf16 v[32:35], v[12:15], a[72:79], v3
s_cbranch_vccnz m_s3_am2
v_smfmac_f32_16x16x64_bf16 v[36:39], v[12:15], a[104:111], v3
v_smfmac_f32_16x16x64_bf16 v[24:27], v[16:19], a[16:23], v3
v_smfmac_f32_16x16x64_bf16 v[28:31], v[16:19], a[48:55], v3
s_waitcnt vmcnt(0)
v_cmp_eq_u32 vcc, -1, v20
v_smfmac_f32_16x16x64_bf16 v[32:35], v[16:19], a[80:87], v3
s_cbranch_vccnz m_s3_am3
v_smfmac_f32_16x16x64_bf16 v[36:39], v[16:19], a[112:119], v3
v_smfmac_f32_16x16x64_bf16 v[24:27], v[20:23], a[24:31], v3
v_smfmac_f32_16x16x64_bf16 v[28:31], v[20:23], a[56:63], v3
v_smfmac_f32_16x16x64_bf16 v[32:35], v[20:23], a[88:95], v3
v_smfmac_f32_16x16x64_bf16 v[36:39], v[20:23], a[120:127], v3
m_s3_ab:
v_smfmac_f32_16x16x64_bf16 v[40:43], v[8:11], a[128:135], v3
v_pk_add_f32 v[24:25], v[24:25], v[26:27]
v_pk_add_f32 v[28:29], v[28:29], v[30:31]
ds_write2_b32 v58, v24, v25 offset0:80 offset1:120
ds_write2_b32 v58, v28, v29 offset0:96 offset1:136
v_smfmac_f32_16x16x64_bf16 v[44:47], v[8:11], a[160:167], v3
v_pk_add_f32 v[32:33], v[32:33], v[34:35]
v_pk_add_f32 v[36:37], v[36:37], v[38:39]
ds_write2_b32 v58, v32, v33 offset0:0 offset1:40
ds_write2_b32 v58, v36, v37 offset0:16 offset1:56
s_and_b32 s30, s18, 3
s_lshl_b32 s19, s30, 19
s_add_u32 s19, s19, 167772160
v_smfmac_f32_16x16x64_bf16 v[40:43], v[12:15], a[136:143], v3
v_smfmac_f32_16x16x64_bf16 v[44:47], v[12:15], a[168:175], v3
s_waitcnt lgkmcnt(0)
s_barrier
v_smfmac_f32_16x16x64_bf16 v[40:43], v[16:19], a[144:151], v3
v_smfmac_f32_16x16x64_bf16 v[44:47], v[16:19], a[176:183], v3
v_smfmac_f32_16x16x64_bf16 v[40:43], v[20:23], a[152:159], v3
v_smfmac_f32_16x16x64_bf16 v[44:47], v[20:23], a[184:191], v3
s_nop 4
v_pk_add_f32 v[96:97], v[40:41], v[42:43]
s_nop 1
v_pk_add_f32 v[98:99], v[44:45], v[46:47]
ds_write_b128 v59, v[96:99] offset:15360
s_waitcnt lgkmcnt(0)
s_barrier
s_cmp_eq_u32 s18, 63
s_cbranch_scc1 m_s3_fin
v_mov_b64 v[24:25], 0
v_mov_b64 v[26:27], 0
v_mov_b64 v[28:29], 0
v_mov_b64 v[30:31], 0
v_mov_b64 v[32:33], 0
v_mov_b64 v[34:35], 0
v_mov_b64 v[36:37], 0
v_mov_b64 v[38:39], 0
v_mov_b64 v[40:41], 0
v_mov_b64 v[42:43], 0
v_mov_b64 v[44:45], 0
v_mov_b64 v[46:47], 0
s_cmp_ge_u32 s18, 15
s_cbranch_scc1 m_s3_ow0
ds_read_b128 v[104:107], v59 offset:40960
ds_read_b128 v[108:111], v59 offset:41984
ds_read_b128 v[112:115], v59 offset:43008
ds_read_b128 v[116:119], v59 offset:44032
ds_read_b128 v[120:123], v59 offset:45056
ds_read_b128 v[124:127], v59 offset:46080
ds_read_b128 v[128:131], v59 offset:47104
ds_read_b128 v[132:135], v59 offset:48128
v_mfma_f32_16x16x32_bf16 v[208:211], a[64:67], v[144:147], 0
v_mfma_f32_16x16x32_bf16 v[224:227], v[144:147], a[128:131], 0
v_mfma_f32_16x16x32_bf16 v[212:215], a[96:99], v[144:147], 0
v_mfma_f32_16x16x32_bf16 v[232:235], v[144:147], a[160:163], 0
v_mfma_f32_16x16x32_bf16 v[216:219], a[64:67], v[148:151], 0
v_mfma_f32_16x16x32_bf16 v[228:231], v[148:151], a[128:131], 0
v_mfma_f32_16x16x32_bf16 v[220:223], a[96:99], v[148:151], 0
s_waitcnt lgkmcnt(4)
v_pk_add_f32 v[104:105], v[104:105], v[112:113]
v_pk_add_f32 v[106:107], v[106:107], v[114:115]
v_mfma_f32_16x16x32_bf16 v[236:239], v[148:151], a[160:163], 0
v_pk_add_f32 v[108:109], v[108:109], v[116:117]
v_pk_add_f32 v[110:111], v[110:111], v[118:119]
s_waitcnt lgkmcnt(2)
v_mfma_f32_16x16x32_bf16 v[208:211], a[68:71], v[152:155], v[208:211]
v_pk_add_f32 v[104:105], v[104:105], v[120:121]
v_pk_add_f32 v[106:107], v[106:107], v[122:123]
v_pk_add_f32 v[108:109], v[108:109], v[124:125]
v_mfma_f32_16x16x32_bf16 v[224:227], v[152:155], a[132:135], v[224:227]
v_pk_add_f32 v[110:111], v[110:111], v[126:127]
s_waitcnt lgkmcnt(0)
v_pk_add_f32 v[104:105], v[104:105], v[128:129]
v_mfma_f32_16x16x32_bf16 v[212:215], a[100:103], v[152:155], v[212:215]
v_pk_add_f32 v[106:107], v[106:107], v[130:131]
v_pk_add_f32 v[108:109], v[108:109], v[132:133]
v_pk_add_f32 v[110:111], v[110:111], v[134:135]
v_mfma_f32_16x16x32_bf16 v[232:235], v[152:155], a[164:167], v[232:235]
v_cvt_pk_bf16_f32 v136, v104, v105
v_cvt_pk_bf16_f32 v137, v106, v107
v_cvt_pk_bf16_f32 v138, v108, v109
v_cvt_pk_bf16_f32 v139, v110, v111
s_nop 0
v_permlane32_swap_b32 v136, v138
v_permlane32_swap_b32 v137, v139
ds_write_b128 v74, v[136:139] offset:25600
ds_read_b128 v[104:107], v59 offset:57344
ds_read_b128 v[108:111], v59 offset:58368
ds_read_b128 v[112:115], v59 offset:59392
ds_read_b128 v[116:119], v59 offset:60416
ds_read_b128 v[120:123], v59 offset:61440
ds_read_b128 v[124:127], v59 offset:62464
ds_read_b128 v[128:131], v59 offset:63488
ds_read_b128 v[132:135], v59 offset:64512
v_mfma_f32_16x16x32_bf16 v[216:219], a[68:71], v[156:159], v[216:219]
v_mfma_f32_16x16x32_bf16 v[228:231], v[156:159], a[132:135], v[228:231]
v_mfma_f32_16x16x32_bf16 v[220:223], a[100:103], v[156:159], v[220:223]
v_mfma_f32_16x16x32_bf16 v[236:239], v[156:159], a[164:167], v[236:239]
v_mfma_f32_16x16x32_bf16 v[208:211], a[72:75], v[160:163], v[208:211]
v_mfma_f32_16x16x32_bf16 v[224:227], v[160:163], a[136:139], v[224:227]
v_mfma_f32_16x16x32_bf16 v[212:215], a[104:107], v[160:163], v[212:215]
s_waitcnt lgkmcnt(4)
v_pk_add_f32 v[104:105], v[104:105], v[112:113]
v_pk_add_f32 v[106:107], v[106:107], v[114:115]
v_mfma_f32_16x16x32_bf16 v[232:235], v[160:163], a[168:171], v[232:235]
v_pk_add_f32 v[108:109], v[108:109], v[116:117]
v_pk_add_f32 v[110:111], v[110:111], v[118:119]
s_waitcnt lgkmcnt(2)
v_mfma_f32_16x16x32_bf16 v[216:219], a[72:75], v[164:167], v[216:219]
v_pk_add_f32 v[104:105], v[104:105], v[120:121]
v_pk_add_f32 v[106:107], v[106:107], v[122:123]
v_pk_add_f32 v[108:109], v[108:109], v[124:125]
v_mfma_f32_16x16x32_bf16 v[228:231], v[164:167], a[136:139], v[228:231]
v_pk_add_f32 v[110:111], v[110:111], v[126:127]
s_waitcnt lgkmcnt(0)
v_pk_add_f32 v[104:105], v[104:105], v[128:129]
v_mfma_f32_16x16x32_bf16 v[220:223], a[104:107], v[164:167], v[220:223]
v_pk_add_f32 v[106:107], v[106:107], v[130:131]
v_pk_add_f32 v[108:109], v[108:109], v[132:133]
v_pk_add_f32 v[110:111], v[110:111], v[134:135]
v_mfma_f32_16x16x32_bf16 v[236:239], v[164:167], a[168:171], v[236:239]
v_cvt_pk_bf16_f32 v140, v104, v105
v_cvt_pk_bf16_f32 v141, v106, v107
v_cvt_pk_bf16_f32 v142, v108, v109
v_cvt_pk_bf16_f32 v143, v110, v111
ds_write_b128 v74, v[140:143] offset:27648
m_s3_ow0:
v_xor_b32 v74, 4096, v74
s_barrier
buffer_load_dwordx4 v[8:11], v57, s[4:7], s19 offen offset:0 sc1
buffer_load_dwordx4 v[12:15], v57, s[4:7], s19 offen offset:1024 sc1
buffer_load_dwordx4 v[16:19], v57, s[4:7], s19 offen offset:2048 sc1
buffer_load_dwordx4 v[20:23], v57, s[4:7], s19 offen offset:3072 sc1
s_waitcnt vmcnt(3)
v_cmp_eq_u32 vcc, -1, v8
s_cbranch_vccnz m_s3_om0
v_smfmac_f32_16x16x64_bf16 v[48:51], v[8:11], a[192:199], v3
s_waitcnt vmcnt(2)
v_cmp_eq_u32 vcc, -1, v12
s_cbranch_vccnz m_s3_om1
v_smfmac_f32_16x16x64_bf16 v[52:55], v[8:11], a[224:231], v3
v_smfmac_f32_16x16x64_bf16 v[48:51], v[12:15], a[200:207], v3
s_waitcnt vmcnt(1)
v_cmp_eq_u32 vcc, -1, v16
s_cbranch_vccnz m_s3_om2
v_smfmac_f32_16x16x64_bf16 v[52:55], v[12:15], a[232:239], v3
v_smfmac_f32_16x16x64_bf16 v[48:51], v[16:19], a[208:215], v3
s_waitcnt vmcnt(0)
v_cmp_eq_u32 vcc, -1, v20
s_cbranch_vccnz m_s3_om3
v_smfmac_f32_16x16x64_bf16 v[52:55], v[16:19], a[240:247], v3
v_smfmac_f32_16x16x64_bf16 v[48:51], v[20:23], a[216:223], v3
v_smfmac_f32_16x16x64_bf16 v[52:55], v[20:23], a[248:255], v3
m_s3_ob:
s_nop 4
v_pk_add_f32 v[96:97], v[48:49], v[50:51]
s_nop 1
v_pk_add_f32 v[98:99], v[52:53], v[54:55]
ds_write2_b32 v240, v96, v97 offset0:0 offset1:72
ds_write2_b32 v240, v98, v99 offset0:160 offset1:232
s_cmp_ge_u32 s18, 15
s_cbranch_scc1 m_s3_ow1
s_lshr_b32 s29, s61, 8
s_xnor_b32 s29, s29, s65
s_and_b32 s29, s29, 8192
s_add_u32 s29, s29, s61
s_add_u32 s28, s29, 33554432
s_add_u32 s61, s61, 524288
buffer_store_dwordx4 v[136:139], v244, s[4:7], s29 offen offset:256 sc1
buffer_store_dwordx4 v[140:143], v244, s[4:7], s28 offen offset:256 sc1
buffer_load_dword v245, v67, s[4:7], s63 offen
s_add_u32 s63, s63, 65536
s_cmp_eq_u32 s18, 3
s_cselect_b32 s63, 176685056, s63
m_s3_ow1:
s_sub_u32 s30, s18, 13
s_cmp_ge_u32 s30, 49
s_cbranch_scc1 m_s3_ntk
s_cmp_eq_u32 s30, 0
s_cbranch_scc1 m_s3_kvf
v_readfirstlane_b32 s30, v75
s_cmp_lt_u32 s30, 16
s_cbranch_scc1 m_s3_kvw
m_s3_kv_d:
s_lshr_b32 s29, s62, 8
s_xor_b32 s29, s29, s65
s_and_b32 s29, s29, 8192
s_add_u32 s29, s29, s62
s_add_u32 s28, s29, 33554432
s_add_u32 m0, s68, 0
s_nop 0
buffer_load_dwordx4 v66, s[4:7], s29 offen offset:0 sc1 lds
s_add_u32 m0, s68, 768
s_nop 0
buffer_load_dwordx4 v66, s[4:7], s29 offen offset:256 sc1 lds
s_add_u32 m0, s68, 2048
s_nop 0
buffer_load_dwordx4 v66, s[4:7], s28 offen offset:0 sc1 lds
s_add_u32 m0, s68, 2816
s_nop 0
buffer_load_dwordx4 v66, s[4:7], s28 offen offset:256 sc1 lds
s_add_u32 s62, s62, 524288
s_xor_b32 s68, s68, 4096
m_s3_kvf:
s_add_u32 s30, s18, 3
s_and_b32 s30, s30, 7
s_cbranch_scc1 m_s3_ntk
s_cselect_b32 s30, 0, 1024
s_add_u32 s64, s64, s30
v_mov_b32 v77, 0
buffer_load_dword v75, v77, s[4:7], s64 offen sc1
m_s3_ntk:
s_waitcnt lgkmcnt(0)
s_barrier
v_mov_b64 v[48:49], 0
v_mov_b64 v[50:51], 0
v_mov_b64 v[52:53], 0
v_mov_b64 v[54:55], 0
s_cmp_ge_u32 s18, 15
s_cbranch_scc1 m_s3_ow2
v_mfma_f32_16x16x32_bf16 v[208:211], a[76:79], v[168:171], v[208:211]
v_mfma_f32_16x16x32_bf16 v[224:227], v[168:171], a[140:143], v[224:227]
s_add_u32 s28, s60, 0
buffer_load_dwordx4 v[144:147], v241, s[4:7], s28 offen offset:0
v_mfma_f32_16x16x32_bf16 v[212:215], a[108:111], v[168:171], v[212:215]
s_add_u32 s28, s60, 4294918144
s_add_u32 m0, s69, 0
s_nop 0
buffer_load_dwordx4 v241, s[4:7], s28 offen offset:0 lds
v_mfma_f32_16x16x32_bf16 v[232:235], v[168:171], a[172:175], v[232:235]
s_add_u32 s28, s60, 4294918144
s_add_u32 m0, s69, 768
s_nop 0
buffer_load_dwordx4 v241, s[4:7], s28 offen offset:256 lds
v_mfma_f32_16x16x32_bf16 v[216:219], a[76:79], v[172:175], v[216:219]
v_mfma_f32_16x16x32_bf16 v[228:231], v[172:175], a[140:143], v[228:231]
s_add_u32 s28, s60, 4096
buffer_load_dwordx4 v[168:171], v241, s[4:7], s28 offen offset:2048
s_add_u32 s28, s60, 0
buffer_load_dwordx4 v[148:151], v241, s[4:7], s28 offen offset:256
v_mfma_f32_16x16x32_bf16 v[220:223], a[108:111], v[172:175], v[220:223]
s_add_u32 s28, s60, 4294918144
s_add_u32 m0, s69, 0
s_nop 0
buffer_load_dwordx4 v241, s[4:7], s28 offen offset:2048 lds
v_mfma_f32_16x16x32_bf16 v[236:239], v[172:175], a[172:175], v[236:239]
s_add_u32 s28, s60, 4294918144
s_add_u32 m0, s69, 768
s_nop 0
buffer_load_dwordx4 v241, s[4:7], s28 offen offset:2304 lds
v_mfma_f32_16x16x32_bf16 v[208:211], a[80:83], v[176:179], v[208:211]
v_mfma_f32_16x16x32_bf16 v[224:227], v[176:179], a[144:147], v[224:227]
s_add_u32 s28, s60, 4096
buffer_load_dwordx4 v[172:175], v241, s[4:7], s28 offen offset:2304
s_add_u32 s28, s60, 0
buffer_load_dwordx4 v[152:155], v241, s[4:7], s28 offen offset:2048
v_mfma_f32_16x16x32_bf16 v[212:215], a[112:115], v[176:179], v[212:215]
s_add_u32 s28, s60, 4294922240
s_add_u32 m0, s69, 4096
s_nop 0
buffer_load_dwordx4 v241, s[4:7], s28 offen offset:0 lds
v_mfma_f32_16x16x32_bf16 v[232:235], v[176:179], a[176:179], v[232:235]
s_add_u32 s28, s60, 4294922240
s_add_u32 m0, s69, 4864
s_nop 0
buffer_load_dwordx4 v241, s[4:7], s28 offen offset:256 lds
v_mfma_f32_16x16x32_bf16 v[216:219], a[80:83], v[180:183], v[216:219]
v_mfma_f32_16x16x32_bf16 v[228:231], v[180:183], a[144:147], v[228:231]
s_add_u32 s28, s60, 8192
buffer_load_dwordx4 v[176:179], v241, s[4:7], s28 offen offset:0
s_add_u32 s28, s60, 0
buffer_load_dwordx4 v[156:159], v241, s[4:7], s28 offen offset:2304
v_mfma_f32_16x16x32_bf16 v[220:223], a[112:115], v[180:183], v[220:223]
s_add_u32 s28, s60, 4294922240
s_add_u32 m0, s69, 4096
s_nop 0
buffer_load_dwordx4 v241, s[4:7], s28 offen offset:2048 lds
v_mfma_f32_16x16x32_bf16 v[236:239], v[180:183], a[176:179], v[236:239]
s_add_u32 s28, s60, 4294922240
s_add_u32 m0, s69, 4864
s_nop 0
buffer_load_dwordx4 v241, s[4:7], s28 offen offset:2304 lds
v_mfma_f32_16x16x32_bf16 v[208:211], a[84:87], v[184:187], v[208:211]
v_mfma_f32_16x16x32_bf16 v[224:227], v[184:187], a[148:151], v[224:227]
s_add_u32 s28, s60, 8192
buffer_load_dwordx4 v[180:183], v241, s[4:7], s28 offen offset:256
s_add_u32 s28, s60, 4096
buffer_load_dwordx4 v[160:163], v241, s[4:7], s28 offen offset:0
v_mfma_f32_16x16x32_bf16 v[212:215], a[116:119], v[184:187], v[212:215]
s_add_u32 s28, s60, 4294926336
s_add_u32 m0, s69, 8192
s_nop 0
buffer_load_dwordx4 v241, s[4:7], s28 offen offset:0 lds
v_mfma_f32_16x16x32_bf16 v[232:235], v[184:187], a[180:183], v[232:235]
s_add_u32 s28, s60, 4294926336
s_add_u32 m0, s69, 8960
s_nop 0
buffer_load_dwordx4 v241, s[4:7], s28 offen offset:256 lds
v_mfma_f32_16x16x32_bf16 v[216:219], a[84:87], v[188:191], v[216:219]
v_mfma_f32_16x16x32_bf16 v[228:231], v[188:191], a[148:151], v[228:231]
s_add_u32 s28, s60, 8192
buffer_load_dwordx4 v[184:187], v241, s[4:7], s28 offen offset:2048
s_add_u32 s28, s60, 4096
buffer_load_dwordx4 v[164:167], v241, s[4:7], s28 offen offset:256
v_mfma_f32_16x16x32_bf16 v[220:223], a[116:119], v[188:191], v[220:223]
s_add_u32 s28, s60, 4294926336
s_add_u32 m0, s69, 8192
s_nop 0
buffer_load_dwordx4 v241, s[4:7], s28 offen offset:2048 lds
v_mfma_f32_16x16x32_bf16 v[236:239], v[188:191], a[180:183], v[236:239]
s_add_u32 s28, s60, 4294926336
s_add_u32 m0, s69, 8960
s_nop 0
buffer_load_dwordx4 v241, s[4:7], s28 offen offset:2304 lds
v_mfma_f32_16x16x32_bf16 v[208:211], a[88:91], v[192:195], v[208:211]
v_mfma_f32_16x16x32_bf16 v[224:227], v[192:195], a[152:155], v[224:227]
s_add_u32 s28, s60, 8192
buffer_load_dwordx4 v[188:191], v241, s[4:7], s28 offen offset:2304
v_mfma_f32_16x16x32_bf16 v[212:215], a[120:123], v[192:195], v[212:215]
s_add_u32 s28, s60, 4294930432
s_add_u32 m0, s69, 12288
s_nop 0
buffer_load_dwordx4 v241, s[4:7], s28 offen offset:0 lds
v_mfma_f32_16x16x32_bf16 v[232:235], v[192:195], a[184:187], v[232:235]
s_add_u32 s28, s60, 4294930432
s_add_u32 m0, s69, 13056
s_nop 0
buffer_load_dwordx4 v241, s[4:7], s28 offen offset:256 lds
v_mfma_f32_16x16x32_bf16 v[216:219], a[88:91], v[196:199], v[216:219]
v_mfma_f32_16x16x32_bf16 v[228:231], v[196:199], a[152:155], v[228:231]
s_add_u32 s28, s60, 12288
buffer_load_dwordx4 v[192:195], v241, s[4:7], s28 offen offset:0
v_mfma_f32_16x16x32_bf16 v[220:223], a[120:123], v[196:199], v[220:223]
s_add_u32 s28, s60, 4294930432
s_add_u32 m0, s69, 12288
s_nop 0
buffer_load_dwordx4 v241, s[4:7], s28 offen offset:2048 lds
v_mfma_f32_16x16x32_bf16 v[236:239], v[196:199], a[184:187], v[236:239]
s_add_u32 s28, s60, 4294930432
s_add_u32 m0, s69, 13056
s_nop 0
buffer_load_dwordx4 v241, s[4:7], s28 offen offset:2304 lds
v_mfma_f32_16x16x32_bf16 v[208:211], a[92:95], v[200:203], v[208:211]
v_mfma_f32_16x16x32_bf16 v[224:227], v[200:203], a[156:159], v[224:227]
s_add_u32 s28, s60, 12288
buffer_load_dwordx4 v[196:199], v241, s[4:7], s28 offen offset:256
v_mfma_f32_16x16x32_bf16 v[212:215], a[124:127], v[200:203], v[212:215]
v_mfma_f32_16x16x32_bf16 v[232:235], v[200:203], a[188:191], v[232:235]
v_mfma_f32_16x16x32_bf16 v[216:219], a[92:95], v[204:207], v[216:219]
v_mfma_f32_16x16x32_bf16 v[228:231], v[204:207], a[156:159], v[228:231]
s_add_u32 s28, s60, 12288
buffer_load_dwordx4 v[200:203], v241, s[4:7], s28 offen offset:2048
v_mfma_f32_16x16x32_bf16 v[220:223], a[124:127], v[204:207], v[220:223]
v_mfma_f32_16x16x32_bf16 v[236:239], v[204:207], a[188:191], v[236:239]
s_add_u32 s28, s60, 12288
buffer_load_dwordx4 v[204:207], v241, s[4:7], s28 offen offset:2304
ds_write_b128 v242, v[208:211] offset:0
ds_write_b128 v242, v[212:215] offset:1024
ds_write_b128 v242, v[224:227] offset:16384
ds_write_b128 v242, v[228:231] offset:17408
ds_write_b128 v242, v[216:219] offset:8192
ds_write_b128 v242, v[220:223] offset:9216
ds_write_b128 v242, v[232:235] offset:24576
ds_write_b128 v242, v[236:239] offset:25600
s_mov_b32 s59, s60
s_add_u32 s60, s60, 65536
s_cmp_eq_u32 s18, 4
s_cselect_b32 s60, 176734208, s60
s_xor_b32 s69, s69, 16384
m_s3_ow2:
s_add_u32 s18, s18, 1
s_mov_b32 s31, s21
s_and_b32 s30, s18, 3
s_lshl_b32 s21, s30, 18
s_xor_b32 s22, s21, 524288
s_add_u32 s21, s21, 169869312
s_add_u32 s22, s22, 169869312
s_xor_b32 s30, s30, 2
s_lshl_b32 s20, s30, 19
s_add_u32 s20, s20, 167772160
s_waitcnt lgkmcnt(0)
s_barrier
buffer_load_dwordx4 v[8:11], v56, s[4:7], s19 offen offset:0 sc1
buffer_load_dwordx4 v[12:15], v56, s[4:7], s19 offen offset:1024 sc1
buffer_load_dwordx4 v[16:19], v56, s[4:7], s19 offen offset:2048 sc1
buffer_load_dwordx4 v[20:23], v56, s[4:7], s19 offen offset:3072 sc1
s_branch m_s3_top
m_s3_am0:
s_mov_b32 s32, 15
s_cmp_eq_u32 s17, 0
s_cbranch_scc1 m_s3_ah40
s_sub_u32 s17, s17, 1
buffer_load_dwordx4 v[8:11], v56, s[4:7], s19 offen offset:0 sc1
s_branch m_s3_al41
m_s3_am1:
v_smfmac_f32_16x16x64_bf16 v[36:39], v[8:11], a[96:103], v3
s_mov_b32 s32, 14
s_cmp_eq_u32 s17, 0
s_cbranch_scc1 m_s3_ah31
s_sub_u32 s17, s17, 1
buffer_load_dwordx4 v[12:15], v56, s[4:7], s19 offen offset:1024 sc1
s_branch m_s3_al32
m_s3_am2:
v_smfmac_f32_16x16x64_bf16 v[36:39], v[12:15], a[104:111], v3
s_mov_b32 s32, 12
s_cmp_eq_u32 s17, 0
s_cbranch_scc1 m_s3_ah22
s_sub_u32 s17, s17, 1
buffer_load_dwordx4 v[16:19], v56, s[4:7], s19 offen offset:2048 sc1
s_branch m_s3_al23
m_s3_am3:
v_smfmac_f32_16x16x64_bf16 v[36:39], v[16:19], a[112:119], v3
s_mov_b32 s32, 8
s_cmp_eq_u32 s17, 0
s_cbranch_scc1 m_s3_ah13
s_sub_u32 s17, s17, 1
buffer_load_dwordx4 v[20:23], v56, s[4:7], s19 offen offset:3072 sc1
s_branch m_s3_al10
m_s3_al10:
s_bitcmp1_b32 s32, 0
s_cbranch_scc0 m_s3_al11
s_waitcnt vmcnt(0)
v_cmp_eq_u32 vcc, -1, v8
s_cbranch_vccz m_s3_ah10
s_cmp_eq_u32 s17, 0
s_cbranch_scc1 m_s3_ah10
s_sub_u32 s17, s17, 1
buffer_load_dwordx4 v[8:11], v56, s[4:7], s19 offen offset:0 sc1
m_s3_al11:
s_bitcmp1_b32 s32, 1
s_cbranch_scc0 m_s3_al12
s_waitcnt vmcnt(0)
v_cmp_eq_u32 vcc, -1, v12
s_cbranch_vccz m_s3_ah11
s_cmp_eq_u32 s17, 0
s_cbranch_scc1 m_s3_ah11
s_sub_u32 s17, s17, 1
buffer_load_dwordx4 v[12:15], v56, s[4:7], s19 offen offset:1024 sc1
m_s3_al12:
s_bitcmp1_b32 s32, 2
s_cbranch_scc0 m_s3_al13
s_waitcnt vmcnt(0)
v_cmp_eq_u32 vcc, -1, v16
s_cbranch_vccz m_s3_ah12
s_cmp_eq_u32 s17, 0
s_cbranch_scc1 m_s3_ah12
s_sub_u32 s17, s17, 1
buffer_load_dwordx4 v[16:19], v56, s[4:7], s19 offen offset:2048 sc1
m_s3_al13:
s_bitcmp1_b32 s32, 3
s_cbranch_scc0 m_s3_al10
s_waitcnt vmcnt(0)
v_cmp_eq_u32 vcc, -1, v20
s_cbranch_vccz m_s3_ah13
s_cmp_eq_u32 s17, 0
s_cbranch_scc1 m_s3_ah13
s_sub_u32 s17, s17, 1
buffer_load_dwordx4 v[20:23], v56, s[4:7], s19 offen offset:3072 sc1
s_branch m_s3_al10
m_s3_ah10:
v_smfmac_f32_16x16x64_bf16 v[24:27], v[8:11], a[0:7], v3
v_smfmac_f32_16x16x64_bf16 v[28:31], v[8:11], a[32:39], v3
v_smfmac_f32_16x16x64_bf16 v[32:35], v[8:11], a[64:71], v3
v_smfmac_f32_16x16x64_bf16 v[36:39], v[8:11], a[96:103], v3
s_branch m_s3_ab
m_s3_ah11:
v_smfmac_f32_16x16x64_bf16 v[24:27], v[12:15], a[8:15], v3
v_smfmac_f32_16x16x64_bf16 v[28:31], v[12:15], a[40:47], v3
v_smfmac_f32_16x16x64_bf16 v[32:35], v[12:15], a[72:79], v3
v_smfmac_f32_16x16x64_bf16 v[36:39], v[12:15], a[104:111], v3
s_branch m_s3_ab
m_s3_ah12:
v_smfmac_f32_16x16x64_bf16 v[24:27], v[16:19], a[16:23], v3
v_smfmac_f32_16x16x64_bf16 v[28:31], v[16:19], a[48:55], v3
v_smfmac_f32_16x16x64_bf16 v[32:35], v[16:19], a[80:87], v3
v_smfmac_f32_16x16x64_bf16 v[36:39], v[16:19], a[112:119], v3
s_branch m_s3_ab
m_s3_ah13:
v_smfmac_f32_16x16x64_bf16 v[24:27], v[20:23], a[24:31], v3
v_smfmac_f32_16x16x64_bf16 v[28:31], v[20:23], a[56:63], v3
v_smfmac_f32_16x16x64_bf16 v[32:35], v[20:23], a[88:95], v3
v_smfmac_f32_16x16x64_bf16 v[36:39], v[20:23], a[120:127], v3
s_branch m_s3_ab
m_s3_al20:
s_bitcmp1_b32 s32, 0
s_cbranch_scc0 m_s3_al21
s_waitcnt vmcnt(1)
v_cmp_eq_u32 vcc, -1, v8
s_cbranch_vccz m_s3_ah20
s_cmp_eq_u32 s17, 0
s_cbranch_scc1 m_s3_ah20
s_sub_u32 s17, s17, 1
buffer_load_dwordx4 v[8:11], v56, s[4:7], s19 offen offset:0 sc1
m_s3_al21:
s_bitcmp1_b32 s32, 1
s_cbranch_scc0 m_s3_al22
s_waitcnt vmcnt(1)
v_cmp_eq_u32 vcc, -1, v12
s_cbranch_vccz m_s3_ah21
s_cmp_eq_u32 s17, 0
s_cbranch_scc1 m_s3_ah21
s_sub_u32 s17, s17, 1
buffer_load_dwordx4 v[12:15], v56, s[4:7], s19 offen offset:1024 sc1
m_s3_al22:
s_bitcmp1_b32 s32, 2
s_cbranch_scc0 m_s3_al23
s_waitcnt vmcnt(1)
v_cmp_eq_u32 vcc, -1, v16
s_cbranch_vccz m_s3_ah22
s_cmp_eq_u32 s17, 0
s_cbranch_scc1 m_s3_ah22
s_sub_u32 s17, s17, 1
buffer_load_dwordx4 v[16:19], v56, s[4:7], s19 offen offset:2048 sc1
m_s3_al23:
s_bitcmp1_b32 s32, 3
s_cbranch_scc0 m_s3_al20
s_waitcnt vmcnt(1)
v_cmp_eq_u32 vcc, -1, v20
s_cbranch_vccz m_s3_ah23
s_cmp_eq_u32 s17, 0
s_cbranch_scc1 m_s3_ah23
s_sub_u32 s17, s17, 1
buffer_load_dwordx4 v[20:23], v56, s[4:7], s19 offen offset:3072 sc1
s_branch m_s3_al20
m_s3_ah20:
v_smfmac_f32_16x16x64_bf16 v[24:27], v[8:11], a[0:7], v3
v_smfmac_f32_16x16x64_bf16 v[28:31], v[8:11], a[32:39], v3
v_smfmac_f32_16x16x64_bf16 v[32:35], v[8:11], a[64:71], v3
v_smfmac_f32_16x16x64_bf16 v[36:39], v[8:11], a[96:103], v3
s_bitset0_b32 s32, 0
s_branch m_s3_al11
m_s3_ah21:
v_smfmac_f32_16x16x64_bf16 v[24:27], v[12:15], a[8:15], v3
v_smfmac_f32_16x16x64_bf16 v[28:31], v[12:15], a[40:47], v3
v_smfmac_f32_16x16x64_bf16 v[32:35], v[12:15], a[72:79], v3
v_smfmac_f32_16x16x64_bf16 v[36:39], v[12:15], a[104:111], v3
s_bitset0_b32 s32, 1
s_branch m_s3_al12
m_s3_ah22:
v_smfmac_f32_16x16x64_bf16 v[24:27], v[16:19], a[16:23], v3
v_smfmac_f32_16x16x64_bf16 v[28:31], v[16:19], a[48:55], v3
v_smfmac_f32_16x16x64_bf16 v[32:35], v[16:19], a[80:87], v3
v_smfmac_f32_16x16x64_bf16 v[36:39], v[16:19], a[112:119], v3
s_bitset0_b32 s32, 2
s_branch m_s3_al13
m_s3_ah23:
v_smfmac_f32_16x16x64_bf16 v[24:27], v[20:23], a[24:31], v3
v_smfmac_f32_16x16x64_bf16 v[28:31], v[20:23], a[56:63], v3
v_smfmac_f32_16x16x64_bf16 v[32:35], v[20:23], a[88:95], v3
v_smfmac_f32_16x16x64_bf16 v[36:39], v[20:23], a[120:127], v3
s_bitset0_b32 s32, 3
s_branch m_s3_al10
m_s3_al30:
s_bitcmp1_b32 s32, 0
s_cbranch_scc0 m_s3_al31
s_waitcnt vmcnt(2)
v_cmp_eq_u32 vcc, -1, v8
s_cbranch_vccz m_s3_ah30
s_cmp_eq_u32 s17, 0
s_cbranch_scc1 m_s3_ah30
s_sub_u32 s17, s17, 1
buffer_load_dwordx4 v[8:11], v56, s[4:7], s19 offen offset:0 sc1
m_s3_al31:
s_bitcmp1_b32 s32, 1
s_cbranch_scc0 m_s3_al32
s_waitcnt vmcnt(2)
v_cmp_eq_u32 vcc, -1, v12
s_cbranch_vccz m_s3_ah31
s_cmp_eq_u32 s17, 0
s_cbranch_scc1 m_s3_ah31
s_sub_u32 s17, s17, 1
buffer_load_dwordx4 v[12:15], v56, s[4:7], s19 offen offset:1024 sc1
m_s3_al32:
s_bitcmp1_b32 s32, 2
s_cbranch_scc0 m_s3_al33
s_waitcnt vmcnt(2)
v_cmp_eq_u32 vcc, -1, v16
s_cbranch_vccz m_s3_ah32
s_cmp_eq_u32 s17, 0
s_cbranch_scc1 m_s3_ah32
s_sub_u32 s17, s17, 1
buffer_load_dwordx4 v[16:19], v56, s[4:7], s19 offen offset:2048 sc1
m_s3_al33:
s_bitcmp1_b32 s32, 3
s_cbranch_scc0 m_s3_al30
s_waitcnt vmcnt(2)
v_cmp_eq_u32 vcc, -1, v20
s_cbranch_vccz m_s3_ah33
s_cmp_eq_u32 s17, 0
s_cbranch_scc1 m_s3_ah33
s_sub_u32 s17, s17, 1
buffer_load_dwordx4 v[20:23], v56, s[4:7], s19 offen offset:3072 sc1
s_branch m_s3_al30
m_s3_ah30:
v_smfmac_f32_16x16x64_bf16 v[24:27], v[8:11], a[0:7], v3
v_smfmac_f32_16x16x64_bf16 v[28:31], v[8:11], a[32:39], v3
v_smfmac_f32_16x16x64_bf16 v[32:35], v[8:11], a[64:71], v3
v_smfmac_f32_16x16x64_bf16 v[36:39], v[8:11], a[96:103], v3
s_bitset0_b32 s32, 0
s_branch m_s3_al21
m_s3_ah31:
v_smfmac_f32_16x16x64_bf16 v[24:27], v[12:15], a[8:15], v3
v_smfmac_f32_16x16x64_bf16 v[28:31], v[12:15], a[40:47], v3
v_smfmac_f32_16x16x64_bf16 v[32:35], v[12:15], a[72:79], v3
v_smfmac_f32_16x16x64_bf16 v[36:39], v[12:15], a[104:111], v3
s_bitset0_b32 s32, 1
s_branch m_s3_al22
m_s3_ah32:
v_smfmac_f32_16x16x64_bf16 v[24:27], v[16:19], a[16:23], v3
v_smfmac_f32_16x16x64_bf16 v[28:31], v[16:19], a[48:55], v3
v_smfmac_f32_16x16x64_bf16 v[32:35], v[16:19], a[80:87], v3
v_smfmac_f32_16x16x64_bf16 v[36:39], v[16:19], a[112:119], v3
s_bitset0_b32 s32, 2
s_branch m_s3_al23
m_s3_ah33:
v_smfmac_f32_16x16x64_bf16 v[24:27], v[20:23], a[24:31], v3
v_smfmac_f32_16x16x64_bf16 v[28:31], v[20:23], a[56:63], v3
v_smfmac_f32_16x16x64_bf16 v[32:35], v[20:23], a[88:95], v3
v_smfmac_f32_16x16x64_bf16 v[36:39], v[20:23], a[120:127], v3
s_bitset0_b32 s32, 3
s_branch m_s3_al20
m_s3_al40:
s_waitcnt vmcnt(3)
v_cmp_eq_u32 vcc, -1, v8
s_cbranch_vccz m_s3_ah40
s_cmp_eq_u32 s17, 0
s_cbranch_scc1 m_s3_ah40
s_sub_u32 s17, s17, 1
buffer_load_dwordx4 v[8:11], v56, s[4:7], s19 offen offset:0 sc1
m_s3_al41:
s_waitcnt vmcnt(3)
v_cmp_eq_u32 vcc, -1, v12
s_cbranch_vccz m_s3_ah41
s_cmp_eq_u32 s17, 0
s_cbranch_scc1 m_s3_ah41
s_sub_u32 s17, s17, 1
buffer_load_dwordx4 v[12:15], v56, s[4:7], s19 offen offset:1024 sc1
m_s3_al42:
s_waitcnt vmcnt(3)
v_cmp_eq_u32 vcc, -1, v16
s_cbranch_vccz m_s3_ah42
s_cmp_eq_u32 s17, 0
s_cbranch_scc1 m_s3_ah42
s_sub_u32 s17, s17, 1
buffer_load_dwordx4 v[16:19], v56, s[4:7], s19 offen offset:2048 sc1
m_s3_al43:
s_waitcnt vmcnt(3)
v_cmp_eq_u32 vcc, -1, v20
s_cbranch_vccz m_s3_ah43
s_cmp_eq_u32 s17, 0
s_cbranch_scc1 m_s3_ah43
s_sub_u32 s17, s17, 1
buffer_load_dwordx4 v[20:23], v56, s[4:7], s19 offen offset:3072 sc1
s_branch m_s3_al40
m_s3_ah40:
v_smfmac_f32_16x16x64_bf16 v[24:27], v[8:11], a[0:7], v3
v_smfmac_f32_16x16x64_bf16 v[28:31], v[8:11], a[32:39], v3
v_smfmac_f32_16x16x64_bf16 v[32:35], v[8:11], a[64:71], v3
v_smfmac_f32_16x16x64_bf16 v[36:39], v[8:11], a[96:103], v3
s_bitset0_b32 s32, 0
s_branch m_s3_al31
m_s3_ah41:
v_smfmac_f32_16x16x64_bf16 v[24:27], v[12:15], a[8:15], v3
v_smfmac_f32_16x16x64_bf16 v[28:31], v[12:15], a[40:47], v3
v_smfmac_f32_16x16x64_bf16 v[32:35], v[12:15], a[72:79], v3
v_smfmac_f32_16x16x64_bf16 v[36:39], v[12:15], a[104:111], v3
s_bitset0_b32 s32, 1
s_branch m_s3_al32
m_s3_ah42:
v_smfmac_f32_16x16x64_bf16 v[24:27], v[16:19], a[16:23], v3
v_smfmac_f32_16x16x64_bf16 v[28:31], v[16:19], a[48:55], v3
v_smfmac_f32_16x16x64_bf16 v[32:35], v[16:19], a[80:87], v3
v_smfmac_f32_16x16x64_bf16 v[36:39], v[16:19], a[112:119], v3
s_bitset0_b32 s32, 2
s_branch m_s3_al33
m_s3_ah43:
v_smfmac_f32_16x16x64_bf16 v[24:27], v[20:23], a[24:31], v3
v_smfmac_f32_16x16x64_bf16 v[28:31], v[20:23], a[56:63], v3
v_smfmac_f32_16x16x64_bf16 v[32:35], v[20:23], a[88:95], v3
v_smfmac_f32_16x16x64_bf16 v[36:39], v[20:23], a[120:127], v3
s_bitset0_b32 s32, 3
s_branch m_s3_al30
m_s3_om0:
s_mov_b32 s32, 15
s_cmp_eq_u32 s17, 0
s_cbranch_scc1 m_s3_oh40
s_sub_u32 s17, s17, 1
buffer_load_dwordx4 v[8:11], v57, s[4:7], s19 offen offset:0 sc1
s_branch m_s3_ol41
m_s3_om1:
v_smfmac_f32_16x16x64_bf16 v[52:55], v[8:11], a[224:231], v3
s_mov_b32 s32, 14
s_cmp_eq_u32 s17, 0
s_cbranch_scc1 m_s3_oh31
s_sub_u32 s17, s17, 1
buffer_load_dwordx4 v[12:15], v57, s[4:7], s19 offen offset:1024 sc1
s_branch m_s3_ol32
m_s3_om2:
v_smfmac_f32_16x16x64_bf16 v[52:55], v[12:15], a[232:239], v3
s_mov_b32 s32, 12
s_cmp_eq_u32 s17, 0
s_cbranch_scc1 m_s3_oh22
s_sub_u32 s17, s17, 1
buffer_load_dwordx4 v[16:19], v57, s[4:7], s19 offen offset:2048 sc1
s_branch m_s3_ol23
m_s3_om3:
v_smfmac_f32_16x16x64_bf16 v[52:55], v[16:19], a[240:247], v3
s_mov_b32 s32, 8
s_cmp_eq_u32 s17, 0
s_cbranch_scc1 m_s3_oh13
s_sub_u32 s17, s17, 1
buffer_load_dwordx4 v[20:23], v57, s[4:7], s19 offen offset:3072 sc1
s_branch m_s3_ol10
m_s3_ol10:
s_bitcmp1_b32 s32, 0
s_cbranch_scc0 m_s3_ol11
s_waitcnt vmcnt(0)
v_cmp_eq_u32 vcc, -1, v8
s_cbranch_vccz m_s3_oh10
s_cmp_eq_u32 s17, 0
s_cbranch_scc1 m_s3_oh10
s_sub_u32 s17, s17, 1
buffer_load_dwordx4 v[8:11], v57, s[4:7], s19 offen offset:0 sc1
m_s3_ol11:
s_bitcmp1_b32 s32, 1
s_cbranch_scc0 m_s3_ol12
s_waitcnt vmcnt(0)
v_cmp_eq_u32 vcc, -1, v12
s_cbranch_vccz m_s3_oh11
s_cmp_eq_u32 s17, 0
s_cbranch_scc1 m_s3_oh11
s_sub_u32 s17, s17, 1
buffer_load_dwordx4 v[12:15], v57, s[4:7], s19 offen offset:1024 sc1
m_s3_ol12:
s_bitcmp1_b32 s32, 2
s_cbranch_scc0 m_s3_ol13
s_waitcnt vmcnt(0)
v_cmp_eq_u32 vcc, -1, v16
s_cbranch_vccz m_s3_oh12
s_cmp_eq_u32 s17, 0
s_cbranch_scc1 m_s3_oh12
s_sub_u32 s17, s17, 1
buffer_load_dwordx4 v[16:19], v57, s[4:7], s19 offen offset:2048 sc1
m_s3_ol13:
s_bitcmp1_b32 s32, 3
s_cbranch_scc0 m_s3_ol10
s_waitcnt vmcnt(0)
v_cmp_eq_u32 vcc, -1, v20
s_cbranch_vccz m_s3_oh13
s_cmp_eq_u32 s17, 0
s_cbranch_scc1 m_s3_oh13
s_sub_u32 s17, s17, 1
buffer_load_dwordx4 v[20:23], v57, s[4:7], s19 offen offset:3072 sc1
s_branch m_s3_ol10
m_s3_oh10:
v_smfmac_f32_16x16x64_bf16 v[48:51], v[8:11], a[192:199], v3
v_smfmac_f32_16x16x64_bf16 v[52:55], v[8:11], a[224:231], v3
s_branch m_s3_ob
m_s3_oh11:
v_smfmac_f32_16x16x64_bf16 v[48:51], v[12:15], a[200:207], v3
v_smfmac_f32_16x16x64_bf16 v[52:55], v[12:15], a[232:239], v3
s_branch m_s3_ob
m_s3_oh12:
v_smfmac_f32_16x16x64_bf16 v[48:51], v[16:19], a[208:215], v3
v_smfmac_f32_16x16x64_bf16 v[52:55], v[16:19], a[240:247], v3
s_branch m_s3_ob
m_s3_oh13:
v_smfmac_f32_16x16x64_bf16 v[48:51], v[20:23], a[216:223], v3
v_smfmac_f32_16x16x64_bf16 v[52:55], v[20:23], a[248:255], v3
s_branch m_s3_ob
m_s3_ol20:
s_bitcmp1_b32 s32, 0
s_cbranch_scc0 m_s3_ol21
s_waitcnt vmcnt(1)
v_cmp_eq_u32 vcc, -1, v8
s_cbranch_vccz m_s3_oh20
s_cmp_eq_u32 s17, 0
s_cbranch_scc1 m_s3_oh20
s_sub_u32 s17, s17, 1
buffer_load_dwordx4 v[8:11], v57, s[4:7], s19 offen offset:0 sc1
m_s3_ol21:
s_bitcmp1_b32 s32, 1
s_cbranch_scc0 m_s3_ol22
s_waitcnt vmcnt(1)
v_cmp_eq_u32 vcc, -1, v12
s_cbranch_vccz m_s3_oh21
s_cmp_eq_u32 s17, 0
s_cbranch_scc1 m_s3_oh21
s_sub_u32 s17, s17, 1
buffer_load_dwordx4 v[12:15], v57, s[4:7], s19 offen offset:1024 sc1
m_s3_ol22:
s_bitcmp1_b32 s32, 2
s_cbranch_scc0 m_s3_ol23
s_waitcnt vmcnt(1)
v_cmp_eq_u32 vcc, -1, v16
s_cbranch_vccz m_s3_oh22
s_cmp_eq_u32 s17, 0
s_cbranch_scc1 m_s3_oh22
s_sub_u32 s17, s17, 1
buffer_load_dwordx4 v[16:19], v57, s[4:7], s19 offen offset:2048 sc1
m_s3_ol23:
s_bitcmp1_b32 s32, 3
s_cbranch_scc0 m_s3_ol20
s_waitcnt vmcnt(1)
v_cmp_eq_u32 vcc, -1, v20
s_cbranch_vccz m_s3_oh23
s_cmp_eq_u32 s17, 0
s_cbranch_scc1 m_s3_oh23
s_sub_u32 s17, s17, 1
buffer_load_dwordx4 v[20:23], v57, s[4:7], s19 offen offset:3072 sc1
s_branch m_s3_ol20
m_s3_oh20:
v_smfmac_f32_16x16x64_bf16 v[48:51], v[8:11], a[192:199], v3
v_smfmac_f32_16x16x64_bf16 v[52:55], v[8:11], a[224:231], v3
s_bitset0_b32 s32, 0
s_branch m_s3_ol11
m_s3_oh21:
v_smfmac_f32_16x16x64_bf16 v[48:51], v[12:15], a[200:207], v3
v_smfmac_f32_16x16x64_bf16 v[52:55], v[12:15], a[232:239], v3
s_bitset0_b32 s32, 1
s_branch m_s3_ol12
m_s3_oh22:
v_smfmac_f32_16x16x64_bf16 v[48:51], v[16:19], a[208:215], v3
v_smfmac_f32_16x16x64_bf16 v[52:55], v[16:19], a[240:247], v3
s_bitset0_b32 s32, 2
s_branch m_s3_ol13
m_s3_oh23:
v_smfmac_f32_16x16x64_bf16 v[48:51], v[20:23], a[216:223], v3
v_smfmac_f32_16x16x64_bf16 v[52:55], v[20:23], a[248:255], v3
s_bitset0_b32 s32, 3
s_branch m_s3_ol10
m_s3_ol30:
s_bitcmp1_b32 s32, 0
s_cbranch_scc0 m_s3_ol31
s_waitcnt vmcnt(2)
v_cmp_eq_u32 vcc, -1, v8
s_cbranch_vccz m_s3_oh30
s_cmp_eq_u32 s17, 0
s_cbranch_scc1 m_s3_oh30
s_sub_u32 s17, s17, 1
buffer_load_dwordx4 v[8:11], v57, s[4:7], s19 offen offset:0 sc1
m_s3_ol31:
s_bitcmp1_b32 s32, 1
s_cbranch_scc0 m_s3_ol32
s_waitcnt vmcnt(2)
v_cmp_eq_u32 vcc, -1, v12
s_cbranch_vccz m_s3_oh31
s_cmp_eq_u32 s17, 0
s_cbranch_scc1 m_s3_oh31
s_sub_u32 s17, s17, 1
buffer_load_dwordx4 v[12:15], v57, s[4:7], s19 offen offset:1024 sc1
m_s3_ol32:
s_bitcmp1_b32 s32, 2
s_cbranch_scc0 m_s3_ol33
s_waitcnt vmcnt(2)
v_cmp_eq_u32 vcc, -1, v16
s_cbranch_vccz m_s3_oh32
s_cmp_eq_u32 s17, 0
s_cbranch_scc1 m_s3_oh32
s_sub_u32 s17, s17, 1
buffer_load_dwordx4 v[16:19], v57, s[4:7], s19 offen offset:2048 sc1
m_s3_ol33:
s_bitcmp1_b32 s32, 3
s_cbranch_scc0 m_s3_ol30
s_waitcnt vmcnt(2)
v_cmp_eq_u32 vcc, -1, v20
s_cbranch_vccz m_s3_oh33
s_cmp_eq_u32 s17, 0
s_cbranch_scc1 m_s3_oh33
s_sub_u32 s17, s17, 1
buffer_load_dwordx4 v[20:23], v57, s[4:7], s19 offen offset:3072 sc1
s_branch m_s3_ol30
m_s3_oh30:
v_smfmac_f32_16x16x64_bf16 v[48:51], v[8:11], a[192:199], v3
v_smfmac_f32_16x16x64_bf16 v[52:55], v[8:11], a[224:231], v3
s_bitset0_b32 s32, 0
s_branch m_s3_ol21
m_s3_oh31:
v_smfmac_f32_16x16x64_bf16 v[48:51], v[12:15], a[200:207], v3
v_smfmac_f32_16x16x64_bf16 v[52:55], v[12:15], a[232:239], v3
s_bitset0_b32 s32, 1
s_branch m_s3_ol22
m_s3_oh32:
v_smfmac_f32_16x16x64_bf16 v[48:51], v[16:19], a[208:215], v3
v_smfmac_f32_16x16x64_bf16 v[52:55], v[16:19], a[240:247], v3
s_bitset0_b32 s32, 2
s_branch m_s3_ol23
m_s3_oh33:
v_smfmac_f32_16x16x64_bf16 v[48:51], v[20:23], a[216:223], v3
v_smfmac_f32_16x16x64_bf16 v[52:55], v[20:23], a[248:255], v3
s_bitset0_b32 s32, 3
s_branch m_s3_ol20
m_s3_ol40:
s_waitcnt vmcnt(3)
v_cmp_eq_u32 vcc, -1, v8
s_cbranch_vccz m_s3_oh40
s_cmp_eq_u32 s17, 0
s_cbranch_scc1 m_s3_oh40
s_sub_u32 s17, s17, 1
buffer_load_dwordx4 v[8:11], v57, s[4:7], s19 offen offset:0 sc1
m_s3_ol41:
s_waitcnt vmcnt(3)
v_cmp_eq_u32 vcc, -1, v12
s_cbranch_vccz m_s3_oh41
s_cmp_eq_u32 s17, 0
s_cbranch_scc1 m_s3_oh41
s_sub_u32 s17, s17, 1
buffer_load_dwordx4 v[12:15], v57, s[4:7], s19 offen offset:1024 sc1
m_s3_ol42:
s_waitcnt vmcnt(3)
v_cmp_eq_u32 vcc, -1, v16
s_cbranch_vccz m_s3_oh42
s_cmp_eq_u32 s17, 0
s_cbranch_scc1 m_s3_oh42
s_sub_u32 s17, s17, 1
buffer_load_dwordx4 v[16:19], v57, s[4:7], s19 offen offset:2048 sc1
m_s3_ol43:
s_waitcnt vmcnt(3)
v_cmp_eq_u32 vcc, -1, v20
s_cbranch_vccz m_s3_oh43
s_cmp_eq_u32 s17, 0
s_cbranch_scc1 m_s3_oh43
s_sub_u32 s17, s17, 1
buffer_load_dwordx4 v[20:23], v57, s[4:7], s19 offen offset:3072 sc1
s_branch m_s3_ol40
m_s3_oh40:
v_smfmac_f32_16x16x64_bf16 v[48:51], v[8:11], a[192:199], v3
v_smfmac_f32_16x16x64_bf16 v[52:55], v[8:11], a[224:231], v3
s_bitset0_b32 s32, 0
s_branch m_s3_ol31
m_s3_oh41:
v_smfmac_f32_16x16x64_bf16 v[48:51], v[12:15], a[200:207], v3
v_smfmac_f32_16x16x64_bf16 v[52:55], v[12:15], a[232:239], v3
s_bitset0_b32 s32, 1
s_branch m_s3_ol32
m_s3_oh42:
v_smfmac_f32_16x16x64_bf16 v[48:51], v[16:19], a[208:215], v3
v_smfmac_f32_16x16x64_bf16 v[52:55], v[16:19], a[240:247], v3
s_bitset0_b32 s32, 2
s_branch m_s3_ol33
m_s3_oh43:
v_smfmac_f32_16x16x64_bf16 v[48:51], v[20:23], a[216:223], v3
v_smfmac_f32_16x16x64_bf16 v[52:55], v[20:23], a[248:255], v3
s_bitset0_b32 s32, 3
s_branch m_s3_ol30
m_s3_kvw:
v_mov_b32 v77, 0
m_s3_kv:
buffer_load_dword v75, v77, s[4:7], s64 offen sc1
s_waitcnt vmcnt(0)
v_readfirstlane_b32 s30, v75
s_cmp_ge_u32 s30, 16
s_cbranch_scc1 m_s3_kv_d
s_cmp_eq_u32 s17, 0
s_cbranch_scc1 m_s3_kv_d
s_sub_u32 s17, s17, 1
s_branch m_s3_kv
m_s3_fin:
s_waitcnt vmcnt(0)
s_barrier
v_mov_b32 v76, 1
buffer_atomic_add v76, v68, s[4:7], 0 offen sc0 sc1
s_and_b32 s26, s12, 1
s_lshr_b32 s27, s12, 1
s_lshl_b32 s27, s27, 2
s_add_u32 s26, s26, s27
s_lshl_b32 s26, s26, 12
s_xor_b32 s27, s65, 8192
s_add_u32 s26, s26, s27
s_add_u32 s26, s26, 170983424
v_mov_b32 v77, 2147483648
v_cmp_gt_u32 vcc, 32, v0
s_waitcnt vmcnt(0)
v_readfirstlane_b32 s27, v76
v_mov_b32 v76, 64
s_cmp_eq_u32 s27, 31
s_cselect_b32 s26, s26, 2147483648
v_lshl_add_u32 v68, v0, 7, s26
v_cndmask_b32 v68, v77, v68, vcc
buffer_store_dword v76, v68, s[4:7], 0 offen sc1
s_branch m_recdone
m_rp0:
s_lshl_b32 s30, s24, 10
s_add_u32 s30, s30, 131072
s_lshr_b32 s31, s24, 2
s_lshl_b32 s31, s31, 10
s_add_u32 s31, s31, 262144
s_and_b32 s27, s24, 3
s_lshl_b32 s27, s27, 2
v_mul_u32_u24 v66, 160, v1
v_lshl_add_u32 v66, v79, 6, v66
v_lshl_add_u32 v66, v78, 4, v66
s_sub_u32 s26, s30, 32
v_add_u32 v67, s26, v59
v_mov_b32 v76, 2147483648
v_cndmask_b32 v67, v76, v67, s[66:67]
s_add_u32 s26, s31, s27
s_sub_u32 s26, s26, 32
v_add_u32 v68, s26, v59
v_mov_b32 v76, 2147483648
v_cndmask_b32 v68, v76, v68, s[66:67]
s_add_u32 s26, s24, 1
s_and_b32 s26, s26, 3
s_and_b32 s25, s24, 0x7c
s_or_b32 s26, s26, s25
s_lshl_b32 s26, s26, 10
s_add_u32 s26, s26, 131072
v_add_u32 v69, s26, v59
s_add_u32 s26, s24, 2
s_and_b32 s26, s26, 3
s_and_b32 s25, s24, 0x7c
s_or_b32 s26, s26, s25
s_lshl_b32 s26, s26, 10
s_add_u32 s26, s26, 131072
v_add_u32 v70, s26, v59
s_add_u32 s26, s24, 3
s_and_b32 s26, s26, 3
s_and_b32 s25, s24, 0x7c
s_or_b32 s26, s26, s25
s_lshl_b32 s26, s26, 10
s_add_u32 s26, s26, 131072
v_add_u32 v71, s26, v59
v_add_u32 v72, s31, v59
v_lshl_add_u32 v73, v79, 4, v1
v_lshl_add_u32 v73, v78, 1, v73
s_add_u32 s26, s28, 65536
v_lshl_add_u32 v73, v73, 4, s26
v_mov_b32 v76, 2147483648
v_cndmask_b32 v73, v73, v76, s[66:67]
s_barrier
ds_write_b128 v59, v[80:83] offset:24576
v_add_u32 v242, 4294868992, v242
ds_write_b128 v242, v[208:211] offset:0
ds_write_b128 v242, v[212:215] offset:1024
ds_write_b128 v242, v[224:227] offset:16384
ds_write_b128 v242, v[228:231] offset:17408
ds_write_b128 v242, v[216:219] offset:8192
ds_write_b128 v242, v[220:223] offset:9216
ds_write_b128 v242, v[232:235] offset:24576
ds_write_b128 v242, v[236:239] offset:25600
v_add_u32 v241, 65536, v59
ds_write_b128 v241, v[144:147] offset:0
ds_write_b128 v241, v[148:151] offset:1024
ds_write_b128 v241, v[152:155] offset:2048
ds_write_b128 v241, v[156:159] offset:3072
ds_write_b128 v241, v[160:163] offset:4096
ds_write_b128 v241, v[164:167] offset:5120
ds_write_b128 v241, v[168:171] offset:6144
ds_write_b128 v241, v[172:175] offset:7168
ds_write_b128 v241, v[176:179] offset:8192
ds_write_b128 v241, v[180:183] offset:9216
ds_write_b128 v241, v[184:187] offset:10240
ds_write_b128 v241, v[188:191] offset:11264
ds_write_b128 v241, v[192:195] offset:12288
ds_write_b128 v241, v[196:199] offset:13312
ds_write_b128 v241, v[200:203] offset:14336
ds_write_b128 v241, v[204:207] offset:15360
s_xor_b32 s30, s65, 8192
s_waitcnt lgkmcnt(0)
s_barrier
v_add_u32 v61, s30, v61
v_add_u32 v62, s30, v62
v_add_u32 v63, s30, v63
v_add_u32 v64, s30, v64
v_mov_b32 v74, v59
ds_read_b128 v[80:83], v74 offset:24576
ds_read_b128 v[84:87], v74 offset:25600
ds_read_b128 v[88:91], v74 offset:26624
ds_read_b128 v[92:95], v74 offset:27648
v_xor_b32 v74, 4096, v74
s_cmp_eq_u32 s15, 0
s_cbranch_scc1 m_safe0
m_f0_top:
s_cmp_ge_u32 s18, 15
s_cbranch_scc1 m_f0_ow0
ds_write_b128 v242, v[208:211] offset:0
ds_write_b128 v242, v[212:215] offset:1024
ds_write_b128 v242, v[224:227] offset:16384
ds_write_b128 v242, v[228:231] offset:17408
ds_write_b128 v242, v[216:219] offset:8192
ds_write_b128 v242, v[220:223] offset:9216
ds_write_b128 v242, v[232:235] offset:24576
ds_write_b128 v242, v[236:239] offset:25600
m_f0_ow0:
s_waitcnt vmcnt(3)
v_cmp_eq_u32 vcc, -1, v8
s_cbranch_vccnz m_f0_am0
v_smfmac_f32_16x16x64_bf16 v[24:27], v[8:11], a[0:7], v3
v_smfmac_f32_16x16x64_bf16 v[28:31], v[8:11], a[32:39], v3
s_waitcnt vmcnt(2)
v_cmp_eq_u32 vcc, -1, v12
v_smfmac_f32_16x16x64_bf16 v[32:35], v[8:11], a[64:71], v3
s_cbranch_vccnz m_f0_am1
v_smfmac_f32_16x16x64_bf16 v[36:39], v[8:11], a[96:103], v3
v_smfmac_f32_16x16x64_bf16 v[24:27], v[12:15], a[8:15], v3
v_smfmac_f32_16x16x64_bf16 v[28:31], v[12:15], a[40:47], v3
s_waitcnt vmcnt(1)
v_cmp_eq_u32 vcc, -1, v16
v_smfmac_f32_16x16x64_bf16 v[32:35], v[12:15], a[72:79], v3
s_cbranch_vccnz m_f0_am2
v_smfmac_f32_16x16x64_bf16 v[36:39], v[12:15], a[104:111], v3
v_smfmac_f32_16x16x64_bf16 v[24:27], v[16:19], a[16:23], v3
v_smfmac_f32_16x16x64_bf16 v[28:31], v[16:19], a[48:55], v3
s_waitcnt vmcnt(0)
v_cmp_eq_u32 vcc, -1, v20
v_smfmac_f32_16x16x64_bf16 v[32:35], v[16:19], a[80:87], v3
s_cbranch_vccnz m_f0_am3
v_smfmac_f32_16x16x64_bf16 v[36:39], v[16:19], a[112:119], v3
v_smfmac_f32_16x16x64_bf16 v[24:27], v[20:23], a[24:31], v3
v_smfmac_f32_16x16x64_bf16 v[28:31], v[20:23], a[56:63], v3
v_smfmac_f32_16x16x64_bf16 v[32:35], v[20:23], a[88:95], v3
v_smfmac_f32_16x16x64_bf16 v[36:39], v[20:23], a[120:127], v3
m_f0_ab:
v_smfmac_f32_16x16x64_bf16 v[40:43], v[8:11], a[128:135], v3
v_pk_add_f32 v[24:25], v[24:25], v[26:27]
v_pk_add_f32 v[28:29], v[28:29], v[30:31]
ds_write2_b32 v58, v24, v25 offset0:80 offset1:120
ds_write2_b32 v58, v28, v29 offset0:96 offset1:136
v_smfmac_f32_16x16x64_bf16 v[44:47], v[8:11], a[160:167], v3
v_pk_add_f32 v[32:33], v[32:33], v[34:35]
v_pk_add_f32 v[36:37], v[36:37], v[38:39]
ds_write2_b32 v58, v32, v33 offset0:0 offset1:40
ds_write2_b32 v58, v36, v37 offset0:16 offset1:56
s_and_b32 s30, s18, 3
s_lshl_b32 s19, s30, 19
s_add_u32 s19, s19, 167772160
v_smfmac_f32_16x16x64_bf16 v[40:43], v[12:15], a[136:143], v3
v_smfmac_f32_16x16x64_bf16 v[44:47], v[12:15], a[168:175], v3
s_waitcnt lgkmcnt(0)
s_barrier
ds_read_b128 v[148:151], v66 offset:0
ds_read_b128 v[152:155], v66 offset:32
ds_read_b128 v[156:159], v66 offset:2560
ds_read_b128 v[160:163], v66 offset:2592
ds_read_b128 v[164:167], v66 offset:5120
ds_read_b128 v[168:171], v66 offset:5152
ds_read_b128 v[172:175], v66 offset:7680
ds_read_b128 v[176:179], v66 offset:7712
v_smfmac_f32_16x16x64_bf16 v[40:43], v[16:19], a[144:151], v3
v_smfmac_f32_16x16x64_bf16 v[44:47], v[16:19], a[176:183], v3
v_smfmac_f32_16x16x64_bf16 v[40:43], v[20:23], a[152:159], v3
v_smfmac_f32_16x16x64_bf16 v[44:47], v[20:23], a[184:191], v3
s_waitcnt lgkmcnt(4)
v_pk_add_f32 v[148:149], v[148:149], v[156:157]
v_pk_add_f32 v[150:151], v[150:151], v[158:159]
v_pk_add_f32 v[152:153], v[152:153], v[160:161]
v_pk_add_f32 v[154:155], v[154:155], v[162:163]
s_waitcnt lgkmcnt(2)
v_pk_add_f32 v[148:149], v[148:149], v[164:165]
v_pk_add_f32 v[150:151], v[150:151], v[166:167]
v_pk_add_f32 v[152:153], v[152:153], v[168:169]
v_pk_add_f32 v[154:155], v[154:155], v[170:171]
s_waitcnt lgkmcnt(1)
v_pk_add_f32 v[148:149], v[148:149], v[172:173]
v_pk_add_f32 v[150:151], v[150:151], v[174:175]
s_waitcnt lgkmcnt(0)
v_pk_add_f32 v[152:153], v[152:153], v[176:177]
v_pk_add_f32 v[154:155], v[154:155], v[178:179]
v_cvt_pk_bf16_f32 v100, v148, v149
v_cvt_pk_bf16_f32 v101, v150, v151
v_cvt_pk_bf16_f32 v102, v152, v153
v_cvt_pk_bf16_f32 v103, v154, v155
s_nop 1
v_mfma_f32_16x16x32_bf16 v[104:107], v[80:83], v[100:103], 0
v_mfma_f32_16x16x32_bf16 v[108:111], v[84:87], v[100:103], 0
v_mfma_f32_16x16x32_bf16 v[112:115], v[100:103], v[100:103], 0
v_pk_add_f32 v[96:97], v[40:41], v[42:43]
v_pk_add_f32 v[98:99], v[44:45], v[46:47]
buffer_store_dwordx4 v[104:107], v67, s[4:7], s19 offen
s_nop 1
buffer_store_dwordx4 v[108:111], v67, s[4:7], s19 offen offset:32
s_nop 1
buffer_store_dword v112, v68, s[4:7], s19 offen
buffer_store_dword v113, v68, s[4:7], s19 offen offset:32
ds_write_b128 v59, v[96:99] offset:12288
s_mov_b64 vcc, s[66:67]
v_cndmask_b32_dpp v144, v104, v108, vcc quad_perm:[2,3,2,3] row_mask:0xf bank_mask:0xf
v_cndmask_b32_dpp v145, v105, v109, vcc quad_perm:[2,3,2,3] row_mask:0xf bank_mask:0xf
v_cndmask_b32_dpp v146, v106, v110, vcc quad_perm:[2,3,2,3] row_mask:0xf bank_mask:0xf
v_cndmask_b32_dpp v147, v107, v111, vcc quad_perm:[2,3,2,3] row_mask:0xf bank_mask:0xf
s_waitcnt lgkmcnt(0)
s_barrier
s_cmp_eq_u32 s18, 63
s_cbranch_scc1 m_f0_fin
buffer_load_dwordx4 v[148:151], v69, s[4:7], s19 offen sc1
buffer_load_dwordx4 v[152:155], v70, s[4:7], s19 offen sc1
buffer_load_dwordx4 v[156:159], v71, s[4:7], s19 offen sc1
buffer_load_dwordx4 v[160:163], v72, s[4:7], s19 offen sc1
ds_read_b128 v[180:183], v59 offset:13312
ds_read_b128 v[184:187], v59 offset:14336
ds_read_b128 v[188:191], v59 offset:15360
s_waitcnt lgkmcnt(0)
v_pk_add_f32 v[192:193], v[96:97], v[180:181]
v_pk_add_f32 v[194:195], v[98:99], v[182:183]
v_pk_add_f32 v[96:97], v[184:185], v[188:189]
v_pk_add_f32 v[98:99], v[186:187], v[190:191]
v_pk_add_f32 v[96:97], v[96:97], v[192:193]
v_pk_add_f32 v[98:99], v[98:99], v[194:195]
v_cvt_pk_bf16_f32 v116, v96, v97
v_cvt_pk_bf16_f32 v120, v98, v99
buffer_load_dwordx4 v[164:167], v69, s[4:7], s19 offen sc1
buffer_load_dwordx4 v[168:171], v70, s[4:7], s19 offen sc1
buffer_load_dwordx4 v[172:175], v71, s[4:7], s19 offen sc1
buffer_load_dwordx4 v[176:179], v72, s[4:7], s19 offen sc1
v_mov_b64 v[24:25], 0
v_mov_b64 v[26:27], 0
v_mov_b64 v[28:29], 0
v_mov_b64 v[30:31], 0
v_mov_b64 v[32:33], 0
v_mov_b64 v[34:35], 0
v_mov_b64 v[36:37], 0
v_mov_b64 v[38:39], 0
v_mov_b64 v[40:41], 0
v_mov_b64 v[42:43], 0
v_mov_b64 v[44:45], 0
v_mov_b64 v[46:47], 0
s_waitcnt vmcnt(7)
v_pk_add_f32 v[136:137], v[144:145], v[148:149]
v_pk_add_f32 v[138:139], v[146:147], v[150:151]
s_waitcnt vmcnt(6)
v_pk_add_f32 v[136:137], v[136:137], v[152:153]
v_pk_add_f32 v[138:139], v[138:139], v[154:155]
s_waitcnt vmcnt(5)
v_pk_add_f32 v[136:137], v[136:137], v[156:157]
v_pk_add_f32 v[138:139], v[138:139], v[158:159]
s_waitcnt vmcnt(4)
v_pk_add_f32 v[140:141], v[160:161], v[162:163]
v_add_f32 v140, v140, v141
v_cmp_u_f32 vcc, v136, v140
s_cbranch_vccnz m_f0_ps
m_f0_psd:
v_max3_f32 v76, v136, v137, v140
v_max3_f32 v76, v76, v138, v139
s_nop 1
v_max_f32_dpp v76, v76, v76 quad_perm:[2,3,0,1] row_mask:0xf bank_mask:0xf
v_mov_b32 v77, v76
s_nop 1
v_permlane16_swap_b32 v76, v77
v_max_f32 v76, v76, v77
v_mov_b32 v77, v76
s_nop 1
v_permlane32_swap_b32 v76, v77
v_max_f32 v76, v76, v77
v_mul_f32 v76, s33, v76
v_fma_f32 v136, v136, s33, -v76
v_fma_f32 v137, v137, s33, -v76
v_fma_f32 v138, v138, s33, -v76
v_fma_f32 v139, v139, s33, -v76
v_fma_f32 v140, v140, s33, -v76
v_exp_f32 v136, v136
v_exp_f32 v137, v137
v_exp_f32 v138, v138
v_exp_f32 v139, v139
v_exp_f32 v140, v140
v_cvt_pk_bf16_f32 v132, v136, v137
v_cvt_pk_bf16_f32 v133, v138, v139
v_mov_b32_dpp v77, v140 quad_perm:[2,3,0,1] row_mask:0xf bank_mask:0xf
v_mov_b32_dpp v134, v132 quad_perm:[2,3,0,1] row_mask:0xf bank_mask:0xf
v_mov_b32_dpp v135, v133 quad_perm:[2,3,0,1] row_mask:0xf bank_mask:0xf
v_cvt_pk_bf16_f32 v124, v140, v77
s_nop 0
v_mfma_f32_16x16x32_bf16 v[112:115], v[128:131], v[132:135], 0
v_mfma_f32_16x16x32_bf16 v[112:115], v[128:131], v[124:127], v[112:115]
v_mfma_f32_16x16x32_bf16 v[104:107], v[88:91], v[132:135], 0
v_mfma_f32_16x16x32_bf16 v[104:107], v[116:119], v[124:127], v[104:107]
v_mfma_f32_16x16x32_bf16 v[108:111], v[92:95], v[132:135], 0
v_rcp_f32 v76, v112
v_mfma_f32_16x16x32_bf16 v[108:111], v[120:123], v[124:127], v[108:111]
s_nop 1
v_pk_mul_f32 v[104:105], v[104:105], v[76:77] op_sel_hi:[1,0]
v_cvt_pk_bf16_f32 v100, v104, v105
v_pk_mul_f32 v[106:107], v[106:107], v[76:77] op_sel_hi:[1,0]
v_cvt_pk_bf16_f32 v101, v106, v107
s_nop 1
v_pk_mul_f32 v[108:109], v[108:109], v[76:77] op_sel_hi:[1,0]
v_cvt_pk_bf16_f32 v102, v108, v109
v_pk_mul_f32 v[110:111], v[110:111], v[76:77] op_sel_hi:[1,0]
v_cvt_pk_bf16_f32 v103, v110, v111
buffer_store_dwordx4 v[100:103], v73, s[4:7], s19 offen
ds_read_b128 v[180:183], v241 offset:0
ds_read_b128 v[184:187], v241 offset:1024
ds_read_b128 v[188:191], v241 offset:2048
ds_read_b128 v[192:195], v241 offset:3072
s_waitcnt vmcnt(0)
s_barrier
buffer_load_dwordx4 v[8:11], v57, s[4:7], s19 offen offset:0 sc1
buffer_load_dwordx4 v[12:15], v57, s[4:7], s19 offen offset:1024 sc1
buffer_load_dwordx4 v[16:19], v57, s[4:7], s19 offen offset:2048 sc1
buffer_load_dwordx4 v[20:23], v57, s[4:7], s19 offen offset:3072 sc1
s_cmp_ge_u32 s18, 15
s_cbranch_scc1 m_f0_ow1
s_waitcnt lgkmcnt(0)
ds_read_b128 v[164:167], v241 offset:4096
ds_read_b128 v[168:171], v241 offset:5120
ds_read_b128 v[172:175], v241 offset:6144
ds_read_b128 v[176:179], v241 offset:7168
v_mfma_f32_16x16x32_bf16 v[208:211], a[64:67], v[180:183], 0
v_mfma_f32_16x16x32_bf16 v[224:227], v[180:183], a[128:131], 0
v_mfma_f32_16x16x32_bf16 v[212:215], a[96:99], v[180:183], 0
v_mfma_f32_16x16x32_bf16 v[232:235], v[180:183], a[160:163], 0
ds_read_b128 v[180:183], v241 offset:8192
v_mfma_f32_16x16x32_bf16 v[216:219], a[64:67], v[184:187], 0
v_mfma_f32_16x16x32_bf16 v[228:231], v[184:187], a[128:131], 0
v_mfma_f32_16x16x32_bf16 v[220:223], a[96:99], v[184:187], 0
v_mfma_f32_16x16x32_bf16 v[236:239], v[184:187], a[160:163], 0
ds_read_b128 v[184:187], v241 offset:9216
v_mfma_f32_16x16x32_bf16 v[208:211], a[68:71], v[188:191], v[208:211]
v_mfma_f32_16x16x32_bf16 v[224:227], v[188:191], a[132:135], v[224:227]
v_mfma_f32_16x16x32_bf16 v[212:215], a[100:103], v[188:191], v[212:215]
v_mfma_f32_16x16x32_bf16 v[232:235], v[188:191], a[164:167], v[232:235]
ds_read_b128 v[188:191], v241 offset:10240
v_mfma_f32_16x16x32_bf16 v[216:219], a[68:71], v[192:195], v[216:219]
v_mfma_f32_16x16x32_bf16 v[228:231], v[192:195], a[132:135], v[228:231]
v_mfma_f32_16x16x32_bf16 v[220:223], a[100:103], v[192:195], v[220:223]
v_mfma_f32_16x16x32_bf16 v[236:239], v[192:195], a[164:167], v[236:239]
ds_read_b128 v[192:195], v241 offset:11264
m_f0_ow1:
s_waitcnt vmcnt(3)
v_cmp_eq_u32 vcc, -1, v8
s_cbranch_vccnz m_f0_om0
v_smfmac_f32_16x16x64_bf16 v[48:51], v[8:11], a[192:199], v3
s_waitcnt vmcnt(2)
v_cmp_eq_u32 vcc, -1, v12
s_cbranch_vccnz m_f0_om1
v_smfmac_f32_16x16x64_bf16 v[52:55], v[8:11], a[224:231], v3
v_smfmac_f32_16x16x64_bf16 v[48:51], v[12:15], a[200:207], v3
s_waitcnt vmcnt(1)
v_cmp_eq_u32 vcc, -1, v16
s_cbranch_vccnz m_f0_om2
v_smfmac_f32_16x16x64_bf16 v[52:55], v[12:15], a[232:239], v3
v_smfmac_f32_16x16x64_bf16 v[48:51], v[16:19], a[208:215], v3
s_waitcnt vmcnt(0)
v_cmp_eq_u32 vcc, -1, v20
s_cbranch_vccnz m_f0_om3
v_smfmac_f32_16x16x64_bf16 v[52:55], v[16:19], a[240:247], v3
v_smfmac_f32_16x16x64_bf16 v[48:51], v[20:23], a[216:223], v3
v_smfmac_f32_16x16x64_bf16 v[52:55], v[20:23], a[248:255], v3
m_f0_ob:
s_nop 4
v_pk_add_f32 v[96:97], v[48:49], v[50:51]
s_nop 1
v_pk_add_f32 v[98:99], v[52:53], v[54:55]
ds_write2_b32 v240, v96, v97 offset0:0 offset1:72
ds_write2_b32 v240, v98, v99 offset0:160 offset1:232
s_waitcnt lgkmcnt(0)
s_barrier
ds_read_b128 v[148:151], v60 offset:16384
ds_read_b128 v[152:155], v60 offset:17664
ds_read_b128 v[156:159], v60 offset:18944
ds_read_b128 v[160:163], v60 offset:20224
buffer_store_dwordx2 v[4:5], v65, s[4:7], s20 offen
s_waitcnt lgkmcnt(2)
v_pk_add_f32 v[148:149], v[148:149], v[152:153]
v_pk_add_f32 v[150:151], v[150:151], v[154:155]
s_waitcnt lgkmcnt(0)
v_pk_add_f32 v[156:157], v[156:157], v[160:161]
v_pk_add_f32 v[158:159], v[158:159], v[162:163]
v_pk_add_f32 v[96:97], v[148:149], v[156:157]
v_pk_add_f32 v[98:99], v[150:151], v[158:159]
buffer_store_dwordx4 v[96:99], v61, s[4:7], s21 offen sc1
ds_read_b128 v[80:83], v74 offset:24576
ds_read_b128 v[84:87], v74 offset:25600
ds_read_b128 v[88:91], v74 offset:26624
ds_read_b128 v[92:95], v74 offset:27648
v_xor_b32 v74, 4096, v74
v_mov_b64 v[48:49], 0
v_mov_b64 v[50:51], 0
v_mov_b64 v[52:53], 0
v_mov_b64 v[54:55], 0
s_add_u32 s18, s18, 1
s_mov_b32 s31, s21
s_and_b32 s30, s18, 3
s_lshl_b32 s21, s30, 18
s_xor_b32 s22, s21, 524288
s_add_u32 s21, s21, 169869312
s_add_u32 s22, s22, 169869312
s_xor_b32 s30, s30, 2
s_lshl_b32 s20, s30, 19
s_add_u32 s20, s20, 167772160
s_cmp_ge_u32 s18, 16
s_cbranch_scc1 m_f0_ow2
v_mfma_f32_16x16x32_bf16 v[208:211], a[72:75], v[164:167], v[208:211]
v_mfma_f32_16x16x32_bf16 v[224:227], v[164:167], a[136:139], v[224:227]
v_mfma_f32_16x16x32_bf16 v[212:215], a[104:107], v[164:167], v[212:215]
v_mfma_f32_16x16x32_bf16 v[232:235], v[164:167], a[168:171], v[232:235]
ds_read_b128 v[164:167], v241 offset:12288
v_mfma_f32_16x16x32_bf16 v[216:219], a[72:75], v[168:171], v[216:219]
v_mfma_f32_16x16x32_bf16 v[228:231], v[168:171], a[136:139], v[228:231]
v_mfma_f32_16x16x32_bf16 v[220:223], a[104:107], v[168:171], v[220:223]
v_mfma_f32_16x16x32_bf16 v[236:239], v[168:171], a[168:171], v[236:239]
ds_read_b128 v[168:171], v241 offset:13312
v_mfma_f32_16x16x32_bf16 v[208:211], a[76:79], v[172:175], v[208:211]
v_mfma_f32_16x16x32_bf16 v[224:227], v[172:175], a[140:143], v[224:227]
v_mfma_f32_16x16x32_bf16 v[212:215], a[108:111], v[172:175], v[212:215]
v_mfma_f32_16x16x32_bf16 v[232:235], v[172:175], a[172:175], v[232:235]
ds_read_b128 v[172:175], v241 offset:14336
v_mfma_f32_16x16x32_bf16 v[216:219], a[76:79], v[176:179], v[216:219]
v_mfma_f32_16x16x32_bf16 v[228:231], v[176:179], a[140:143], v[228:231]
v_mfma_f32_16x16x32_bf16 v[220:223], a[108:111], v[176:179], v[220:223]
v_mfma_f32_16x16x32_bf16 v[236:239], v[176:179], a[172:175], v[236:239]
ds_read_b128 v[176:179], v241 offset:15360
v_mfma_f32_16x16x32_bf16 v[208:211], a[80:83], v[180:183], v[208:211]
v_mfma_f32_16x16x32_bf16 v[224:227], v[180:183], a[144:147], v[224:227]
v_mfma_f32_16x16x32_bf16 v[212:215], a[112:115], v[180:183], v[212:215]
v_mfma_f32_16x16x32_bf16 v[232:235], v[180:183], a[176:179], v[232:235]
v_mfma_f32_16x16x32_bf16 v[216:219], a[80:83], v[184:187], v[216:219]
v_mfma_f32_16x16x32_bf16 v[228:231], v[184:187], a[144:147], v[228:231]
v_mfma_f32_16x16x32_bf16 v[220:223], a[112:115], v[184:187], v[220:223]
v_mfma_f32_16x16x32_bf16 v[236:239], v[184:187], a[176:179], v[236:239]
m_f0_ow2:
s_waitcnt vmcnt(1)
buffer_load_dwordx4 v[148:151], v62, s[4:7], s31 offen sc1
buffer_load_dwordx4 v[152:155], v63, s[4:7], s31 offen sc1
buffer_load_dwordx4 v[156:159], v64, s[4:7], s31 offen sc1
s_cmp_ge_u32 s18, 16
s_cbranch_scc1 m_f0_ow3
s_waitcnt lgkmcnt(0)
v_mfma_f32_16x16x32_bf16 v[208:211], a[84:87], v[188:191], v[208:211]
v_mfma_f32_16x16x32_bf16 v[224:227], v[188:191], a[148:151], v[224:227]
v_mfma_f32_16x16x32_bf16 v[212:215], a[116:119], v[188:191], v[212:215]
v_mfma_f32_16x16x32_bf16 v[232:235], v[188:191], a[180:183], v[232:235]
v_mfma_f32_16x16x32_bf16 v[216:219], a[84:87], v[192:195], v[216:219]
v_mfma_f32_16x16x32_bf16 v[228:231], v[192:195], a[148:151], v[228:231]
v_mfma_f32_16x16x32_bf16 v[220:223], a[116:119], v[192:195], v[220:223]
v_mfma_f32_16x16x32_bf16 v[236:239], v[192:195], a[180:183], v[236:239]
v_mfma_f32_16x16x32_bf16 v[208:211], a[88:91], v[164:167], v[208:211]
v_mfma_f32_16x16x32_bf16 v[224:227], v[164:167], a[152:155], v[224:227]
v_mfma_f32_16x16x32_bf16 v[212:215], a[120:123], v[164:167], v[212:215]
v_mfma_f32_16x16x32_bf16 v[232:235], v[164:167], a[184:187], v[232:235]
v_mfma_f32_16x16x32_bf16 v[216:219], a[88:91], v[168:171], v[216:219]
v_mfma_f32_16x16x32_bf16 v[228:231], v[168:171], a[152:155], v[228:231]
v_mfma_f32_16x16x32_bf16 v[220:223], a[120:123], v[168:171], v[220:223]
v_mfma_f32_16x16x32_bf16 v[236:239], v[168:171], a[184:187], v[236:239]
v_mfma_f32_16x16x32_bf16 v[208:211], a[92:95], v[172:175], v[208:211]
v_mfma_f32_16x16x32_bf16 v[224:227], v[172:175], a[156:159], v[224:227]
v_mfma_f32_16x16x32_bf16 v[212:215], a[124:127], v[172:175], v[212:215]
v_mfma_f32_16x16x32_bf16 v[232:235], v[172:175], a[188:191], v[232:235]
v_mfma_f32_16x16x32_bf16 v[216:219], a[92:95], v[176:179], v[216:219]
v_mfma_f32_16x16x32_bf16 v[228:231], v[176:179], a[156:159], v[228:231]
v_mfma_f32_16x16x32_bf16 v[220:223], a[124:127], v[176:179], v[220:223]
v_mfma_f32_16x16x32_bf16 v[236:239], v[176:179], a[188:191], v[236:239]
m_f0_ow3:
v_xor_b32 v241, 16384, v241
s_waitcnt vmcnt(1)
v_pk_add_f32 v[148:149], v[148:149], v[152:153]
v_pk_add_f32 v[150:151], v[150:151], v[154:155]
s_waitcnt vmcnt(0)
v_pk_add_f32 v[156:157], v[156:157], v[96:97]
v_pk_add_f32 v[158:159], v[158:159], v[98:99]
v_pk_add_f32 v[148:149], v[148:149], v[156:157]
v_pk_add_f32 v[150:151], v[150:151], v[158:159]
v_cmp_u_f32 vcc, v148, v151
v_cvt_pk_bf16_f32 v100, v148, v149
v_cvt_pk_bf16_f32 v101, v150, v151
s_cbranch_vccnz m_f0_ppr
m_f0_ppd:
buffer_store_dwordx2 v[100:101], v65, s[4:7], s19 offen
s_waitcnt lgkmcnt(0)
s_barrier
buffer_load_dwordx4 v[8:11], v56, s[4:7], s19 offen offset:0 sc1
buffer_load_dwordx4 v[12:15], v56, s[4:7], s19 offen offset:1024 sc1
buffer_load_dwordx4 v[16:19], v56, s[4:7], s19 offen offset:2048 sc1
buffer_load_dwordx4 v[20:23], v56, s[4:7], s19 offen offset:3072 sc1
s_branch m_f0_top
m_f0_am0:
s_mov_b32 s32, 15
s_cmp_eq_u32 s17, 0
s_cbranch_scc1 m_f0_ah40
s_sub_u32 s17, s17, 1
buffer_load_dwordx4 v[8:11], v56, s[4:7], s19 offen offset:0 sc1
s_branch m_f0_al41
m_f0_am1:
v_smfmac_f32_16x16x64_bf16 v[36:39], v[8:11], a[96:103], v3
s_mov_b32 s32, 14
s_cmp_eq_u32 s17, 0
s_cbranch_scc1 m_f0_ah31
s_sub_u32 s17, s17, 1
buffer_load_dwordx4 v[12:15], v56, s[4:7], s19 offen offset:1024 sc1
s_branch m_f0_al32
m_f0_am2:
v_smfmac_f32_16x16x64_bf16 v[36:39], v[12:15], a[104:111], v3
s_mov_b32 s32, 12
s_cmp_eq_u32 s17, 0
s_cbranch_scc1 m_f0_ah22
s_sub_u32 s17, s17, 1
buffer_load_dwordx4 v[16:19], v56, s[4:7], s19 offen offset:2048 sc1
s_branch m_f0_al23
m_f0_am3:
v_smfmac_f32_16x16x64_bf16 v[36:39], v[16:19], a[112:119], v3
s_mov_b32 s32, 8
s_cmp_eq_u32 s17, 0
s_cbranch_scc1 m_f0_ah13
s_sub_u32 s17, s17, 1
buffer_load_dwordx4 v[20:23], v56, s[4:7], s19 offen offset:3072 sc1
s_branch m_f0_al10
m_f0_al10:
s_bitcmp1_b32 s32, 0
s_cbranch_scc0 m_f0_al11
s_waitcnt vmcnt(0)
v_cmp_eq_u32 vcc, -1, v8
s_cbranch_vccz m_f0_ah10
s_cmp_eq_u32 s17, 0
s_cbranch_scc1 m_f0_ah10
s_sub_u32 s17, s17, 1
buffer_load_dwordx4 v[8:11], v56, s[4:7], s19 offen offset:0 sc1
m_f0_al11:
s_bitcmp1_b32 s32, 1
s_cbranch_scc0 m_f0_al12
s_waitcnt vmcnt(0)
v_cmp_eq_u32 vcc, -1, v12
s_cbranch_vccz m_f0_ah11
s_cmp_eq_u32 s17, 0
s_cbranch_scc1 m_f0_ah11
s_sub_u32 s17, s17, 1
buffer_load_dwordx4 v[12:15], v56, s[4:7], s19 offen offset:1024 sc1
m_f0_al12:
s_bitcmp1_b32 s32, 2
s_cbranch_scc0 m_f0_al13
s_waitcnt vmcnt(0)
v_cmp_eq_u32 vcc, -1, v16
s_cbranch_vccz m_f0_ah12
s_cmp_eq_u32 s17, 0
s_cbranch_scc1 m_f0_ah12
s_sub_u32 s17, s17, 1
buffer_load_dwordx4 v[16:19], v56, s[4:7], s19 offen offset:2048 sc1
m_f0_al13:
s_bitcmp1_b32 s32, 3
s_cbranch_scc0 m_f0_al10
s_waitcnt vmcnt(0)
v_cmp_eq_u32 vcc, -1, v20
s_cbranch_vccz m_f0_ah13
s_cmp_eq_u32 s17, 0
s_cbranch_scc1 m_f0_ah13
s_sub_u32 s17, s17, 1
buffer_load_dwordx4 v[20:23], v56, s[4:7], s19 offen offset:3072 sc1
s_branch m_f0_al10
m_f0_ah10:
v_smfmac_f32_16x16x64_bf16 v[24:27], v[8:11], a[0:7], v3
v_smfmac_f32_16x16x64_bf16 v[28:31], v[8:11], a[32:39], v3
v_smfmac_f32_16x16x64_bf16 v[32:35], v[8:11], a[64:71], v3
v_smfmac_f32_16x16x64_bf16 v[36:39], v[8:11], a[96:103], v3
s_branch m_f0_ab
m_f0_ah11:
v_smfmac_f32_16x16x64_bf16 v[24:27], v[12:15], a[8:15], v3
v_smfmac_f32_16x16x64_bf16 v[28:31], v[12:15], a[40:47], v3
v_smfmac_f32_16x16x64_bf16 v[32:35], v[12:15], a[72:79], v3
v_smfmac_f32_16x16x64_bf16 v[36:39], v[12:15], a[104:111], v3
s_branch m_f0_ab
m_f0_ah12:
v_smfmac_f32_16x16x64_bf16 v[24:27], v[16:19], a[16:23], v3
v_smfmac_f32_16x16x64_bf16 v[28:31], v[16:19], a[48:55], v3
v_smfmac_f32_16x16x64_bf16 v[32:35], v[16:19], a[80:87], v3
v_smfmac_f32_16x16x64_bf16 v[36:39], v[16:19], a[112:119], v3
s_branch m_f0_ab
m_f0_ah13:
v_smfmac_f32_16x16x64_bf16 v[24:27], v[20:23], a[24:31], v3
v_smfmac_f32_16x16x64_bf16 v[28:31], v[20:23], a[56:63], v3
v_smfmac_f32_16x16x64_bf16 v[32:35], v[20:23], a[88:95], v3
v_smfmac_f32_16x16x64_bf16 v[36:39], v[20:23], a[120:127], v3
s_branch m_f0_ab
m_f0_al20:
s_bitcmp1_b32 s32, 0
s_cbranch_scc0 m_f0_al21
s_waitcnt vmcnt(1)
v_cmp_eq_u32 vcc, -1, v8
s_cbranch_vccz m_f0_ah20
s_cmp_eq_u32 s17, 0
s_cbranch_scc1 m_f0_ah20
s_sub_u32 s17, s17, 1
buffer_load_dwordx4 v[8:11], v56, s[4:7], s19 offen offset:0 sc1
m_f0_al21:
s_bitcmp1_b32 s32, 1
s_cbranch_scc0 m_f0_al22
s_waitcnt vmcnt(1)
v_cmp_eq_u32 vcc, -1, v12
s_cbranch_vccz m_f0_ah21
s_cmp_eq_u32 s17, 0
s_cbranch_scc1 m_f0_ah21
s_sub_u32 s17, s17, 1
buffer_load_dwordx4 v[12:15], v56, s[4:7], s19 offen offset:1024 sc1
m_f0_al22:
s_bitcmp1_b32 s32, 2
s_cbranch_scc0 m_f0_al23
s_waitcnt vmcnt(1)
v_cmp_eq_u32 vcc, -1, v16
s_cbranch_vccz m_f0_ah22
s_cmp_eq_u32 s17, 0
s_cbranch_scc1 m_f0_ah22
s_sub_u32 s17, s17, 1
buffer_load_dwordx4 v[16:19], v56, s[4:7], s19 offen offset:2048 sc1
m_f0_al23:
s_bitcmp1_b32 s32, 3
s_cbranch_scc0 m_f0_al20
s_waitcnt vmcnt(1)
v_cmp_eq_u32 vcc, -1, v20
s_cbranch_vccz m_f0_ah23
s_cmp_eq_u32 s17, 0
s_cbranch_scc1 m_f0_ah23
s_sub_u32 s17, s17, 1
buffer_load_dwordx4 v[20:23], v56, s[4:7], s19 offen offset:3072 sc1
s_branch m_f0_al20
m_f0_ah20:
v_smfmac_f32_16x16x64_bf16 v[24:27], v[8:11], a[0:7], v3
v_smfmac_f32_16x16x64_bf16 v[28:31], v[8:11], a[32:39], v3
v_smfmac_f32_16x16x64_bf16 v[32:35], v[8:11], a[64:71], v3
v_smfmac_f32_16x16x64_bf16 v[36:39], v[8:11], a[96:103], v3
s_bitset0_b32 s32, 0
s_branch m_f0_al11
m_f0_ah21:
v_smfmac_f32_16x16x64_bf16 v[24:27], v[12:15], a[8:15], v3
v_smfmac_f32_16x16x64_bf16 v[28:31], v[12:15], a[40:47], v3
v_smfmac_f32_16x16x64_bf16 v[32:35], v[12:15], a[72:79], v3
v_smfmac_f32_16x16x64_bf16 v[36:39], v[12:15], a[104:111], v3
s_bitset0_b32 s32, 1
s_branch m_f0_al12
m_f0_ah22:
v_smfmac_f32_16x16x64_bf16 v[24:27], v[16:19], a[16:23], v3
v_smfmac_f32_16x16x64_bf16 v[28:31], v[16:19], a[48:55], v3
v_smfmac_f32_16x16x64_bf16 v[32:35], v[16:19], a[80:87], v3
v_smfmac_f32_16x16x64_bf16 v[36:39], v[16:19], a[112:119], v3
s_bitset0_b32 s32, 2
s_branch m_f0_al13
m_f0_ah23:
v_smfmac_f32_16x16x64_bf16 v[24:27], v[20:23], a[24:31], v3
v_smfmac_f32_16x16x64_bf16 v[28:31], v[20:23], a[56:63], v3
v_smfmac_f32_16x16x64_bf16 v[32:35], v[20:23], a[88:95], v3
v_smfmac_f32_16x16x64_bf16 v[36:39], v[20:23], a[120:127], v3
s_bitset0_b32 s32, 3
s_branch m_f0_al10
m_f0_al30:
s_bitcmp1_b32 s32, 0
s_cbranch_scc0 m_f0_al31
s_waitcnt vmcnt(2)
v_cmp_eq_u32 vcc, -1, v8
s_cbranch_vccz m_f0_ah30
s_cmp_eq_u32 s17, 0
s_cbranch_scc1 m_f0_ah30
s_sub_u32 s17, s17, 1
buffer_load_dwordx4 v[8:11], v56, s[4:7], s19 offen offset:0 sc1
m_f0_al31:
s_bitcmp1_b32 s32, 1
s_cbranch_scc0 m_f0_al32
s_waitcnt vmcnt(2)
v_cmp_eq_u32 vcc, -1, v12
s_cbranch_vccz m_f0_ah31
s_cmp_eq_u32 s17, 0
s_cbranch_scc1 m_f0_ah31
s_sub_u32 s17, s17, 1
buffer_load_dwordx4 v[12:15], v56, s[4:7], s19 offen offset:1024 sc1
m_f0_al32:
s_bitcmp1_b32 s32, 2
s_cbranch_scc0 m_f0_al33
s_waitcnt vmcnt(2)
v_cmp_eq_u32 vcc, -1, v16
s_cbranch_vccz m_f0_ah32
s_cmp_eq_u32 s17, 0
s_cbranch_scc1 m_f0_ah32
s_sub_u32 s17, s17, 1
buffer_load_dwordx4 v[16:19], v56, s[4:7], s19 offen offset:2048 sc1
m_f0_al33:
s_bitcmp1_b32 s32, 3
s_cbranch_scc0 m_f0_al30
s_waitcnt vmcnt(2)
v_cmp_eq_u32 vcc, -1, v20
s_cbranch_vccz m_f0_ah33
s_cmp_eq_u32 s17, 0
s_cbranch_scc1 m_f0_ah33
s_sub_u32 s17, s17, 1
buffer_load_dwordx4 v[20:23], v56, s[4:7], s19 offen offset:3072 sc1
s_branch m_f0_al30
m_f0_ah30:
v_smfmac_f32_16x16x64_bf16 v[24:27], v[8:11], a[0:7], v3
v_smfmac_f32_16x16x64_bf16 v[28:31], v[8:11], a[32:39], v3
v_smfmac_f32_16x16x64_bf16 v[32:35], v[8:11], a[64:71], v3
v_smfmac_f32_16x16x64_bf16 v[36:39], v[8:11], a[96:103], v3
s_bitset0_b32 s32, 0
s_branch m_f0_al21
m_f0_ah31:
v_smfmac_f32_16x16x64_bf16 v[24:27], v[12:15], a[8:15], v3
v_smfmac_f32_16x16x64_bf16 v[28:31], v[12:15], a[40:47], v3
v_smfmac_f32_16x16x64_bf16 v[32:35], v[12:15], a[72:79], v3
v_smfmac_f32_16x16x64_bf16 v[36:39], v[12:15], a[104:111], v3
s_bitset0_b32 s32, 1
s_branch m_f0_al22
m_f0_ah32:
v_smfmac_f32_16x16x64_bf16 v[24:27], v[16:19], a[16:23], v3
v_smfmac_f32_16x16x64_bf16 v[28:31], v[16:19], a[48:55], v3
v_smfmac_f32_16x16x64_bf16 v[32:35], v[16:19], a[80:87], v3
v_smfmac_f32_16x16x64_bf16 v[36:39], v[16:19], a[112:119], v3
s_bitset0_b32 s32, 2
s_branch m_f0_al23
m_f0_ah33:
v_smfmac_f32_16x16x64_bf16 v[24:27], v[20:23], a[24:31], v3
v_smfmac_f32_16x16x64_bf16 v[28:31], v[20:23], a[56:63], v3
v_smfmac_f32_16x16x64_bf16 v[32:35], v[20:23], a[88:95], v3
v_smfmac_f32_16x16x64_bf16 v[36:39], v[20:23], a[120:127], v3
s_bitset0_b32 s32, 3
s_branch m_f0_al20
m_f0_al40:
s_waitcnt vmcnt(3)
v_cmp_eq_u32 vcc, -1, v8
s_cbranch_vccz m_f0_ah40
s_cmp_eq_u32 s17, 0
s_cbranch_scc1 m_f0_ah40
s_sub_u32 s17, s17, 1
buffer_load_dwordx4 v[8:11], v56, s[4:7], s19 offen offset:0 sc1
m_f0_al41:
s_waitcnt vmcnt(3)
v_cmp_eq_u32 vcc, -1, v12
s_cbranch_vccz m_f0_ah41
s_cmp_eq_u32 s17, 0
s_cbranch_scc1 m_f0_ah41
s_sub_u32 s17, s17, 1
buffer_load_dwordx4 v[12:15], v56, s[4:7], s19 offen offset:1024 sc1
m_f0_al42:
s_waitcnt vmcnt(3)
v_cmp_eq_u32 vcc, -1, v16
s_cbranch_vccz m_f0_ah42
s_cmp_eq_u32 s17, 0
s_cbranch_scc1 m_f0_ah42
s_sub_u32 s17, s17, 1
buffer_load_dwordx4 v[16:19], v56, s[4:7], s19 offen offset:2048 sc1
m_f0_al43:
s_waitcnt vmcnt(3)
v_cmp_eq_u32 vcc, -1, v20
s_cbranch_vccz m_f0_ah43
s_cmp_eq_u32 s17, 0
s_cbranch_scc1 m_f0_ah43
s_sub_u32 s17, s17, 1
buffer_load_dwordx4 v[20:23], v56, s[4:7], s19 offen offset:3072 sc1
s_branch m_f0_al40
m_f0_ah40:
v_smfmac_f32_16x16x64_bf16 v[24:27], v[8:11], a[0:7], v3
v_smfmac_f32_16x16x64_bf16 v[28:31], v[8:11], a[32:39], v3
v_smfmac_f32_16x16x64_bf16 v[32:35], v[8:11], a[64:71], v3
v_smfmac_f32_16x16x64_bf16 v[36:39], v[8:11], a[96:103], v3
s_bitset0_b32 s32, 0
s_branch m_f0_al31
m_f0_ah41:
v_smfmac_f32_16x16x64_bf16 v[24:27], v[12:15], a[8:15], v3
v_smfmac_f32_16x16x64_bf16 v[28:31], v[12:15], a[40:47], v3
v_smfmac_f32_16x16x64_bf16 v[32:35], v[12:15], a[72:79], v3
v_smfmac_f32_16x16x64_bf16 v[36:39], v[12:15], a[104:111], v3
s_bitset0_b32 s32, 1
s_branch m_f0_al32
m_f0_ah42:
v_smfmac_f32_16x16x64_bf16 v[24:27], v[16:19], a[16:23], v3
v_smfmac_f32_16x16x64_bf16 v[28:31], v[16:19], a[48:55], v3
v_smfmac_f32_16x16x64_bf16 v[32:35], v[16:19], a[80:87], v3
v_smfmac_f32_16x16x64_bf16 v[36:39], v[16:19], a[112:119], v3
s_bitset0_b32 s32, 2
s_branch m_f0_al33
m_f0_ah43:
v_smfmac_f32_16x16x64_bf16 v[24:27], v[20:23], a[24:31], v3
v_smfmac_f32_16x16x64_bf16 v[28:31], v[20:23], a[56:63], v3
v_smfmac_f32_16x16x64_bf16 v[32:35], v[20:23], a[88:95], v3
v_smfmac_f32_16x16x64_bf16 v[36:39], v[20:23], a[120:127], v3
s_bitset0_b32 s32, 3
s_branch m_f0_al30
m_f0_ps:
s_cmp_eq_u32 s17, 0
s_cbranch_scc1 m_f0_psd
s_sub_u32 s17, s17, 1
buffer_load_dwordx4 v[148:151], v69, s[4:7], s19 offen sc1
buffer_load_dwordx4 v[152:155], v70, s[4:7], s19 offen sc1
buffer_load_dwordx4 v[156:159], v71, s[4:7], s19 offen sc1
buffer_load_dwordx4 v[160:163], v72, s[4:7], s19 offen sc1
s_waitcnt vmcnt(7)
v_pk_add_f32 v[136:137], v[144:145], v[164:165]
v_pk_add_f32 v[138:139], v[146:147], v[166:167]
s_waitcnt vmcnt(6)
v_pk_add_f32 v[136:137], v[136:137], v[168:169]
v_pk_add_f32 v[138:139], v[138:139], v[170:171]
s_waitcnt vmcnt(5)
v_pk_add_f32 v[136:137], v[136:137], v[172:173]
v_pk_add_f32 v[138:139], v[138:139], v[174:175]
s_waitcnt vmcnt(4)
v_pk_add_f32 v[140:141], v[176:177], v[178:179]
v_add_f32 v140, v140, v141
v_cmp_u_f32 vcc, v136, v140
s_cbranch_vccz m_f0_psd
s_cmp_eq_u32 s17, 0
s_cbranch_scc1 m_f0_psd
s_sub_u32 s17, s17, 1
buffer_load_dwordx4 v[164:167], v69, s[4:7], s19 offen sc1
buffer_load_dwordx4 v[168:171], v70, s[4:7], s19 offen sc1
buffer_load_dwordx4 v[172:175], v71, s[4:7], s19 offen sc1
buffer_load_dwordx4 v[176:179], v72, s[4:7], s19 offen sc1
s_waitcnt vmcnt(7)
v_pk_add_f32 v[136:137], v[144:145], v[148:149]
v_pk_add_f32 v[138:139], v[146:147], v[150:151]
s_waitcnt vmcnt(6)
v_pk_add_f32 v[136:137], v[136:137], v[152:153]
v_pk_add_f32 v[138:139], v[138:139], v[154:155]
s_waitcnt vmcnt(5)
v_pk_add_f32 v[136:137], v[136:137], v[156:157]
v_pk_add_f32 v[138:139], v[138:139], v[158:159]
s_waitcnt vmcnt(4)
v_pk_add_f32 v[140:141], v[160:161], v[162:163]
v_add_f32 v140, v140, v141
v_cmp_u_f32 vcc, v136, v140
s_cbranch_vccz m_f0_psd
s_branch m_f0_ps
m_f0_om0:
s_mov_b32 s32, 15
s_cmp_eq_u32 s17, 0
s_cbranch_scc1 m_f0_oh40
s_sub_u32 s17, s17, 1
buffer_load_dwordx4 v[8:11], v57, s[4:7], s19 offen offset:0 sc1
s_branch m_f0_ol41
m_f0_om1:
v_smfmac_f32_16x16x64_bf16 v[52:55], v[8:11], a[224:231], v3
s_mov_b32 s32, 14
s_cmp_eq_u32 s17, 0
s_cbranch_scc1 m_f0_oh31
s_sub_u32 s17, s17, 1
buffer_load_dwordx4 v[12:15], v57, s[4:7], s19 offen offset:1024 sc1
s_branch m_f0_ol32
m_f0_om2:
v_smfmac_f32_16x16x64_bf16 v[52:55], v[12:15], a[232:239], v3
s_mov_b32 s32, 12
s_cmp_eq_u32 s17, 0
s_cbranch_scc1 m_f0_oh22
s_sub_u32 s17, s17, 1
buffer_load_dwordx4 v[16:19], v57, s[4:7], s19 offen offset:2048 sc1
s_branch m_f0_ol23
m_f0_om3:
v_smfmac_f32_16x16x64_bf16 v[52:55], v[16:19], a[240:247], v3
s_mov_b32 s32, 8
s_cmp_eq_u32 s17, 0
s_cbranch_scc1 m_f0_oh13
s_sub_u32 s17, s17, 1
buffer_load_dwordx4 v[20:23], v57, s[4:7], s19 offen offset:3072 sc1
s_branch m_f0_ol10
m_f0_ol10:
s_bitcmp1_b32 s32, 0
s_cbranch_scc0 m_f0_ol11
s_waitcnt vmcnt(0)
v_cmp_eq_u32 vcc, -1, v8
s_cbranch_vccz m_f0_oh10
s_cmp_eq_u32 s17, 0
s_cbranch_scc1 m_f0_oh10
s_sub_u32 s17, s17, 1
buffer_load_dwordx4 v[8:11], v57, s[4:7], s19 offen offset:0 sc1
m_f0_ol11:
s_bitcmp1_b32 s32, 1
s_cbranch_scc0 m_f0_ol12
s_waitcnt vmcnt(0)
v_cmp_eq_u32 vcc, -1, v12
s_cbranch_vccz m_f0_oh11
s_cmp_eq_u32 s17, 0
s_cbranch_scc1 m_f0_oh11
s_sub_u32 s17, s17, 1
buffer_load_dwordx4 v[12:15], v57, s[4:7], s19 offen offset:1024 sc1
m_f0_ol12:
s_bitcmp1_b32 s32, 2
s_cbranch_scc0 m_f0_ol13
s_waitcnt vmcnt(0)
v_cmp_eq_u32 vcc, -1, v16
s_cbranch_vccz m_f0_oh12
s_cmp_eq_u32 s17, 0
s_cbranch_scc1 m_f0_oh12
s_sub_u32 s17, s17, 1
buffer_load_dwordx4 v[16:19], v57, s[4:7], s19 offen offset:2048 sc1
m_f0_ol13:
s_bitcmp1_b32 s32, 3
s_cbranch_scc0 m_f0_ol10
s_waitcnt vmcnt(0)
v_cmp_eq_u32 vcc, -1, v20
s_cbranch_vccz m_f0_oh13
s_cmp_eq_u32 s17, 0
s_cbranch_scc1 m_f0_oh13
s_sub_u32 s17, s17, 1
buffer_load_dwordx4 v[20:23], v57, s[4:7], s19 offen offset:3072 sc1
s_branch m_f0_ol10
m_f0_oh10:
v_smfmac_f32_16x16x64_bf16 v[48:51], v[8:11], a[192:199], v3
v_smfmac_f32_16x16x64_bf16 v[52:55], v[8:11], a[224:231], v3
s_branch m_f0_ob
m_f0_oh11:
v_smfmac_f32_16x16x64_bf16 v[48:51], v[12:15], a[200:207], v3
v_smfmac_f32_16x16x64_bf16 v[52:55], v[12:15], a[232:239], v3
s_branch m_f0_ob
m_f0_oh12:
v_smfmac_f32_16x16x64_bf16 v[48:51], v[16:19], a[208:215], v3
v_smfmac_f32_16x16x64_bf16 v[52:55], v[16:19], a[240:247], v3
s_branch m_f0_ob
m_f0_oh13:
v_smfmac_f32_16x16x64_bf16 v[48:51], v[20:23], a[216:223], v3
v_smfmac_f32_16x16x64_bf16 v[52:55], v[20:23], a[248:255], v3
s_branch m_f0_ob
m_f0_ol20:
s_bitcmp1_b32 s32, 0
s_cbranch_scc0 m_f0_ol21
s_waitcnt vmcnt(1)
v_cmp_eq_u32 vcc, -1, v8
s_cbranch_vccz m_f0_oh20
s_cmp_eq_u32 s17, 0
s_cbranch_scc1 m_f0_oh20
s_sub_u32 s17, s17, 1
buffer_load_dwordx4 v[8:11], v57, s[4:7], s19 offen offset:0 sc1
m_f0_ol21:
s_bitcmp1_b32 s32, 1
s_cbranch_scc0 m_f0_ol22
s_waitcnt vmcnt(1)
v_cmp_eq_u32 vcc, -1, v12
s_cbranch_vccz m_f0_oh21
s_cmp_eq_u32 s17, 0
s_cbranch_scc1 m_f0_oh21
s_sub_u32 s17, s17, 1
buffer_load_dwordx4 v[12:15], v57, s[4:7], s19 offen offset:1024 sc1
m_f0_ol22:
s_bitcmp1_b32 s32, 2
s_cbranch_scc0 m_f0_ol23
s_waitcnt vmcnt(1)
v_cmp_eq_u32 vcc, -1, v16
s_cbranch_vccz m_f0_oh22
s_cmp_eq_u32 s17, 0
s_cbranch_scc1 m_f0_oh22
s_sub_u32 s17, s17, 1
buffer_load_dwordx4 v[16:19], v57, s[4:7], s19 offen offset:2048 sc1
m_f0_ol23:
s_bitcmp1_b32 s32, 3
s_cbranch_scc0 m_f0_ol20
s_waitcnt vmcnt(1)
v_cmp_eq_u32 vcc, -1, v20
s_cbranch_vccz m_f0_oh23
s_cmp_eq_u32 s17, 0
s_cbranch_scc1 m_f0_oh23
s_sub_u32 s17, s17, 1
buffer_load_dwordx4 v[20:23], v57, s[4:7], s19 offen offset:3072 sc1
s_branch m_f0_ol20
m_f0_oh20:
v_smfmac_f32_16x16x64_bf16 v[48:51], v[8:11], a[192:199], v3
v_smfmac_f32_16x16x64_bf16 v[52:55], v[8:11], a[224:231], v3
s_bitset0_b32 s32, 0
s_branch m_f0_ol11
m_f0_oh21:
v_smfmac_f32_16x16x64_bf16 v[48:51], v[12:15], a[200:207], v3
v_smfmac_f32_16x16x64_bf16 v[52:55], v[12:15], a[232:239], v3
s_bitset0_b32 s32, 1
s_branch m_f0_ol12
m_f0_oh22:
v_smfmac_f32_16x16x64_bf16 v[48:51], v[16:19], a[208:215], v3
v_smfmac_f32_16x16x64_bf16 v[52:55], v[16:19], a[240:247], v3
s_bitset0_b32 s32, 2
s_branch m_f0_ol13
m_f0_oh23:
v_smfmac_f32_16x16x64_bf16 v[48:51], v[20:23], a[216:223], v3
v_smfmac_f32_16x16x64_bf16 v[52:55], v[20:23], a[248:255], v3
s_bitset0_b32 s32, 3
s_branch m_f0_ol10
m_f0_ol30:
s_bitcmp1_b32 s32, 0
s_cbranch_scc0 m_f0_ol31
s_waitcnt vmcnt(2)
v_cmp_eq_u32 vcc, -1, v8
s_cbranch_vccz m_f0_oh30
s_cmp_eq_u32 s17, 0
s_cbranch_scc1 m_f0_oh30
s_sub_u32 s17, s17, 1
buffer_load_dwordx4 v[8:11], v57, s[4:7], s19 offen offset:0 sc1
m_f0_ol31:
s_bitcmp1_b32 s32, 1
s_cbranch_scc0 m_f0_ol32
s_waitcnt vmcnt(2)
v_cmp_eq_u32 vcc, -1, v12
s_cbranch_vccz m_f0_oh31
s_cmp_eq_u32 s17, 0
s_cbranch_scc1 m_f0_oh31
s_sub_u32 s17, s17, 1
buffer_load_dwordx4 v[12:15], v57, s[4:7], s19 offen offset:1024 sc1
m_f0_ol32:
s_bitcmp1_b32 s32, 2
s_cbranch_scc0 m_f0_ol33
s_waitcnt vmcnt(2)
v_cmp_eq_u32 vcc, -1, v16
s_cbranch_vccz m_f0_oh32
s_cmp_eq_u32 s17, 0
s_cbranch_scc1 m_f0_oh32
s_sub_u32 s17, s17, 1
buffer_load_dwordx4 v[16:19], v57, s[4:7], s19 offen offset:2048 sc1
m_f0_ol33:
s_bitcmp1_b32 s32, 3
s_cbranch_scc0 m_f0_ol30
s_waitcnt vmcnt(2)
v_cmp_eq_u32 vcc, -1, v20
s_cbranch_vccz m_f0_oh33
s_cmp_eq_u32 s17, 0
s_cbranch_scc1 m_f0_oh33
s_sub_u32 s17, s17, 1
buffer_load_dwordx4 v[20:23], v57, s[4:7], s19 offen offset:3072 sc1
s_branch m_f0_ol30
m_f0_oh30:
v_smfmac_f32_16x16x64_bf16 v[48:51], v[8:11], a[192:199], v3
v_smfmac_f32_16x16x64_bf16 v[52:55], v[8:11], a[224:231], v3
s_bitset0_b32 s32, 0
s_branch m_f0_ol21
m_f0_oh31:
v_smfmac_f32_16x16x64_bf16 v[48:51], v[12:15], a[200:207], v3
v_smfmac_f32_16x16x64_bf16 v[52:55], v[12:15], a[232:239], v3
s_bitset0_b32 s32, 1
s_branch m_f0_ol22
m_f0_oh32:
v_smfmac_f32_16x16x64_bf16 v[48:51], v[16:19], a[208:215], v3
v_smfmac_f32_16x16x64_bf16 v[52:55], v[16:19], a[240:247], v3
s_bitset0_b32 s32, 2
s_branch m_f0_ol23
m_f0_oh33:
v_smfmac_f32_16x16x64_bf16 v[48:51], v[20:23], a[216:223], v3
v_smfmac_f32_16x16x64_bf16 v[52:55], v[20:23], a[248:255], v3
s_bitset0_b32 s32, 3
s_branch m_f0_ol20
m_f0_ol40:
s_waitcnt vmcnt(3)
v_cmp_eq_u32 vcc, -1, v8
s_cbranch_vccz m_f0_oh40
s_cmp_eq_u32 s17, 0
s_cbranch_scc1 m_f0_oh40
s_sub_u32 s17, s17, 1
buffer_load_dwordx4 v[8:11], v57, s[4:7], s19 offen offset:0 sc1
m_f0_ol41:
s_waitcnt vmcnt(3)
v_cmp_eq_u32 vcc, -1, v12
s_cbranch_vccz m_f0_oh41
s_cmp_eq_u32 s17, 0
s_cbranch_scc1 m_f0_oh41
s_sub_u32 s17, s17, 1
buffer_load_dwordx4 v[12:15], v57, s[4:7], s19 offen offset:1024 sc1
m_f0_ol42:
s_waitcnt vmcnt(3)
v_cmp_eq_u32 vcc, -1, v16
s_cbranch_vccz m_f0_oh42
s_cmp_eq_u32 s17, 0
s_cbranch_scc1 m_f0_oh42
s_sub_u32 s17, s17, 1
buffer_load_dwordx4 v[16:19], v57, s[4:7], s19 offen offset:2048 sc1
m_f0_ol43:
s_waitcnt vmcnt(3)
v_cmp_eq_u32 vcc, -1, v20
s_cbranch_vccz m_f0_oh43
s_cmp_eq_u32 s17, 0
s_cbranch_scc1 m_f0_oh43
s_sub_u32 s17, s17, 1
buffer_load_dwordx4 v[20:23], v57, s[4:7], s19 offen offset:3072 sc1
s_branch m_f0_ol40
m_f0_oh40:
v_smfmac_f32_16x16x64_bf16 v[48:51], v[8:11], a[192:199], v3
v_smfmac_f32_16x16x64_bf16 v[52:55], v[8:11], a[224:231], v3
s_bitset0_b32 s32, 0
s_branch m_f0_ol31
m_f0_oh41:
v_smfmac_f32_16x16x64_bf16 v[48:51], v[12:15], a[200:207], v3
v_smfmac_f32_16x16x64_bf16 v[52:55], v[12:15], a[232:239], v3
s_bitset0_b32 s32, 1
s_branch m_f0_ol32
m_f0_oh42:
v_smfmac_f32_16x16x64_bf16 v[48:51], v[16:19], a[208:215], v3
v_smfmac_f32_16x16x64_bf16 v[52:55], v[16:19], a[240:247], v3
s_bitset0_b32 s32, 2
s_branch m_f0_ol33
m_f0_oh43:
v_smfmac_f32_16x16x64_bf16 v[48:51], v[20:23], a[216:223], v3
v_smfmac_f32_16x16x64_bf16 v[52:55], v[20:23], a[248:255], v3
s_bitset0_b32 s32, 3
s_branch m_f0_ol30
m_f0_ppr:
s_cmp_eq_u32 s17, 0
s_cbranch_scc1 m_f0_ppd
s_sub_u32 s17, s17, 1
buffer_load_dwordx4 v[148:151], v62, s[4:7], s31 offen sc1
buffer_load_dwordx4 v[152:155], v63, s[4:7], s31 offen sc1
buffer_load_dwordx4 v[156:159], v64, s[4:7], s31 offen sc1
s_waitcnt vmcnt(1)
v_pk_add_f32 v[148:149], v[148:149], v[152:153]
v_pk_add_f32 v[150:151], v[150:151], v[154:155]
s_waitcnt vmcnt(0)
v_pk_add_f32 v[156:157], v[156:157], v[96:97]
v_pk_add_f32 v[158:159], v[158:159], v[98:99]
v_pk_add_f32 v[148:149], v[148:149], v[156:157]
v_pk_add_f32 v[150:151], v[150:151], v[158:159]
v_cmp_u_f32 vcc, v148, v151
v_cvt_pk_bf16_f32 v100, v148, v149
v_cvt_pk_bf16_f32 v101, v150, v151
s_cbranch_vccz m_f0_ppd
s_branch m_f0_ppr
m_f0_fin:
s_waitcnt vmcnt(0)
s_barrier
s_branch m_recdone
m_safe0:
m_s0_top:
s_cmp_ge_u32 s18, 15
s_cbranch_scc1 m_s0_ow0
ds_write_b128 v242, v[208:211] offset:0
ds_write_b128 v242, v[212:215] offset:1024
ds_write_b128 v242, v[224:227] offset:16384
ds_write_b128 v242, v[228:231] offset:17408
ds_write_b128 v242, v[216:219] offset:8192
ds_write_b128 v242, v[220:223] offset:9216
ds_write_b128 v242, v[232:235] offset:24576
ds_write_b128 v242, v[236:239] offset:25600
m_s0_ow0:
s_waitcnt vmcnt(3)
v_cmp_eq_u32 vcc, -1, v8
s_cbranch_vccnz m_s0_am0
v_smfmac_f32_16x16x64_bf16 v[24:27], v[8:11], a[0:7], v3
v_smfmac_f32_16x16x64_bf16 v[28:31], v[8:11], a[32:39], v3
s_waitcnt vmcnt(2)
v_cmp_eq_u32 vcc, -1, v12
v_smfmac_f32_16x16x64_bf16 v[32:35], v[8:11], a[64:71], v3
s_cbranch_vccnz m_s0_am1
v_smfmac_f32_16x16x64_bf16 v[36:39], v[8:11], a[96:103], v3
v_smfmac_f32_16x16x64_bf16 v[24:27], v[12:15], a[8:15], v3
v_smfmac_f32_16x16x64_bf16 v[28:31], v[12:15], a[40:47], v3
s_waitcnt vmcnt(1)
v_cmp_eq_u32 vcc, -1, v16
v_smfmac_f32_16x16x64_bf16 v[32:35], v[12:15], a[72:79], v3
s_cbranch_vccnz m_s0_am2
v_smfmac_f32_16x16x64_bf16 v[36:39], v[12:15], a[104:111], v3
v_smfmac_f32_16x16x64_bf16 v[24:27], v[16:19], a[16:23], v3
v_smfmac_f32_16x16x64_bf16 v[28:31], v[16:19], a[48:55], v3
s_waitcnt vmcnt(0)
v_cmp_eq_u32 vcc, -1, v20
v_smfmac_f32_16x16x64_bf16 v[32:35], v[16:19], a[80:87], v3
s_cbranch_vccnz m_s0_am3
v_smfmac_f32_16x16x64_bf16 v[36:39], v[16:19], a[112:119], v3
v_smfmac_f32_16x16x64_bf16 v[24:27], v[20:23], a[24:31], v3
v_smfmac_f32_16x16x64_bf16 v[28:31], v[20:23], a[56:63], v3
v_smfmac_f32_16x16x64_bf16 v[32:35], v[20:23], a[88:95], v3
v_smfmac_f32_16x16x64_bf16 v[36:39], v[20:23], a[120:127], v3
m_s0_ab:
v_smfmac_f32_16x16x64_bf16 v[40:43], v[8:11], a[128:135], v3
v_pk_add_f32 v[24:25], v[24:25], v[26:27]
v_pk_add_f32 v[28:29], v[28:29], v[30:31]
ds_write2_b32 v58, v24, v25 offset0:80 offset1:120
ds_write2_b32 v58, v28, v29 offset0:96 offset1:136
v_smfmac_f32_16x16x64_bf16 v[44:47], v[8:11], a[160:167], v3
v_pk_add_f32 v[32:33], v[32:33], v[34:35]
v_pk_add_f32 v[36:37], v[36:37], v[38:39]
ds_write2_b32 v58, v32, v33 offset0:0 offset1:40
ds_write2_b32 v58, v36, v37 offset0:16 offset1:56
s_and_b32 s30, s18, 3
s_lshl_b32 s19, s30, 19
s_add_u32 s19, s19, 167772160
v_smfmac_f32_16x16x64_bf16 v[40:43], v[12:15], a[136:143], v3
v_smfmac_f32_16x16x64_bf16 v[44:47], v[12:15], a[168:175], v3
s_waitcnt lgkmcnt(0)
s_barrier
ds_read_b128 v[148:151], v66 offset:0
ds_read_b128 v[152:155], v66 offset:32
ds_read_b128 v[156:159], v66 offset:2560
ds_read_b128 v[160:163], v66 offset:2592
ds_read_b128 v[164:167], v66 offset:5120
ds_read_b128 v[168:171], v66 offset:5152
ds_read_b128 v[172:175], v66 offset:7680
ds_read_b128 v[176:179], v66 offset:7712
v_smfmac_f32_16x16x64_bf16 v[40:43], v[16:19], a[144:151], v3
v_smfmac_f32_16x16x64_bf16 v[44:47], v[16:19], a[176:183], v3
v_smfmac_f32_16x16x64_bf16 v[40:43], v[20:23], a[152:159], v3
v_smfmac_f32_16x16x64_bf16 v[44:47], v[20:23], a[184:191], v3
s_waitcnt lgkmcnt(4)
v_pk_add_f32 v[148:149], v[148:149], v[156:157]
v_pk_add_f32 v[150:151], v[150:151], v[158:159]
v_pk_add_f32 v[152:153], v[152:153], v[160:161]
v_pk_add_f32 v[154:155], v[154:155], v[162:163]
s_waitcnt lgkmcnt(2)
v_pk_add_f32 v[148:149], v[148:149], v[164:165]
v_pk_add_f32 v[150:151], v[150:151], v[166:167]
v_pk_add_f32 v[152:153], v[152:153], v[168:169]
v_pk_add_f32 v[154:155], v[154:155], v[170:171]
s_waitcnt lgkmcnt(1)
v_pk_add_f32 v[148:149], v[148:149], v[172:173]
v_pk_add_f32 v[150:151], v[150:151], v[174:175]
s_waitcnt lgkmcnt(0)
v_pk_add_f32 v[152:153], v[152:153], v[176:177]
v_pk_add_f32 v[154:155], v[154:155], v[178:179]
v_cvt_pk_bf16_f32 v100, v148, v149
v_cvt_pk_bf16_f32 v101, v150, v151
v_cvt_pk_bf16_f32 v102, v152, v153
v_cvt_pk_bf16_f32 v103, v154, v155
s_nop 1
v_mfma_f32_16x16x32_bf16 v[104:107], v[80:83], v[100:103], 0
v_mfma_f32_16x16x32_bf16 v[108:111], v[84:87], v[100:103], 0
v_mfma_f32_16x16x32_bf16 v[112:115], v[100:103], v[100:103], 0
v_pk_add_f32 v[96:97], v[40:41], v[42:43]
v_pk_add_f32 v[98:99], v[44:45], v[46:47]
buffer_store_dwordx4 v[104:107], v67, s[4:7], s19 offen sc1
s_nop 1
buffer_store_dwordx4 v[108:111], v67, s[4:7], s19 offen offset:32 sc1
s_nop 1
buffer_store_dword v112, v68, s[4:7], s19 offen sc1
buffer_store_dword v113, v68, s[4:7], s19 offen offset:32 sc1
ds_write_b128 v59, v[96:99] offset:12288
s_mov_b64 vcc, s[66:67]
v_cndmask_b32_dpp v144, v104, v108, vcc quad_perm:[2,3,2,3] row_mask:0xf bank_mask:0xf
v_cndmask_b32_dpp v145, v105, v109, vcc quad_perm:[2,3,2,3] row_mask:0xf bank_mask:0xf
v_cndmask_b32_dpp v146, v106, v110, vcc quad_perm:[2,3,2,3] row_mask:0xf bank_mask:0xf
v_cndmask_b32_dpp v147, v107, v111, vcc quad_perm:[2,3,2,3] row_mask:0xf bank_mask:0xf
s_waitcnt lgkmcnt(0)
s_barrier
s_cmp_eq_u32 s18, 63
s_cbranch_scc1 m_s0_fin
buffer_load_dwordx4 v[148:151], v69, s[4:7], s19 offen sc1
buffer_load_dwordx4 v[152:155], v70, s[4:7], s19 offen sc1
buffer_load_dwordx4 v[156:159], v71, s[4:7], s19 offen sc1
buffer_load_dwordx4 v[160:163], v72, s[4:7], s19 offen sc1
ds_read_b128 v[180:183], v59 offset:13312
ds_read_b128 v[184:187], v59 offset:14336
ds_read_b128 v[188:191], v59 offset:15360
s_waitcnt lgkmcnt(0)
v_pk_add_f32 v[192:193], v[96:97], v[180:181]
v_pk_add_f32 v[194:195], v[98:99], v[182:183]
v_pk_add_f32 v[96:97], v[184:185], v[188:189]
v_pk_add_f32 v[98:99], v[186:187], v[190:191]
v_pk_add_f32 v[96:97], v[96:97], v[192:193]
v_pk_add_f32 v[98:99], v[98:99], v[194:195]
v_cvt_pk_bf16_f32 v116, v96, v97
v_cvt_pk_bf16_f32 v120, v98, v99
buffer_load_dwordx4 v[164:167], v69, s[4:7], s19 offen sc1
buffer_load_dwordx4 v[168:171], v70, s[4:7], s19 offen sc1
buffer_load_dwordx4 v[172:175], v71, s[4:7], s19 offen sc1
buffer_load_dwordx4 v[176:179], v72, s[4:7], s19 offen sc1
v_mov_b64 v[24:25], 0
v_mov_b64 v[26:27], 0
v_mov_b64 v[28:29], 0
v_mov_b64 v[30:31], 0
v_mov_b64 v[32:33], 0
v_mov_b64 v[34:35], 0
v_mov_b64 v[36:37], 0
v_mov_b64 v[38:39], 0
v_mov_b64 v[40:41], 0
v_mov_b64 v[42:43], 0
v_mov_b64 v[44:45], 0
v_mov_b64 v[46:47], 0
s_waitcnt vmcnt(7)
v_pk_add_f32 v[136:137], v[144:145], v[148:149]
v_pk_add_f32 v[138:139], v[146:147], v[150:151]
s_waitcnt vmcnt(6)
v_pk_add_f32 v[136:137], v[136:137], v[152:153]
v_pk_add_f32 v[138:139], v[138:139], v[154:155]
s_waitcnt vmcnt(5)
v_pk_add_f32 v[136:137], v[136:137], v[156:157]
v_pk_add_f32 v[138:139], v[138:139], v[158:159]
s_waitcnt vmcnt(4)
v_pk_add_f32 v[140:141], v[160:161], v[162:163]
v_add_f32 v140, v140, v141
v_cmp_u_f32 vcc, v136, v140
s_cbranch_vccnz m_s0_ps
m_s0_psd:
v_max3_f32 v76, v136, v137, v140
v_max3_f32 v76, v76, v138, v139
s_nop 1
v_max_f32_dpp v76, v76, v76 quad_perm:[2,3,0,1] row_mask:0xf bank_mask:0xf
v_mov_b32 v77, v76
s_nop 1
v_permlane16_swap_b32 v76, v77
v_max_f32 v76, v76, v77
v_mov_b32 v77, v76
s_nop 1
v_permlane32_swap_b32 v76, v77
v_max_f32 v76, v76, v77
v_mul_f32 v76, s33, v76
v_fma_f32 v136, v136, s33, -v76
v_fma_f32 v137, v137, s33, -v76
v_fma_f32 v138, v138, s33, -v76
v_fma_f32 v139, v139, s33, -v76
v_fma_f32 v140, v140, s33, -v76
v_exp_f32 v136, v136
v_exp_f32 v137, v137
v_exp_f32 v138, v138
v_exp_f32 v139, v139
v_exp_f32 v140, v140
v_cvt_pk_bf16_f32 v132, v136, v137
v_cvt_pk_bf16_f32 v133, v138, v139
v_mov_b32_dpp v77, v140 quad_perm:[2,3,0,1] row_mask:0xf bank_mask:0xf
v_mov_b32_dpp v134, v132 quad_perm:[2,3,0,1] row_mask:0xf bank_mask:0xf
v_mov_b32_dpp v135, v133 quad_perm:[2,3,0,1] row_mask:0xf bank_mask:0xf
v_cvt_pk_bf16_f32 v124, v140, v77
s_nop 0
v_mfma_f32_16x16x32_bf16 v[112:115], v[128:131], v[132:135], 0
v_mfma_f32_16x16x32_bf16 v[112:115], v[128:131], v[124:127], v[112:115]
v_mfma_f32_16x16x32_bf16 v[104:107], v[88:91], v[132:135], 0
v_mfma_f32_16x16x32_bf16 v[104:107], v[116:119], v[124:127], v[104:107]
v_mfma_f32_16x16x32_bf16 v[108:111], v[92:95], v[132:135], 0
v_rcp_f32 v76, v112
v_mfma_f32_16x16x32_bf16 v[108:111], v[120:123], v[124:127], v[108:111]
s_nop 1
v_pk_mul_f32 v[104:105], v[104:105], v[76:77] op_sel_hi:[1,0]
v_cvt_pk_bf16_f32 v100, v104, v105
v_pk_mul_f32 v[106:107], v[106:107], v[76:77] op_sel_hi:[1,0]
v_cvt_pk_bf16_f32 v101, v106, v107
s_nop 1
v_pk_mul_f32 v[108:109], v[108:109], v[76:77] op_sel_hi:[1,0]
v_cvt_pk_bf16_f32 v102, v108, v109
v_pk_mul_f32 v[110:111], v[110:111], v[76:77] op_sel_hi:[1,0]
v_cvt_pk_bf16_f32 v103, v110, v111
buffer_store_dwordx4 v[100:103], v73, s[4:7], s19 offen sc1
ds_read_b128 v[180:183], v241 offset:0
ds_read_b128 v[184:187], v241 offset:1024
ds_read_b128 v[188:191], v241 offset:2048
ds_read_b128 v[192:195], v241 offset:3072
s_waitcnt vmcnt(0)
s_barrier
buffer_load_dwordx4 v[8:11], v57, s[4:7], s19 offen offset:0 sc1
buffer_load_dwordx4 v[12:15], v57, s[4:7], s19 offen offset:1024 sc1
buffer_load_dwordx4 v[16:19], v57, s[4:7], s19 offen offset:2048 sc1
buffer_load_dwordx4 v[20:23], v57, s[4:7], s19 offen offset:3072 sc1
s_cmp_ge_u32 s18, 15
s_cbranch_scc1 m_s0_ow1
s_waitcnt lgkmcnt(0)
ds_read_b128 v[164:167], v241 offset:4096
ds_read_b128 v[168:171], v241 offset:5120
ds_read_b128 v[172:175], v241 offset:6144
ds_read_b128 v[176:179], v241 offset:7168
v_mfma_f32_16x16x32_bf16 v[208:211], a[64:67], v[180:183], 0
v_mfma_f32_16x16x32_bf16 v[224:227], v[180:183], a[128:131], 0
v_mfma_f32_16x16x32_bf16 v[212:215], a[96:99], v[180:183], 0
v_mfma_f32_16x16x32_bf16 v[232:235], v[180:183], a[160:163], 0
ds_read_b128 v[180:183], v241 offset:8192
v_mfma_f32_16x16x32_bf16 v[216:219], a[64:67], v[184:187], 0
v_mfma_f32_16x16x32_bf16 v[228:231], v[184:187], a[128:131], 0
v_mfma_f32_16x16x32_bf16 v[220:223], a[96:99], v[184:187], 0
v_mfma_f32_16x16x32_bf16 v[236:239], v[184:187], a[160:163], 0
ds_read_b128 v[184:187], v241 offset:9216
v_mfma_f32_16x16x32_bf16 v[208:211], a[68:71], v[188:191], v[208:211]
v_mfma_f32_16x16x32_bf16 v[224:227], v[188:191], a[132:135], v[224:227]
v_mfma_f32_16x16x32_bf16 v[212:215], a[100:103], v[188:191], v[212:215]
v_mfma_f32_16x16x32_bf16 v[232:235], v[188:191], a[164:167], v[232:235]
ds_read_b128 v[188:191], v241 offset:10240
v_mfma_f32_16x16x32_bf16 v[216:219], a[68:71], v[192:195], v[216:219]
v_mfma_f32_16x16x32_bf16 v[228:231], v[192:195], a[132:135], v[228:231]
v_mfma_f32_16x16x32_bf16 v[220:223], a[100:103], v[192:195], v[220:223]
v_mfma_f32_16x16x32_bf16 v[236:239], v[192:195], a[164:167], v[236:239]
ds_read_b128 v[192:195], v241 offset:11264
m_s0_ow1:
s_waitcnt vmcnt(3)
v_cmp_eq_u32 vcc, -1, v8
s_cbranch_vccnz m_s0_om0
v_smfmac_f32_16x16x64_bf16 v[48:51], v[8:11], a[192:199], v3
s_waitcnt vmcnt(2)
v_cmp_eq_u32 vcc, -1, v12
s_cbranch_vccnz m_s0_om1
v_smfmac_f32_16x16x64_bf16 v[52:55], v[8:11], a[224:231], v3
v_smfmac_f32_16x16x64_bf16 v[48:51], v[12:15], a[200:207], v3
s_waitcnt vmcnt(1)
v_cmp_eq_u32 vcc, -1, v16
s_cbranch_vccnz m_s0_om2
v_smfmac_f32_16x16x64_bf16 v[52:55], v[12:15], a[232:239], v3
v_smfmac_f32_16x16x64_bf16 v[48:51], v[16:19], a[208:215], v3
s_waitcnt vmcnt(0)
v_cmp_eq_u32 vcc, -1, v20
s_cbranch_vccnz m_s0_om3
v_smfmac_f32_16x16x64_bf16 v[52:55], v[16:19], a[240:247], v3
v_smfmac_f32_16x16x64_bf16 v[48:51], v[20:23], a[216:223], v3
v_smfmac_f32_16x16x64_bf16 v[52:55], v[20:23], a[248:255], v3
m_s0_ob:
s_nop 4
v_pk_add_f32 v[96:97], v[48:49], v[50:51]
s_nop 1
v_pk_add_f32 v[98:99], v[52:53], v[54:55]
ds_write2_b32 v240, v96, v97 offset0:0 offset1:72
ds_write2_b32 v240, v98, v99 offset0:160 offset1:232
s_waitcnt lgkmcnt(0)
s_barrier
ds_read_b128 v[148:151], v60 offset:16384
ds_read_b128 v[152:155], v60 offset:17664
ds_read_b128 v[156:159], v60 offset:18944
ds_read_b128 v[160:163], v60 offset:20224
buffer_store_dwordx2 v[4:5], v65, s[4:7], s20 offen sc1
s_waitcnt lgkmcnt(2)
v_pk_add_f32 v[148:149], v[148:149], v[152:153]
v_pk_add_f32 v[150:151], v[150:151], v[154:155]
s_waitcnt lgkmcnt(0)
v_pk_add_f32 v[156:157], v[156:157], v[160:161]
v_pk_add_f32 v[158:159], v[158:159], v[162:163]
v_pk_add_f32 v[96:97], v[148:149], v[156:157]
v_pk_add_f32 v[98:99], v[150:151], v[158:159]
buffer_store_dwordx4 v[96:99], v61, s[4:7], s21 offen sc1
ds_read_b128 v[80:83], v74 offset:24576
ds_read_b128 v[84:87], v74 offset:25600
ds_read_b128 v[88:91], v74 offset:26624
ds_read_b128 v[92:95], v74 offset:27648
v_xor_b32 v74, 4096, v74
v_mov_b64 v[48:49], 0
v_mov_b64 v[50:51], 0
v_mov_b64 v[52:53], 0
v_mov_b64 v[54:55], 0
s_add_u32 s18, s18, 1
s_mov_b32 s31, s21
s_and_b32 s30, s18, 3
s_lshl_b32 s21, s30, 18
s_xor_b32 s22, s21, 524288
s_add_u32 s21, s21, 169869312
s_add_u32 s22, s22, 169869312
s_xor_b32 s30, s30, 2
s_lshl_b32 s20, s30, 19
s_add_u32 s20, s20, 167772160
s_cmp_ge_u32 s18, 16
s_cbranch_scc1 m_s0_ow2
v_mfma_f32_16x16x32_bf16 v[208:211], a[72:75], v[164:167], v[208:211]
v_mfma_f32_16x16x32_bf16 v[224:227], v[164:167], a[136:139], v[224:227]
v_mfma_f32_16x16x32_bf16 v[212:215], a[104:107], v[164:167], v[212:215]
v_mfma_f32_16x16x32_bf16 v[232:235], v[164:167], a[168:171], v[232:235]
ds_read_b128 v[164:167], v241 offset:12288
v_mfma_f32_16x16x32_bf16 v[216:219], a[72:75], v[168:171], v[216:219]
v_mfma_f32_16x16x32_bf16 v[228:231], v[168:171], a[136:139], v[228:231]
v_mfma_f32_16x16x32_bf16 v[220:223], a[104:107], v[168:171], v[220:223]
v_mfma_f32_16x16x32_bf16 v[236:239], v[168:171], a[168:171], v[236:239]
ds_read_b128 v[168:171], v241 offset:13312
v_mfma_f32_16x16x32_bf16 v[208:211], a[76:79], v[172:175], v[208:211]
v_mfma_f32_16x16x32_bf16 v[224:227], v[172:175], a[140:143], v[224:227]
v_mfma_f32_16x16x32_bf16 v[212:215], a[108:111], v[172:175], v[212:215]
v_mfma_f32_16x16x32_bf16 v[232:235], v[172:175], a[172:175], v[232:235]
ds_read_b128 v[172:175], v241 offset:14336
v_mfma_f32_16x16x32_bf16 v[216:219], a[76:79], v[176:179], v[216:219]
v_mfma_f32_16x16x32_bf16 v[228:231], v[176:179], a[140:143], v[228:231]
v_mfma_f32_16x16x32_bf16 v[220:223], a[108:111], v[176:179], v[220:223]
v_mfma_f32_16x16x32_bf16 v[236:239], v[176:179], a[172:175], v[236:239]
ds_read_b128 v[176:179], v241 offset:15360
v_mfma_f32_16x16x32_bf16 v[208:211], a[80:83], v[180:183], v[208:211]
v_mfma_f32_16x16x32_bf16 v[224:227], v[180:183], a[144:147], v[224:227]
v_mfma_f32_16x16x32_bf16 v[212:215], a[112:115], v[180:183], v[212:215]
v_mfma_f32_16x16x32_bf16 v[232:235], v[180:183], a[176:179], v[232:235]
v_mfma_f32_16x16x32_bf16 v[216:219], a[80:83], v[184:187], v[216:219]
v_mfma_f32_16x16x32_bf16 v[228:231], v[184:187], a[144:147], v[228:231]
v_mfma_f32_16x16x32_bf16 v[220:223], a[112:115], v[184:187], v[220:223]
v_mfma_f32_16x16x32_bf16 v[236:239], v[184:187], a[176:179], v[236:239]
m_s0_ow2:
s_waitcnt vmcnt(1)
buffer_load_dwordx4 v[148:151], v62, s[4:7], s31 offen sc1
buffer_load_dwordx4 v[152:155], v63, s[4:7], s31 offen sc1
buffer_load_dwordx4 v[156:159], v64, s[4:7], s31 offen sc1
s_cmp_ge_u32 s18, 16
s_cbranch_scc1 m_s0_ow3
s_waitcnt lgkmcnt(0)
v_mfma_f32_16x16x32_bf16 v[208:211], a[84:87], v[188:191], v[208:211]
v_mfma_f32_16x16x32_bf16 v[224:227], v[188:191], a[148:151], v[224:227]
v_mfma_f32_16x16x32_bf16 v[212:215], a[116:119], v[188:191], v[212:215]
v_mfma_f32_16x16x32_bf16 v[232:235], v[188:191], a[180:183], v[232:235]
v_mfma_f32_16x16x32_bf16 v[216:219], a[84:87], v[192:195], v[216:219]
v_mfma_f32_16x16x32_bf16 v[228:231], v[192:195], a[148:151], v[228:231]
v_mfma_f32_16x16x32_bf16 v[220:223], a[116:119], v[192:195], v[220:223]
v_mfma_f32_16x16x32_bf16 v[236:239], v[192:195], a[180:183], v[236:239]
v_mfma_f32_16x16x32_bf16 v[208:211], a[88:91], v[164:167], v[208:211]
v_mfma_f32_16x16x32_bf16 v[224:227], v[164:167], a[152:155], v[224:227]
v_mfma_f32_16x16x32_bf16 v[212:215], a[120:123], v[164:167], v[212:215]
v_mfma_f32_16x16x32_bf16 v[232:235], v[164:167], a[184:187], v[232:235]
v_mfma_f32_16x16x32_bf16 v[216:219], a[88:91], v[168:171], v[216:219]
v_mfma_f32_16x16x32_bf16 v[228:231], v[168:171], a[152:155], v[228:231]
v_mfma_f32_16x16x32_bf16 v[220:223], a[120:123], v[168:171], v[220:223]
v_mfma_f32_16x16x32_bf16 v[236:239], v[168:171], a[184:187], v[236:239]
v_mfma_f32_16x16x32_bf16 v[208:211], a[92:95], v[172:175], v[208:211]
v_mfma_f32_16x16x32_bf16 v[224:227], v[172:175], a[156:159], v[224:227]
v_mfma_f32_16x16x32_bf16 v[212:215], a[124:127], v[172:175], v[212:215]
v_mfma_f32_16x16x32_bf16 v[232:235], v[172:175], a[188:191], v[232:235]
v_mfma_f32_16x16x32_bf16 v[216:219], a[92:95], v[176:179], v[216:219]
v_mfma_f32_16x16x32_bf16 v[228:231], v[176:179], a[156:159], v[228:231]
v_mfma_f32_16x16x32_bf16 v[220:223], a[124:127], v[176:179], v[220:223]
v_mfma_f32_16x16x32_bf16 v[236:239], v[176:179], a[188:191], v[236:239]
m_s0_ow3:
v_xor_b32 v241, 16384, v241
s_waitcnt vmcnt(1)
v_pk_add_f32 v[148:149], v[148:149], v[152:153]
v_pk_add_f32 v[150:151], v[150:151], v[154:155]
s_waitcnt vmcnt(0)
v_pk_add_f32 v[156:157], v[156:157], v[96:97]
v_pk_add_f32 v[158:159], v[158:159], v[98:99]
v_pk_add_f32 v[148:149], v[148:149], v[156:157]
v_pk_add_f32 v[150:151], v[150:151], v[158:159]
v_cmp_u_f32 vcc, v148, v151
v_cvt_pk_bf16_f32 v100, v148, v149
v_cvt_pk_bf16_f32 v101, v150, v151
s_cbranch_vccnz m_s0_ppr
m_s0_ppd:
buffer_store_dwordx2 v[100:101], v65, s[4:7], s19 offen sc1
s_waitcnt lgkmcnt(0)
s_barrier
buffer_load_dwordx4 v[8:11], v56, s[4:7], s19 offen offset:0 sc1
buffer_load_dwordx4 v[12:15], v56, s[4:7], s19 offen offset:1024 sc1
buffer_load_dwordx4 v[16:19], v56, s[4:7], s19 offen offset:2048 sc1
buffer_load_dwordx4 v[20:23], v56, s[4:7], s19 offen offset:3072 sc1
s_branch m_s0_top
m_s0_am0:
s_mov_b32 s32, 15
s_cmp_eq_u32 s17, 0
s_cbranch_scc1 m_s0_ah40
s_sub_u32 s17, s17, 1
buffer_load_dwordx4 v[8:11], v56, s[4:7], s19 offen offset:0 sc1
s_branch m_s0_al41
m_s0_am1:
v_smfmac_f32_16x16x64_bf16 v[36:39], v[8:11], a[96:103], v3
s_mov_b32 s32, 14
s_cmp_eq_u32 s17, 0
s_cbranch_scc1 m_s0_ah31
s_sub_u32 s17, s17, 1
buffer_load_dwordx4 v[12:15], v56, s[4:7], s19 offen offset:1024 sc1
s_branch m_s0_al32
m_s0_am2:
v_smfmac_f32_16x16x64_bf16 v[36:39], v[12:15], a[104:111], v3
s_mov_b32 s32, 12
s_cmp_eq_u32 s17, 0
s_cbranch_scc1 m_s0_ah22
s_sub_u32 s17, s17, 1
buffer_load_dwordx4 v[16:19], v56, s[4:7], s19 offen offset:2048 sc1
s_branch m_s0_al23
m_s0_am3:
v_smfmac_f32_16x16x64_bf16 v[36:39], v[16:19], a[112:119], v3
s_mov_b32 s32, 8
s_cmp_eq_u32 s17, 0
s_cbranch_scc1 m_s0_ah13
s_sub_u32 s17, s17, 1
buffer_load_dwordx4 v[20:23], v56, s[4:7], s19 offen offset:3072 sc1
s_branch m_s0_al10
m_s0_al10:
s_bitcmp1_b32 s32, 0
s_cbranch_scc0 m_s0_al11
s_waitcnt vmcnt(0)
v_cmp_eq_u32 vcc, -1, v8
s_cbranch_vccz m_s0_ah10
s_cmp_eq_u32 s17, 0
s_cbranch_scc1 m_s0_ah10
s_sub_u32 s17, s17, 1
buffer_load_dwordx4 v[8:11], v56, s[4:7], s19 offen offset:0 sc1
m_s0_al11:
s_bitcmp1_b32 s32, 1
s_cbranch_scc0 m_s0_al12
s_waitcnt vmcnt(0)
v_cmp_eq_u32 vcc, -1, v12
s_cbranch_vccz m_s0_ah11
s_cmp_eq_u32 s17, 0
s_cbranch_scc1 m_s0_ah11
s_sub_u32 s17, s17, 1
buffer_load_dwordx4 v[12:15], v56, s[4:7], s19 offen offset:1024 sc1
m_s0_al12:
s_bitcmp1_b32 s32, 2
s_cbranch_scc0 m_s0_al13
s_waitcnt vmcnt(0)
v_cmp_eq_u32 vcc, -1, v16
s_cbranch_vccz m_s0_ah12
s_cmp_eq_u32 s17, 0
s_cbranch_scc1 m_s0_ah12
s_sub_u32 s17, s17, 1
buffer_load_dwordx4 v[16:19], v56, s[4:7], s19 offen offset:2048 sc1
m_s0_al13:
s_bitcmp1_b32 s32, 3
s_cbranch_scc0 m_s0_al10
s_waitcnt vmcnt(0)
v_cmp_eq_u32 vcc, -1, v20
s_cbranch_vccz m_s0_ah13
s_cmp_eq_u32 s17, 0
s_cbranch_scc1 m_s0_ah13
s_sub_u32 s17, s17, 1
buffer_load_dwordx4 v[20:23], v56, s[4:7], s19 offen offset:3072 sc1
s_branch m_s0_al10
m_s0_ah10:
v_smfmac_f32_16x16x64_bf16 v[24:27], v[8:11], a[0:7], v3
v_smfmac_f32_16x16x64_bf16 v[28:31], v[8:11], a[32:39], v3
v_smfmac_f32_16x16x64_bf16 v[32:35], v[8:11], a[64:71], v3
v_smfmac_f32_16x16x64_bf16 v[36:39], v[8:11], a[96:103], v3
s_branch m_s0_ab
m_s0_ah11:
v_smfmac_f32_16x16x64_bf16 v[24:27], v[12:15], a[8:15], v3
v_smfmac_f32_16x16x64_bf16 v[28:31], v[12:15], a[40:47], v3
v_smfmac_f32_16x16x64_bf16 v[32:35], v[12:15], a[72:79], v3
v_smfmac_f32_16x16x64_bf16 v[36:39], v[12:15], a[104:111], v3
s_branch m_s0_ab
m_s0_ah12:
v_smfmac_f32_16x16x64_bf16 v[24:27], v[16:19], a[16:23], v3
v_smfmac_f32_16x16x64_bf16 v[28:31], v[16:19], a[48:55], v3
v_smfmac_f32_16x16x64_bf16 v[32:35], v[16:19], a[80:87], v3
v_smfmac_f32_16x16x64_bf16 v[36:39], v[16:19], a[112:119], v3
s_branch m_s0_ab
m_s0_ah13:
v_smfmac_f32_16x16x64_bf16 v[24:27], v[20:23], a[24:31], v3
v_smfmac_f32_16x16x64_bf16 v[28:31], v[20:23], a[56:63], v3
v_smfmac_f32_16x16x64_bf16 v[32:35], v[20:23], a[88:95], v3
v_smfmac_f32_16x16x64_bf16 v[36:39], v[20:23], a[120:127], v3
s_branch m_s0_ab
m_s0_al20:
s_bitcmp1_b32 s32, 0
s_cbranch_scc0 m_s0_al21
s_waitcnt vmcnt(1)
v_cmp_eq_u32 vcc, -1, v8
s_cbranch_vccz m_s0_ah20
s_cmp_eq_u32 s17, 0
s_cbranch_scc1 m_s0_ah20
s_sub_u32 s17, s17, 1
buffer_load_dwordx4 v[8:11], v56, s[4:7], s19 offen offset:0 sc1
m_s0_al21:
s_bitcmp1_b32 s32, 1
s_cbranch_scc0 m_s0_al22
s_waitcnt vmcnt(1)
v_cmp_eq_u32 vcc, -1, v12
s_cbranch_vccz m_s0_ah21
s_cmp_eq_u32 s17, 0
s_cbranch_scc1 m_s0_ah21
s_sub_u32 s17, s17, 1
buffer_load_dwordx4 v[12:15], v56, s[4:7], s19 offen offset:1024 sc1
m_s0_al22:
s_bitcmp1_b32 s32, 2
s_cbranch_scc0 m_s0_al23
s_waitcnt vmcnt(1)
v_cmp_eq_u32 vcc, -1, v16
s_cbranch_vccz m_s0_ah22
s_cmp_eq_u32 s17, 0
s_cbranch_scc1 m_s0_ah22
s_sub_u32 s17, s17, 1
buffer_load_dwordx4 v[16:19], v56, s[4:7], s19 offen offset:2048 sc1
m_s0_al23:
s_bitcmp1_b32 s32, 3
s_cbranch_scc0 m_s0_al20
s_waitcnt vmcnt(1)
v_cmp_eq_u32 vcc, -1, v20
s_cbranch_vccz m_s0_ah23
s_cmp_eq_u32 s17, 0
s_cbranch_scc1 m_s0_ah23
s_sub_u32 s17, s17, 1
buffer_load_dwordx4 v[20:23], v56, s[4:7], s19 offen offset:3072 sc1
s_branch m_s0_al20
m_s0_ah20:
v_smfmac_f32_16x16x64_bf16 v[24:27], v[8:11], a[0:7], v3
v_smfmac_f32_16x16x64_bf16 v[28:31], v[8:11], a[32:39], v3
v_smfmac_f32_16x16x64_bf16 v[32:35], v[8:11], a[64:71], v3
v_smfmac_f32_16x16x64_bf16 v[36:39], v[8:11], a[96:103], v3
s_bitset0_b32 s32, 0
s_branch m_s0_al11
m_s0_ah21:
v_smfmac_f32_16x16x64_bf16 v[24:27], v[12:15], a[8:15], v3
v_smfmac_f32_16x16x64_bf16 v[28:31], v[12:15], a[40:47], v3
v_smfmac_f32_16x16x64_bf16 v[32:35], v[12:15], a[72:79], v3
v_smfmac_f32_16x16x64_bf16 v[36:39], v[12:15], a[104:111], v3
s_bitset0_b32 s32, 1
s_branch m_s0_al12
m_s0_ah22:
v_smfmac_f32_16x16x64_bf16 v[24:27], v[16:19], a[16:23], v3
v_smfmac_f32_16x16x64_bf16 v[28:31], v[16:19], a[48:55], v3
v_smfmac_f32_16x16x64_bf16 v[32:35], v[16:19], a[80:87], v3
v_smfmac_f32_16x16x64_bf16 v[36:39], v[16:19], a[112:119], v3
s_bitset0_b32 s32, 2
s_branch m_s0_al13
m_s0_ah23:
v_smfmac_f32_16x16x64_bf16 v[24:27], v[20:23], a[24:31], v3
v_smfmac_f32_16x16x64_bf16 v[28:31], v[20:23], a[56:63], v3
v_smfmac_f32_16x16x64_bf16 v[32:35], v[20:23], a[88:95], v3
v_smfmac_f32_16x16x64_bf16 v[36:39], v[20:23], a[120:127], v3
s_bitset0_b32 s32, 3
s_branch m_s0_al10
m_s0_al30:
s_bitcmp1_b32 s32, 0
s_cbranch_scc0 m_s0_al31
s_waitcnt vmcnt(2)
v_cmp_eq_u32 vcc, -1, v8
s_cbranch_vccz m_s0_ah30
s_cmp_eq_u32 s17, 0
s_cbranch_scc1 m_s0_ah30
s_sub_u32 s17, s17, 1
buffer_load_dwordx4 v[8:11], v56, s[4:7], s19 offen offset:0 sc1
m_s0_al31:
s_bitcmp1_b32 s32, 1
s_cbranch_scc0 m_s0_al32
s_waitcnt vmcnt(2)
v_cmp_eq_u32 vcc, -1, v12
s_cbranch_vccz m_s0_ah31
s_cmp_eq_u32 s17, 0
s_cbranch_scc1 m_s0_ah31
s_sub_u32 s17, s17, 1
buffer_load_dwordx4 v[12:15], v56, s[4:7], s19 offen offset:1024 sc1
m_s0_al32:
s_bitcmp1_b32 s32, 2
s_cbranch_scc0 m_s0_al33
s_waitcnt vmcnt(2)
v_cmp_eq_u32 vcc, -1, v16
s_cbranch_vccz m_s0_ah32
s_cmp_eq_u32 s17, 0
s_cbranch_scc1 m_s0_ah32
s_sub_u32 s17, s17, 1
buffer_load_dwordx4 v[16:19], v56, s[4:7], s19 offen offset:2048 sc1
m_s0_al33:
s_bitcmp1_b32 s32, 3
s_cbranch_scc0 m_s0_al30
s_waitcnt vmcnt(2)
v_cmp_eq_u32 vcc, -1, v20
s_cbranch_vccz m_s0_ah33
s_cmp_eq_u32 s17, 0
s_cbranch_scc1 m_s0_ah33
s_sub_u32 s17, s17, 1
buffer_load_dwordx4 v[20:23], v56, s[4:7], s19 offen offset:3072 sc1
s_branch m_s0_al30
m_s0_ah30:
v_smfmac_f32_16x16x64_bf16 v[24:27], v[8:11], a[0:7], v3
v_smfmac_f32_16x16x64_bf16 v[28:31], v[8:11], a[32:39], v3
v_smfmac_f32_16x16x64_bf16 v[32:35], v[8:11], a[64:71], v3
v_smfmac_f32_16x16x64_bf16 v[36:39], v[8:11], a[96:103], v3
s_bitset0_b32 s32, 0
s_branch m_s0_al21
m_s0_ah31:
v_smfmac_f32_16x16x64_bf16 v[24:27], v[12:15], a[8:15], v3
v_smfmac_f32_16x16x64_bf16 v[28:31], v[12:15], a[40:47], v3
v_smfmac_f32_16x16x64_bf16 v[32:35], v[12:15], a[72:79], v3
v_smfmac_f32_16x16x64_bf16 v[36:39], v[12:15], a[104:111], v3
s_bitset0_b32 s32, 1
s_branch m_s0_al22
m_s0_ah32:
v_smfmac_f32_16x16x64_bf16 v[24:27], v[16:19], a[16:23], v3
v_smfmac_f32_16x16x64_bf16 v[28:31], v[16:19], a[48:55], v3
v_smfmac_f32_16x16x64_bf16 v[32:35], v[16:19], a[80:87], v3
v_smfmac_f32_16x16x64_bf16 v[36:39], v[16:19], a[112:119], v3
s_bitset0_b32 s32, 2
s_branch m_s0_al23
m_s0_ah33:
v_smfmac_f32_16x16x64_bf16 v[24:27], v[20:23], a[24:31], v3
v_smfmac_f32_16x16x64_bf16 v[28:31], v[20:23], a[56:63], v3
v_smfmac_f32_16x16x64_bf16 v[32:35], v[20:23], a[88:95], v3
v_smfmac_f32_16x16x64_bf16 v[36:39], v[20:23], a[120:127], v3
s_bitset0_b32 s32, 3
s_branch m_s0_al20
m_s0_al40:
s_waitcnt vmcnt(3)
v_cmp_eq_u32 vcc, -1, v8
s_cbranch_vccz m_s0_ah40
s_cmp_eq_u32 s17, 0
s_cbranch_scc1 m_s0_ah40
s_sub_u32 s17, s17, 1
buffer_load_dwordx4 v[8:11], v56, s[4:7], s19 offen offset:0 sc1
m_s0_al41:
s_waitcnt vmcnt(3)
v_cmp_eq_u32 vcc, -1, v12
s_cbranch_vccz m_s0_ah41
s_cmp_eq_u32 s17, 0
s_cbranch_scc1 m_s0_ah41
s_sub_u32 s17, s17, 1
buffer_load_dwordx4 v[12:15], v56, s[4:7], s19 offen offset:1024 sc1
m_s0_al42:
s_waitcnt vmcnt(3)
v_cmp_eq_u32 vcc, -1, v16
s_cbranch_vccz m_s0_ah42
s_cmp_eq_u32 s17, 0
s_cbranch_scc1 m_s0_ah42
s_sub_u32 s17, s17, 1
buffer_load_dwordx4 v[16:19], v56, s[4:7], s19 offen offset:2048 sc1
m_s0_al43:
s_waitcnt vmcnt(3)
v_cmp_eq_u32 vcc, -1, v20
s_cbranch_vccz m_s0_ah43
s_cmp_eq_u32 s17, 0
s_cbranch_scc1 m_s0_ah43
s_sub_u32 s17, s17, 1
buffer_load_dwordx4 v[20:23], v56, s[4:7], s19 offen offset:3072 sc1
s_branch m_s0_al40
m_s0_ah40:
v_smfmac_f32_16x16x64_bf16 v[24:27], v[8:11], a[0:7], v3
v_smfmac_f32_16x16x64_bf16 v[28:31], v[8:11], a[32:39], v3
v_smfmac_f32_16x16x64_bf16 v[32:35], v[8:11], a[64:71], v3
v_smfmac_f32_16x16x64_bf16 v[36:39], v[8:11], a[96:103], v3
s_bitset0_b32 s32, 0
s_branch m_s0_al31
m_s0_ah41:
v_smfmac_f32_16x16x64_bf16 v[24:27], v[12:15], a[8:15], v3
v_smfmac_f32_16x16x64_bf16 v[28:31], v[12:15], a[40:47], v3
v_smfmac_f32_16x16x64_bf16 v[32:35], v[12:15], a[72:79], v3
v_smfmac_f32_16x16x64_bf16 v[36:39], v[12:15], a[104:111], v3
s_bitset0_b32 s32, 1
s_branch m_s0_al32
m_s0_ah42:
v_smfmac_f32_16x16x64_bf16 v[24:27], v[16:19], a[16:23], v3
v_smfmac_f32_16x16x64_bf16 v[28:31], v[16:19], a[48:55], v3
v_smfmac_f32_16x16x64_bf16 v[32:35], v[16:19], a[80:87], v3
v_smfmac_f32_16x16x64_bf16 v[36:39], v[16:19], a[112:119], v3
s_bitset0_b32 s32, 2
s_branch m_s0_al33
m_s0_ah43:
v_smfmac_f32_16x16x64_bf16 v[24:27], v[20:23], a[24:31], v3
v_smfmac_f32_16x16x64_bf16 v[28:31], v[20:23], a[56:63], v3
v_smfmac_f32_16x16x64_bf16 v[32:35], v[20:23], a[88:95], v3
v_smfmac_f32_16x16x64_bf16 v[36:39], v[20:23], a[120:127], v3
s_bitset0_b32 s32, 3
s_branch m_s0_al30
m_s0_ps:
s_cmp_eq_u32 s17, 0
s_cbranch_scc1 m_s0_psd
s_sub_u32 s17, s17, 1
buffer_load_dwordx4 v[148:151], v69, s[4:7], s19 offen sc1
buffer_load_dwordx4 v[152:155], v70, s[4:7], s19 offen sc1
buffer_load_dwordx4 v[156:159], v71, s[4:7], s19 offen sc1
buffer_load_dwordx4 v[160:163], v72, s[4:7], s19 offen sc1
s_waitcnt vmcnt(7)
v_pk_add_f32 v[136:137], v[144:145], v[164:165]
v_pk_add_f32 v[138:139], v[146:147], v[166:167]
s_waitcnt vmcnt(6)
v_pk_add_f32 v[136:137], v[136:137], v[168:169]
v_pk_add_f32 v[138:139], v[138:139], v[170:171]
s_waitcnt vmcnt(5)
v_pk_add_f32 v[136:137], v[136:137], v[172:173]
v_pk_add_f32 v[138:139], v[138:139], v[174:175]
s_waitcnt vmcnt(4)
v_pk_add_f32 v[140:141], v[176:177], v[178:179]
v_add_f32 v140, v140, v141
v_cmp_u_f32 vcc, v136, v140
s_cbranch_vccz m_s0_psd
s_cmp_eq_u32 s17, 0
s_cbranch_scc1 m_s0_psd
s_sub_u32 s17, s17, 1
buffer_load_dwordx4 v[164:167], v69, s[4:7], s19 offen sc1
buffer_load_dwordx4 v[168:171], v70, s[4:7], s19 offen sc1
buffer_load_dwordx4 v[172:175], v71, s[4:7], s19 offen sc1
buffer_load_dwordx4 v[176:179], v72, s[4:7], s19 offen sc1
s_waitcnt vmcnt(7)
v_pk_add_f32 v[136:137], v[144:145], v[148:149]
v_pk_add_f32 v[138:139], v[146:147], v[150:151]
s_waitcnt vmcnt(6)
v_pk_add_f32 v[136:137], v[136:137], v[152:153]
v_pk_add_f32 v[138:139], v[138:139], v[154:155]
s_waitcnt vmcnt(5)
v_pk_add_f32 v[136:137], v[136:137], v[156:157]
v_pk_add_f32 v[138:139], v[138:139], v[158:159]
s_waitcnt vmcnt(4)
v_pk_add_f32 v[140:141], v[160:161], v[162:163]
v_add_f32 v140, v140, v141
v_cmp_u_f32 vcc, v136, v140
s_cbranch_vccz m_s0_psd
s_branch m_s0_ps
m_s0_om0:
s_mov_b32 s32, 15
s_cmp_eq_u32 s17, 0
s_cbranch_scc1 m_s0_oh40
s_sub_u32 s17, s17, 1
buffer_load_dwordx4 v[8:11], v57, s[4:7], s19 offen offset:0 sc1
s_branch m_s0_ol41
m_s0_om1:
v_smfmac_f32_16x16x64_bf16 v[52:55], v[8:11], a[224:231], v3
s_mov_b32 s32, 14
s_cmp_eq_u32 s17, 0
s_cbranch_scc1 m_s0_oh31
s_sub_u32 s17, s17, 1
buffer_load_dwordx4 v[12:15], v57, s[4:7], s19 offen offset:1024 sc1
s_branch m_s0_ol32
m_s0_om2:
v_smfmac_f32_16x16x64_bf16 v[52:55], v[12:15], a[232:239], v3
s_mov_b32 s32, 12
s_cmp_eq_u32 s17, 0
s_cbranch_scc1 m_s0_oh22
s_sub_u32 s17, s17, 1
buffer_load_dwordx4 v[16:19], v57, s[4:7], s19 offen offset:2048 sc1
s_branch m_s0_ol23
m_s0_om3:
v_smfmac_f32_16x16x64_bf16 v[52:55], v[16:19], a[240:247], v3
s_mov_b32 s32, 8
s_cmp_eq_u32 s17, 0
s_cbranch_scc1 m_s0_oh13
s_sub_u32 s17, s17, 1
buffer_load_dwordx4 v[20:23], v57, s[4:7], s19 offen offset:3072 sc1
s_branch m_s0_ol10
m_s0_ol10:
s_bitcmp1_b32 s32, 0
s_cbranch_scc0 m_s0_ol11
s_waitcnt vmcnt(0)
v_cmp_eq_u32 vcc, -1, v8
s_cbranch_vccz m_s0_oh10
s_cmp_eq_u32 s17, 0
s_cbranch_scc1 m_s0_oh10
s_sub_u32 s17, s17, 1
buffer_load_dwordx4 v[8:11], v57, s[4:7], s19 offen offset:0 sc1
m_s0_ol11:
s_bitcmp1_b32 s32, 1
s_cbranch_scc0 m_s0_ol12
s_waitcnt vmcnt(0)
v_cmp_eq_u32 vcc, -1, v12
s_cbranch_vccz m_s0_oh11
s_cmp_eq_u32 s17, 0
s_cbranch_scc1 m_s0_oh11
s_sub_u32 s17, s17, 1
buffer_load_dwordx4 v[12:15], v57, s[4:7], s19 offen offset:1024 sc1
m_s0_ol12:
s_bitcmp1_b32 s32, 2
s_cbranch_scc0 m_s0_ol13
s_waitcnt vmcnt(0)
v_cmp_eq_u32 vcc, -1, v16
s_cbranch_vccz m_s0_oh12
s_cmp_eq_u32 s17, 0
s_cbranch_scc1 m_s0_oh12
s_sub_u32 s17, s17, 1
buffer_load_dwordx4 v[16:19], v57, s[4:7], s19 offen offset:2048 sc1
m_s0_ol13:
s_bitcmp1_b32 s32, 3
s_cbranch_scc0 m_s0_ol10
s_waitcnt vmcnt(0)
v_cmp_eq_u32 vcc, -1, v20
s_cbranch_vccz m_s0_oh13
s_cmp_eq_u32 s17, 0
s_cbranch_scc1 m_s0_oh13
s_sub_u32 s17, s17, 1
buffer_load_dwordx4 v[20:23], v57, s[4:7], s19 offen offset:3072 sc1
s_branch m_s0_ol10
m_s0_oh10:
v_smfmac_f32_16x16x64_bf16 v[48:51], v[8:11], a[192:199], v3
v_smfmac_f32_16x16x64_bf16 v[52:55], v[8:11], a[224:231], v3
s_branch m_s0_ob
m_s0_oh11:
v_smfmac_f32_16x16x64_bf16 v[48:51], v[12:15], a[200:207], v3
v_smfmac_f32_16x16x64_bf16 v[52:55], v[12:15], a[232:239], v3
s_branch m_s0_ob
m_s0_oh12:
v_smfmac_f32_16x16x64_bf16 v[48:51], v[16:19], a[208:215], v3
v_smfmac_f32_16x16x64_bf16 v[52:55], v[16:19], a[240:247], v3
s_branch m_s0_ob
m_s0_oh13:
v_smfmac_f32_16x16x64_bf16 v[48:51], v[20:23], a[216:223], v3
v_smfmac_f32_16x16x64_bf16 v[52:55], v[20:23], a[248:255], v3
s_branch m_s0_ob
m_s0_ol20:
s_bitcmp1_b32 s32, 0
s_cbranch_scc0 m_s0_ol21
s_waitcnt vmcnt(1)
v_cmp_eq_u32 vcc, -1, v8
s_cbranch_vccz m_s0_oh20
s_cmp_eq_u32 s17, 0
s_cbranch_scc1 m_s0_oh20
s_sub_u32 s17, s17, 1
buffer_load_dwordx4 v[8:11], v57, s[4:7], s19 offen offset:0 sc1
m_s0_ol21:
s_bitcmp1_b32 s32, 1
s_cbranch_scc0 m_s0_ol22
s_waitcnt vmcnt(1)
v_cmp_eq_u32 vcc, -1, v12
s_cbranch_vccz m_s0_oh21
s_cmp_eq_u32 s17, 0
s_cbranch_scc1 m_s0_oh21
s_sub_u32 s17, s17, 1
buffer_load_dwordx4 v[12:15], v57, s[4:7], s19 offen offset:1024 sc1
m_s0_ol22:
s_bitcmp1_b32 s32, 2
s_cbranch_scc0 m_s0_ol23
s_waitcnt vmcnt(1)
v_cmp_eq_u32 vcc, -1, v16
s_cbranch_vccz m_s0_oh22
s_cmp_eq_u32 s17, 0
s_cbranch_scc1 m_s0_oh22
s_sub_u32 s17, s17, 1
buffer_load_dwordx4 v[16:19], v57, s[4:7], s19 offen offset:2048 sc1
m_s0_ol23:
s_bitcmp1_b32 s32, 3
s_cbranch_scc0 m_s0_ol20
s_waitcnt vmcnt(1)
v_cmp_eq_u32 vcc, -1, v20
s_cbranch_vccz m_s0_oh23
s_cmp_eq_u32 s17, 0
s_cbranch_scc1 m_s0_oh23
s_sub_u32 s17, s17, 1
buffer_load_dwordx4 v[20:23], v57, s[4:7], s19 offen offset:3072 sc1
s_branch m_s0_ol20
m_s0_oh20:
v_smfmac_f32_16x16x64_bf16 v[48:51], v[8:11], a[192:199], v3
v_smfmac_f32_16x16x64_bf16 v[52:55], v[8:11], a[224:231], v3
s_bitset0_b32 s32, 0
s_branch m_s0_ol11
m_s0_oh21:
v_smfmac_f32_16x16x64_bf16 v[48:51], v[12:15], a[200:207], v3
v_smfmac_f32_16x16x64_bf16 v[52:55], v[12:15], a[232:239], v3
s_bitset0_b32 s32, 1
s_branch m_s0_ol12
m_s0_oh22:
v_smfmac_f32_16x16x64_bf16 v[48:51], v[16:19], a[208:215], v3
v_smfmac_f32_16x16x64_bf16 v[52:55], v[16:19], a[240:247], v3
s_bitset0_b32 s32, 2
s_branch m_s0_ol13
m_s0_oh23:
v_smfmac_f32_16x16x64_bf16 v[48:51], v[20:23], a[216:223], v3
v_smfmac_f32_16x16x64_bf16 v[52:55], v[20:23], a[248:255], v3
s_bitset0_b32 s32, 3
s_branch m_s0_ol10
m_s0_ol30:
s_bitcmp1_b32 s32, 0
s_cbranch_scc0 m_s0_ol31
s_waitcnt vmcnt(2)
v_cmp_eq_u32 vcc, -1, v8
s_cbranch_vccz m_s0_oh30
s_cmp_eq_u32 s17, 0
s_cbranch_scc1 m_s0_oh30
s_sub_u32 s17, s17, 1
buffer_load_dwordx4 v[8:11], v57, s[4:7], s19 offen offset:0 sc1
m_s0_ol31:
s_bitcmp1_b32 s32, 1
s_cbranch_scc0 m_s0_ol32
s_waitcnt vmcnt(2)
v_cmp_eq_u32 vcc, -1, v12
s_cbranch_vccz m_s0_oh31
s_cmp_eq_u32 s17, 0
s_cbranch_scc1 m_s0_oh31
s_sub_u32 s17, s17, 1
buffer_load_dwordx4 v[12:15], v57, s[4:7], s19 offen offset:1024 sc1
m_s0_ol32:
s_bitcmp1_b32 s32, 2
s_cbranch_scc0 m_s0_ol33
s_waitcnt vmcnt(2)
v_cmp_eq_u32 vcc, -1, v16
s_cbranch_vccz m_s0_oh32
s_cmp_eq_u32 s17, 0
s_cbranch_scc1 m_s0_oh32
s_sub_u32 s17, s17, 1
buffer_load_dwordx4 v[16:19], v57, s[4:7], s19 offen offset:2048 sc1
m_s0_ol33:
s_bitcmp1_b32 s32, 3
s_cbranch_scc0 m_s0_ol30
s_waitcnt vmcnt(2)
v_cmp_eq_u32 vcc, -1, v20
s_cbranch_vccz m_s0_oh33
s_cmp_eq_u32 s17, 0
s_cbranch_scc1 m_s0_oh33
s_sub_u32 s17, s17, 1
buffer_load_dwordx4 v[20:23], v57, s[4:7], s19 offen offset:3072 sc1
s_branch m_s0_ol30
m_s0_oh30:
v_smfmac_f32_16x16x64_bf16 v[48:51], v[8:11], a[192:199], v3
v_smfmac_f32_16x16x64_bf16 v[52:55], v[8:11], a[224:231], v3
s_bitset0_b32 s32, 0
s_branch m_s0_ol21
m_s0_oh31:
v_smfmac_f32_16x16x64_bf16 v[48:51], v[12:15], a[200:207], v3
v_smfmac_f32_16x16x64_bf16 v[52:55], v[12:15], a[232:239], v3
s_bitset0_b32 s32, 1
s_branch m_s0_ol22
m_s0_oh32:
v_smfmac_f32_16x16x64_bf16 v[48:51], v[16:19], a[208:215], v3
v_smfmac_f32_16x16x64_bf16 v[52:55], v[16:19], a[240:247], v3
s_bitset0_b32 s32, 2
s_branch m_s0_ol23
m_s0_oh33:
v_smfmac_f32_16x16x64_bf16 v[48:51], v[20:23], a[216:223], v3
v_smfmac_f32_16x16x64_bf16 v[52:55], v[20:23], a[248:255], v3
s_bitset0_b32 s32, 3
s_branch m_s0_ol20
m_s0_ol40:
s_waitcnt vmcnt(3)
v_cmp_eq_u32 vcc, -1, v8
s_cbranch_vccz m_s0_oh40
s_cmp_eq_u32 s17, 0
s_cbranch_scc1 m_s0_oh40
s_sub_u32 s17, s17, 1
buffer_load_dwordx4 v[8:11], v57, s[4:7], s19 offen offset:0 sc1
m_s0_ol41:
s_waitcnt vmcnt(3)
v_cmp_eq_u32 vcc, -1, v12
s_cbranch_vccz m_s0_oh41
s_cmp_eq_u32 s17, 0
s_cbranch_scc1 m_s0_oh41
s_sub_u32 s17, s17, 1
buffer_load_dwordx4 v[12:15], v57, s[4:7], s19 offen offset:1024 sc1
m_s0_ol42:
s_waitcnt vmcnt(3)
v_cmp_eq_u32 vcc, -1, v16
s_cbranch_vccz m_s0_oh42
s_cmp_eq_u32 s17, 0
s_cbranch_scc1 m_s0_oh42
s_sub_u32 s17, s17, 1
buffer_load_dwordx4 v[16:19], v57, s[4:7], s19 offen offset:2048 sc1
m_s0_ol43:
s_waitcnt vmcnt(3)
v_cmp_eq_u32 vcc, -1, v20
s_cbranch_vccz m_s0_oh43
s_cmp_eq_u32 s17, 0
s_cbranch_scc1 m_s0_oh43
s_sub_u32 s17, s17, 1
buffer_load_dwordx4 v[20:23], v57, s[4:7], s19 offen offset:3072 sc1
s_branch m_s0_ol40
m_s0_oh40:
v_smfmac_f32_16x16x64_bf16 v[48:51], v[8:11], a[192:199], v3
v_smfmac_f32_16x16x64_bf16 v[52:55], v[8:11], a[224:231], v3
s_bitset0_b32 s32, 0
s_branch m_s0_ol31
m_s0_oh41:
v_smfmac_f32_16x16x64_bf16 v[48:51], v[12:15], a[200:207], v3
v_smfmac_f32_16x16x64_bf16 v[52:55], v[12:15], a[232:239], v3
s_bitset0_b32 s32, 1
s_branch m_s0_ol32
m_s0_oh42:
v_smfmac_f32_16x16x64_bf16 v[48:51], v[16:19], a[208:215], v3
v_smfmac_f32_16x16x64_bf16 v[52:55], v[16:19], a[240:247], v3
s_bitset0_b32 s32, 2
s_branch m_s0_ol33
m_s0_oh43:
v_smfmac_f32_16x16x64_bf16 v[48:51], v[20:23], a[216:223], v3
v_smfmac_f32_16x16x64_bf16 v[52:55], v[20:23], a[248:255], v3
s_bitset0_b32 s32, 3
s_branch m_s0_ol30
m_s0_ppr:
s_cmp_eq_u32 s17, 0
s_cbranch_scc1 m_s0_ppd
s_sub_u32 s17, s17, 1
buffer_load_dwordx4 v[148:151], v62, s[4:7], s31 offen sc1
buffer_load_dwordx4 v[152:155], v63, s[4:7], s31 offen sc1
buffer_load_dwordx4 v[156:159], v64, s[4:7], s31 offen sc1
s_waitcnt vmcnt(1)
v_pk_add_f32 v[148:149], v[148:149], v[152:153]
v_pk_add_f32 v[150:151], v[150:151], v[154:155]
s_waitcnt vmcnt(0)
v_pk_add_f32 v[156:157], v[156:157], v[96:97]
v_pk_add_f32 v[158:159], v[158:159], v[98:99]
v_pk_add_f32 v[148:149], v[148:149], v[156:157]
v_pk_add_f32 v[150:151], v[150:151], v[158:159]
v_cmp_u_f32 vcc, v148, v151
v_cvt_pk_bf16_f32 v100, v148, v149
v_cvt_pk_bf16_f32 v101, v150, v151
s_cbranch_vccz m_s0_ppd
s_branch m_s0_ppr
m_s0_fin:
s_waitcnt vmcnt(0)
s_barrier
s_branch m_recdone
m_rp1:
s_lshl_b32 s30, s24, 10
s_add_u32 s30, s30, 131072
s_lshr_b32 s31, s24, 2
s_lshl_b32 s31, s31, 10
s_add_u32 s31, s31, 262144
s_and_b32 s27, s24, 3
s_lshl_b32 s27, s27, 2
v_mul_u32_u24 v66, 160, v1
v_lshl_add_u32 v66, v79, 6, v66
v_lshl_add_u32 v66, v78, 4, v66
s_lshr_b32 s26, s24, 4
s_lshl_b32 s26, s26, 14
s_and_b32 s25, s24, 15
s_lshl_b32 s25, s25, 9
s_add_u32 s26, s26, s25
s_add_u32 s26, s26, 8388608
v_lshrrev_b32 v67, 2, v1
v_and_b32 v76, 1, v0
v_lshl_add_u32 v67, v67, 1, v76
v_lshl_add_u32 v67, v2, 3, v67
v_lshl_add_u32 v67, v67, 4, s26
v_mov_b32 v76, 2147483648
v_cndmask_b32 v67, v67, v76, s[66:67]
v_add_u32 v68, s30, v59
s_add_u32 s26, s31, s27
v_add_u32 v69, s26, v59
s_barrier
ds_write_b128 v59, v[80:83] offset:25600
v_add_u32 v242, 4294868992, v242
ds_write_b128 v242, v[208:211] offset:0
ds_write_b128 v242, v[212:215] offset:1024
ds_write_b128 v242, v[224:227] offset:16384
ds_write_b128 v242, v[228:231] offset:17408
ds_write_b128 v242, v[216:219] offset:8192
ds_write_b128 v242, v[220:223] offset:9216
ds_write_b128 v242, v[232:235] offset:24576
ds_write_b128 v242, v[236:239] offset:25600
v_add_u32 v74, 4096, v59
s_mov_b32 s69, 81920
s_sub_u32 s59, s60, 65536
s_xor_b32 s30, s65, 8192
s_waitcnt lgkmcnt(0)
s_barrier
v_add_u32 v61, s30, v61
v_add_u32 v62, s30, v62
v_add_u32 v63, s30, v63
v_add_u32 v64, s30, v64
s_cmp_eq_u32 s15, 0
s_cbranch_scc1 m_safe1
m_f1_top:
s_waitcnt vmcnt(3)
v_cmp_eq_u32 vcc, -1, v8
s_cbranch_vccnz m_f1_am0
v_smfmac_f32_16x16x64_bf16 v[24:27], v[8:11], a[0:7], v3
v_smfmac_f32_16x16x64_bf16 v[28:31], v[8:11], a[32:39], v3
s_waitcnt vmcnt(2)
v_cmp_eq_u32 vcc, -1, v12
v_smfmac_f32_16x16x64_bf16 v[32:35], v[8:11], a[64:71], v3
s_cbranch_vccnz m_f1_am1
v_smfmac_f32_16x16x64_bf16 v[36:39], v[8:11], a[96:103], v3
v_smfmac_f32_16x16x64_bf16 v[24:27], v[12:15], a[8:15], v3
v_smfmac_f32_16x16x64_bf16 v[28:31], v[12:15], a[40:47], v3
s_waitcnt vmcnt(1)
v_cmp_eq_u32 vcc, -1, v16
v_smfmac_f32_16x16x64_bf16 v[32:35], v[12:15], a[72:79], v3
s_cbranch_vccnz m_f1_am2
v_smfmac_f32_16x16x64_bf16 v[36:39], v[12:15], a[104:111], v3
v_smfmac_f32_16x16x64_bf16 v[24:27], v[16:19], a[16:23], v3
v_smfmac_f32_16x16x64_bf16 v[28:31], v[16:19], a[48:55], v3
s_waitcnt vmcnt(0)
v_cmp_eq_u32 vcc, -1, v20
v_smfmac_f32_16x16x64_bf16 v[32:35], v[16:19], a[80:87], v3
s_cbranch_vccnz m_f1_am3
v_smfmac_f32_16x16x64_bf16 v[36:39], v[16:19], a[112:119], v3
v_smfmac_f32_16x16x64_bf16 v[24:27], v[20:23], a[24:31], v3
v_smfmac_f32_16x16x64_bf16 v[28:31], v[20:23], a[56:63], v3
v_smfmac_f32_16x16x64_bf16 v[32:35], v[20:23], a[88:95], v3
v_smfmac_f32_16x16x64_bf16 v[36:39], v[20:23], a[120:127], v3
m_f1_ab:
buffer_store_dwordx4 v[4:7], v68, s[4:7], s20 offen
buffer_store_dword v4, v69, s[4:7], s20 offen
v_smfmac_f32_16x16x64_bf16 v[40:43], v[8:11], a[128:135], v3
v_pk_add_f32 v[24:25], v[24:25], v[26:27]
v_pk_add_f32 v[28:29], v[28:29], v[30:31]
ds_write2_b32 v58, v24, v25 offset0:80 offset1:120
ds_write2_b32 v58, v28, v29 offset0:96 offset1:136
v_smfmac_f32_16x16x64_bf16 v[44:47], v[8:11], a[160:167], v3
v_pk_add_f32 v[32:33], v[32:33], v[34:35]
v_pk_add_f32 v[36:37], v[36:37], v[38:39]
ds_write2_b32 v58, v32, v33 offset0:0 offset1:40
ds_write2_b32 v58, v36, v37 offset0:16 offset1:56
s_and_b32 s30, s18, 3
s_lshl_b32 s19, s30, 19
s_add_u32 s19, s19, 167772160
v_smfmac_f32_16x16x64_bf16 v[40:43], v[12:15], a[136:143], v3
v_smfmac_f32_16x16x64_bf16 v[44:47], v[12:15], a[168:175], v3
s_waitcnt lgkmcnt(0)
s_barrier
v_smfmac_f32_16x16x64_bf16 v[40:43], v[16:19], a[144:151], v3
v_smfmac_f32_16x16x64_bf16 v[44:47], v[16:19], a[176:183], v3
v_smfmac_f32_16x16x64_bf16 v[40:43], v[20:23], a[152:159], v3
v_smfmac_f32_16x16x64_bf16 v[44:47], v[20:23], a[184:191], v3
s_nop 4
v_pk_add_f32 v[96:97], v[40:41], v[42:43]
s_nop 1
v_pk_add_f32 v[98:99], v[44:45], v[46:47]
ds_write_b128 v59, v[96:99] offset:13312
s_waitcnt lgkmcnt(0)
s_barrier
ds_read_b128 v[104:107], v66 offset:0
ds_read_b128 v[108:111], v66 offset:32
ds_read_b128 v[112:115], v66 offset:2560
ds_read_b128 v[116:119], v66 offset:2592
ds_read_b128 v[120:123], v66 offset:5120
ds_read_b128 v[124:127], v66 offset:5152
ds_read_b128 v[128:131], v66 offset:7680
ds_read_b128 v[132:135], v66 offset:7712
s_waitcnt lgkmcnt(4)
v_pk_add_f32 v[104:105], v[104:105], v[112:113]
v_pk_add_f32 v[106:107], v[106:107], v[114:115]
v_pk_add_f32 v[108:109], v[108:109], v[116:117]
v_pk_add_f32 v[110:111], v[110:111], v[118:119]
s_waitcnt lgkmcnt(2)
v_pk_add_f32 v[104:105], v[104:105], v[120:121]
v_pk_add_f32 v[106:107], v[106:107], v[122:123]
v_pk_add_f32 v[108:109], v[108:109], v[124:125]
v_pk_add_f32 v[110:111], v[110:111], v[126:127]
s_waitcnt lgkmcnt(1)
v_pk_add_f32 v[104:105], v[104:105], v[128:129]
v_pk_add_f32 v[106:107], v[106:107], v[130:131]
s_waitcnt lgkmcnt(0)
v_pk_add_f32 v[108:109], v[108:109], v[132:133]
v_pk_add_f32 v[110:111], v[110:111], v[134:135]
v_cvt_pk_bf16_f32 v100, v104, v105
v_cvt_pk_bf16_f32 v101, v106, v107
v_cvt_pk_bf16_f32 v102, v108, v109
v_cvt_pk_bf16_f32 v103, v110, v111
s_cmp_eq_u32 s18, 63
s_cbranch_scc1 m_f1_fin
v_mov_b64 v[24:25], 0
v_mov_b64 v[26:27], 0
v_mov_b64 v[28:29], 0
v_mov_b64 v[30:31], 0
v_mov_b64 v[32:33], 0
v_mov_b64 v[34:35], 0
v_mov_b64 v[36:37], 0
v_mov_b64 v[38:39], 0
v_mov_b64 v[40:41], 0
v_mov_b64 v[42:43], 0
v_mov_b64 v[44:45], 0
v_mov_b64 v[46:47], 0
s_cmp_ge_u32 s18, 15
s_cbranch_scc1 m_f1_ow0
ds_read_b128 v[104:107], v59 offset:32768
ds_read_b128 v[108:111], v59 offset:33792
ds_read_b128 v[112:115], v59 offset:34816
ds_read_b128 v[116:119], v59 offset:35840
ds_read_b128 v[120:123], v59 offset:36864
ds_read_b128 v[124:127], v59 offset:37888
ds_read_b128 v[128:131], v59 offset:38912
ds_read_b128 v[132:135], v59 offset:39936
v_mfma_f32_16x16x32_bf16 v[208:211], a[64:67], v[144:147], 0
v_mfma_f32_16x16x32_bf16 v[224:227], v[144:147], a[128:131], 0
v_mfma_f32_16x16x32_bf16 v[212:215], a[96:99], v[144:147], 0
v_mfma_f32_16x16x32_bf16 v[232:235], v[144:147], a[160:163], 0
v_mfma_f32_16x16x32_bf16 v[216:219], a[64:67], v[148:151], 0
v_mfma_f32_16x16x32_bf16 v[228:231], v[148:151], a[128:131], 0
v_mfma_f32_16x16x32_bf16 v[220:223], a[96:99], v[148:151], 0
s_waitcnt lgkmcnt(4)
v_pk_add_f32 v[104:105], v[104:105], v[112:113]
v_pk_add_f32 v[106:107], v[106:107], v[114:115]
v_mfma_f32_16x16x32_bf16 v[236:239], v[148:151], a[160:163], 0
v_pk_add_f32 v[108:109], v[108:109], v[116:117]
v_pk_add_f32 v[110:111], v[110:111], v[118:119]
s_waitcnt lgkmcnt(2)
v_mfma_f32_16x16x32_bf16 v[208:211], a[68:71], v[152:155], v[208:211]
v_pk_add_f32 v[104:105], v[104:105], v[120:121]
v_pk_add_f32 v[106:107], v[106:107], v[122:123]
v_pk_add_f32 v[108:109], v[108:109], v[124:125]
v_mfma_f32_16x16x32_bf16 v[224:227], v[152:155], a[132:135], v[224:227]
v_pk_add_f32 v[110:111], v[110:111], v[126:127]
s_waitcnt lgkmcnt(0)
v_pk_add_f32 v[104:105], v[104:105], v[128:129]
v_mfma_f32_16x16x32_bf16 v[212:215], a[100:103], v[152:155], v[212:215]
v_pk_add_f32 v[106:107], v[106:107], v[130:131]
v_pk_add_f32 v[108:109], v[108:109], v[132:133]
v_pk_add_f32 v[110:111], v[110:111], v[134:135]
v_mfma_f32_16x16x32_bf16 v[232:235], v[152:155], a[164:167], v[232:235]
v_cvt_pk_bf16_f32 v136, v104, v105
v_cvt_pk_bf16_f32 v137, v106, v107
v_cvt_pk_bf16_f32 v138, v108, v109
v_mfma_f32_16x16x32_bf16 v[216:219], a[68:71], v[156:159], v[216:219]
v_cvt_pk_bf16_f32 v139, v110, v111
v_permlane32_swap_b32 v136, v138
s_nop 0
v_permlane32_swap_b32 v137, v139
v_mfma_f32_16x16x32_bf16 v[228:231], v[156:159], a[132:135], v[228:231]
ds_write_b128 v74, v[136:139] offset:24576
v_mfma_f32_16x16x32_bf16 v[220:223], a[100:103], v[156:159], v[220:223]
v_mfma_f32_16x16x32_bf16 v[236:239], v[156:159], a[164:167], v[236:239]
v_mfma_f32_16x16x32_bf16 v[208:211], a[72:75], v[160:163], v[208:211]
v_mfma_f32_16x16x32_bf16 v[224:227], v[160:163], a[136:139], v[224:227]
v_mfma_f32_16x16x32_bf16 v[212:215], a[104:107], v[160:163], v[212:215]
v_mfma_f32_16x16x32_bf16 v[232:235], v[160:163], a[168:171], v[232:235]
v_mfma_f32_16x16x32_bf16 v[216:219], a[72:75], v[164:167], v[216:219]
v_mfma_f32_16x16x32_bf16 v[228:231], v[164:167], a[136:139], v[228:231]
v_mfma_f32_16x16x32_bf16 v[220:223], a[104:107], v[164:167], v[220:223]
v_mfma_f32_16x16x32_bf16 v[236:239], v[164:167], a[168:171], v[236:239]
m_f1_ow0:
v_xor_b32 v74, 4096, v74
s_barrier
buffer_load_dwordx4 v[8:11], v57, s[4:7], s19 offen offset:0 sc1
buffer_load_dwordx4 v[12:15], v57, s[4:7], s19 offen offset:1024 sc1
buffer_load_dwordx4 v[16:19], v57, s[4:7], s19 offen offset:2048 sc1
buffer_load_dwordx4 v[20:23], v57, s[4:7], s19 offen offset:3072 sc1
s_waitcnt vmcnt(3)
v_cmp_eq_u32 vcc, -1, v8
s_cbranch_vccnz m_f1_om0
v_smfmac_f32_16x16x64_bf16 v[48:51], v[8:11], a[192:199], v3
s_waitcnt vmcnt(2)
v_cmp_eq_u32 vcc, -1, v12
s_cbranch_vccnz m_f1_om1
v_smfmac_f32_16x16x64_bf16 v[52:55], v[8:11], a[224:231], v3
v_smfmac_f32_16x16x64_bf16 v[48:51], v[12:15], a[200:207], v3
s_waitcnt vmcnt(1)
v_cmp_eq_u32 vcc, -1, v16
s_cbranch_vccnz m_f1_om2
v_smfmac_f32_16x16x64_bf16 v[52:55], v[12:15], a[232:239], v3
v_smfmac_f32_16x16x64_bf16 v[48:51], v[16:19], a[208:215], v3
s_waitcnt vmcnt(0)
v_cmp_eq_u32 vcc, -1, v20
s_cbranch_vccnz m_f1_om3
v_smfmac_f32_16x16x64_bf16 v[52:55], v[16:19], a[240:247], v3
v_smfmac_f32_16x16x64_bf16 v[48:51], v[20:23], a[216:223], v3
v_smfmac_f32_16x16x64_bf16 v[52:55], v[20:23], a[248:255], v3
m_f1_ob:
s_nop 4
v_pk_add_f32 v[96:97], v[48:49], v[50:51]
s_nop 1
v_pk_add_f32 v[98:99], v[52:53], v[54:55]
ds_write2_b32 v240, v96, v97 offset0:0 offset1:72
ds_write2_b32 v240, v98, v99 offset0:160 offset1:232
s_lshr_b32 s29, s23, 8
s_xor_b32 s29, s29, s65
s_and_b32 s29, s29, 8192
s_add_u32 s29, s29, s23
buffer_store_dwordx4 v[100:103], v67, s[4:7], s29 offen sc1
s_add_u32 s23, s23, 131072
buffer_store_dwordx4 v[4:7], v61, s[4:7], s22 offen sc1
s_cmp_ge_u32 s18, 15
s_cbranch_scc1 m_f1_ow1
s_lshr_b32 s29, s61, 8
s_xnor_b32 s29, s29, s65
s_and_b32 s29, s29, 8192
s_add_u32 s29, s29, s61
s_add_u32 s28, s29, 33554432
s_add_u32 s61, s61, 524288
buffer_store_dwordx4 v[136:139], v244, s[4:7], s29 offen offset:0 sc1
m_f1_ow1:
s_waitcnt lgkmcnt(0)
s_barrier
s_sub_u32 s28, s18, 48
s_cmp_ge_u32 s28, 4
s_cbranch_scc1 m_f1_sn
s_xor_b32 s29, s65, 8192
s_and_b32 s29, s29, 8192
s_mul_i32 s28, s28, 262144
s_add_u32 s29, s29, s28
s_add_u32 s29, s29, 7340032
buffer_store_dwordx4 v[4:7], v67, s[4:7], s29 offen sc1
s_add_u32 s29, s29, 131072
buffer_store_dwordx4 v[4:7], v67, s[4:7], s29 offen sc1
m_f1_sn:
v_mov_b64 v[48:49], 0
v_mov_b64 v[50:51], 0
v_mov_b64 v[52:53], 0
v_mov_b64 v[54:55], 0
s_cmp_ge_u32 s18, 15
s_cbranch_scc1 m_f1_ow2
v_mfma_f32_16x16x32_bf16 v[208:211], a[76:79], v[168:171], v[208:211]
v_mfma_f32_16x16x32_bf16 v[224:227], v[168:171], a[140:143], v[224:227]
s_add_u32 s28, s60, 0
buffer_load_dwordx4 v[144:147], v241, s[4:7], s28 offen offset:0
v_mfma_f32_16x16x32_bf16 v[212:215], a[108:111], v[168:171], v[212:215]
v_mfma_f32_16x16x32_bf16 v[232:235], v[168:171], a[172:175], v[232:235]
v_mfma_f32_16x16x32_bf16 v[216:219], a[76:79], v[172:175], v[216:219]
v_mfma_f32_16x16x32_bf16 v[228:231], v[172:175], a[140:143], v[228:231]
s_add_u32 s28, s60, 4096
buffer_load_dwordx4 v[168:171], v241, s[4:7], s28 offen offset:2048
s_add_u32 s28, s60, 0
buffer_load_dwordx4 v[148:151], v241, s[4:7], s28 offen offset:256
v_mfma_f32_16x16x32_bf16 v[220:223], a[108:111], v[172:175], v[220:223]
v_mfma_f32_16x16x32_bf16 v[236:239], v[172:175], a[172:175], v[236:239]
v_mfma_f32_16x16x32_bf16 v[208:211], a[80:83], v[176:179], v[208:211]
v_mfma_f32_16x16x32_bf16 v[224:227], v[176:179], a[144:147], v[224:227]
s_add_u32 s28, s60, 4096
buffer_load_dwordx4 v[172:175], v241, s[4:7], s28 offen offset:2304
s_add_u32 s28, s60, 0
buffer_load_dwordx4 v[152:155], v241, s[4:7], s28 offen offset:2048
v_mfma_f32_16x16x32_bf16 v[212:215], a[112:115], v[176:179], v[212:215]
v_mfma_f32_16x16x32_bf16 v[232:235], v[176:179], a[176:179], v[232:235]
v_mfma_f32_16x16x32_bf16 v[216:219], a[80:83], v[180:183], v[216:219]
v_mfma_f32_16x16x32_bf16 v[228:231], v[180:183], a[144:147], v[228:231]
s_add_u32 s28, s60, 8192
buffer_load_dwordx4 v[176:179], v241, s[4:7], s28 offen offset:0
s_add_u32 s28, s60, 0
buffer_load_dwordx4 v[156:159], v241, s[4:7], s28 offen offset:2304
v_mfma_f32_16x16x32_bf16 v[220:223], a[112:115], v[180:183], v[220:223]
v_mfma_f32_16x16x32_bf16 v[236:239], v[180:183], a[176:179], v[236:239]
v_mfma_f32_16x16x32_bf16 v[208:211], a[84:87], v[184:187], v[208:211]
v_mfma_f32_16x16x32_bf16 v[224:227], v[184:187], a[148:151], v[224:227]
s_add_u32 s28, s60, 8192
buffer_load_dwordx4 v[180:183], v241, s[4:7], s28 offen offset:256
s_add_u32 s28, s60, 4096
buffer_load_dwordx4 v[160:163], v241, s[4:7], s28 offen offset:0
v_mfma_f32_16x16x32_bf16 v[212:215], a[116:119], v[184:187], v[212:215]
v_mfma_f32_16x16x32_bf16 v[232:235], v[184:187], a[180:183], v[232:235]
v_mfma_f32_16x16x32_bf16 v[216:219], a[84:87], v[188:191], v[216:219]
v_mfma_f32_16x16x32_bf16 v[228:231], v[188:191], a[148:151], v[228:231]
s_add_u32 s28, s60, 8192
buffer_load_dwordx4 v[184:187], v241, s[4:7], s28 offen offset:2048
s_add_u32 s28, s60, 4096
buffer_load_dwordx4 v[164:167], v241, s[4:7], s28 offen offset:256
v_mfma_f32_16x16x32_bf16 v[220:223], a[116:119], v[188:191], v[220:223]
v_mfma_f32_16x16x32_bf16 v[236:239], v[188:191], a[180:183], v[236:239]
v_mfma_f32_16x16x32_bf16 v[208:211], a[88:91], v[192:195], v[208:211]
v_mfma_f32_16x16x32_bf16 v[224:227], v[192:195], a[152:155], v[224:227]
s_add_u32 s28, s60, 8192
buffer_load_dwordx4 v[188:191], v241, s[4:7], s28 offen offset:2304
v_mfma_f32_16x16x32_bf16 v[212:215], a[120:123], v[192:195], v[212:215]
v_mfma_f32_16x16x32_bf16 v[232:235], v[192:195], a[184:187], v[232:235]
v_mfma_f32_16x16x32_bf16 v[216:219], a[88:91], v[196:199], v[216:219]
v_mfma_f32_16x16x32_bf16 v[228:231], v[196:199], a[152:155], v[228:231]
s_add_u32 s28, s60, 12288
buffer_load_dwordx4 v[192:195], v241, s[4:7], s28 offen offset:0
v_mfma_f32_16x16x32_bf16 v[220:223], a[120:123], v[196:199], v[220:223]
v_mfma_f32_16x16x32_bf16 v[236:239], v[196:199], a[184:187], v[236:239]
v_mfma_f32_16x16x32_bf16 v[208:211], a[92:95], v[200:203], v[208:211]
v_mfma_f32_16x16x32_bf16 v[224:227], v[200:203], a[156:159], v[224:227]
s_add_u32 s28, s60, 12288
buffer_load_dwordx4 v[196:199], v241, s[4:7], s28 offen offset:256
v_mfma_f32_16x16x32_bf16 v[212:215], a[124:127], v[200:203], v[212:215]
v_mfma_f32_16x16x32_bf16 v[232:235], v[200:203], a[188:191], v[232:235]
v_mfma_f32_16x16x32_bf16 v[216:219], a[92:95], v[204:207], v[216:219]
v_mfma_f32_16x16x32_bf16 v[228:231], v[204:207], a[156:159], v[228:231]
s_add_u32 s28, s60, 12288
buffer_load_dwordx4 v[200:203], v241, s[4:7], s28 offen offset:2048
v_mfma_f32_16x16x32_bf16 v[220:223], a[124:127], v[204:207], v[220:223]
v_mfma_f32_16x16x32_bf16 v[236:239], v[204:207], a[188:191], v[236:239]
s_add_u32 s28, s60, 12288
buffer_load_dwordx4 v[204:207], v241, s[4:7], s28 offen offset:2304
ds_write_b128 v242, v[208:211] offset:0
ds_write_b128 v242, v[212:215] offset:1024
ds_write_b128 v242, v[224:227] offset:16384
ds_write_b128 v242, v[228:231] offset:17408
ds_write_b128 v242, v[216:219] offset:8192
ds_write_b128 v242, v[220:223] offset:9216
ds_write_b128 v242, v[232:235] offset:24576
ds_write_b128 v242, v[236:239] offset:25600
s_mov_b32 s59, s60
s_add_u32 s60, s60, 65536
s_cmp_eq_u32 s18, 4
s_cselect_b32 s60, 176701440, s60
s_xor_b32 s69, s69, 16384
m_f1_ow2:
s_add_u32 s18, s18, 1
s_mov_b32 s31, s21
s_and_b32 s30, s18, 3
s_lshl_b32 s21, s30, 18
s_xor_b32 s22, s21, 524288
s_add_u32 s21, s21, 169869312
s_add_u32 s22, s22, 169869312
s_xor_b32 s30, s30, 2
s_lshl_b32 s20, s30, 19
s_add_u32 s20, s20, 167772160
s_waitcnt lgkmcnt(0)
s_barrier
buffer_load_dwordx4 v[8:11], v56, s[4:7], s19 offen offset:0 sc1
buffer_load_dwordx4 v[12:15], v56, s[4:7], s19 offen offset:1024 sc1
buffer_load_dwordx4 v[16:19], v56, s[4:7], s19 offen offset:2048 sc1
buffer_load_dwordx4 v[20:23], v56, s[4:7], s19 offen offset:3072 sc1
s_branch m_f1_top
m_f1_am0:
s_mov_b32 s32, 15
s_cmp_eq_u32 s17, 0
s_cbranch_scc1 m_f1_ah40
s_sub_u32 s17, s17, 1
buffer_load_dwordx4 v[8:11], v56, s[4:7], s19 offen offset:0 sc1
s_branch m_f1_al41
m_f1_am1:
v_smfmac_f32_16x16x64_bf16 v[36:39], v[8:11], a[96:103], v3
s_mov_b32 s32, 14
s_cmp_eq_u32 s17, 0
s_cbranch_scc1 m_f1_ah31
s_sub_u32 s17, s17, 1
buffer_load_dwordx4 v[12:15], v56, s[4:7], s19 offen offset:1024 sc1
s_branch m_f1_al32
m_f1_am2:
v_smfmac_f32_16x16x64_bf16 v[36:39], v[12:15], a[104:111], v3
s_mov_b32 s32, 12
s_cmp_eq_u32 s17, 0
s_cbranch_scc1 m_f1_ah22
s_sub_u32 s17, s17, 1
buffer_load_dwordx4 v[16:19], v56, s[4:7], s19 offen offset:2048 sc1
s_branch m_f1_al23
m_f1_am3:
v_smfmac_f32_16x16x64_bf16 v[36:39], v[16:19], a[112:119], v3
s_mov_b32 s32, 8
s_cmp_eq_u32 s17, 0
s_cbranch_scc1 m_f1_ah13
s_sub_u32 s17, s17, 1
buffer_load_dwordx4 v[20:23], v56, s[4:7], s19 offen offset:3072 sc1
s_branch m_f1_al10
m_f1_al10:
s_bitcmp1_b32 s32, 0
s_cbranch_scc0 m_f1_al11
s_waitcnt vmcnt(0)
v_cmp_eq_u32 vcc, -1, v8
s_cbranch_vccz m_f1_ah10
s_cmp_eq_u32 s17, 0
s_cbranch_scc1 m_f1_ah10
s_sub_u32 s17, s17, 1
buffer_load_dwordx4 v[8:11], v56, s[4:7], s19 offen offset:0 sc1
m_f1_al11:
s_bitcmp1_b32 s32, 1
s_cbranch_scc0 m_f1_al12
s_waitcnt vmcnt(0)
v_cmp_eq_u32 vcc, -1, v12
s_cbranch_vccz m_f1_ah11
s_cmp_eq_u32 s17, 0
s_cbranch_scc1 m_f1_ah11
s_sub_u32 s17, s17, 1
buffer_load_dwordx4 v[12:15], v56, s[4:7], s19 offen offset:1024 sc1
m_f1_al12:
s_bitcmp1_b32 s32, 2
s_cbranch_scc0 m_f1_al13
s_waitcnt vmcnt(0)
v_cmp_eq_u32 vcc, -1, v16
s_cbranch_vccz m_f1_ah12
s_cmp_eq_u32 s17, 0
s_cbranch_scc1 m_f1_ah12
s_sub_u32 s17, s17, 1
buffer_load_dwordx4 v[16:19], v56, s[4:7], s19 offen offset:2048 sc1
m_f1_al13:
s_bitcmp1_b32 s32, 3
s_cbranch_scc0 m_f1_al10
s_waitcnt vmcnt(0)
v_cmp_eq_u32 vcc, -1, v20
s_cbranch_vccz m_f1_ah13
s_cmp_eq_u32 s17, 0
s_cbranch_scc1 m_f1_ah13
s_sub_u32 s17, s17, 1
buffer_load_dwordx4 v[20:23], v56, s[4:7], s19 offen offset:3072 sc1
s_branch m_f1_al10
m_f1_ah10:
v_smfmac_f32_16x16x64_bf16 v[24:27], v[8:11], a[0:7], v3
v_smfmac_f32_16x16x64_bf16 v[28:31], v[8:11], a[32:39], v3
v_smfmac_f32_16x16x64_bf16 v[32:35], v[8:11], a[64:71], v3
v_smfmac_f32_16x16x64_bf16 v[36:39], v[8:11], a[96:103], v3
s_branch m_f1_ab
m_f1_ah11:
v_smfmac_f32_16x16x64_bf16 v[24:27], v[12:15], a[8:15], v3
v_smfmac_f32_16x16x64_bf16 v[28:31], v[12:15], a[40:47], v3
v_smfmac_f32_16x16x64_bf16 v[32:35], v[12:15], a[72:79], v3
v_smfmac_f32_16x16x64_bf16 v[36:39], v[12:15], a[104:111], v3
s_branch m_f1_ab
m_f1_ah12:
v_smfmac_f32_16x16x64_bf16 v[24:27], v[16:19], a[16:23], v3
v_smfmac_f32_16x16x64_bf16 v[28:31], v[16:19], a[48:55], v3
v_smfmac_f32_16x16x64_bf16 v[32:35], v[16:19], a[80:87], v3
v_smfmac_f32_16x16x64_bf16 v[36:39], v[16:19], a[112:119], v3
s_branch m_f1_ab
m_f1_ah13:
v_smfmac_f32_16x16x64_bf16 v[24:27], v[20:23], a[24:31], v3
v_smfmac_f32_16x16x64_bf16 v[28:31], v[20:23], a[56:63], v3
v_smfmac_f32_16x16x64_bf16 v[32:35], v[20:23], a[88:95], v3
v_smfmac_f32_16x16x64_bf16 v[36:39], v[20:23], a[120:127], v3
s_branch m_f1_ab
m_f1_al20:
s_bitcmp1_b32 s32, 0
s_cbranch_scc0 m_f1_al21
s_waitcnt vmcnt(1)
v_cmp_eq_u32 vcc, -1, v8
s_cbranch_vccz m_f1_ah20
s_cmp_eq_u32 s17, 0
s_cbranch_scc1 m_f1_ah20
s_sub_u32 s17, s17, 1
buffer_load_dwordx4 v[8:11], v56, s[4:7], s19 offen offset:0 sc1
m_f1_al21:
s_bitcmp1_b32 s32, 1
s_cbranch_scc0 m_f1_al22
s_waitcnt vmcnt(1)
v_cmp_eq_u32 vcc, -1, v12
s_cbranch_vccz m_f1_ah21
s_cmp_eq_u32 s17, 0
s_cbranch_scc1 m_f1_ah21
s_sub_u32 s17, s17, 1
buffer_load_dwordx4 v[12:15], v56, s[4:7], s19 offen offset:1024 sc1
m_f1_al22:
s_bitcmp1_b32 s32, 2
s_cbranch_scc0 m_f1_al23
s_waitcnt vmcnt(1)
v_cmp_eq_u32 vcc, -1, v16
s_cbranch_vccz m_f1_ah22
s_cmp_eq_u32 s17, 0
s_cbranch_scc1 m_f1_ah22
s_sub_u32 s17, s17, 1
buffer_load_dwordx4 v[16:19], v56, s[4:7], s19 offen offset:2048 sc1
m_f1_al23:
s_bitcmp1_b32 s32, 3
s_cbranch_scc0 m_f1_al20
s_waitcnt vmcnt(1)
v_cmp_eq_u32 vcc, -1, v20
s_cbranch_vccz m_f1_ah23
s_cmp_eq_u32 s17, 0
s_cbranch_scc1 m_f1_ah23
s_sub_u32 s17, s17, 1
buffer_load_dwordx4 v[20:23], v56, s[4:7], s19 offen offset:3072 sc1
s_branch m_f1_al20
m_f1_ah20:
v_smfmac_f32_16x16x64_bf16 v[24:27], v[8:11], a[0:7], v3
v_smfmac_f32_16x16x64_bf16 v[28:31], v[8:11], a[32:39], v3
v_smfmac_f32_16x16x64_bf16 v[32:35], v[8:11], a[64:71], v3
v_smfmac_f32_16x16x64_bf16 v[36:39], v[8:11], a[96:103], v3
s_bitset0_b32 s32, 0
s_branch m_f1_al11
m_f1_ah21:
v_smfmac_f32_16x16x64_bf16 v[24:27], v[12:15], a[8:15], v3
v_smfmac_f32_16x16x64_bf16 v[28:31], v[12:15], a[40:47], v3
v_smfmac_f32_16x16x64_bf16 v[32:35], v[12:15], a[72:79], v3
v_smfmac_f32_16x16x64_bf16 v[36:39], v[12:15], a[104:111], v3
s_bitset0_b32 s32, 1
s_branch m_f1_al12
m_f1_ah22:
v_smfmac_f32_16x16x64_bf16 v[24:27], v[16:19], a[16:23], v3
v_smfmac_f32_16x16x64_bf16 v[28:31], v[16:19], a[48:55], v3
v_smfmac_f32_16x16x64_bf16 v[32:35], v[16:19], a[80:87], v3
v_smfmac_f32_16x16x64_bf16 v[36:39], v[16:19], a[112:119], v3
s_bitset0_b32 s32, 2
s_branch m_f1_al13
m_f1_ah23:
v_smfmac_f32_16x16x64_bf16 v[24:27], v[20:23], a[24:31], v3
v_smfmac_f32_16x16x64_bf16 v[28:31], v[20:23], a[56:63], v3
v_smfmac_f32_16x16x64_bf16 v[32:35], v[20:23], a[88:95], v3
v_smfmac_f32_16x16x64_bf16 v[36:39], v[20:23], a[120:127], v3
s_bitset0_b32 s32, 3
s_branch m_f1_al10
m_f1_al30:
s_bitcmp1_b32 s32, 0
s_cbranch_scc0 m_f1_al31
s_waitcnt vmcnt(2)
v_cmp_eq_u32 vcc, -1, v8
s_cbranch_vccz m_f1_ah30
s_cmp_eq_u32 s17, 0
s_cbranch_scc1 m_f1_ah30
s_sub_u32 s17, s17, 1
buffer_load_dwordx4 v[8:11], v56, s[4:7], s19 offen offset:0 sc1
m_f1_al31:
s_bitcmp1_b32 s32, 1
s_cbranch_scc0 m_f1_al32
s_waitcnt vmcnt(2)
v_cmp_eq_u32 vcc, -1, v12
s_cbranch_vccz m_f1_ah31
s_cmp_eq_u32 s17, 0
s_cbranch_scc1 m_f1_ah31
s_sub_u32 s17, s17, 1
buffer_load_dwordx4 v[12:15], v56, s[4:7], s19 offen offset:1024 sc1
m_f1_al32:
s_bitcmp1_b32 s32, 2
s_cbranch_scc0 m_f1_al33
s_waitcnt vmcnt(2)
v_cmp_eq_u32 vcc, -1, v16
s_cbranch_vccz m_f1_ah32
s_cmp_eq_u32 s17, 0
s_cbranch_scc1 m_f1_ah32
s_sub_u32 s17, s17, 1
buffer_load_dwordx4 v[16:19], v56, s[4:7], s19 offen offset:2048 sc1
m_f1_al33:
s_bitcmp1_b32 s32, 3
s_cbranch_scc0 m_f1_al30
s_waitcnt vmcnt(2)
v_cmp_eq_u32 vcc, -1, v20
s_cbranch_vccz m_f1_ah33
s_cmp_eq_u32 s17, 0
s_cbranch_scc1 m_f1_ah33
s_sub_u32 s17, s17, 1
buffer_load_dwordx4 v[20:23], v56, s[4:7], s19 offen offset:3072 sc1
s_branch m_f1_al30
m_f1_ah30:
v_smfmac_f32_16x16x64_bf16 v[24:27], v[8:11], a[0:7], v3
v_smfmac_f32_16x16x64_bf16 v[28:31], v[8:11], a[32:39], v3
v_smfmac_f32_16x16x64_bf16 v[32:35], v[8:11], a[64:71], v3
v_smfmac_f32_16x16x64_bf16 v[36:39], v[8:11], a[96:103], v3
s_bitset0_b32 s32, 0
s_branch m_f1_al21
m_f1_ah31:
v_smfmac_f32_16x16x64_bf16 v[24:27], v[12:15], a[8:15], v3
v_smfmac_f32_16x16x64_bf16 v[28:31], v[12:15], a[40:47], v3
v_smfmac_f32_16x16x64_bf16 v[32:35], v[12:15], a[72:79], v3
v_smfmac_f32_16x16x64_bf16 v[36:39], v[12:15], a[104:111], v3
s_bitset0_b32 s32, 1
s_branch m_f1_al22
m_f1_ah32:
v_smfmac_f32_16x16x64_bf16 v[24:27], v[16:19], a[16:23], v3
v_smfmac_f32_16x16x64_bf16 v[28:31], v[16:19], a[48:55], v3
v_smfmac_f32_16x16x64_bf16 v[32:35], v[16:19], a[80:87], v3
v_smfmac_f32_16x16x64_bf16 v[36:39], v[16:19], a[112:119], v3
s_bitset0_b32 s32, 2
s_branch m_f1_al23
m_f1_ah33:
v_smfmac_f32_16x16x64_bf16 v[24:27], v[20:23], a[24:31], v3
v_smfmac_f32_16x16x64_bf16 v[28:31], v[20:23], a[56:63], v3
v_smfmac_f32_16x16x64_bf16 v[32:35], v[20:23], a[88:95], v3
v_smfmac_f32_16x16x64_bf16 v[36:39], v[20:23], a[120:127], v3
s_bitset0_b32 s32, 3
s_branch m_f1_al20
m_f1_al40:
s_waitcnt vmcnt(3)
v_cmp_eq_u32 vcc, -1, v8
s_cbranch_vccz m_f1_ah40
s_cmp_eq_u32 s17, 0
s_cbranch_scc1 m_f1_ah40
s_sub_u32 s17, s17, 1
buffer_load_dwordx4 v[8:11], v56, s[4:7], s19 offen offset:0 sc1
m_f1_al41:
s_waitcnt vmcnt(3)
v_cmp_eq_u32 vcc, -1, v12
s_cbranch_vccz m_f1_ah41
s_cmp_eq_u32 s17, 0
s_cbranch_scc1 m_f1_ah41
s_sub_u32 s17, s17, 1
buffer_load_dwordx4 v[12:15], v56, s[4:7], s19 offen offset:1024 sc1
m_f1_al42:
s_waitcnt vmcnt(3)
v_cmp_eq_u32 vcc, -1, v16
s_cbranch_vccz m_f1_ah42
s_cmp_eq_u32 s17, 0
s_cbranch_scc1 m_f1_ah42
s_sub_u32 s17, s17, 1
buffer_load_dwordx4 v[16:19], v56, s[4:7], s19 offen offset:2048 sc1
m_f1_al43:
s_waitcnt vmcnt(3)
v_cmp_eq_u32 vcc, -1, v20
s_cbranch_vccz m_f1_ah43
s_cmp_eq_u32 s17, 0
s_cbranch_scc1 m_f1_ah43
s_sub_u32 s17, s17, 1
buffer_load_dwordx4 v[20:23], v56, s[4:7], s19 offen offset:3072 sc1
s_branch m_f1_al40
m_f1_ah40:
v_smfmac_f32_16x16x64_bf16 v[24:27], v[8:11], a[0:7], v3
v_smfmac_f32_16x16x64_bf16 v[28:31], v[8:11], a[32:39], v3
v_smfmac_f32_16x16x64_bf16 v[32:35], v[8:11], a[64:71], v3
v_smfmac_f32_16x16x64_bf16 v[36:39], v[8:11], a[96:103], v3
s_bitset0_b32 s32, 0
s_branch m_f1_al31
m_f1_ah41:
v_smfmac_f32_16x16x64_bf16 v[24:27], v[12:15], a[8:15], v3
v_smfmac_f32_16x16x64_bf16 v[28:31], v[12:15], a[40:47], v3
v_smfmac_f32_16x16x64_bf16 v[32:35], v[12:15], a[72:79], v3
v_smfmac_f32_16x16x64_bf16 v[36:39], v[12:15], a[104:111], v3
s_bitset0_b32 s32, 1
s_branch m_f1_al32
m_f1_ah42:
v_smfmac_f32_16x16x64_bf16 v[24:27], v[16:19], a[16:23], v3
v_smfmac_f32_16x16x64_bf16 v[28:31], v[16:19], a[48:55], v3
v_smfmac_f32_16x16x64_bf16 v[32:35], v[16:19], a[80:87], v3
v_smfmac_f32_16x16x64_bf16 v[36:39], v[16:19], a[112:119], v3
s_bitset0_b32 s32, 2
s_branch m_f1_al33
m_f1_ah43:
v_smfmac_f32_16x16x64_bf16 v[24:27], v[20:23], a[24:31], v3
v_smfmac_f32_16x16x64_bf16 v[28:31], v[20:23], a[56:63], v3
v_smfmac_f32_16x16x64_bf16 v[32:35], v[20:23], a[88:95], v3
v_smfmac_f32_16x16x64_bf16 v[36:39], v[20:23], a[120:127], v3
s_bitset0_b32 s32, 3
s_branch m_f1_al30
m_f1_om0:
s_mov_b32 s32, 15
s_cmp_eq_u32 s17, 0
s_cbranch_scc1 m_f1_oh40
s_sub_u32 s17, s17, 1
buffer_load_dwordx4 v[8:11], v57, s[4:7], s19 offen offset:0 sc1
s_branch m_f1_ol41
m_f1_om1:
v_smfmac_f32_16x16x64_bf16 v[52:55], v[8:11], a[224:231], v3
s_mov_b32 s32, 14
s_cmp_eq_u32 s17, 0
s_cbranch_scc1 m_f1_oh31
s_sub_u32 s17, s17, 1
buffer_load_dwordx4 v[12:15], v57, s[4:7], s19 offen offset:1024 sc1
s_branch m_f1_ol32
m_f1_om2:
v_smfmac_f32_16x16x64_bf16 v[52:55], v[12:15], a[232:239], v3
s_mov_b32 s32, 12
s_cmp_eq_u32 s17, 0
s_cbranch_scc1 m_f1_oh22
s_sub_u32 s17, s17, 1
buffer_load_dwordx4 v[16:19], v57, s[4:7], s19 offen offset:2048 sc1
s_branch m_f1_ol23
m_f1_om3:
v_smfmac_f32_16x16x64_bf16 v[52:55], v[16:19], a[240:247], v3
s_mov_b32 s32, 8
s_cmp_eq_u32 s17, 0
s_cbranch_scc1 m_f1_oh13
s_sub_u32 s17, s17, 1
buffer_load_dwordx4 v[20:23], v57, s[4:7], s19 offen offset:3072 sc1
s_branch m_f1_ol10
m_f1_ol10:
s_bitcmp1_b32 s32, 0
s_cbranch_scc0 m_f1_ol11
s_waitcnt vmcnt(0)
v_cmp_eq_u32 vcc, -1, v8
s_cbranch_vccz m_f1_oh10
s_cmp_eq_u32 s17, 0
s_cbranch_scc1 m_f1_oh10
s_sub_u32 s17, s17, 1
buffer_load_dwordx4 v[8:11], v57, s[4:7], s19 offen offset:0 sc1
m_f1_ol11:
s_bitcmp1_b32 s32, 1
s_cbranch_scc0 m_f1_ol12
s_waitcnt vmcnt(0)
v_cmp_eq_u32 vcc, -1, v12
s_cbranch_vccz m_f1_oh11
s_cmp_eq_u32 s17, 0
s_cbranch_scc1 m_f1_oh11
s_sub_u32 s17, s17, 1
buffer_load_dwordx4 v[12:15], v57, s[4:7], s19 offen offset:1024 sc1
m_f1_ol12:
s_bitcmp1_b32 s32, 2
s_cbranch_scc0 m_f1_ol13
s_waitcnt vmcnt(0)
v_cmp_eq_u32 vcc, -1, v16
s_cbranch_vccz m_f1_oh12
s_cmp_eq_u32 s17, 0
s_cbranch_scc1 m_f1_oh12
s_sub_u32 s17, s17, 1
buffer_load_dwordx4 v[16:19], v57, s[4:7], s19 offen offset:2048 sc1
m_f1_ol13:
s_bitcmp1_b32 s32, 3
s_cbranch_scc0 m_f1_ol10
s_waitcnt vmcnt(0)
v_cmp_eq_u32 vcc, -1, v20
s_cbranch_vccz m_f1_oh13
s_cmp_eq_u32 s17, 0
s_cbranch_scc1 m_f1_oh13
s_sub_u32 s17, s17, 1
buffer_load_dwordx4 v[20:23], v57, s[4:7], s19 offen offset:3072 sc1
s_branch m_f1_ol10
m_f1_oh10:
v_smfmac_f32_16x16x64_bf16 v[48:51], v[8:11], a[192:199], v3
v_smfmac_f32_16x16x64_bf16 v[52:55], v[8:11], a[224:231], v3
s_branch m_f1_ob
m_f1_oh11:
v_smfmac_f32_16x16x64_bf16 v[48:51], v[12:15], a[200:207], v3
v_smfmac_f32_16x16x64_bf16 v[52:55], v[12:15], a[232:239], v3
s_branch m_f1_ob
m_f1_oh12:
v_smfmac_f32_16x16x64_bf16 v[48:51], v[16:19], a[208:215], v3
v_smfmac_f32_16x16x64_bf16 v[52:55], v[16:19], a[240:247], v3
s_branch m_f1_ob
m_f1_oh13:
v_smfmac_f32_16x16x64_bf16 v[48:51], v[20:23], a[216:223], v3
v_smfmac_f32_16x16x64_bf16 v[52:55], v[20:23], a[248:255], v3
s_branch m_f1_ob
m_f1_ol20:
s_bitcmp1_b32 s32, 0
s_cbranch_scc0 m_f1_ol21
s_waitcnt vmcnt(1)
v_cmp_eq_u32 vcc, -1, v8
s_cbranch_vccz m_f1_oh20
s_cmp_eq_u32 s17, 0
s_cbranch_scc1 m_f1_oh20
s_sub_u32 s17, s17, 1
buffer_load_dwordx4 v[8:11], v57, s[4:7], s19 offen offset:0 sc1
m_f1_ol21:
s_bitcmp1_b32 s32, 1
s_cbranch_scc0 m_f1_ol22
s_waitcnt vmcnt(1)
v_cmp_eq_u32 vcc, -1, v12
s_cbranch_vccz m_f1_oh21
s_cmp_eq_u32 s17, 0
s_cbranch_scc1 m_f1_oh21
s_sub_u32 s17, s17, 1
buffer_load_dwordx4 v[12:15], v57, s[4:7], s19 offen offset:1024 sc1
m_f1_ol22:
s_bitcmp1_b32 s32, 2
s_cbranch_scc0 m_f1_ol23
s_waitcnt vmcnt(1)
v_cmp_eq_u32 vcc, -1, v16
s_cbranch_vccz m_f1_oh22
s_cmp_eq_u32 s17, 0
s_cbranch_scc1 m_f1_oh22
s_sub_u32 s17, s17, 1
buffer_load_dwordx4 v[16:19], v57, s[4:7], s19 offen offset:2048 sc1
m_f1_ol23:
s_bitcmp1_b32 s32, 3
s_cbranch_scc0 m_f1_ol20
s_waitcnt vmcnt(1)
v_cmp_eq_u32 vcc, -1, v20
s_cbranch_vccz m_f1_oh23
s_cmp_eq_u32 s17, 0
s_cbranch_scc1 m_f1_oh23
s_sub_u32 s17, s17, 1
buffer_load_dwordx4 v[20:23], v57, s[4:7], s19 offen offset:3072 sc1
s_branch m_f1_ol20
m_f1_oh20:
v_smfmac_f32_16x16x64_bf16 v[48:51], v[8:11], a[192:199], v3
v_smfmac_f32_16x16x64_bf16 v[52:55], v[8:11], a[224:231], v3
s_bitset0_b32 s32, 0
s_branch m_f1_ol11
m_f1_oh21:
v_smfmac_f32_16x16x64_bf16 v[48:51], v[12:15], a[200:207], v3
v_smfmac_f32_16x16x64_bf16 v[52:55], v[12:15], a[232:239], v3
s_bitset0_b32 s32, 1
s_branch m_f1_ol12
m_f1_oh22:
v_smfmac_f32_16x16x64_bf16 v[48:51], v[16:19], a[208:215], v3
v_smfmac_f32_16x16x64_bf16 v[52:55], v[16:19], a[240:247], v3
s_bitset0_b32 s32, 2
s_branch m_f1_ol13
m_f1_oh23:
v_smfmac_f32_16x16x64_bf16 v[48:51], v[20:23], a[216:223], v3
v_smfmac_f32_16x16x64_bf16 v[52:55], v[20:23], a[248:255], v3
s_bitset0_b32 s32, 3
s_branch m_f1_ol10
m_f1_ol30:
s_bitcmp1_b32 s32, 0
s_cbranch_scc0 m_f1_ol31
s_waitcnt vmcnt(2)
v_cmp_eq_u32 vcc, -1, v8
s_cbranch_vccz m_f1_oh30
s_cmp_eq_u32 s17, 0
s_cbranch_scc1 m_f1_oh30
s_sub_u32 s17, s17, 1
buffer_load_dwordx4 v[8:11], v57, s[4:7], s19 offen offset:0 sc1
m_f1_ol31:
s_bitcmp1_b32 s32, 1
s_cbranch_scc0 m_f1_ol32
s_waitcnt vmcnt(2)
v_cmp_eq_u32 vcc, -1, v12
s_cbranch_vccz m_f1_oh31
s_cmp_eq_u32 s17, 0
s_cbranch_scc1 m_f1_oh31
s_sub_u32 s17, s17, 1
buffer_load_dwordx4 v[12:15], v57, s[4:7], s19 offen offset:1024 sc1
m_f1_ol32:
s_bitcmp1_b32 s32, 2
s_cbranch_scc0 m_f1_ol33
s_waitcnt vmcnt(2)
v_cmp_eq_u32 vcc, -1, v16
s_cbranch_vccz m_f1_oh32
s_cmp_eq_u32 s17, 0
s_cbranch_scc1 m_f1_oh32
s_sub_u32 s17, s17, 1
buffer_load_dwordx4 v[16:19], v57, s[4:7], s19 offen offset:2048 sc1
m_f1_ol33:
s_bitcmp1_b32 s32, 3
s_cbranch_scc0 m_f1_ol30
s_waitcnt vmcnt(2)
v_cmp_eq_u32 vcc, -1, v20
s_cbranch_vccz m_f1_oh33
s_cmp_eq_u32 s17, 0
s_cbranch_scc1 m_f1_oh33
s_sub_u32 s17, s17, 1
buffer_load_dwordx4 v[20:23], v57, s[4:7], s19 offen offset:3072 sc1
s_branch m_f1_ol30
m_f1_oh30:
v_smfmac_f32_16x16x64_bf16 v[48:51], v[8:11], a[192:199], v3
v_smfmac_f32_16x16x64_bf16 v[52:55], v[8:11], a[224:231], v3
s_bitset0_b32 s32, 0
s_branch m_f1_ol21
m_f1_oh31:
v_smfmac_f32_16x16x64_bf16 v[48:51], v[12:15], a[200:207], v3
v_smfmac_f32_16x16x64_bf16 v[52:55], v[12:15], a[232:239], v3
s_bitset0_b32 s32, 1
s_branch m_f1_ol22
m_f1_oh32:
v_smfmac_f32_16x16x64_bf16 v[48:51], v[16:19], a[208:215], v3
v_smfmac_f32_16x16x64_bf16 v[52:55], v[16:19], a[240:247], v3
s_bitset0_b32 s32, 2
s_branch m_f1_ol23
m_f1_oh33:
v_smfmac_f32_16x16x64_bf16 v[48:51], v[20:23], a[216:223], v3
v_smfmac_f32_16x16x64_bf16 v[52:55], v[20:23], a[248:255], v3
s_bitset0_b32 s32, 3
s_branch m_f1_ol20
m_f1_ol40:
s_waitcnt vmcnt(3)
v_cmp_eq_u32 vcc, -1, v8
s_cbranch_vccz m_f1_oh40
s_cmp_eq_u32 s17, 0
s_cbranch_scc1 m_f1_oh40
s_sub_u32 s17, s17, 1
buffer_load_dwordx4 v[8:11], v57, s[4:7], s19 offen offset:0 sc1
m_f1_ol41:
s_waitcnt vmcnt(3)
v_cmp_eq_u32 vcc, -1, v12
s_cbranch_vccz m_f1_oh41
s_cmp_eq_u32 s17, 0
s_cbranch_scc1 m_f1_oh41
s_sub_u32 s17, s17, 1
buffer_load_dwordx4 v[12:15], v57, s[4:7], s19 offen offset:1024 sc1
m_f1_ol42:
s_waitcnt vmcnt(3)
v_cmp_eq_u32 vcc, -1, v16
s_cbranch_vccz m_f1_oh42
s_cmp_eq_u32 s17, 0
s_cbranch_scc1 m_f1_oh42
s_sub_u32 s17, s17, 1
buffer_load_dwordx4 v[16:19], v57, s[4:7], s19 offen offset:2048 sc1
m_f1_ol43:
s_waitcnt vmcnt(3)
v_cmp_eq_u32 vcc, -1, v20
s_cbranch_vccz m_f1_oh43
s_cmp_eq_u32 s17, 0
s_cbranch_scc1 m_f1_oh43
s_sub_u32 s17, s17, 1
buffer_load_dwordx4 v[20:23], v57, s[4:7], s19 offen offset:3072 sc1
s_branch m_f1_ol40
m_f1_oh40:
v_smfmac_f32_16x16x64_bf16 v[48:51], v[8:11], a[192:199], v3
v_smfmac_f32_16x16x64_bf16 v[52:55], v[8:11], a[224:231], v3
s_bitset0_b32 s32, 0
s_branch m_f1_ol31
m_f1_oh41:
v_smfmac_f32_16x16x64_bf16 v[48:51], v[12:15], a[200:207], v3
v_smfmac_f32_16x16x64_bf16 v[52:55], v[12:15], a[232:239], v3
s_bitset0_b32 s32, 1
s_branch m_f1_ol32
m_f1_oh42:
v_smfmac_f32_16x16x64_bf16 v[48:51], v[16:19], a[208:215], v3
v_smfmac_f32_16x16x64_bf16 v[52:55], v[16:19], a[240:247], v3
s_bitset0_b32 s32, 2
s_branch m_f1_ol33
m_f1_oh43:
v_smfmac_f32_16x16x64_bf16 v[48:51], v[20:23], a[216:223], v3
v_smfmac_f32_16x16x64_bf16 v[52:55], v[20:23], a[248:255], v3
s_bitset0_b32 s32, 3
s_branch m_f1_ol30
m_f1_fin:
s_lshr_b32 s29, s23, 8
s_xor_b32 s29, s29, s65
s_and_b32 s29, s29, 8192
s_add_u32 s29, s29, s23
buffer_store_dwordx4 v[100:103], v67, s[4:7], s29 offen sc1
s_add_u32 s23, s23, 131072
s_waitcnt vmcnt(0)
s_barrier
s_branch m_recdone
m_safe1:
m_s1_top:
s_waitcnt vmcnt(3)
v_cmp_eq_u32 vcc, -1, v8
s_cbranch_vccnz m_s1_am0
v_smfmac_f32_16x16x64_bf16 v[24:27], v[8:11], a[0:7], v3
v_smfmac_f32_16x16x64_bf16 v[28:31], v[8:11], a[32:39], v3
s_waitcnt vmcnt(2)
v_cmp_eq_u32 vcc, -1, v12
v_smfmac_f32_16x16x64_bf16 v[32:35], v[8:11], a[64:71], v3
s_cbranch_vccnz m_s1_am1
v_smfmac_f32_16x16x64_bf16 v[36:39], v[8:11], a[96:103], v3
v_smfmac_f32_16x16x64_bf16 v[24:27], v[12:15], a[8:15], v3
v_smfmac_f32_16x16x64_bf16 v[28:31], v[12:15], a[40:47], v3
s_waitcnt vmcnt(1)
v_cmp_eq_u32 vcc, -1, v16
v_smfmac_f32_16x16x64_bf16 v[32:35], v[12:15], a[72:79], v3
s_cbranch_vccnz m_s1_am2
v_smfmac_f32_16x16x64_bf16 v[36:39], v[12:15], a[104:111], v3
v_smfmac_f32_16x16x64_bf16 v[24:27], v[16:19], a[16:23], v3
v_smfmac_f32_16x16x64_bf16 v[28:31], v[16:19], a[48:55], v3
s_waitcnt vmcnt(0)
v_cmp_eq_u32 vcc, -1, v20
v_smfmac_f32_16x16x64_bf16 v[32:35], v[16:19], a[80:87], v3
s_cbranch_vccnz m_s1_am3
v_smfmac_f32_16x16x64_bf16 v[36:39], v[16:19], a[112:119], v3
v_smfmac_f32_16x16x64_bf16 v[24:27], v[20:23], a[24:31], v3
v_smfmac_f32_16x16x64_bf16 v[28:31], v[20:23], a[56:63], v3
v_smfmac_f32_16x16x64_bf16 v[32:35], v[20:23], a[88:95], v3
v_smfmac_f32_16x16x64_bf16 v[36:39], v[20:23], a[120:127], v3
m_s1_ab:
buffer_store_dwordx4 v[4:7], v68, s[4:7], s20 offen sc1
buffer_store_dword v4, v69, s[4:7], s20 offen sc1
v_smfmac_f32_16x16x64_bf16 v[40:43], v[8:11], a[128:135], v3
v_pk_add_f32 v[24:25], v[24:25], v[26:27]
v_pk_add_f32 v[28:29], v[28:29], v[30:31]
ds_write2_b32 v58, v24, v25 offset0:80 offset1:120
ds_write2_b32 v58, v28, v29 offset0:96 offset1:136
v_smfmac_f32_16x16x64_bf16 v[44:47], v[8:11], a[160:167], v3
v_pk_add_f32 v[32:33], v[32:33], v[34:35]
v_pk_add_f32 v[36:37], v[36:37], v[38:39]
ds_write2_b32 v58, v32, v33 offset0:0 offset1:40
ds_write2_b32 v58, v36, v37 offset0:16 offset1:56
s_and_b32 s30, s18, 3
s_lshl_b32 s19, s30, 19
s_add_u32 s19, s19, 167772160
v_smfmac_f32_16x16x64_bf16 v[40:43], v[12:15], a[136:143], v3
v_smfmac_f32_16x16x64_bf16 v[44:47], v[12:15], a[168:175], v3
s_waitcnt lgkmcnt(0)
s_barrier
v_smfmac_f32_16x16x64_bf16 v[40:43], v[16:19], a[144:151], v3
v_smfmac_f32_16x16x64_bf16 v[44:47], v[16:19], a[176:183], v3
v_smfmac_f32_16x16x64_bf16 v[40:43], v[20:23], a[152:159], v3
v_smfmac_f32_16x16x64_bf16 v[44:47], v[20:23], a[184:191], v3
s_nop 4
v_pk_add_f32 v[96:97], v[40:41], v[42:43]
s_nop 1
v_pk_add_f32 v[98:99], v[44:45], v[46:47]
ds_write_b128 v59, v[96:99] offset:13312
s_waitcnt lgkmcnt(0)
s_barrier
ds_read_b128 v[104:107], v66 offset:0
ds_read_b128 v[108:111], v66 offset:32
ds_read_b128 v[112:115], v66 offset:2560
ds_read_b128 v[116:119], v66 offset:2592
ds_read_b128 v[120:123], v66 offset:5120
ds_read_b128 v[124:127], v66 offset:5152
ds_read_b128 v[128:131], v66 offset:7680
ds_read_b128 v[132:135], v66 offset:7712
s_waitcnt lgkmcnt(4)
v_pk_add_f32 v[104:105], v[104:105], v[112:113]
v_pk_add_f32 v[106:107], v[106:107], v[114:115]
v_pk_add_f32 v[108:109], v[108:109], v[116:117]
v_pk_add_f32 v[110:111], v[110:111], v[118:119]
s_waitcnt lgkmcnt(2)
v_pk_add_f32 v[104:105], v[104:105], v[120:121]
v_pk_add_f32 v[106:107], v[106:107], v[122:123]
v_pk_add_f32 v[108:109], v[108:109], v[124:125]
v_pk_add_f32 v[110:111], v[110:111], v[126:127]
s_waitcnt lgkmcnt(1)
v_pk_add_f32 v[104:105], v[104:105], v[128:129]
v_pk_add_f32 v[106:107], v[106:107], v[130:131]
s_waitcnt lgkmcnt(0)
v_pk_add_f32 v[108:109], v[108:109], v[132:133]
v_pk_add_f32 v[110:111], v[110:111], v[134:135]
v_cvt_pk_bf16_f32 v100, v104, v105
v_cvt_pk_bf16_f32 v101, v106, v107
v_cvt_pk_bf16_f32 v102, v108, v109
v_cvt_pk_bf16_f32 v103, v110, v111
s_cmp_eq_u32 s18, 63
s_cbranch_scc1 m_s1_fin
v_mov_b64 v[24:25], 0
v_mov_b64 v[26:27], 0
v_mov_b64 v[28:29], 0
v_mov_b64 v[30:31], 0
v_mov_b64 v[32:33], 0
v_mov_b64 v[34:35], 0
v_mov_b64 v[36:37], 0
v_mov_b64 v[38:39], 0
v_mov_b64 v[40:41], 0
v_mov_b64 v[42:43], 0
v_mov_b64 v[44:45], 0
v_mov_b64 v[46:47], 0
s_cmp_ge_u32 s18, 15
s_cbranch_scc1 m_s1_ow0
ds_read_b128 v[104:107], v59 offset:32768
ds_read_b128 v[108:111], v59 offset:33792
ds_read_b128 v[112:115], v59 offset:34816
ds_read_b128 v[116:119], v59 offset:35840
ds_read_b128 v[120:123], v59 offset:36864
ds_read_b128 v[124:127], v59 offset:37888
ds_read_b128 v[128:131], v59 offset:38912
ds_read_b128 v[132:135], v59 offset:39936
v_mfma_f32_16x16x32_bf16 v[208:211], a[64:67], v[144:147], 0
v_mfma_f32_16x16x32_bf16 v[224:227], v[144:147], a[128:131], 0
v_mfma_f32_16x16x32_bf16 v[212:215], a[96:99], v[144:147], 0
v_mfma_f32_16x16x32_bf16 v[232:235], v[144:147], a[160:163], 0
v_mfma_f32_16x16x32_bf16 v[216:219], a[64:67], v[148:151], 0
v_mfma_f32_16x16x32_bf16 v[228:231], v[148:151], a[128:131], 0
v_mfma_f32_16x16x32_bf16 v[220:223], a[96:99], v[148:151], 0
s_waitcnt lgkmcnt(4)
v_pk_add_f32 v[104:105], v[104:105], v[112:113]
v_pk_add_f32 v[106:107], v[106:107], v[114:115]
v_mfma_f32_16x16x32_bf16 v[236:239], v[148:151], a[160:163], 0
v_pk_add_f32 v[108:109], v[108:109], v[116:117]
v_pk_add_f32 v[110:111], v[110:111], v[118:119]
s_waitcnt lgkmcnt(2)
v_mfma_f32_16x16x32_bf16 v[208:211], a[68:71], v[152:155], v[208:211]
v_pk_add_f32 v[104:105], v[104:105], v[120:121]
v_pk_add_f32 v[106:107], v[106:107], v[122:123]
v_pk_add_f32 v[108:109], v[108:109], v[124:125]
v_mfma_f32_16x16x32_bf16 v[224:227], v[152:155], a[132:135], v[224:227]
v_pk_add_f32 v[110:111], v[110:111], v[126:127]
s_waitcnt lgkmcnt(0)
v_pk_add_f32 v[104:105], v[104:105], v[128:129]
v_mfma_f32_16x16x32_bf16 v[212:215], a[100:103], v[152:155], v[212:215]
v_pk_add_f32 v[106:107], v[106:107], v[130:131]
v_pk_add_f32 v[108:109], v[108:109], v[132:133]
v_pk_add_f32 v[110:111], v[110:111], v[134:135]
v_mfma_f32_16x16x32_bf16 v[232:235], v[152:155], a[164:167], v[232:235]
v_cvt_pk_bf16_f32 v136, v104, v105
v_cvt_pk_bf16_f32 v137, v106, v107
v_cvt_pk_bf16_f32 v138, v108, v109
v_mfma_f32_16x16x32_bf16 v[216:219], a[68:71], v[156:159], v[216:219]
v_cvt_pk_bf16_f32 v139, v110, v111
v_permlane32_swap_b32 v136, v138
s_nop 0
v_permlane32_swap_b32 v137, v139
v_mfma_f32_16x16x32_bf16 v[228:231], v[156:159], a[132:135], v[228:231]
ds_write_b128 v74, v[136:139] offset:24576
v_mfma_f32_16x16x32_bf16 v[220:223], a[100:103], v[156:159], v[220:223]
v_mfma_f32_16x16x32_bf16 v[236:239], v[156:159], a[164:167], v[236:239]
v_mfma_f32_16x16x32_bf16 v[208:211], a[72:75], v[160:163], v[208:211]
v_mfma_f32_16x16x32_bf16 v[224:227], v[160:163], a[136:139], v[224:227]
v_mfma_f32_16x16x32_bf16 v[212:215], a[104:107], v[160:163], v[212:215]
v_mfma_f32_16x16x32_bf16 v[232:235], v[160:163], a[168:171], v[232:235]
v_mfma_f32_16x16x32_bf16 v[216:219], a[72:75], v[164:167], v[216:219]
v_mfma_f32_16x16x32_bf16 v[228:231], v[164:167], a[136:139], v[228:231]
v_mfma_f32_16x16x32_bf16 v[220:223], a[104:107], v[164:167], v[220:223]
v_mfma_f32_16x16x32_bf16 v[236:239], v[164:167], a[168:171], v[236:239]
m_s1_ow0:
v_xor_b32 v74, 4096, v74
s_barrier
buffer_load_dwordx4 v[8:11], v57, s[4:7], s19 offen offset:0 sc1
buffer_load_dwordx4 v[12:15], v57, s[4:7], s19 offen offset:1024 sc1
buffer_load_dwordx4 v[16:19], v57, s[4:7], s19 offen offset:2048 sc1
buffer_load_dwordx4 v[20:23], v57, s[4:7], s19 offen offset:3072 sc1
s_waitcnt vmcnt(3)
v_cmp_eq_u32 vcc, -1, v8
s_cbranch_vccnz m_s1_om0
v_smfmac_f32_16x16x64_bf16 v[48:51], v[8:11], a[192:199], v3
s_waitcnt vmcnt(2)
v_cmp_eq_u32 vcc, -1, v12
s_cbranch_vccnz m_s1_om1
v_smfmac_f32_16x16x64_bf16 v[52:55], v[8:11], a[224:231], v3
v_smfmac_f32_16x16x64_bf16 v[48:51], v[12:15], a[200:207], v3
s_waitcnt vmcnt(1)
v_cmp_eq_u32 vcc, -1, v16
s_cbranch_vccnz m_s1_om2
v_smfmac_f32_16x16x64_bf16 v[52:55], v[12:15], a[232:239], v3
v_smfmac_f32_16x16x64_bf16 v[48:51], v[16:19], a[208:215], v3
s_waitcnt vmcnt(0)
v_cmp_eq_u32 vcc, -1, v20
s_cbranch_vccnz m_s1_om3
v_smfmac_f32_16x16x64_bf16 v[52:55], v[16:19], a[240:247], v3
v_smfmac_f32_16x16x64_bf16 v[48:51], v[20:23], a[216:223], v3
v_smfmac_f32_16x16x64_bf16 v[52:55], v[20:23], a[248:255], v3
m_s1_ob:
s_nop 4
v_pk_add_f32 v[96:97], v[48:49], v[50:51]
s_nop 1
v_pk_add_f32 v[98:99], v[52:53], v[54:55]
ds_write2_b32 v240, v96, v97 offset0:0 offset1:72
ds_write2_b32 v240, v98, v99 offset0:160 offset1:232
s_lshr_b32 s29, s23, 8
s_xor_b32 s29, s29, s65
s_and_b32 s29, s29, 8192
s_add_u32 s29, s29, s23
buffer_store_dwordx4 v[100:103], v67, s[4:7], s29 offen sc1
s_add_u32 s23, s23, 131072
buffer_store_dwordx4 v[4:7], v61, s[4:7], s22 offen sc1
s_cmp_ge_u32 s18, 15
s_cbranch_scc1 m_s1_ow1
s_lshr_b32 s29, s61, 8
s_xnor_b32 s29, s29, s65
s_and_b32 s29, s29, 8192
s_add_u32 s29, s29, s61
s_add_u32 s28, s29, 33554432
s_add_u32 s61, s61, 524288
buffer_store_dwordx4 v[136:139], v244, s[4:7], s29 offen offset:0 sc1
m_s1_ow1:
s_waitcnt lgkmcnt(0)
s_barrier
s_sub_u32 s28, s18, 48
s_cmp_ge_u32 s28, 4
s_cbranch_scc1 m_s1_sn
s_xor_b32 s29, s65, 8192
s_and_b32 s29, s29, 8192
s_mul_i32 s28, s28, 262144
s_add_u32 s29, s29, s28
s_add_u32 s29, s29, 7340032
buffer_store_dwordx4 v[4:7], v67, s[4:7], s29 offen sc1
s_add_u32 s29, s29, 131072
buffer_store_dwordx4 v[4:7], v67, s[4:7], s29 offen sc1
m_s1_sn:
v_mov_b64 v[48:49], 0
v_mov_b64 v[50:51], 0
v_mov_b64 v[52:53], 0
v_mov_b64 v[54:55], 0
s_cmp_ge_u32 s18, 15
s_cbranch_scc1 m_s1_ow2
v_mfma_f32_16x16x32_bf16 v[208:211], a[76:79], v[168:171], v[208:211]
v_mfma_f32_16x16x32_bf16 v[224:227], v[168:171], a[140:143], v[224:227]
s_add_u32 s28, s60, 0
buffer_load_dwordx4 v[144:147], v241, s[4:7], s28 offen offset:0
v_mfma_f32_16x16x32_bf16 v[212:215], a[108:111], v[168:171], v[212:215]
v_mfma_f32_16x16x32_bf16 v[232:235], v[168:171], a[172:175], v[232:235]
v_mfma_f32_16x16x32_bf16 v[216:219], a[76:79], v[172:175], v[216:219]
v_mfma_f32_16x16x32_bf16 v[228:231], v[172:175], a[140:143], v[228:231]
s_add_u32 s28, s60, 4096
buffer_load_dwordx4 v[168:171], v241, s[4:7], s28 offen offset:2048
s_add_u32 s28, s60, 0
buffer_load_dwordx4 v[148:151], v241, s[4:7], s28 offen offset:256
v_mfma_f32_16x16x32_bf16 v[220:223], a[108:111], v[172:175], v[220:223]
v_mfma_f32_16x16x32_bf16 v[236:239], v[172:175], a[172:175], v[236:239]
v_mfma_f32_16x16x32_bf16 v[208:211], a[80:83], v[176:179], v[208:211]
v_mfma_f32_16x16x32_bf16 v[224:227], v[176:179], a[144:147], v[224:227]
s_add_u32 s28, s60, 4096
buffer_load_dwordx4 v[172:175], v241, s[4:7], s28 offen offset:2304
s_add_u32 s28, s60, 0
buffer_load_dwordx4 v[152:155], v241, s[4:7], s28 offen offset:2048
v_mfma_f32_16x16x32_bf16 v[212:215], a[112:115], v[176:179], v[212:215]
v_mfma_f32_16x16x32_bf16 v[232:235], v[176:179], a[176:179], v[232:235]
v_mfma_f32_16x16x32_bf16 v[216:219], a[80:83], v[180:183], v[216:219]
v_mfma_f32_16x16x32_bf16 v[228:231], v[180:183], a[144:147], v[228:231]
s_add_u32 s28, s60, 8192
buffer_load_dwordx4 v[176:179], v241, s[4:7], s28 offen offset:0
s_add_u32 s28, s60, 0
buffer_load_dwordx4 v[156:159], v241, s[4:7], s28 offen offset:2304
v_mfma_f32_16x16x32_bf16 v[220:223], a[112:115], v[180:183], v[220:223]
v_mfma_f32_16x16x32_bf16 v[236:239], v[180:183], a[176:179], v[236:239]
v_mfma_f32_16x16x32_bf16 v[208:211], a[84:87], v[184:187], v[208:211]
v_mfma_f32_16x16x32_bf16 v[224:227], v[184:187], a[148:151], v[224:227]
s_add_u32 s28, s60, 8192
buffer_load_dwordx4 v[180:183], v241, s[4:7], s28 offen offset:256
s_add_u32 s28, s60, 4096
buffer_load_dwordx4 v[160:163], v241, s[4:7], s28 offen offset:0
v_mfma_f32_16x16x32_bf16 v[212:215], a[116:119], v[184:187], v[212:215]
v_mfma_f32_16x16x32_bf16 v[232:235], v[184:187], a[180:183], v[232:235]
v_mfma_f32_16x16x32_bf16 v[216:219], a[84:87], v[188:191], v[216:219]
v_mfma_f32_16x16x32_bf16 v[228:231], v[188:191], a[148:151], v[228:231]
s_add_u32 s28, s60, 8192
buffer_load_dwordx4 v[184:187], v241, s[4:7], s28 offen offset:2048
s_add_u32 s28, s60, 4096
buffer_load_dwordx4 v[164:167], v241, s[4:7], s28 offen offset:256
v_mfma_f32_16x16x32_bf16 v[220:223], a[116:119], v[188:191], v[220:223]
v_mfma_f32_16x16x32_bf16 v[236:239], v[188:191], a[180:183], v[236:239]
v_mfma_f32_16x16x32_bf16 v[208:211], a[88:91], v[192:195], v[208:211]
v_mfma_f32_16x16x32_bf16 v[224:227], v[192:195], a[152:155], v[224:227]
s_add_u32 s28, s60, 8192
buffer_load_dwordx4 v[188:191], v241, s[4:7], s28 offen offset:2304
v_mfma_f32_16x16x32_bf16 v[212:215], a[120:123], v[192:195], v[212:215]
v_mfma_f32_16x16x32_bf16 v[232:235], v[192:195], a[184:187], v[232:235]
v_mfma_f32_16x16x32_bf16 v[216:219], a[88:91], v[196:199], v[216:219]
v_mfma_f32_16x16x32_bf16 v[228:231], v[196:199], a[152:155], v[228:231]
s_add_u32 s28, s60, 12288
buffer_load_dwordx4 v[192:195], v241, s[4:7], s28 offen offset:0
v_mfma_f32_16x16x32_bf16 v[220:223], a[120:123], v[196:199], v[220:223]
v_mfma_f32_16x16x32_bf16 v[236:239], v[196:199], a[184:187], v[236:239]
v_mfma_f32_16x16x32_bf16 v[208:211], a[92:95], v[200:203], v[208:211]
v_mfma_f32_16x16x32_bf16 v[224:227], v[200:203], a[156:159], v[224:227]
s_add_u32 s28, s60, 12288
buffer_load_dwordx4 v[196:199], v241, s[4:7], s28 offen offset:256
v_mfma_f32_16x16x32_bf16 v[212:215], a[124:127], v[200:203], v[212:215]
v_mfma_f32_16x16x32_bf16 v[232:235], v[200:203], a[188:191], v[232:235]
v_mfma_f32_16x16x32_bf16 v[216:219], a[92:95], v[204:207], v[216:219]
v_mfma_f32_16x16x32_bf16 v[228:231], v[204:207], a[156:159], v[228:231]
s_add_u32 s28, s60, 12288
buffer_load_dwordx4 v[200:203], v241, s[4:7], s28 offen offset:2048
v_mfma_f32_16x16x32_bf16 v[220:223], a[124:127], v[204:207], v[220:223]
v_mfma_f32_16x16x32_bf16 v[236:239], v[204:207], a[188:191], v[236:239]
s_add_u32 s28, s60, 12288
buffer_load_dwordx4 v[204:207], v241, s[4:7], s28 offen offset:2304
ds_write_b128 v242, v[208:211] offset:0
ds_write_b128 v242, v[212:215] offset:1024
ds_write_b128 v242, v[224:227] offset:16384
ds_write_b128 v242, v[228:231] offset:17408
ds_write_b128 v242, v[216:219] offset:8192
ds_write_b128 v242, v[220:223] offset:9216
ds_write_b128 v242, v[232:235] offset:24576
ds_write_b128 v242, v[236:239] offset:25600
s_mov_b32 s59, s60
s_add_u32 s60, s60, 65536
s_cmp_eq_u32 s18, 4
s_cselect_b32 s60, 176701440, s60
s_xor_b32 s69, s69, 16384
m_s1_ow2:
s_add_u32 s18, s18, 1
s_mov_b32 s31, s21
s_and_b32 s30, s18, 3
s_lshl_b32 s21, s30, 18
s_xor_b32 s22, s21, 524288
s_add_u32 s21, s21, 169869312
s_add_u32 s22, s22, 169869312
s_xor_b32 s30, s30, 2
s_lshl_b32 s20, s30, 19
s_add_u32 s20, s20, 167772160
s_waitcnt lgkmcnt(0)
s_barrier
buffer_load_dwordx4 v[8:11], v56, s[4:7], s19 offen offset:0 sc1
buffer_load_dwordx4 v[12:15], v56, s[4:7], s19 offen offset:1024 sc1
buffer_load_dwordx4 v[16:19], v56, s[4:7], s19 offen offset:2048 sc1
buffer_load_dwordx4 v[20:23], v56, s[4:7], s19 offen offset:3072 sc1
s_branch m_s1_top
m_s1_am0:
s_mov_b32 s32, 15
s_cmp_eq_u32 s17, 0
s_cbranch_scc1 m_s1_ah40
s_sub_u32 s17, s17, 1
buffer_load_dwordx4 v[8:11], v56, s[4:7], s19 offen offset:0 sc1
s_branch m_s1_al41
m_s1_am1:
v_smfmac_f32_16x16x64_bf16 v[36:39], v[8:11], a[96:103], v3
s_mov_b32 s32, 14
s_cmp_eq_u32 s17, 0
s_cbranch_scc1 m_s1_ah31
s_sub_u32 s17, s17, 1
buffer_load_dwordx4 v[12:15], v56, s[4:7], s19 offen offset:1024 sc1
s_branch m_s1_al32
m_s1_am2:
v_smfmac_f32_16x16x64_bf16 v[36:39], v[12:15], a[104:111], v3
s_mov_b32 s32, 12
s_cmp_eq_u32 s17, 0
s_cbranch_scc1 m_s1_ah22
s_sub_u32 s17, s17, 1
buffer_load_dwordx4 v[16:19], v56, s[4:7], s19 offen offset:2048 sc1
s_branch m_s1_al23
m_s1_am3:
v_smfmac_f32_16x16x64_bf16 v[36:39], v[16:19], a[112:119], v3
s_mov_b32 s32, 8
s_cmp_eq_u32 s17, 0
s_cbranch_scc1 m_s1_ah13
s_sub_u32 s17, s17, 1
buffer_load_dwordx4 v[20:23], v56, s[4:7], s19 offen offset:3072 sc1
s_branch m_s1_al10
m_s1_al10:
s_bitcmp1_b32 s32, 0
s_cbranch_scc0 m_s1_al11
s_waitcnt vmcnt(0)
v_cmp_eq_u32 vcc, -1, v8
s_cbranch_vccz m_s1_ah10
s_cmp_eq_u32 s17, 0
s_cbranch_scc1 m_s1_ah10
s_sub_u32 s17, s17, 1
buffer_load_dwordx4 v[8:11], v56, s[4:7], s19 offen offset:0 sc1
m_s1_al11:
s_bitcmp1_b32 s32, 1
s_cbranch_scc0 m_s1_al12
s_waitcnt vmcnt(0)
v_cmp_eq_u32 vcc, -1, v12
s_cbranch_vccz m_s1_ah11
s_cmp_eq_u32 s17, 0
s_cbranch_scc1 m_s1_ah11
s_sub_u32 s17, s17, 1
buffer_load_dwordx4 v[12:15], v56, s[4:7], s19 offen offset:1024 sc1
m_s1_al12:
s_bitcmp1_b32 s32, 2
s_cbranch_scc0 m_s1_al13
s_waitcnt vmcnt(0)
v_cmp_eq_u32 vcc, -1, v16
s_cbranch_vccz m_s1_ah12
s_cmp_eq_u32 s17, 0
s_cbranch_scc1 m_s1_ah12
s_sub_u32 s17, s17, 1
buffer_load_dwordx4 v[16:19], v56, s[4:7], s19 offen offset:2048 sc1
m_s1_al13:
s_bitcmp1_b32 s32, 3
s_cbranch_scc0 m_s1_al10
s_waitcnt vmcnt(0)
v_cmp_eq_u32 vcc, -1, v20
s_cbranch_vccz m_s1_ah13
s_cmp_eq_u32 s17, 0
s_cbranch_scc1 m_s1_ah13
s_sub_u32 s17, s17, 1
buffer_load_dwordx4 v[20:23], v56, s[4:7], s19 offen offset:3072 sc1
s_branch m_s1_al10
m_s1_ah10:
v_smfmac_f32_16x16x64_bf16 v[24:27], v[8:11], a[0:7], v3
v_smfmac_f32_16x16x64_bf16 v[28:31], v[8:11], a[32:39], v3
v_smfmac_f32_16x16x64_bf16 v[32:35], v[8:11], a[64:71], v3
v_smfmac_f32_16x16x64_bf16 v[36:39], v[8:11], a[96:103], v3
s_branch m_s1_ab
m_s1_ah11:
v_smfmac_f32_16x16x64_bf16 v[24:27], v[12:15], a[8:15], v3
v_smfmac_f32_16x16x64_bf16 v[28:31], v[12:15], a[40:47], v3
v_smfmac_f32_16x16x64_bf16 v[32:35], v[12:15], a[72:79], v3
v_smfmac_f32_16x16x64_bf16 v[36:39], v[12:15], a[104:111], v3
s_branch m_s1_ab
m_s1_ah12:
v_smfmac_f32_16x16x64_bf16 v[24:27], v[16:19], a[16:23], v3
v_smfmac_f32_16x16x64_bf16 v[28:31], v[16:19], a[48:55], v3
v_smfmac_f32_16x16x64_bf16 v[32:35], v[16:19], a[80:87], v3
v_smfmac_f32_16x16x64_bf16 v[36:39], v[16:19], a[112:119], v3
s_branch m_s1_ab
m_s1_ah13:
v_smfmac_f32_16x16x64_bf16 v[24:27], v[20:23], a[24:31], v3
v_smfmac_f32_16x16x64_bf16 v[28:31], v[20:23], a[56:63], v3
v_smfmac_f32_16x16x64_bf16 v[32:35], v[20:23], a[88:95], v3
v_smfmac_f32_16x16x64_bf16 v[36:39], v[20:23], a[120:127], v3
s_branch m_s1_ab
m_s1_al20:
s_bitcmp1_b32 s32, 0
s_cbranch_scc0 m_s1_al21
s_waitcnt vmcnt(1)
v_cmp_eq_u32 vcc, -1, v8
s_cbranch_vccz m_s1_ah20
s_cmp_eq_u32 s17, 0
s_cbranch_scc1 m_s1_ah20
s_sub_u32 s17, s17, 1
buffer_load_dwordx4 v[8:11], v56, s[4:7], s19 offen offset:0 sc1
m_s1_al21:
s_bitcmp1_b32 s32, 1
s_cbranch_scc0 m_s1_al22
s_waitcnt vmcnt(1)
v_cmp_eq_u32 vcc, -1, v12
s_cbranch_vccz m_s1_ah21
s_cmp_eq_u32 s17, 0
s_cbranch_scc1 m_s1_ah21
s_sub_u32 s17, s17, 1
buffer_load_dwordx4 v[12:15], v56, s[4:7], s19 offen offset:1024 sc1
m_s1_al22:
s_bitcmp1_b32 s32, 2
s_cbranch_scc0 m_s1_al23
s_waitcnt vmcnt(1)
v_cmp_eq_u32 vcc, -1, v16
s_cbranch_vccz m_s1_ah22
s_cmp_eq_u32 s17, 0
s_cbranch_scc1 m_s1_ah22
s_sub_u32 s17, s17, 1
buffer_load_dwordx4 v[16:19], v56, s[4:7], s19 offen offset:2048 sc1
m_s1_al23:
s_bitcmp1_b32 s32, 3
s_cbranch_scc0 m_s1_al20
s_waitcnt vmcnt(1)
v_cmp_eq_u32 vcc, -1, v20
s_cbranch_vccz m_s1_ah23
s_cmp_eq_u32 s17, 0
s_cbranch_scc1 m_s1_ah23
s_sub_u32 s17, s17, 1
buffer_load_dwordx4 v[20:23], v56, s[4:7], s19 offen offset:3072 sc1
s_branch m_s1_al20
m_s1_ah20:
v_smfmac_f32_16x16x64_bf16 v[24:27], v[8:11], a[0:7], v3
v_smfmac_f32_16x16x64_bf16 v[28:31], v[8:11], a[32:39], v3
v_smfmac_f32_16x16x64_bf16 v[32:35], v[8:11], a[64:71], v3
v_smfmac_f32_16x16x64_bf16 v[36:39], v[8:11], a[96:103], v3
s_bitset0_b32 s32, 0
s_branch m_s1_al11
m_s1_ah21:
v_smfmac_f32_16x16x64_bf16 v[24:27], v[12:15], a[8:15], v3
v_smfmac_f32_16x16x64_bf16 v[28:31], v[12:15], a[40:47], v3
v_smfmac_f32_16x16x64_bf16 v[32:35], v[12:15], a[72:79], v3
v_smfmac_f32_16x16x64_bf16 v[36:39], v[12:15], a[104:111], v3
s_bitset0_b32 s32, 1
s_branch m_s1_al12
m_s1_ah22:
v_smfmac_f32_16x16x64_bf16 v[24:27], v[16:19], a[16:23], v3
v_smfmac_f32_16x16x64_bf16 v[28:31], v[16:19], a[48:55], v3
v_smfmac_f32_16x16x64_bf16 v[32:35], v[16:19], a[80:87], v3
v_smfmac_f32_16x16x64_bf16 v[36:39], v[16:19], a[112:119], v3
s_bitset0_b32 s32, 2
s_branch m_s1_al13
m_s1_ah23:
v_smfmac_f32_16x16x64_bf16 v[24:27], v[20:23], a[24:31], v3
v_smfmac_f32_16x16x64_bf16 v[28:31], v[20:23], a[56:63], v3
v_smfmac_f32_16x16x64_bf16 v[32:35], v[20:23], a[88:95], v3
v_smfmac_f32_16x16x64_bf16 v[36:39], v[20:23], a[120:127], v3
s_bitset0_b32 s32, 3
s_branch m_s1_al10
m_s1_al30:
s_bitcmp1_b32 s32, 0
s_cbranch_scc0 m_s1_al31
s_waitcnt vmcnt(2)
v_cmp_eq_u32 vcc, -1, v8
s_cbranch_vccz m_s1_ah30
s_cmp_eq_u32 s17, 0
s_cbranch_scc1 m_s1_ah30
s_sub_u32 s17, s17, 1
buffer_load_dwordx4 v[8:11], v56, s[4:7], s19 offen offset:0 sc1
m_s1_al31:
s_bitcmp1_b32 s32, 1
s_cbranch_scc0 m_s1_al32
s_waitcnt vmcnt(2)
v_cmp_eq_u32 vcc, -1, v12
s_cbranch_vccz m_s1_ah31
s_cmp_eq_u32 s17, 0
s_cbranch_scc1 m_s1_ah31
s_sub_u32 s17, s17, 1
buffer_load_dwordx4 v[12:15], v56, s[4:7], s19 offen offset:1024 sc1
m_s1_al32:
s_bitcmp1_b32 s32, 2
s_cbranch_scc0 m_s1_al33
s_waitcnt vmcnt(2)
v_cmp_eq_u32 vcc, -1, v16
s_cbranch_vccz m_s1_ah32
s_cmp_eq_u32 s17, 0
s_cbranch_scc1 m_s1_ah32
s_sub_u32 s17, s17, 1
buffer_load_dwordx4 v[16:19], v56, s[4:7], s19 offen offset:2048 sc1
m_s1_al33:
s_bitcmp1_b32 s32, 3
s_cbranch_scc0 m_s1_al30
s_waitcnt vmcnt(2)
v_cmp_eq_u32 vcc, -1, v20
s_cbranch_vccz m_s1_ah33
s_cmp_eq_u32 s17, 0
s_cbranch_scc1 m_s1_ah33
s_sub_u32 s17, s17, 1
buffer_load_dwordx4 v[20:23], v56, s[4:7], s19 offen offset:3072 sc1
s_branch m_s1_al30
m_s1_ah30:
v_smfmac_f32_16x16x64_bf16 v[24:27], v[8:11], a[0:7], v3
v_smfmac_f32_16x16x64_bf16 v[28:31], v[8:11], a[32:39], v3
v_smfmac_f32_16x16x64_bf16 v[32:35], v[8:11], a[64:71], v3
v_smfmac_f32_16x16x64_bf16 v[36:39], v[8:11], a[96:103], v3
s_bitset0_b32 s32, 0
s_branch m_s1_al21
m_s1_ah31:
v_smfmac_f32_16x16x64_bf16 v[24:27], v[12:15], a[8:15], v3
v_smfmac_f32_16x16x64_bf16 v[28:31], v[12:15], a[40:47], v3
v_smfmac_f32_16x16x64_bf16 v[32:35], v[12:15], a[72:79], v3
v_smfmac_f32_16x16x64_bf16 v[36:39], v[12:15], a[104:111], v3
s_bitset0_b32 s32, 1
s_branch m_s1_al22
m_s1_ah32:
v_smfmac_f32_16x16x64_bf16 v[24:27], v[16:19], a[16:23], v3
v_smfmac_f32_16x16x64_bf16 v[28:31], v[16:19], a[48:55], v3
v_smfmac_f32_16x16x64_bf16 v[32:35], v[16:19], a[80:87], v3
v_smfmac_f32_16x16x64_bf16 v[36:39], v[16:19], a[112:119], v3
s_bitset0_b32 s32, 2
s_branch m_s1_al23
m_s1_ah33:
v_smfmac_f32_16x16x64_bf16 v[24:27], v[20:23], a[24:31], v3
v_smfmac_f32_16x16x64_bf16 v[28:31], v[20:23], a[56:63], v3
v_smfmac_f32_16x16x64_bf16 v[32:35], v[20:23], a[88:95], v3
v_smfmac_f32_16x16x64_bf16 v[36:39], v[20:23], a[120:127], v3
s_bitset0_b32 s32, 3
s_branch m_s1_al20
m_s1_al40:
s_waitcnt vmcnt(3)
v_cmp_eq_u32 vcc, -1, v8
s_cbranch_vccz m_s1_ah40
s_cmp_eq_u32 s17, 0
s_cbranch_scc1 m_s1_ah40
s_sub_u32 s17, s17, 1
buffer_load_dwordx4 v[8:11], v56, s[4:7], s19 offen offset:0 sc1
m_s1_al41:
s_waitcnt vmcnt(3)
v_cmp_eq_u32 vcc, -1, v12
s_cbranch_vccz m_s1_ah41
s_cmp_eq_u32 s17, 0
s_cbranch_scc1 m_s1_ah41
s_sub_u32 s17, s17, 1
buffer_load_dwordx4 v[12:15], v56, s[4:7], s19 offen offset:1024 sc1
m_s1_al42:
s_waitcnt vmcnt(3)
v_cmp_eq_u32 vcc, -1, v16
s_cbranch_vccz m_s1_ah42
s_cmp_eq_u32 s17, 0
s_cbranch_scc1 m_s1_ah42
s_sub_u32 s17, s17, 1
buffer_load_dwordx4 v[16:19], v56, s[4:7], s19 offen offset:2048 sc1
m_s1_al43:
s_waitcnt vmcnt(3)
v_cmp_eq_u32 vcc, -1, v20
s_cbranch_vccz m_s1_ah43
s_cmp_eq_u32 s17, 0
s_cbranch_scc1 m_s1_ah43
s_sub_u32 s17, s17, 1
buffer_load_dwordx4 v[20:23], v56, s[4:7], s19 offen offset:3072 sc1
s_branch m_s1_al40
m_s1_ah40:
v_smfmac_f32_16x16x64_bf16 v[24:27], v[8:11], a[0:7], v3
v_smfmac_f32_16x16x64_bf16 v[28:31], v[8:11], a[32:39], v3
v_smfmac_f32_16x16x64_bf16 v[32:35], v[8:11], a[64:71], v3
v_smfmac_f32_16x16x64_bf16 v[36:39], v[8:11], a[96:103], v3
s_bitset0_b32 s32, 0
s_branch m_s1_al31
m_s1_ah41:
v_smfmac_f32_16x16x64_bf16 v[24:27], v[12:15], a[8:15], v3
v_smfmac_f32_16x16x64_bf16 v[28:31], v[12:15], a[40:47], v3
v_smfmac_f32_16x16x64_bf16 v[32:35], v[12:15], a[72:79], v3
v_smfmac_f32_16x16x64_bf16 v[36:39], v[12:15], a[104:111], v3
s_bitset0_b32 s32, 1
s_branch m_s1_al32
m_s1_ah42:
v_smfmac_f32_16x16x64_bf16 v[24:27], v[16:19], a[16:23], v3
v_smfmac_f32_16x16x64_bf16 v[28:31], v[16:19], a[48:55], v3
v_smfmac_f32_16x16x64_bf16 v[32:35], v[16:19], a[80:87], v3
v_smfmac_f32_16x16x64_bf16 v[36:39], v[16:19], a[112:119], v3
s_bitset0_b32 s32, 2
s_branch m_s1_al33
m_s1_ah43:
v_smfmac_f32_16x16x64_bf16 v[24:27], v[20:23], a[24:31], v3
v_smfmac_f32_16x16x64_bf16 v[28:31], v[20:23], a[56:63], v3
v_smfmac_f32_16x16x64_bf16 v[32:35], v[20:23], a[88:95], v3
v_smfmac_f32_16x16x64_bf16 v[36:39], v[20:23], a[120:127], v3
s_bitset0_b32 s32, 3
s_branch m_s1_al30
m_s1_om0:
s_mov_b32 s32, 15
s_cmp_eq_u32 s17, 0
s_cbranch_scc1 m_s1_oh40
s_sub_u32 s17, s17, 1
buffer_load_dwordx4 v[8:11], v57, s[4:7], s19 offen offset:0 sc1
s_branch m_s1_ol41
m_s1_om1:
v_smfmac_f32_16x16x64_bf16 v[52:55], v[8:11], a[224:231], v3
s_mov_b32 s32, 14
s_cmp_eq_u32 s17, 0
s_cbranch_scc1 m_s1_oh31
s_sub_u32 s17, s17, 1
buffer_load_dwordx4 v[12:15], v57, s[4:7], s19 offen offset:1024 sc1
s_branch m_s1_ol32
m_s1_om2:
v_smfmac_f32_16x16x64_bf16 v[52:55], v[12:15], a[232:239], v3
s_mov_b32 s32, 12
s_cmp_eq_u32 s17, 0
s_cbranch_scc1 m_s1_oh22
s_sub_u32 s17, s17, 1
buffer_load_dwordx4 v[16:19], v57, s[4:7], s19 offen offset:2048 sc1
s_branch m_s1_ol23
m_s1_om3:
v_smfmac_f32_16x16x64_bf16 v[52:55], v[16:19], a[240:247], v3
s_mov_b32 s32, 8
s_cmp_eq_u32 s17, 0
s_cbranch_scc1 m_s1_oh13
s_sub_u32 s17, s17, 1
buffer_load_dwordx4 v[20:23], v57, s[4:7], s19 offen offset:3072 sc1
s_branch m_s1_ol10
m_s1_ol10:
s_bitcmp1_b32 s32, 0
s_cbranch_scc0 m_s1_ol11
s_waitcnt vmcnt(0)
v_cmp_eq_u32 vcc, -1, v8
s_cbranch_vccz m_s1_oh10
s_cmp_eq_u32 s17, 0
s_cbranch_scc1 m_s1_oh10
s_sub_u32 s17, s17, 1
buffer_load_dwordx4 v[8:11], v57, s[4:7], s19 offen offset:0 sc1
m_s1_ol11:
s_bitcmp1_b32 s32, 1
s_cbranch_scc0 m_s1_ol12
s_waitcnt vmcnt(0)
v_cmp_eq_u32 vcc, -1, v12
s_cbranch_vccz m_s1_oh11
s_cmp_eq_u32 s17, 0
s_cbranch_scc1 m_s1_oh11
s_sub_u32 s17, s17, 1
buffer_load_dwordx4 v[12:15], v57, s[4:7], s19 offen offset:1024 sc1
m_s1_ol12:
s_bitcmp1_b32 s32, 2
s_cbranch_scc0 m_s1_ol13
s_waitcnt vmcnt(0)
v_cmp_eq_u32 vcc, -1, v16
s_cbranch_vccz m_s1_oh12
s_cmp_eq_u32 s17, 0
s_cbranch_scc1 m_s1_oh12
s_sub_u32 s17, s17, 1
buffer_load_dwordx4 v[16:19], v57, s[4:7], s19 offen offset:2048 sc1
m_s1_ol13:
s_bitcmp1_b32 s32, 3
s_cbranch_scc0 m_s1_ol10
s_waitcnt vmcnt(0)
v_cmp_eq_u32 vcc, -1, v20
s_cbranch_vccz m_s1_oh13
s_cmp_eq_u32 s17, 0
s_cbranch_scc1 m_s1_oh13
s_sub_u32 s17, s17, 1
buffer_load_dwordx4 v[20:23], v57, s[4:7], s19 offen offset:3072 sc1
s_branch m_s1_ol10
m_s1_oh10:
v_smfmac_f32_16x16x64_bf16 v[48:51], v[8:11], a[192:199], v3
v_smfmac_f32_16x16x64_bf16 v[52:55], v[8:11], a[224:231], v3
s_branch m_s1_ob
m_s1_oh11:
v_smfmac_f32_16x16x64_bf16 v[48:51], v[12:15], a[200:207], v3
v_smfmac_f32_16x16x64_bf16 v[52:55], v[12:15], a[232:239], v3
s_branch m_s1_ob
m_s1_oh12:
v_smfmac_f32_16x16x64_bf16 v[48:51], v[16:19], a[208:215], v3
v_smfmac_f32_16x16x64_bf16 v[52:55], v[16:19], a[240:247], v3
s_branch m_s1_ob
m_s1_oh13:
v_smfmac_f32_16x16x64_bf16 v[48:51], v[20:23], a[216:223], v3
v_smfmac_f32_16x16x64_bf16 v[52:55], v[20:23], a[248:255], v3
s_branch m_s1_ob
m_s1_ol20:
s_bitcmp1_b32 s32, 0
s_cbranch_scc0 m_s1_ol21
s_waitcnt vmcnt(1)
v_cmp_eq_u32 vcc, -1, v8
s_cbranch_vccz m_s1_oh20
s_cmp_eq_u32 s17, 0
s_cbranch_scc1 m_s1_oh20
s_sub_u32 s17, s17, 1
buffer_load_dwordx4 v[8:11], v57, s[4:7], s19 offen offset:0 sc1
m_s1_ol21:
s_bitcmp1_b32 s32, 1
s_cbranch_scc0 m_s1_ol22
s_waitcnt vmcnt(1)
v_cmp_eq_u32 vcc, -1, v12
s_cbranch_vccz m_s1_oh21
s_cmp_eq_u32 s17, 0
s_cbranch_scc1 m_s1_oh21
s_sub_u32 s17, s17, 1
buffer_load_dwordx4 v[12:15], v57, s[4:7], s19 offen offset:1024 sc1
m_s1_ol22:
s_bitcmp1_b32 s32, 2
s_cbranch_scc0 m_s1_ol23
s_waitcnt vmcnt(1)
v_cmp_eq_u32 vcc, -1, v16
s_cbranch_vccz m_s1_oh22
s_cmp_eq_u32 s17, 0
s_cbranch_scc1 m_s1_oh22
s_sub_u32 s17, s17, 1
buffer_load_dwordx4 v[16:19], v57, s[4:7], s19 offen offset:2048 sc1
m_s1_ol23:
s_bitcmp1_b32 s32, 3
s_cbranch_scc0 m_s1_ol20
s_waitcnt vmcnt(1)
v_cmp_eq_u32 vcc, -1, v20
s_cbranch_vccz m_s1_oh23
s_cmp_eq_u32 s17, 0
s_cbranch_scc1 m_s1_oh23
s_sub_u32 s17, s17, 1
buffer_load_dwordx4 v[20:23], v57, s[4:7], s19 offen offset:3072 sc1
s_branch m_s1_ol20
m_s1_oh20:
v_smfmac_f32_16x16x64_bf16 v[48:51], v[8:11], a[192:199], v3
v_smfmac_f32_16x16x64_bf16 v[52:55], v[8:11], a[224:231], v3
s_bitset0_b32 s32, 0
s_branch m_s1_ol11
m_s1_oh21:
v_smfmac_f32_16x16x64_bf16 v[48:51], v[12:15], a[200:207], v3
v_smfmac_f32_16x16x64_bf16 v[52:55], v[12:15], a[232:239], v3
s_bitset0_b32 s32, 1
s_branch m_s1_ol12
m_s1_oh22:
v_smfmac_f32_16x16x64_bf16 v[48:51], v[16:19], a[208:215], v3
v_smfmac_f32_16x16x64_bf16 v[52:55], v[16:19], a[240:247], v3
s_bitset0_b32 s32, 2
s_branch m_s1_ol13
m_s1_oh23:
v_smfmac_f32_16x16x64_bf16 v[48:51], v[20:23], a[216:223], v3
v_smfmac_f32_16x16x64_bf16 v[52:55], v[20:23], a[248:255], v3
s_bitset0_b32 s32, 3
s_branch m_s1_ol10
m_s1_ol30:
s_bitcmp1_b32 s32, 0
s_cbranch_scc0 m_s1_ol31
s_waitcnt vmcnt(2)
v_cmp_eq_u32 vcc, -1, v8
s_cbranch_vccz m_s1_oh30
s_cmp_eq_u32 s17, 0
s_cbranch_scc1 m_s1_oh30
s_sub_u32 s17, s17, 1
buffer_load_dwordx4 v[8:11], v57, s[4:7], s19 offen offset:0 sc1
m_s1_ol31:
s_bitcmp1_b32 s32, 1
s_cbranch_scc0 m_s1_ol32
s_waitcnt vmcnt(2)
v_cmp_eq_u32 vcc, -1, v12
s_cbranch_vccz m_s1_oh31
s_cmp_eq_u32 s17, 0
s_cbranch_scc1 m_s1_oh31
s_sub_u32 s17, s17, 1
buffer_load_dwordx4 v[12:15], v57, s[4:7], s19 offen offset:1024 sc1
m_s1_ol32:
s_bitcmp1_b32 s32, 2
s_cbranch_scc0 m_s1_ol33
s_waitcnt vmcnt(2)
v_cmp_eq_u32 vcc, -1, v16
s_cbranch_vccz m_s1_oh32
s_cmp_eq_u32 s17, 0
s_cbranch_scc1 m_s1_oh32
s_sub_u32 s17, s17, 1
buffer_load_dwordx4 v[16:19], v57, s[4:7], s19 offen offset:2048 sc1
m_s1_ol33:
s_bitcmp1_b32 s32, 3
s_cbranch_scc0 m_s1_ol30
s_waitcnt vmcnt(2)
v_cmp_eq_u32 vcc, -1, v20
s_cbranch_vccz m_s1_oh33
s_cmp_eq_u32 s17, 0
s_cbranch_scc1 m_s1_oh33
s_sub_u32 s17, s17, 1
buffer_load_dwordx4 v[20:23], v57, s[4:7], s19 offen offset:3072 sc1
s_branch m_s1_ol30
m_s1_oh30:
v_smfmac_f32_16x16x64_bf16 v[48:51], v[8:11], a[192:199], v3
v_smfmac_f32_16x16x64_bf16 v[52:55], v[8:11], a[224:231], v3
s_bitset0_b32 s32, 0
s_branch m_s1_ol21
m_s1_oh31:
v_smfmac_f32_16x16x64_bf16 v[48:51], v[12:15], a[200:207], v3
v_smfmac_f32_16x16x64_bf16 v[52:55], v[12:15], a[232:239], v3
s_bitset0_b32 s32, 1
s_branch m_s1_ol22
m_s1_oh32:
v_smfmac_f32_16x16x64_bf16 v[48:51], v[16:19], a[208:215], v3
v_smfmac_f32_16x16x64_bf16 v[52:55], v[16:19], a[240:247], v3
s_bitset0_b32 s32, 2
s_branch m_s1_ol23
m_s1_oh33:
v_smfmac_f32_16x16x64_bf16 v[48:51], v[20:23], a[216:223], v3
v_smfmac_f32_16x16x64_bf16 v[52:55], v[20:23], a[248:255], v3
s_bitset0_b32 s32, 3
s_branch m_s1_ol20
m_s1_ol40:
s_waitcnt vmcnt(3)
v_cmp_eq_u32 vcc, -1, v8
s_cbranch_vccz m_s1_oh40
s_cmp_eq_u32 s17, 0
s_cbranch_scc1 m_s1_oh40
s_sub_u32 s17, s17, 1
buffer_load_dwordx4 v[8:11], v57, s[4:7], s19 offen offset:0 sc1
m_s1_ol41:
s_waitcnt vmcnt(3)
v_cmp_eq_u32 vcc, -1, v12
s_cbranch_vccz m_s1_oh41
s_cmp_eq_u32 s17, 0
s_cbranch_scc1 m_s1_oh41
s_sub_u32 s17, s17, 1
buffer_load_dwordx4 v[12:15], v57, s[4:7], s19 offen offset:1024 sc1
m_s1_ol42:
s_waitcnt vmcnt(3)
v_cmp_eq_u32 vcc, -1, v16
s_cbranch_vccz m_s1_oh42
s_cmp_eq_u32 s17, 0
s_cbranch_scc1 m_s1_oh42
s_sub_u32 s17, s17, 1
buffer_load_dwordx4 v[16:19], v57, s[4:7], s19 offen offset:2048 sc1
m_s1_ol43:
s_waitcnt vmcnt(3)
v_cmp_eq_u32 vcc, -1, v20
s_cbranch_vccz m_s1_oh43
s_cmp_eq_u32 s17, 0
s_cbranch_scc1 m_s1_oh43
s_sub_u32 s17, s17, 1
buffer_load_dwordx4 v[20:23], v57, s[4:7], s19 offen offset:3072 sc1
s_branch m_s1_ol40
m_s1_oh40:
v_smfmac_f32_16x16x64_bf16 v[48:51], v[8:11], a[192:199], v3
v_smfmac_f32_16x16x64_bf16 v[52:55], v[8:11], a[224:231], v3
s_bitset0_b32 s32, 0
s_branch m_s1_ol31
m_s1_oh41:
v_smfmac_f32_16x16x64_bf16 v[48:51], v[12:15], a[200:207], v3
v_smfmac_f32_16x16x64_bf16 v[52:55], v[12:15], a[232:239], v3
s_bitset0_b32 s32, 1
s_branch m_s1_ol32
m_s1_oh42:
v_smfmac_f32_16x16x64_bf16 v[48:51], v[16:19], a[208:215], v3
v_smfmac_f32_16x16x64_bf16 v[52:55], v[16:19], a[240:247], v3
s_bitset0_b32 s32, 2
s_branch m_s1_ol33
m_s1_oh43:
v_smfmac_f32_16x16x64_bf16 v[48:51], v[20:23], a[216:223], v3
v_smfmac_f32_16x16x64_bf16 v[52:55], v[20:23], a[248:255], v3
s_bitset0_b32 s32, 3
s_branch m_s1_ol30
m_s1_fin:
s_lshr_b32 s29, s23, 8
s_xor_b32 s29, s29, s65
s_and_b32 s29, s29, 8192
s_add_u32 s29, s29, s23
buffer_store_dwordx4 v[100:103], v67, s[4:7], s29 offen sc1
s_add_u32 s23, s23, 131072
s_waitcnt vmcnt(0)
s_barrier
s_branch m_recdone
m_rp2:
s_lshl_b32 s30, s24, 10
s_add_u32 s30, s30, 131072
s_lshr_b32 s31, s24, 2
s_lshl_b32 s31, s31, 10
s_add_u32 s31, s31, 262144
s_and_b32 s27, s24, 3
s_lshl_b32 s27, s27, 2
s_lshr_b32 s26, s24, 4
s_lshl_b32 s26, s26, 14
s_and_b32 s25, s24, 15
s_lshl_b32 s25, s25, 9
s_add_u32 s26, s26, s25
s_add_u32 s26, s26, 16777216
v_add_u32 v66, s26, v59
v_mov_b32 v76, 2147483648
v_cmp_gt_u32 vcc, 32, v0
s_nop 1
v_cndmask_b32 v66, v76, v66, vcc
v_lshl_add_u32 v67, v0, 3, s28
v_add_u32 v68, 65536, v67
s_and_b32 s26, s12, 1
s_lshr_b32 s27, s12, 1
s_lshl_b32 s27, s27, 2
s_add_u32 s26, s26, s27
s_lshl_b32 s26, s26, 12
s_xor_b32 s27, s65, 8192
s_add_u32 s26, s26, s27
s_add_u32 s26, s26, 170983424
s_cmp_eq_u32 s13, 0
s_cselect_b32 s26, s26, 2147483648
v_lshl_add_u32 v69, v0, 7, s26
v_mov_b32 v76, 2147483648
v_cmp_gt_u32 vcc, 32, v0
s_nop 1
v_cndmask_b32 v69, v76, v69, vcc
s_barrier
ds_write_b128 v59, v[80:83] offset:26624
v_add_u32 v242, 4294868992, v242
ds_write_b128 v242, v[208:211] offset:0
ds_write_b128 v242, v[212:215] offset:1024
ds_write_b128 v242, v[224:227] offset:16384
ds_write_b128 v242, v[228:231] offset:17408
ds_write_b128 v242, v[216:219] offset:8192
ds_write_b128 v242, v[220:223] offset:9216
ds_write_b128 v242, v[232:235] offset:24576
ds_write_b128 v242, v[236:239] offset:25600
v_add_u32 v74, 4096, v59
s_mov_b32 s69, 81920
s_sub_u32 s59, s60, 65536
s_xor_b32 s30, s65, 8192
s_waitcnt lgkmcnt(0)
s_barrier
v_add_u32 v61, s30, v61
v_add_u32 v62, s30, v62
v_add_u32 v63, s30, v63
v_add_u32 v64, s30, v64
s_cmp_eq_u32 s15, 0
s_cbranch_scc1 m_safe2
m_f2_top:
s_waitcnt vmcnt(3)
v_cmp_eq_u32 vcc, -1, v8
s_cbranch_vccnz m_f2_am0
v_smfmac_f32_16x16x64_bf16 v[24:27], v[8:11], a[0:7], v3
v_smfmac_f32_16x16x64_bf16 v[28:31], v[8:11], a[32:39], v3
s_waitcnt vmcnt(2)
v_cmp_eq_u32 vcc, -1, v12
v_smfmac_f32_16x16x64_bf16 v[32:35], v[8:11], a[64:71], v3
s_cbranch_vccnz m_f2_am1
v_smfmac_f32_16x16x64_bf16 v[36:39], v[8:11], a[96:103], v3
v_smfmac_f32_16x16x64_bf16 v[24:27], v[12:15], a[8:15], v3
v_smfmac_f32_16x16x64_bf16 v[28:31], v[12:15], a[40:47], v3
s_waitcnt vmcnt(1)
v_cmp_eq_u32 vcc, -1, v16
v_smfmac_f32_16x16x64_bf16 v[32:35], v[12:15], a[72:79], v3
s_cbranch_vccnz m_f2_am2
v_smfmac_f32_16x16x64_bf16 v[36:39], v[12:15], a[104:111], v3
v_smfmac_f32_16x16x64_bf16 v[24:27], v[16:19], a[16:23], v3
v_smfmac_f32_16x16x64_bf16 v[28:31], v[16:19], a[48:55], v3
s_waitcnt vmcnt(0)
v_cmp_eq_u32 vcc, -1, v20
v_smfmac_f32_16x16x64_bf16 v[32:35], v[16:19], a[80:87], v3
s_cbranch_vccnz m_f2_am3
v_smfmac_f32_16x16x64_bf16 v[36:39], v[16:19], a[112:119], v3
v_smfmac_f32_16x16x64_bf16 v[24:27], v[20:23], a[24:31], v3
v_smfmac_f32_16x16x64_bf16 v[28:31], v[20:23], a[56:63], v3
v_smfmac_f32_16x16x64_bf16 v[32:35], v[20:23], a[88:95], v3
v_smfmac_f32_16x16x64_bf16 v[36:39], v[20:23], a[120:127], v3
m_f2_ab:
buffer_store_dwordx2 v[4:5], v68, s[4:7], s20 offen
v_smfmac_f32_16x16x64_bf16 v[40:43], v[8:11], a[128:135], v3
v_pk_add_f32 v[24:25], v[24:25], v[26:27]
v_pk_add_f32 v[28:29], v[28:29], v[30:31]
ds_write2_b32 v58, v24, v25 offset0:80 offset1:120
ds_write2_b32 v58, v28, v29 offset0:96 offset1:136
v_smfmac_f32_16x16x64_bf16 v[44:47], v[8:11], a[160:167], v3
v_pk_add_f32 v[32:33], v[32:33], v[34:35]
v_pk_add_f32 v[36:37], v[36:37], v[38:39]
ds_write2_b32 v58, v32, v33 offset0:0 offset1:40
ds_write2_b32 v58, v36, v37 offset0:16 offset1:56
s_and_b32 s30, s18, 3
s_lshl_b32 s19, s30, 19
s_add_u32 s19, s19, 167772160
v_smfmac_f32_16x16x64_bf16 v[40:43], v[12:15], a[136:143], v3
v_smfmac_f32_16x16x64_bf16 v[44:47], v[12:15], a[168:175], v3
s_waitcnt lgkmcnt(0)
s_barrier
v_smfmac_f32_16x16x64_bf16 v[40:43], v[16:19], a[144:151], v3
v_smfmac_f32_16x16x64_bf16 v[44:47], v[16:19], a[176:183], v3
v_smfmac_f32_16x16x64_bf16 v[40:43], v[20:23], a[152:159], v3
v_smfmac_f32_16x16x64_bf16 v[44:47], v[20:23], a[184:191], v3
s_nop 4
v_pk_add_f32 v[96:97], v[40:41], v[42:43]
s_nop 1
v_pk_add_f32 v[98:99], v[44:45], v[46:47]
ds_write_b128 v59, v[96:99] offset:14336
s_waitcnt lgkmcnt(0)
s_barrier
ds_read_b128 v[124:127], v59 offset:12288
ds_read_b128 v[128:131], v59 offset:13312
ds_read_b128 v[132:135], v59 offset:15360
s_waitcnt lgkmcnt(0)
v_pk_add_f32 v[136:137], v[124:125], v[128:129]
v_pk_add_f32 v[138:139], v[126:127], v[130:131]
v_pk_add_f32 v[96:97], v[96:97], v[132:133]
v_pk_add_f32 v[98:99], v[98:99], v[134:135]
v_pk_add_f32 v[96:97], v[96:97], v[136:137]
v_pk_add_f32 v[98:99], v[98:99], v[138:139]
v_cvt_pk_bf16_f32 v116, v96, v97
v_cvt_pk_bf16_f32 v120, v98, v99
s_nop 1
v_permlane16_swap_b32 v116, v120
v_mov_b32 v100, v116
v_mov_b32 v101, v120
v_mov_b32 v102, v116
v_mov_b32 v103, v120
s_nop 0
v_permlane32_swap_b32 v100, v102
v_permlane32_swap_b32 v101, v103
s_cmp_eq_u32 s18, 63
s_cbranch_scc1 m_f2_fin
v_mov_b64 v[24:25], 0
v_mov_b64 v[26:27], 0
v_mov_b64 v[28:29], 0
v_mov_b64 v[30:31], 0
v_mov_b64 v[32:33], 0
v_mov_b64 v[34:35], 0
v_mov_b64 v[36:37], 0
v_mov_b64 v[38:39], 0
v_mov_b64 v[40:41], 0
v_mov_b64 v[42:43], 0
v_mov_b64 v[44:45], 0
v_mov_b64 v[46:47], 0
s_cmp_ge_u32 s18, 15
s_cbranch_scc1 m_f2_ow0
ds_read_b128 v[104:107], v59 offset:49152
ds_read_b128 v[108:111], v59 offset:50176
ds_read_b128 v[112:115], v59 offset:51200
ds_read_b128 v[116:119], v59 offset:52224
ds_read_b128 v[120:123], v59 offset:53248
ds_read_b128 v[124:127], v59 offset:54272
ds_read_b128 v[128:131], v59 offset:55296
ds_read_b128 v[132:135], v59 offset:56320
v_mfma_f32_16x16x32_bf16 v[208:211], a[64:67], v[144:147], 0
v_mfma_f32_16x16x32_bf16 v[224:227], v[144:147], a[128:131], 0
v_mfma_f32_16x16x32_bf16 v[212:215], a[96:99], v[144:147], 0
v_mfma_f32_16x16x32_bf16 v[232:235], v[144:147], a[160:163], 0
v_mfma_f32_16x16x32_bf16 v[216:219], a[64:67], v[148:151], 0
v_mfma_f32_16x16x32_bf16 v[228:231], v[148:151], a[128:131], 0
v_mfma_f32_16x16x32_bf16 v[220:223], a[96:99], v[148:151], 0
s_waitcnt lgkmcnt(4)
v_pk_add_f32 v[104:105], v[104:105], v[112:113]
v_pk_add_f32 v[106:107], v[106:107], v[114:115]
v_mfma_f32_16x16x32_bf16 v[236:239], v[148:151], a[160:163], 0
v_pk_add_f32 v[108:109], v[108:109], v[116:117]
v_pk_add_f32 v[110:111], v[110:111], v[118:119]
s_waitcnt lgkmcnt(2)
v_mfma_f32_16x16x32_bf16 v[208:211], a[68:71], v[152:155], v[208:211]
v_pk_add_f32 v[104:105], v[104:105], v[120:121]
v_pk_add_f32 v[106:107], v[106:107], v[122:123]
v_pk_add_f32 v[108:109], v[108:109], v[124:125]
v_mfma_f32_16x16x32_bf16 v[224:227], v[152:155], a[132:135], v[224:227]
v_pk_add_f32 v[110:111], v[110:111], v[126:127]
s_waitcnt lgkmcnt(0)
v_pk_add_f32 v[104:105], v[104:105], v[128:129]
v_mfma_f32_16x16x32_bf16 v[212:215], a[100:103], v[152:155], v[212:215]
v_pk_add_f32 v[106:107], v[106:107], v[130:131]
v_pk_add_f32 v[108:109], v[108:109], v[132:133]
v_pk_add_f32 v[110:111], v[110:111], v[134:135]
v_mfma_f32_16x16x32_bf16 v[232:235], v[152:155], a[164:167], v[232:235]
v_cvt_pk_bf16_f32 v136, v104, v105
v_cvt_pk_bf16_f32 v137, v106, v107
v_cvt_pk_bf16_f32 v138, v108, v109
v_mfma_f32_16x16x32_bf16 v[216:219], a[68:71], v[156:159], v[216:219]
v_cvt_pk_bf16_f32 v139, v110, v111
ds_write_b128 v74, v[136:139] offset:26624
v_mfma_f32_16x16x32_bf16 v[228:231], v[156:159], a[132:135], v[228:231]
v_mfma_f32_16x16x32_bf16 v[220:223], a[100:103], v[156:159], v[220:223]
v_mfma_f32_16x16x32_bf16 v[236:239], v[156:159], a[164:167], v[236:239]
v_mfma_f32_16x16x32_bf16 v[208:211], a[72:75], v[160:163], v[208:211]
v_mfma_f32_16x16x32_bf16 v[224:227], v[160:163], a[136:139], v[224:227]
v_mfma_f32_16x16x32_bf16 v[212:215], a[104:107], v[160:163], v[212:215]
v_mfma_f32_16x16x32_bf16 v[232:235], v[160:163], a[168:171], v[232:235]
v_mfma_f32_16x16x32_bf16 v[216:219], a[72:75], v[164:167], v[216:219]
v_mfma_f32_16x16x32_bf16 v[228:231], v[164:167], a[136:139], v[228:231]
v_mfma_f32_16x16x32_bf16 v[220:223], a[104:107], v[164:167], v[220:223]
v_mfma_f32_16x16x32_bf16 v[236:239], v[164:167], a[168:171], v[236:239]
m_f2_ow0:
v_xor_b32 v74, 4096, v74
s_barrier
buffer_load_dwordx4 v[8:11], v57, s[4:7], s19 offen offset:0 sc1
buffer_load_dwordx4 v[12:15], v57, s[4:7], s19 offen offset:1024 sc1
buffer_load_dwordx4 v[16:19], v57, s[4:7], s19 offen offset:2048 sc1
buffer_load_dwordx4 v[20:23], v57, s[4:7], s19 offen offset:3072 sc1
s_waitcnt vmcnt(3)
v_cmp_eq_u32 vcc, -1, v8
s_cbranch_vccnz m_f2_om0
v_smfmac_f32_16x16x64_bf16 v[48:51], v[8:11], a[192:199], v3
s_waitcnt vmcnt(2)
v_cmp_eq_u32 vcc, -1, v12
s_cbranch_vccnz m_f2_om1
v_smfmac_f32_16x16x64_bf16 v[52:55], v[8:11], a[224:231], v3
v_smfmac_f32_16x16x64_bf16 v[48:51], v[12:15], a[200:207], v3
s_waitcnt vmcnt(1)
v_cmp_eq_u32 vcc, -1, v16
s_cbranch_vccnz m_f2_om2
v_smfmac_f32_16x16x64_bf16 v[52:55], v[12:15], a[232:239], v3
v_smfmac_f32_16x16x64_bf16 v[48:51], v[16:19], a[208:215], v3
s_waitcnt vmcnt(0)
v_cmp_eq_u32 vcc, -1, v20
s_cbranch_vccnz m_f2_om3
v_smfmac_f32_16x16x64_bf16 v[52:55], v[16:19], a[240:247], v3
v_smfmac_f32_16x16x64_bf16 v[48:51], v[20:23], a[216:223], v3
v_smfmac_f32_16x16x64_bf16 v[52:55], v[20:23], a[248:255], v3
m_f2_ob:
s_nop 4
v_pk_add_f32 v[96:97], v[48:49], v[50:51]
s_nop 1
v_pk_add_f32 v[98:99], v[52:53], v[54:55]
ds_write2_b32 v240, v96, v97 offset0:0 offset1:72
ds_write2_b32 v240, v98, v99 offset0:160 offset1:232
s_lshr_b32 s29, s23, 8
s_xor_b32 s29, s29, s65
s_and_b32 s29, s29, 8192
s_add_u32 s29, s29, s23
buffer_store_dwordx4 v[100:103], v66, s[4:7], s29 offen sc1
s_add_u32 s23, s23, 131072
s_cmp_ge_u32 s18, 15
s_cbranch_scc1 m_f2_ow1
s_lshr_b32 s29, s61, 8
s_xnor_b32 s29, s29, s65
s_and_b32 s29, s29, 8192
s_add_u32 s29, s29, s61
s_add_u32 s28, s29, 33554432
s_add_u32 s61, s61, 524288
buffer_store_dwordx4 v[136:139], v244, s[4:7], s28 offen offset:0 sc1
m_f2_ow1:
s_waitcnt lgkmcnt(0)
s_barrier
v_mov_b32 v76, s18
buffer_store_dword v76, v69, s[4:7], 0 offen sc1
s_sub_u32 s28, s18, 48
s_cmp_ge_u32 s28, 4
s_cbranch_scc1 m_f2_sn
s_xor_b32 s29, s65, 8192
s_and_b32 s29, s29, 8192
s_mul_i32 s28, s28, 262144
s_add_u32 s29, s29, s28
s_add_u32 s29, s29, 7340032
buffer_store_dwordx4 v[4:7], v66, s[4:7], s29 offen sc1
s_add_u32 s29, s29, 131072
buffer_store_dwordx4 v[4:7], v66, s[4:7], s29 offen sc1
m_f2_sn:
v_mov_b64 v[48:49], 0
v_mov_b64 v[50:51], 0
v_mov_b64 v[52:53], 0
v_mov_b64 v[54:55], 0
s_cmp_ge_u32 s18, 15
s_cbranch_scc1 m_f2_ow2
v_mfma_f32_16x16x32_bf16 v[208:211], a[76:79], v[168:171], v[208:211]
v_mfma_f32_16x16x32_bf16 v[224:227], v[168:171], a[140:143], v[224:227]
s_add_u32 s28, s60, 0
buffer_load_dwordx4 v[144:147], v241, s[4:7], s28 offen offset:0
v_mfma_f32_16x16x32_bf16 v[212:215], a[108:111], v[168:171], v[212:215]
v_mfma_f32_16x16x32_bf16 v[232:235], v[168:171], a[172:175], v[232:235]
v_mfma_f32_16x16x32_bf16 v[216:219], a[76:79], v[172:175], v[216:219]
v_mfma_f32_16x16x32_bf16 v[228:231], v[172:175], a[140:143], v[228:231]
s_add_u32 s28, s60, 4096
buffer_load_dwordx4 v[168:171], v241, s[4:7], s28 offen offset:2048
s_add_u32 s28, s60, 0
buffer_load_dwordx4 v[148:151], v241, s[4:7], s28 offen offset:256
v_mfma_f32_16x16x32_bf16 v[220:223], a[108:111], v[172:175], v[220:223]
v_mfma_f32_16x16x32_bf16 v[236:239], v[172:175], a[172:175], v[236:239]
v_mfma_f32_16x16x32_bf16 v[208:211], a[80:83], v[176:179], v[208:211]
v_mfma_f32_16x16x32_bf16 v[224:227], v[176:179], a[144:147], v[224:227]
s_add_u32 s28, s60, 4096
buffer_load_dwordx4 v[172:175], v241, s[4:7], s28 offen offset:2304
s_add_u32 s28, s60, 0
buffer_load_dwordx4 v[152:155], v241, s[4:7], s28 offen offset:2048
v_mfma_f32_16x16x32_bf16 v[212:215], a[112:115], v[176:179], v[212:215]
v_mfma_f32_16x16x32_bf16 v[232:235], v[176:179], a[176:179], v[232:235]
v_mfma_f32_16x16x32_bf16 v[216:219], a[80:83], v[180:183], v[216:219]
v_mfma_f32_16x16x32_bf16 v[228:231], v[180:183], a[144:147], v[228:231]
s_add_u32 s28, s60, 8192
buffer_load_dwordx4 v[176:179], v241, s[4:7], s28 offen offset:0
s_add_u32 s28, s60, 0
buffer_load_dwordx4 v[156:159], v241, s[4:7], s28 offen offset:2304
v_mfma_f32_16x16x32_bf16 v[220:223], a[112:115], v[180:183], v[220:223]
v_mfma_f32_16x16x32_bf16 v[236:239], v[180:183], a[176:179], v[236:239]
v_mfma_f32_16x16x32_bf16 v[208:211], a[84:87], v[184:187], v[208:211]
v_mfma_f32_16x16x32_bf16 v[224:227], v[184:187], a[148:151], v[224:227]
s_add_u32 s28, s60, 8192
buffer_load_dwordx4 v[180:183], v241, s[4:7], s28 offen offset:256
s_add_u32 s28, s60, 4096
buffer_load_dwordx4 v[160:163], v241, s[4:7], s28 offen offset:0
v_mfma_f32_16x16x32_bf16 v[212:215], a[116:119], v[184:187], v[212:215]
v_mfma_f32_16x16x32_bf16 v[232:235], v[184:187], a[180:183], v[232:235]
v_mfma_f32_16x16x32_bf16 v[216:219], a[84:87], v[188:191], v[216:219]
v_mfma_f32_16x16x32_bf16 v[228:231], v[188:191], a[148:151], v[228:231]
s_add_u32 s28, s60, 8192
buffer_load_dwordx4 v[184:187], v241, s[4:7], s28 offen offset:2048
s_add_u32 s28, s60, 4096
buffer_load_dwordx4 v[164:167], v241, s[4:7], s28 offen offset:256
v_mfma_f32_16x16x32_bf16 v[220:223], a[116:119], v[188:191], v[220:223]
v_mfma_f32_16x16x32_bf16 v[236:239], v[188:191], a[180:183], v[236:239]
v_mfma_f32_16x16x32_bf16 v[208:211], a[88:91], v[192:195], v[208:211]
v_mfma_f32_16x16x32_bf16 v[224:227], v[192:195], a[152:155], v[224:227]
s_add_u32 s28, s60, 8192
buffer_load_dwordx4 v[188:191], v241, s[4:7], s28 offen offset:2304
v_mfma_f32_16x16x32_bf16 v[212:215], a[120:123], v[192:195], v[212:215]
v_mfma_f32_16x16x32_bf16 v[232:235], v[192:195], a[184:187], v[232:235]
v_mfma_f32_16x16x32_bf16 v[216:219], a[88:91], v[196:199], v[216:219]
v_mfma_f32_16x16x32_bf16 v[228:231], v[196:199], a[152:155], v[228:231]
s_add_u32 s28, s60, 12288
buffer_load_dwordx4 v[192:195], v241, s[4:7], s28 offen offset:0
v_mfma_f32_16x16x32_bf16 v[220:223], a[120:123], v[196:199], v[220:223]
v_mfma_f32_16x16x32_bf16 v[236:239], v[196:199], a[184:187], v[236:239]
v_mfma_f32_16x16x32_bf16 v[208:211], a[92:95], v[200:203], v[208:211]
v_mfma_f32_16x16x32_bf16 v[224:227], v[200:203], a[156:159], v[224:227]
s_add_u32 s28, s60, 12288
buffer_load_dwordx4 v[196:199], v241, s[4:7], s28 offen offset:256
v_mfma_f32_16x16x32_bf16 v[212:215], a[124:127], v[200:203], v[212:215]
v_mfma_f32_16x16x32_bf16 v[232:235], v[200:203], a[188:191], v[232:235]
v_mfma_f32_16x16x32_bf16 v[216:219], a[92:95], v[204:207], v[216:219]
v_mfma_f32_16x16x32_bf16 v[228:231], v[204:207], a[156:159], v[228:231]
s_add_u32 s28, s60, 12288
buffer_load_dwordx4 v[200:203], v241, s[4:7], s28 offen offset:2048
v_mfma_f32_16x16x32_bf16 v[220:223], a[124:127], v[204:207], v[220:223]
v_mfma_f32_16x16x32_bf16 v[236:239], v[204:207], a[188:191], v[236:239]
s_add_u32 s28, s60, 12288
buffer_load_dwordx4 v[204:207], v241, s[4:7], s28 offen offset:2304
ds_write_b128 v242, v[208:211] offset:0
ds_write_b128 v242, v[212:215] offset:1024
ds_write_b128 v242, v[224:227] offset:16384
ds_write_b128 v242, v[228:231] offset:17408
ds_write_b128 v242, v[216:219] offset:8192
ds_write_b128 v242, v[220:223] offset:9216
ds_write_b128 v242, v[232:235] offset:24576
ds_write_b128 v242, v[236:239] offset:25600
s_mov_b32 s59, s60
s_add_u32 s60, s60, 65536
s_cmp_eq_u32 s18, 4
s_cselect_b32 s60, 176717824, s60
s_xor_b32 s69, s69, 16384
m_f2_ow2:
s_add_u32 s18, s18, 1
s_mov_b32 s31, s21
s_and_b32 s30, s18, 3
s_lshl_b32 s21, s30, 18
s_xor_b32 s22, s21, 524288
s_add_u32 s21, s21, 169869312
s_add_u32 s22, s22, 169869312
s_xor_b32 s30, s30, 2
s_lshl_b32 s20, s30, 19
s_add_u32 s20, s20, 167772160
s_waitcnt lgkmcnt(0)
s_barrier
buffer_load_dwordx4 v[8:11], v56, s[4:7], s19 offen offset:0 sc1
buffer_load_dwordx4 v[12:15], v56, s[4:7], s19 offen offset:1024 sc1
buffer_load_dwordx4 v[16:19], v56, s[4:7], s19 offen offset:2048 sc1
buffer_load_dwordx4 v[20:23], v56, s[4:7], s19 offen offset:3072 sc1
s_branch m_f2_top
m_f2_am0:
s_mov_b32 s32, 15
s_cmp_eq_u32 s17, 0
s_cbranch_scc1 m_f2_ah40
s_sub_u32 s17, s17, 1
buffer_load_dwordx4 v[8:11], v56, s[4:7], s19 offen offset:0 sc1
s_branch m_f2_al41
m_f2_am1:
v_smfmac_f32_16x16x64_bf16 v[36:39], v[8:11], a[96:103], v3
s_mov_b32 s32, 14
s_cmp_eq_u32 s17, 0
s_cbranch_scc1 m_f2_ah31
s_sub_u32 s17, s17, 1
buffer_load_dwordx4 v[12:15], v56, s[4:7], s19 offen offset:1024 sc1
s_branch m_f2_al32
m_f2_am2:
v_smfmac_f32_16x16x64_bf16 v[36:39], v[12:15], a[104:111], v3
s_mov_b32 s32, 12
s_cmp_eq_u32 s17, 0
s_cbranch_scc1 m_f2_ah22
s_sub_u32 s17, s17, 1
buffer_load_dwordx4 v[16:19], v56, s[4:7], s19 offen offset:2048 sc1
s_branch m_f2_al23
m_f2_am3:
v_smfmac_f32_16x16x64_bf16 v[36:39], v[16:19], a[112:119], v3
s_mov_b32 s32, 8
s_cmp_eq_u32 s17, 0
s_cbranch_scc1 m_f2_ah13
s_sub_u32 s17, s17, 1
buffer_load_dwordx4 v[20:23], v56, s[4:7], s19 offen offset:3072 sc1
s_branch m_f2_al10
m_f2_al10:
s_bitcmp1_b32 s32, 0
s_cbranch_scc0 m_f2_al11
s_waitcnt vmcnt(0)
v_cmp_eq_u32 vcc, -1, v8
s_cbranch_vccz m_f2_ah10
s_cmp_eq_u32 s17, 0
s_cbranch_scc1 m_f2_ah10
s_sub_u32 s17, s17, 1
buffer_load_dwordx4 v[8:11], v56, s[4:7], s19 offen offset:0 sc1
m_f2_al11:
s_bitcmp1_b32 s32, 1
s_cbranch_scc0 m_f2_al12
s_waitcnt vmcnt(0)
v_cmp_eq_u32 vcc, -1, v12
s_cbranch_vccz m_f2_ah11
s_cmp_eq_u32 s17, 0
s_cbranch_scc1 m_f2_ah11
s_sub_u32 s17, s17, 1
buffer_load_dwordx4 v[12:15], v56, s[4:7], s19 offen offset:1024 sc1
m_f2_al12:
s_bitcmp1_b32 s32, 2
s_cbranch_scc0 m_f2_al13
s_waitcnt vmcnt(0)
v_cmp_eq_u32 vcc, -1, v16
s_cbranch_vccz m_f2_ah12
s_cmp_eq_u32 s17, 0
s_cbranch_scc1 m_f2_ah12
s_sub_u32 s17, s17, 1
buffer_load_dwordx4 v[16:19], v56, s[4:7], s19 offen offset:2048 sc1
m_f2_al13:
s_bitcmp1_b32 s32, 3
s_cbranch_scc0 m_f2_al10
s_waitcnt vmcnt(0)
v_cmp_eq_u32 vcc, -1, v20
s_cbranch_vccz m_f2_ah13
s_cmp_eq_u32 s17, 0
s_cbranch_scc1 m_f2_ah13
s_sub_u32 s17, s17, 1
buffer_load_dwordx4 v[20:23], v56, s[4:7], s19 offen offset:3072 sc1
s_branch m_f2_al10
m_f2_ah10:
v_smfmac_f32_16x16x64_bf16 v[24:27], v[8:11], a[0:7], v3
v_smfmac_f32_16x16x64_bf16 v[28:31], v[8:11], a[32:39], v3
v_smfmac_f32_16x16x64_bf16 v[32:35], v[8:11], a[64:71], v3
v_smfmac_f32_16x16x64_bf16 v[36:39], v[8:11], a[96:103], v3
s_branch m_f2_ab
m_f2_ah11:
v_smfmac_f32_16x16x64_bf16 v[24:27], v[12:15], a[8:15], v3
v_smfmac_f32_16x16x64_bf16 v[28:31], v[12:15], a[40:47], v3
v_smfmac_f32_16x16x64_bf16 v[32:35], v[12:15], a[72:79], v3
v_smfmac_f32_16x16x64_bf16 v[36:39], v[12:15], a[104:111], v3
s_branch m_f2_ab
m_f2_ah12:
v_smfmac_f32_16x16x64_bf16 v[24:27], v[16:19], a[16:23], v3
v_smfmac_f32_16x16x64_bf16 v[28:31], v[16:19], a[48:55], v3
v_smfmac_f32_16x16x64_bf16 v[32:35], v[16:19], a[80:87], v3
v_smfmac_f32_16x16x64_bf16 v[36:39], v[16:19], a[112:119], v3
s_branch m_f2_ab
m_f2_ah13:
v_smfmac_f32_16x16x64_bf16 v[24:27], v[20:23], a[24:31], v3
v_smfmac_f32_16x16x64_bf16 v[28:31], v[20:23], a[56:63], v3
v_smfmac_f32_16x16x64_bf16 v[32:35], v[20:23], a[88:95], v3
v_smfmac_f32_16x16x64_bf16 v[36:39], v[20:23], a[120:127], v3
s_branch m_f2_ab
m_f2_al20:
s_bitcmp1_b32 s32, 0
s_cbranch_scc0 m_f2_al21
s_waitcnt vmcnt(1)
v_cmp_eq_u32 vcc, -1, v8
s_cbranch_vccz m_f2_ah20
s_cmp_eq_u32 s17, 0
s_cbranch_scc1 m_f2_ah20
s_sub_u32 s17, s17, 1
buffer_load_dwordx4 v[8:11], v56, s[4:7], s19 offen offset:0 sc1
m_f2_al21:
s_bitcmp1_b32 s32, 1
s_cbranch_scc0 m_f2_al22
s_waitcnt vmcnt(1)
v_cmp_eq_u32 vcc, -1, v12
s_cbranch_vccz m_f2_ah21
s_cmp_eq_u32 s17, 0
s_cbranch_scc1 m_f2_ah21
s_sub_u32 s17, s17, 1
buffer_load_dwordx4 v[12:15], v56, s[4:7], s19 offen offset:1024 sc1
m_f2_al22:
s_bitcmp1_b32 s32, 2
s_cbranch_scc0 m_f2_al23
s_waitcnt vmcnt(1)
v_cmp_eq_u32 vcc, -1, v16
s_cbranch_vccz m_f2_ah22
s_cmp_eq_u32 s17, 0
s_cbranch_scc1 m_f2_ah22
s_sub_u32 s17, s17, 1
buffer_load_dwordx4 v[16:19], v56, s[4:7], s19 offen offset:2048 sc1
m_f2_al23:
s_bitcmp1_b32 s32, 3
s_cbranch_scc0 m_f2_al20
s_waitcnt vmcnt(1)
v_cmp_eq_u32 vcc, -1, v20
s_cbranch_vccz m_f2_ah23
s_cmp_eq_u32 s17, 0
s_cbranch_scc1 m_f2_ah23
s_sub_u32 s17, s17, 1
buffer_load_dwordx4 v[20:23], v56, s[4:7], s19 offen offset:3072 sc1
s_branch m_f2_al20
m_f2_ah20:
v_smfmac_f32_16x16x64_bf16 v[24:27], v[8:11], a[0:7], v3
v_smfmac_f32_16x16x64_bf16 v[28:31], v[8:11], a[32:39], v3
v_smfmac_f32_16x16x64_bf16 v[32:35], v[8:11], a[64:71], v3
v_smfmac_f32_16x16x64_bf16 v[36:39], v[8:11], a[96:103], v3
s_bitset0_b32 s32, 0
s_branch m_f2_al11
m_f2_ah21:
v_smfmac_f32_16x16x64_bf16 v[24:27], v[12:15], a[8:15], v3
v_smfmac_f32_16x16x64_bf16 v[28:31], v[12:15], a[40:47], v3
v_smfmac_f32_16x16x64_bf16 v[32:35], v[12:15], a[72:79], v3
v_smfmac_f32_16x16x64_bf16 v[36:39], v[12:15], a[104:111], v3
s_bitset0_b32 s32, 1
s_branch m_f2_al12
m_f2_ah22:
v_smfmac_f32_16x16x64_bf16 v[24:27], v[16:19], a[16:23], v3
v_smfmac_f32_16x16x64_bf16 v[28:31], v[16:19], a[48:55], v3
v_smfmac_f32_16x16x64_bf16 v[32:35], v[16:19], a[80:87], v3
v_smfmac_f32_16x16x64_bf16 v[36:39], v[16:19], a[112:119], v3
s_bitset0_b32 s32, 2
s_branch m_f2_al13
m_f2_ah23:
v_smfmac_f32_16x16x64_bf16 v[24:27], v[20:23], a[24:31], v3
v_smfmac_f32_16x16x64_bf16 v[28:31], v[20:23], a[56:63], v3
v_smfmac_f32_16x16x64_bf16 v[32:35], v[20:23], a[88:95], v3
v_smfmac_f32_16x16x64_bf16 v[36:39], v[20:23], a[120:127], v3
s_bitset0_b32 s32, 3
s_branch m_f2_al10
m_f2_al30:
s_bitcmp1_b32 s32, 0
s_cbranch_scc0 m_f2_al31
s_waitcnt vmcnt(2)
v_cmp_eq_u32 vcc, -1, v8
s_cbranch_vccz m_f2_ah30
s_cmp_eq_u32 s17, 0
s_cbranch_scc1 m_f2_ah30
s_sub_u32 s17, s17, 1
buffer_load_dwordx4 v[8:11], v56, s[4:7], s19 offen offset:0 sc1
m_f2_al31:
s_bitcmp1_b32 s32, 1
s_cbranch_scc0 m_f2_al32
s_waitcnt vmcnt(2)
v_cmp_eq_u32 vcc, -1, v12
s_cbranch_vccz m_f2_ah31
s_cmp_eq_u32 s17, 0
s_cbranch_scc1 m_f2_ah31
s_sub_u32 s17, s17, 1
buffer_load_dwordx4 v[12:15], v56, s[4:7], s19 offen offset:1024 sc1
m_f2_al32:
s_bitcmp1_b32 s32, 2
s_cbranch_scc0 m_f2_al33
s_waitcnt vmcnt(2)
v_cmp_eq_u32 vcc, -1, v16
s_cbranch_vccz m_f2_ah32
s_cmp_eq_u32 s17, 0
s_cbranch_scc1 m_f2_ah32
s_sub_u32 s17, s17, 1
buffer_load_dwordx4 v[16:19], v56, s[4:7], s19 offen offset:2048 sc1
m_f2_al33:
s_bitcmp1_b32 s32, 3
s_cbranch_scc0 m_f2_al30
s_waitcnt vmcnt(2)
v_cmp_eq_u32 vcc, -1, v20
s_cbranch_vccz m_f2_ah33
s_cmp_eq_u32 s17, 0
s_cbranch_scc1 m_f2_ah33
s_sub_u32 s17, s17, 1
buffer_load_dwordx4 v[20:23], v56, s[4:7], s19 offen offset:3072 sc1
s_branch m_f2_al30
m_f2_ah30:
v_smfmac_f32_16x16x64_bf16 v[24:27], v[8:11], a[0:7], v3
v_smfmac_f32_16x16x64_bf16 v[28:31], v[8:11], a[32:39], v3
v_smfmac_f32_16x16x64_bf16 v[32:35], v[8:11], a[64:71], v3
v_smfmac_f32_16x16x64_bf16 v[36:39], v[8:11], a[96:103], v3
s_bitset0_b32 s32, 0
s_branch m_f2_al21
m_f2_ah31:
v_smfmac_f32_16x16x64_bf16 v[24:27], v[12:15], a[8:15], v3
v_smfmac_f32_16x16x64_bf16 v[28:31], v[12:15], a[40:47], v3
v_smfmac_f32_16x16x64_bf16 v[32:35], v[12:15], a[72:79], v3
v_smfmac_f32_16x16x64_bf16 v[36:39], v[12:15], a[104:111], v3
s_bitset0_b32 s32, 1
s_branch m_f2_al22
m_f2_ah32:
v_smfmac_f32_16x16x64_bf16 v[24:27], v[16:19], a[16:23], v3
v_smfmac_f32_16x16x64_bf16 v[28:31], v[16:19], a[48:55], v3
v_smfmac_f32_16x16x64_bf16 v[32:35], v[16:19], a[80:87], v3
v_smfmac_f32_16x16x64_bf16 v[36:39], v[16:19], a[112:119], v3
s_bitset0_b32 s32, 2
s_branch m_f2_al23
m_f2_ah33:
v_smfmac_f32_16x16x64_bf16 v[24:27], v[20:23], a[24:31], v3
v_smfmac_f32_16x16x64_bf16 v[28:31], v[20:23], a[56:63], v3
v_smfmac_f32_16x16x64_bf16 v[32:35], v[20:23], a[88:95], v3
v_smfmac_f32_16x16x64_bf16 v[36:39], v[20:23], a[120:127], v3
s_bitset0_b32 s32, 3
s_branch m_f2_al20
m_f2_al40:
s_waitcnt vmcnt(3)
v_cmp_eq_u32 vcc, -1, v8
s_cbranch_vccz m_f2_ah40
s_cmp_eq_u32 s17, 0
s_cbranch_scc1 m_f2_ah40
s_sub_u32 s17, s17, 1
buffer_load_dwordx4 v[8:11], v56, s[4:7], s19 offen offset:0 sc1
m_f2_al41:
s_waitcnt vmcnt(3)
v_cmp_eq_u32 vcc, -1, v12
s_cbranch_vccz m_f2_ah41
s_cmp_eq_u32 s17, 0
s_cbranch_scc1 m_f2_ah41
s_sub_u32 s17, s17, 1
buffer_load_dwordx4 v[12:15], v56, s[4:7], s19 offen offset:1024 sc1
m_f2_al42:
s_waitcnt vmcnt(3)
v_cmp_eq_u32 vcc, -1, v16
s_cbranch_vccz m_f2_ah42
s_cmp_eq_u32 s17, 0
s_cbranch_scc1 m_f2_ah42
s_sub_u32 s17, s17, 1
buffer_load_dwordx4 v[16:19], v56, s[4:7], s19 offen offset:2048 sc1
m_f2_al43:
s_waitcnt vmcnt(3)
v_cmp_eq_u32 vcc, -1, v20
s_cbranch_vccz m_f2_ah43
s_cmp_eq_u32 s17, 0
s_cbranch_scc1 m_f2_ah43
s_sub_u32 s17, s17, 1
buffer_load_dwordx4 v[20:23], v56, s[4:7], s19 offen offset:3072 sc1
s_branch m_f2_al40
m_f2_ah40:
v_smfmac_f32_16x16x64_bf16 v[24:27], v[8:11], a[0:7], v3
v_smfmac_f32_16x16x64_bf16 v[28:31], v[8:11], a[32:39], v3
v_smfmac_f32_16x16x64_bf16 v[32:35], v[8:11], a[64:71], v3
v_smfmac_f32_16x16x64_bf16 v[36:39], v[8:11], a[96:103], v3
s_bitset0_b32 s32, 0
s_branch m_f2_al31
m_f2_ah41:
v_smfmac_f32_16x16x64_bf16 v[24:27], v[12:15], a[8:15], v3
v_smfmac_f32_16x16x64_bf16 v[28:31], v[12:15], a[40:47], v3
v_smfmac_f32_16x16x64_bf16 v[32:35], v[12:15], a[72:79], v3
v_smfmac_f32_16x16x64_bf16 v[36:39], v[12:15], a[104:111], v3
s_bitset0_b32 s32, 1
s_branch m_f2_al32
m_f2_ah42:
v_smfmac_f32_16x16x64_bf16 v[24:27], v[16:19], a[16:23], v3
v_smfmac_f32_16x16x64_bf16 v[28:31], v[16:19], a[48:55], v3
v_smfmac_f32_16x16x64_bf16 v[32:35], v[16:19], a[80:87], v3
v_smfmac_f32_16x16x64_bf16 v[36:39], v[16:19], a[112:119], v3
s_bitset0_b32 s32, 2
s_branch m_f2_al33
m_f2_ah43:
v_smfmac_f32_16x16x64_bf16 v[24:27], v[20:23], a[24:31], v3
v_smfmac_f32_16x16x64_bf16 v[28:31], v[20:23], a[56:63], v3
v_smfmac_f32_16x16x64_bf16 v[32:35], v[20:23], a[88:95], v3
v_smfmac_f32_16x16x64_bf16 v[36:39], v[20:23], a[120:127], v3
s_bitset0_b32 s32, 3
s_branch m_f2_al30
m_f2_om0:
s_mov_b32 s32, 15
s_cmp_eq_u32 s17, 0
s_cbranch_scc1 m_f2_oh40
s_sub_u32 s17, s17, 1
buffer_load_dwordx4 v[8:11], v57, s[4:7], s19 offen offset:0 sc1
s_branch m_f2_ol41
m_f2_om1:
v_smfmac_f32_16x16x64_bf16 v[52:55], v[8:11], a[224:231], v3
s_mov_b32 s32, 14
s_cmp_eq_u32 s17, 0
s_cbranch_scc1 m_f2_oh31
s_sub_u32 s17, s17, 1
buffer_load_dwordx4 v[12:15], v57, s[4:7], s19 offen offset:1024 sc1
s_branch m_f2_ol32
m_f2_om2:
v_smfmac_f32_16x16x64_bf16 v[52:55], v[12:15], a[232:239], v3
s_mov_b32 s32, 12
s_cmp_eq_u32 s17, 0
s_cbranch_scc1 m_f2_oh22
s_sub_u32 s17, s17, 1
buffer_load_dwordx4 v[16:19], v57, s[4:7], s19 offen offset:2048 sc1
s_branch m_f2_ol23
m_f2_om3:
v_smfmac_f32_16x16x64_bf16 v[52:55], v[16:19], a[240:247], v3
s_mov_b32 s32, 8
s_cmp_eq_u32 s17, 0
s_cbranch_scc1 m_f2_oh13
s_sub_u32 s17, s17, 1
buffer_load_dwordx4 v[20:23], v57, s[4:7], s19 offen offset:3072 sc1
s_branch m_f2_ol10
m_f2_ol10:
s_bitcmp1_b32 s32, 0
s_cbranch_scc0 m_f2_ol11
s_waitcnt vmcnt(0)
v_cmp_eq_u32 vcc, -1, v8
s_cbranch_vccz m_f2_oh10
s_cmp_eq_u32 s17, 0
s_cbranch_scc1 m_f2_oh10
s_sub_u32 s17, s17, 1
buffer_load_dwordx4 v[8:11], v57, s[4:7], s19 offen offset:0 sc1
m_f2_ol11:
s_bitcmp1_b32 s32, 1
s_cbranch_scc0 m_f2_ol12
s_waitcnt vmcnt(0)
v_cmp_eq_u32 vcc, -1, v12
s_cbranch_vccz m_f2_oh11
s_cmp_eq_u32 s17, 0
s_cbranch_scc1 m_f2_oh11
s_sub_u32 s17, s17, 1
buffer_load_dwordx4 v[12:15], v57, s[4:7], s19 offen offset:1024 sc1
m_f2_ol12:
s_bitcmp1_b32 s32, 2
s_cbranch_scc0 m_f2_ol13
s_waitcnt vmcnt(0)
v_cmp_eq_u32 vcc, -1, v16
s_cbranch_vccz m_f2_oh12
s_cmp_eq_u32 s17, 0
s_cbranch_scc1 m_f2_oh12
s_sub_u32 s17, s17, 1
buffer_load_dwordx4 v[16:19], v57, s[4:7], s19 offen offset:2048 sc1
m_f2_ol13:
s_bitcmp1_b32 s32, 3
s_cbranch_scc0 m_f2_ol10
s_waitcnt vmcnt(0)
v_cmp_eq_u32 vcc, -1, v20
s_cbranch_vccz m_f2_oh13
s_cmp_eq_u32 s17, 0
s_cbranch_scc1 m_f2_oh13
s_sub_u32 s17, s17, 1
buffer_load_dwordx4 v[20:23], v57, s[4:7], s19 offen offset:3072 sc1
s_branch m_f2_ol10
m_f2_oh10:
v_smfmac_f32_16x16x64_bf16 v[48:51], v[8:11], a[192:199], v3
v_smfmac_f32_16x16x64_bf16 v[52:55], v[8:11], a[224:231], v3
s_branch m_f2_ob
m_f2_oh11:
v_smfmac_f32_16x16x64_bf16 v[48:51], v[12:15], a[200:207], v3
v_smfmac_f32_16x16x64_bf16 v[52:55], v[12:15], a[232:239], v3
s_branch m_f2_ob
m_f2_oh12:
v_smfmac_f32_16x16x64_bf16 v[48:51], v[16:19], a[208:215], v3
v_smfmac_f32_16x16x64_bf16 v[52:55], v[16:19], a[240:247], v3
s_branch m_f2_ob
m_f2_oh13:
v_smfmac_f32_16x16x64_bf16 v[48:51], v[20:23], a[216:223], v3
v_smfmac_f32_16x16x64_bf16 v[52:55], v[20:23], a[248:255], v3
s_branch m_f2_ob
m_f2_ol20:
s_bitcmp1_b32 s32, 0
s_cbranch_scc0 m_f2_ol21
s_waitcnt vmcnt(1)
v_cmp_eq_u32 vcc, -1, v8
s_cbranch_vccz m_f2_oh20
s_cmp_eq_u32 s17, 0
s_cbranch_scc1 m_f2_oh20
s_sub_u32 s17, s17, 1
buffer_load_dwordx4 v[8:11], v57, s[4:7], s19 offen offset:0 sc1
m_f2_ol21:
s_bitcmp1_b32 s32, 1
s_cbranch_scc0 m_f2_ol22
s_waitcnt vmcnt(1)
v_cmp_eq_u32 vcc, -1, v12
s_cbranch_vccz m_f2_oh21
s_cmp_eq_u32 s17, 0
s_cbranch_scc1 m_f2_oh21
s_sub_u32 s17, s17, 1
buffer_load_dwordx4 v[12:15], v57, s[4:7], s19 offen offset:1024 sc1
m_f2_ol22:
s_bitcmp1_b32 s32, 2
s_cbranch_scc0 m_f2_ol23
s_waitcnt vmcnt(1)
v_cmp_eq_u32 vcc, -1, v16
s_cbranch_vccz m_f2_oh22
s_cmp_eq_u32 s17, 0
s_cbranch_scc1 m_f2_oh22
s_sub_u32 s17, s17, 1
buffer_load_dwordx4 v[16:19], v57, s[4:7], s19 offen offset:2048 sc1
m_f2_ol23:
s_bitcmp1_b32 s32, 3
s_cbranch_scc0 m_f2_ol20
s_waitcnt vmcnt(1)
v_cmp_eq_u32 vcc, -1, v20
s_cbranch_vccz m_f2_oh23
s_cmp_eq_u32 s17, 0
s_cbranch_scc1 m_f2_oh23
s_sub_u32 s17, s17, 1
buffer_load_dwordx4 v[20:23], v57, s[4:7], s19 offen offset:3072 sc1
s_branch m_f2_ol20
m_f2_oh20:
v_smfmac_f32_16x16x64_bf16 v[48:51], v[8:11], a[192:199], v3
v_smfmac_f32_16x16x64_bf16 v[52:55], v[8:11], a[224:231], v3
s_bitset0_b32 s32, 0
s_branch m_f2_ol11
m_f2_oh21:
v_smfmac_f32_16x16x64_bf16 v[48:51], v[12:15], a[200:207], v3
v_smfmac_f32_16x16x64_bf16 v[52:55], v[12:15], a[232:239], v3
s_bitset0_b32 s32, 1
s_branch m_f2_ol12
m_f2_oh22:
v_smfmac_f32_16x16x64_bf16 v[48:51], v[16:19], a[208:215], v3
v_smfmac_f32_16x16x64_bf16 v[52:55], v[16:19], a[240:247], v3
s_bitset0_b32 s32, 2
s_branch m_f2_ol13
m_f2_oh23:
v_smfmac_f32_16x16x64_bf16 v[48:51], v[20:23], a[216:223], v3
v_smfmac_f32_16x16x64_bf16 v[52:55], v[20:23], a[248:255], v3
s_bitset0_b32 s32, 3
s_branch m_f2_ol10
m_f2_ol30:
s_bitcmp1_b32 s32, 0
s_cbranch_scc0 m_f2_ol31
s_waitcnt vmcnt(2)
v_cmp_eq_u32 vcc, -1, v8
s_cbranch_vccz m_f2_oh30
s_cmp_eq_u32 s17, 0
s_cbranch_scc1 m_f2_oh30
s_sub_u32 s17, s17, 1
buffer_load_dwordx4 v[8:11], v57, s[4:7], s19 offen offset:0 sc1
m_f2_ol31:
s_bitcmp1_b32 s32, 1
s_cbranch_scc0 m_f2_ol32
s_waitcnt vmcnt(2)
v_cmp_eq_u32 vcc, -1, v12
s_cbranch_vccz m_f2_oh31
s_cmp_eq_u32 s17, 0
s_cbranch_scc1 m_f2_oh31
s_sub_u32 s17, s17, 1
buffer_load_dwordx4 v[12:15], v57, s[4:7], s19 offen offset:1024 sc1
m_f2_ol32:
s_bitcmp1_b32 s32, 2
s_cbranch_scc0 m_f2_ol33
s_waitcnt vmcnt(2)
v_cmp_eq_u32 vcc, -1, v16
s_cbranch_vccz m_f2_oh32
s_cmp_eq_u32 s17, 0
s_cbranch_scc1 m_f2_oh32
s_sub_u32 s17, s17, 1
buffer_load_dwordx4 v[16:19], v57, s[4:7], s19 offen offset:2048 sc1
m_f2_ol33:
s_bitcmp1_b32 s32, 3
s_cbranch_scc0 m_f2_ol30
s_waitcnt vmcnt(2)
v_cmp_eq_u32 vcc, -1, v20
s_cbranch_vccz m_f2_oh33
s_cmp_eq_u32 s17, 0
s_cbranch_scc1 m_f2_oh33
s_sub_u32 s17, s17, 1
buffer_load_dwordx4 v[20:23], v57, s[4:7], s19 offen offset:3072 sc1
s_branch m_f2_ol30
m_f2_oh30:
v_smfmac_f32_16x16x64_bf16 v[48:51], v[8:11], a[192:199], v3
v_smfmac_f32_16x16x64_bf16 v[52:55], v[8:11], a[224:231], v3
s_bitset0_b32 s32, 0
s_branch m_f2_ol21
m_f2_oh31:
v_smfmac_f32_16x16x64_bf16 v[48:51], v[12:15], a[200:207], v3
v_smfmac_f32_16x16x64_bf16 v[52:55], v[12:15], a[232:239], v3
s_bitset0_b32 s32, 1
s_branch m_f2_ol22
m_f2_oh32:
v_smfmac_f32_16x16x64_bf16 v[48:51], v[16:19], a[208:215], v3
v_smfmac_f32_16x16x64_bf16 v[52:55], v[16:19], a[240:247], v3
s_bitset0_b32 s32, 2
s_branch m_f2_ol23
m_f2_oh33:
v_smfmac_f32_16x16x64_bf16 v[48:51], v[20:23], a[216:223], v3
v_smfmac_f32_16x16x64_bf16 v[52:55], v[20:23], a[248:255], v3
s_bitset0_b32 s32, 3
s_branch m_f2_ol20
m_f2_ol40:
s_waitcnt vmcnt(3)
v_cmp_eq_u32 vcc, -1, v8
s_cbranch_vccz m_f2_oh40
s_cmp_eq_u32 s17, 0
s_cbranch_scc1 m_f2_oh40
s_sub_u32 s17, s17, 1
buffer_load_dwordx4 v[8:11], v57, s[4:7], s19 offen offset:0 sc1
m_f2_ol41:
s_waitcnt vmcnt(3)
v_cmp_eq_u32 vcc, -1, v12
s_cbranch_vccz m_f2_oh41
s_cmp_eq_u32 s17, 0
s_cbranch_scc1 m_f2_oh41
s_sub_u32 s17, s17, 1
buffer_load_dwordx4 v[12:15], v57, s[4:7], s19 offen offset:1024 sc1
m_f2_ol42:
s_waitcnt vmcnt(3)
v_cmp_eq_u32 vcc, -1, v16
s_cbranch_vccz m_f2_oh42
s_cmp_eq_u32 s17, 0
s_cbranch_scc1 m_f2_oh42
s_sub_u32 s17, s17, 1
buffer_load_dwordx4 v[16:19], v57, s[4:7], s19 offen offset:2048 sc1
m_f2_ol43:
s_waitcnt vmcnt(3)
v_cmp_eq_u32 vcc, -1, v20
s_cbranch_vccz m_f2_oh43
s_cmp_eq_u32 s17, 0
s_cbranch_scc1 m_f2_oh43
s_sub_u32 s17, s17, 1
buffer_load_dwordx4 v[20:23], v57, s[4:7], s19 offen offset:3072 sc1
s_branch m_f2_ol40
m_f2_oh40:
v_smfmac_f32_16x16x64_bf16 v[48:51], v[8:11], a[192:199], v3
v_smfmac_f32_16x16x64_bf16 v[52:55], v[8:11], a[224:231], v3
s_bitset0_b32 s32, 0
s_branch m_f2_ol31
m_f2_oh41:
v_smfmac_f32_16x16x64_bf16 v[48:51], v[12:15], a[200:207], v3
v_smfmac_f32_16x16x64_bf16 v[52:55], v[12:15], a[232:239], v3
s_bitset0_b32 s32, 1
s_branch m_f2_ol32
m_f2_oh42:
v_smfmac_f32_16x16x64_bf16 v[48:51], v[16:19], a[208:215], v3
v_smfmac_f32_16x16x64_bf16 v[52:55], v[16:19], a[240:247], v3
s_bitset0_b32 s32, 2
s_branch m_f2_ol33
m_f2_oh43:
v_smfmac_f32_16x16x64_bf16 v[48:51], v[20:23], a[216:223], v3
v_smfmac_f32_16x16x64_bf16 v[52:55], v[20:23], a[248:255], v3
s_bitset0_b32 s32, 3
s_branch m_f2_ol30
m_f2_fin:
s_lshr_b32 s29, s23, 8
s_xor_b32 s29, s29, s65
s_and_b32 s29, s29, 8192
s_add_u32 s29, s29, s23
buffer_store_dwordx4 v[100:103], v66, s[4:7], s29 offen sc1
s_add_u32 s23, s23, 131072
s_waitcnt vmcnt(0)
s_barrier
s_branch m_recdone
m_safe2:
m_s2_top:
s_waitcnt vmcnt(3)
v_cmp_eq_u32 vcc, -1, v8
s_cbranch_vccnz m_s2_am0
v_smfmac_f32_16x16x64_bf16 v[24:27], v[8:11], a[0:7], v3
v_smfmac_f32_16x16x64_bf16 v[28:31], v[8:11], a[32:39], v3
s_waitcnt vmcnt(2)
v_cmp_eq_u32 vcc, -1, v12
v_smfmac_f32_16x16x64_bf16 v[32:35], v[8:11], a[64:71], v3
s_cbranch_vccnz m_s2_am1
v_smfmac_f32_16x16x64_bf16 v[36:39], v[8:11], a[96:103], v3
v_smfmac_f32_16x16x64_bf16 v[24:27], v[12:15], a[8:15], v3
v_smfmac_f32_16x16x64_bf16 v[28:31], v[12:15], a[40:47], v3
s_waitcnt vmcnt(1)
v_cmp_eq_u32 vcc, -1, v16
v_smfmac_f32_16x16x64_bf16 v[32:35], v[12:15], a[72:79], v3
s_cbranch_vccnz m_s2_am2
v_smfmac_f32_16x16x64_bf16 v[36:39], v[12:15], a[104:111], v3
v_smfmac_f32_16x16x64_bf16 v[24:27], v[16:19], a[16:23], v3
v_smfmac_f32_16x16x64_bf16 v[28:31], v[16:19], a[48:55], v3
s_waitcnt vmcnt(0)
v_cmp_eq_u32 vcc, -1, v20
v_smfmac_f32_16x16x64_bf16 v[32:35], v[16:19], a[80:87], v3
s_cbranch_vccnz m_s2_am3
v_smfmac_f32_16x16x64_bf16 v[36:39], v[16:19], a[112:119], v3
v_smfmac_f32_16x16x64_bf16 v[24:27], v[20:23], a[24:31], v3
v_smfmac_f32_16x16x64_bf16 v[28:31], v[20:23], a[56:63], v3
v_smfmac_f32_16x16x64_bf16 v[32:35], v[20:23], a[88:95], v3
v_smfmac_f32_16x16x64_bf16 v[36:39], v[20:23], a[120:127], v3
m_s2_ab:
buffer_store_dwordx2 v[4:5], v68, s[4:7], s20 offen sc1
v_smfmac_f32_16x16x64_bf16 v[40:43], v[8:11], a[128:135], v3
v_pk_add_f32 v[24:25], v[24:25], v[26:27]
v_pk_add_f32 v[28:29], v[28:29], v[30:31]
ds_write2_b32 v58, v24, v25 offset0:80 offset1:120
ds_write2_b32 v58, v28, v29 offset0:96 offset1:136
v_smfmac_f32_16x16x64_bf16 v[44:47], v[8:11], a[160:167], v3
v_pk_add_f32 v[32:33], v[32:33], v[34:35]
v_pk_add_f32 v[36:37], v[36:37], v[38:39]
ds_write2_b32 v58, v32, v33 offset0:0 offset1:40
ds_write2_b32 v58, v36, v37 offset0:16 offset1:56
s_and_b32 s30, s18, 3
s_lshl_b32 s19, s30, 19
s_add_u32 s19, s19, 167772160
v_smfmac_f32_16x16x64_bf16 v[40:43], v[12:15], a[136:143], v3
v_smfmac_f32_16x16x64_bf16 v[44:47], v[12:15], a[168:175], v3
s_waitcnt lgkmcnt(0)
s_barrier
v_smfmac_f32_16x16x64_bf16 v[40:43], v[16:19], a[144:151], v3
v_smfmac_f32_16x16x64_bf16 v[44:47], v[16:19], a[176:183], v3
v_smfmac_f32_16x16x64_bf16 v[40:43], v[20:23], a[152:159], v3
v_smfmac_f32_16x16x64_bf16 v[44:47], v[20:23], a[184:191], v3
s_nop 4
v_pk_add_f32 v[96:97], v[40:41], v[42:43]
s_nop 1
v_pk_add_f32 v[98:99], v[44:45], v[46:47]
ds_write_b128 v59, v[96:99] offset:14336
s_waitcnt lgkmcnt(0)
s_barrier
ds_read_b128 v[124:127], v59 offset:12288
ds_read_b128 v[128:131], v59 offset:13312
ds_read_b128 v[132:135], v59 offset:15360
s_waitcnt lgkmcnt(0)
v_pk_add_f32 v[136:137], v[124:125], v[128:129]
v_pk_add_f32 v[138:139], v[126:127], v[130:131]
v_pk_add_f32 v[96:97], v[96:97], v[132:133]
v_pk_add_f32 v[98:99], v[98:99], v[134:135]
v_pk_add_f32 v[96:97], v[96:97], v[136:137]
v_pk_add_f32 v[98:99], v[98:99], v[138:139]
v_cvt_pk_bf16_f32 v116, v96, v97
v_cvt_pk_bf16_f32 v120, v98, v99
s_nop 1
v_permlane16_swap_b32 v116, v120
v_mov_b32 v100, v116
v_mov_b32 v101, v120
v_mov_b32 v102, v116
v_mov_b32 v103, v120
s_nop 0
v_permlane32_swap_b32 v100, v102
v_permlane32_swap_b32 v101, v103
s_cmp_eq_u32 s18, 63
s_cbranch_scc1 m_s2_fin
v_mov_b64 v[24:25], 0
v_mov_b64 v[26:27], 0
v_mov_b64 v[28:29], 0
v_mov_b64 v[30:31], 0
v_mov_b64 v[32:33], 0
v_mov_b64 v[34:35], 0
v_mov_b64 v[36:37], 0
v_mov_b64 v[38:39], 0
v_mov_b64 v[40:41], 0
v_mov_b64 v[42:43], 0
v_mov_b64 v[44:45], 0
v_mov_b64 v[46:47], 0
s_cmp_ge_u32 s18, 15
s_cbranch_scc1 m_s2_ow0
ds_read_b128 v[104:107], v59 offset:49152
ds_read_b128 v[108:111], v59 offset:50176
ds_read_b128 v[112:115], v59 offset:51200
ds_read_b128 v[116:119], v59 offset:52224
ds_read_b128 v[120:123], v59 offset:53248
ds_read_b128 v[124:127], v59 offset:54272
ds_read_b128 v[128:131], v59 offset:55296
ds_read_b128 v[132:135], v59 offset:56320
v_mfma_f32_16x16x32_bf16 v[208:211], a[64:67], v[144:147], 0
v_mfma_f32_16x16x32_bf16 v[224:227], v[144:147], a[128:131], 0
v_mfma_f32_16x16x32_bf16 v[212:215], a[96:99], v[144:147], 0
v_mfma_f32_16x16x32_bf16 v[232:235], v[144:147], a[160:163], 0
v_mfma_f32_16x16x32_bf16 v[216:219], a[64:67], v[148:151], 0
v_mfma_f32_16x16x32_bf16 v[228:231], v[148:151], a[128:131], 0
v_mfma_f32_16x16x32_bf16 v[220:223], a[96:99], v[148:151], 0
s_waitcnt lgkmcnt(4)
v_pk_add_f32 v[104:105], v[104:105], v[112:113]
v_pk_add_f32 v[106:107], v[106:107], v[114:115]
v_mfma_f32_16x16x32_bf16 v[236:239], v[148:151], a[160:163], 0
v_pk_add_f32 v[108:109], v[108:109], v[116:117]
v_pk_add_f32 v[110:111], v[110:111], v[118:119]
s_waitcnt lgkmcnt(2)
v_mfma_f32_16x16x32_bf16 v[208:211], a[68:71], v[152:155], v[208:211]
v_pk_add_f32 v[104:105], v[104:105], v[120:121]
v_pk_add_f32 v[106:107], v[106:107], v[122:123]
v_pk_add_f32 v[108:109], v[108:109], v[124:125]
v_mfma_f32_16x16x32_bf16 v[224:227], v[152:155], a[132:135], v[224:227]
v_pk_add_f32 v[110:111], v[110:111], v[126:127]
s_waitcnt lgkmcnt(0)
v_pk_add_f32 v[104:105], v[104:105], v[128:129]
v_mfma_f32_16x16x32_bf16 v[212:215], a[100:103], v[152:155], v[212:215]
v_pk_add_f32 v[106:107], v[106:107], v[130:131]
v_pk_add_f32 v[108:109], v[108:109], v[132:133]
v_pk_add_f32 v[110:111], v[110:111], v[134:135]
v_mfma_f32_16x16x32_bf16 v[232:235], v[152:155], a[164:167], v[232:235]
v_cvt_pk_bf16_f32 v136, v104, v105
v_cvt_pk_bf16_f32 v137, v106, v107
v_cvt_pk_bf16_f32 v138, v108, v109
v_mfma_f32_16x16x32_bf16 v[216:219], a[68:71], v[156:159], v[216:219]
v_cvt_pk_bf16_f32 v139, v110, v111
ds_write_b128 v74, v[136:139] offset:26624
v_mfma_f32_16x16x32_bf16 v[228:231], v[156:159], a[132:135], v[228:231]
v_mfma_f32_16x16x32_bf16 v[220:223], a[100:103], v[156:159], v[220:223]
v_mfma_f32_16x16x32_bf16 v[236:239], v[156:159], a[164:167], v[236:239]
v_mfma_f32_16x16x32_bf16 v[208:211], a[72:75], v[160:163], v[208:211]
v_mfma_f32_16x16x32_bf16 v[224:227], v[160:163], a[136:139], v[224:227]
v_mfma_f32_16x16x32_bf16 v[212:215], a[104:107], v[160:163], v[212:215]
v_mfma_f32_16x16x32_bf16 v[232:235], v[160:163], a[168:171], v[232:235]
v_mfma_f32_16x16x32_bf16 v[216:219], a[72:75], v[164:167], v[216:219]
v_mfma_f32_16x16x32_bf16 v[228:231], v[164:167], a[136:139], v[228:231]
v_mfma_f32_16x16x32_bf16 v[220:223], a[104:107], v[164:167], v[220:223]
v_mfma_f32_16x16x32_bf16 v[236:239], v[164:167], a[168:171], v[236:239]
m_s2_ow0:
v_xor_b32 v74, 4096, v74
s_barrier
buffer_load_dwordx4 v[8:11], v57, s[4:7], s19 offen offset:0 sc1
buffer_load_dwordx4 v[12:15], v57, s[4:7], s19 offen offset:1024 sc1
buffer_load_dwordx4 v[16:19], v57, s[4:7], s19 offen offset:2048 sc1
buffer_load_dwordx4 v[20:23], v57, s[4:7], s19 offen offset:3072 sc1
s_waitcnt vmcnt(3)
v_cmp_eq_u32 vcc, -1, v8
s_cbranch_vccnz m_s2_om0
v_smfmac_f32_16x16x64_bf16 v[48:51], v[8:11], a[192:199], v3
s_waitcnt vmcnt(2)
v_cmp_eq_u32 vcc, -1, v12
s_cbranch_vccnz m_s2_om1
v_smfmac_f32_16x16x64_bf16 v[52:55], v[8:11], a[224:231], v3
v_smfmac_f32_16x16x64_bf16 v[48:51], v[12:15], a[200:207], v3
s_waitcnt vmcnt(1)
v_cmp_eq_u32 vcc, -1, v16
s_cbranch_vccnz m_s2_om2
v_smfmac_f32_16x16x64_bf16 v[52:55], v[12:15], a[232:239], v3
v_smfmac_f32_16x16x64_bf16 v[48:51], v[16:19], a[208:215], v3
s_waitcnt vmcnt(0)
v_cmp_eq_u32 vcc, -1, v20
s_cbranch_vccnz m_s2_om3
v_smfmac_f32_16x16x64_bf16 v[52:55], v[16:19], a[240:247], v3
v_smfmac_f32_16x16x64_bf16 v[48:51], v[20:23], a[216:223], v3
v_smfmac_f32_16x16x64_bf16 v[52:55], v[20:23], a[248:255], v3
m_s2_ob:
s_nop 4
v_pk_add_f32 v[96:97], v[48:49], v[50:51]
s_nop 1
v_pk_add_f32 v[98:99], v[52:53], v[54:55]
ds_write2_b32 v240, v96, v97 offset0:0 offset1:72
ds_write2_b32 v240, v98, v99 offset0:160 offset1:232
s_lshr_b32 s29, s23, 8
s_xor_b32 s29, s29, s65
s_and_b32 s29, s29, 8192
s_add_u32 s29, s29, s23
buffer_store_dwordx4 v[100:103], v66, s[4:7], s29 offen sc1
s_add_u32 s23, s23, 131072
s_cmp_ge_u32 s18, 15
s_cbranch_scc1 m_s2_ow1
s_lshr_b32 s29, s61, 8
s_xnor_b32 s29, s29, s65
s_and_b32 s29, s29, 8192
s_add_u32 s29, s29, s61
s_add_u32 s28, s29, 33554432
s_add_u32 s61, s61, 524288
buffer_store_dwordx4 v[136:139], v244, s[4:7], s28 offen offset:0 sc1
m_s2_ow1:
s_waitcnt lgkmcnt(0)
s_barrier
v_mov_b32 v76, s18
buffer_store_dword v76, v69, s[4:7], 0 offen sc1
s_sub_u32 s28, s18, 48
s_cmp_ge_u32 s28, 4
s_cbranch_scc1 m_s2_sn
s_xor_b32 s29, s65, 8192
s_and_b32 s29, s29, 8192
s_mul_i32 s28, s28, 262144
s_add_u32 s29, s29, s28
s_add_u32 s29, s29, 7340032
buffer_store_dwordx4 v[4:7], v66, s[4:7], s29 offen sc1
s_add_u32 s29, s29, 131072
buffer_store_dwordx4 v[4:7], v66, s[4:7], s29 offen sc1
m_s2_sn:
v_mov_b64 v[48:49], 0
v_mov_b64 v[50:51], 0
v_mov_b64 v[52:53], 0
v_mov_b64 v[54:55], 0
s_cmp_ge_u32 s18, 15
s_cbranch_scc1 m_s2_ow2
v_mfma_f32_16x16x32_bf16 v[208:211], a[76:79], v[168:171], v[208:211]
v_mfma_f32_16x16x32_bf16 v[224:227], v[168:171], a[140:143], v[224:227]
s_add_u32 s28, s60, 0
buffer_load_dwordx4 v[144:147], v241, s[4:7], s28 offen offset:0
v_mfma_f32_16x16x32_bf16 v[212:215], a[108:111], v[168:171], v[212:215]
v_mfma_f32_16x16x32_bf16 v[232:235], v[168:171], a[172:175], v[232:235]
v_mfma_f32_16x16x32_bf16 v[216:219], a[76:79], v[172:175], v[216:219]
v_mfma_f32_16x16x32_bf16 v[228:231], v[172:175], a[140:143], v[228:231]
s_add_u32 s28, s60, 4096
buffer_load_dwordx4 v[168:171], v241, s[4:7], s28 offen offset:2048
s_add_u32 s28, s60, 0
buffer_load_dwordx4 v[148:151], v241, s[4:7], s28 offen offset:256
v_mfma_f32_16x16x32_bf16 v[220:223], a[108:111], v[172:175], v[220:223]
v_mfma_f32_16x16x32_bf16 v[236:239], v[172:175], a[172:175], v[236:239]
v_mfma_f32_16x16x32_bf16 v[208:211], a[80:83], v[176:179], v[208:211]
v_mfma_f32_16x16x32_bf16 v[224:227], v[176:179], a[144:147], v[224:227]
s_add_u32 s28, s60, 4096
buffer_load_dwordx4 v[172:175], v241, s[4:7], s28 offen offset:2304
s_add_u32 s28, s60, 0
buffer_load_dwordx4 v[152:155], v241, s[4:7], s28 offen offset:2048
v_mfma_f32_16x16x32_bf16 v[212:215], a[112:115], v[176:179], v[212:215]
v_mfma_f32_16x16x32_bf16 v[232:235], v[176:179], a[176:179], v[232:235]
v_mfma_f32_16x16x32_bf16 v[216:219], a[80:83], v[180:183], v[216:219]
v_mfma_f32_16x16x32_bf16 v[228:231], v[180:183], a[144:147], v[228:231]
s_add_u32 s28, s60, 8192
buffer_load_dwordx4 v[176:179], v241, s[4:7], s28 offen offset:0
s_add_u32 s28, s60, 0
buffer_load_dwordx4 v[156:159], v241, s[4:7], s28 offen offset:2304
v_mfma_f32_16x16x32_bf16 v[220:223], a[112:115], v[180:183], v[220:223]
v_mfma_f32_16x16x32_bf16 v[236:239], v[180:183], a[176:179], v[236:239]
v_mfma_f32_16x16x32_bf16 v[208:211], a[84:87], v[184:187], v[208:211]
v_mfma_f32_16x16x32_bf16 v[224:227], v[184:187], a[148:151], v[224:227]
s_add_u32 s28, s60, 8192
buffer_load_dwordx4 v[180:183], v241, s[4:7], s28 offen offset:256
s_add_u32 s28, s60, 4096
buffer_load_dwordx4 v[160:163], v241, s[4:7], s28 offen offset:0
v_mfma_f32_16x16x32_bf16 v[212:215], a[116:119], v[184:187], v[212:215]
v_mfma_f32_16x16x32_bf16 v[232:235], v[184:187], a[180:183], v[232:235]
v_mfma_f32_16x16x32_bf16 v[216:219], a[84:87], v[188:191], v[216:219]
v_mfma_f32_16x16x32_bf16 v[228:231], v[188:191], a[148:151], v[228:231]
s_add_u32 s28, s60, 8192
buffer_load_dwordx4 v[184:187], v241, s[4:7], s28 offen offset:2048
s_add_u32 s28, s60, 4096
buffer_load_dwordx4 v[164:167], v241, s[4:7], s28 offen offset:256
v_mfma_f32_16x16x32_bf16 v[220:223], a[116:119], v[188:191], v[220:223]
v_mfma_f32_16x16x32_bf16 v[236:239], v[188:191], a[180:183], v[236:239]
v_mfma_f32_16x16x32_bf16 v[208:211], a[88:91], v[192:195], v[208:211]
v_mfma_f32_16x16x32_bf16 v[224:227], v[192:195], a[152:155], v[224:227]
s_add_u32 s28, s60, 8192
buffer_load_dwordx4 v[188:191], v241, s[4:7], s28 offen offset:2304
v_mfma_f32_16x16x32_bf16 v[212:215], a[120:123], v[192:195], v[212:215]
v_mfma_f32_16x16x32_bf16 v[232:235], v[192:195], a[184:187], v[232:235]
v_mfma_f32_16x16x32_bf16 v[216:219], a[88:91], v[196:199], v[216:219]
v_mfma_f32_16x16x32_bf16 v[228:231], v[196:199], a[152:155], v[228:231]
s_add_u32 s28, s60, 12288
buffer_load_dwordx4 v[192:195], v241, s[4:7], s28 offen offset:0
v_mfma_f32_16x16x32_bf16 v[220:223], a[120:123], v[196:199], v[220:223]
v_mfma_f32_16x16x32_bf16 v[236:239], v[196:199], a[184:187], v[236:239]
v_mfma_f32_16x16x32_bf16 v[208:211], a[92:95], v[200:203], v[208:211]
v_mfma_f32_16x16x32_bf16 v[224:227], v[200:203], a[156:159], v[224:227]
s_add_u32 s28, s60, 12288
buffer_load_dwordx4 v[196:199], v241, s[4:7], s28 offen offset:256
v_mfma_f32_16x16x32_bf16 v[212:215], a[124:127], v[200:203], v[212:215]
v_mfma_f32_16x16x32_bf16 v[232:235], v[200:203], a[188:191], v[232:235]
v_mfma_f32_16x16x32_bf16 v[216:219], a[92:95], v[204:207], v[216:219]
v_mfma_f32_16x16x32_bf16 v[228:231], v[204:207], a[156:159], v[228:231]
s_add_u32 s28, s60, 12288
buffer_load_dwordx4 v[200:203], v241, s[4:7], s28 offen offset:2048
v_mfma_f32_16x16x32_bf16 v[220:223], a[124:127], v[204:207], v[220:223]
v_mfma_f32_16x16x32_bf16 v[236:239], v[204:207], a[188:191], v[236:239]
s_add_u32 s28, s60, 12288
buffer_load_dwordx4 v[204:207], v241, s[4:7], s28 offen offset:2304
ds_write_b128 v242, v[208:211] offset:0
ds_write_b128 v242, v[212:215] offset:1024
ds_write_b128 v242, v[224:227] offset:16384
ds_write_b128 v242, v[228:231] offset:17408
ds_write_b128 v242, v[216:219] offset:8192
ds_write_b128 v242, v[220:223] offset:9216
ds_write_b128 v242, v[232:235] offset:24576
ds_write_b128 v242, v[236:239] offset:25600
s_mov_b32 s59, s60
s_add_u32 s60, s60, 65536
s_cmp_eq_u32 s18, 4
s_cselect_b32 s60, 176717824, s60
s_xor_b32 s69, s69, 16384
m_s2_ow2:
s_add_u32 s18, s18, 1
s_mov_b32 s31, s21
s_and_b32 s30, s18, 3
s_lshl_b32 s21, s30, 18
s_xor_b32 s22, s21, 524288
s_add_u32 s21, s21, 169869312
s_add_u32 s22, s22, 169869312
s_xor_b32 s30, s30, 2
s_lshl_b32 s20, s30, 19
s_add_u32 s20, s20, 167772160
s_waitcnt lgkmcnt(0)
s_barrier
buffer_load_dwordx4 v[8:11], v56, s[4:7], s19 offen offset:0 sc1
buffer_load_dwordx4 v[12:15], v56, s[4:7], s19 offen offset:1024 sc1
buffer_load_dwordx4 v[16:19], v56, s[4:7], s19 offen offset:2048 sc1
buffer_load_dwordx4 v[20:23], v56, s[4:7], s19 offen offset:3072 sc1
s_branch m_s2_top
m_s2_am0:
s_mov_b32 s32, 15
s_cmp_eq_u32 s17, 0
s_cbranch_scc1 m_s2_ah40
s_sub_u32 s17, s17, 1
buffer_load_dwordx4 v[8:11], v56, s[4:7], s19 offen offset:0 sc1
s_branch m_s2_al41
m_s2_am1:
v_smfmac_f32_16x16x64_bf16 v[36:39], v[8:11], a[96:103], v3
s_mov_b32 s32, 14
s_cmp_eq_u32 s17, 0
s_cbranch_scc1 m_s2_ah31
s_sub_u32 s17, s17, 1
buffer_load_dwordx4 v[12:15], v56, s[4:7], s19 offen offset:1024 sc1
s_branch m_s2_al32
m_s2_am2:
v_smfmac_f32_16x16x64_bf16 v[36:39], v[12:15], a[104:111], v3
s_mov_b32 s32, 12
s_cmp_eq_u32 s17, 0
s_cbranch_scc1 m_s2_ah22
s_sub_u32 s17, s17, 1
buffer_load_dwordx4 v[16:19], v56, s[4:7], s19 offen offset:2048 sc1
s_branch m_s2_al23
m_s2_am3:
v_smfmac_f32_16x16x64_bf16 v[36:39], v[16:19], a[112:119], v3
s_mov_b32 s32, 8
s_cmp_eq_u32 s17, 0
s_cbranch_scc1 m_s2_ah13
s_sub_u32 s17, s17, 1
buffer_load_dwordx4 v[20:23], v56, s[4:7], s19 offen offset:3072 sc1
s_branch m_s2_al10
m_s2_al10:
s_bitcmp1_b32 s32, 0
s_cbranch_scc0 m_s2_al11
s_waitcnt vmcnt(0)
v_cmp_eq_u32 vcc, -1, v8
s_cbranch_vccz m_s2_ah10
s_cmp_eq_u32 s17, 0
s_cbranch_scc1 m_s2_ah10
s_sub_u32 s17, s17, 1
buffer_load_dwordx4 v[8:11], v56, s[4:7], s19 offen offset:0 sc1
m_s2_al11:
s_bitcmp1_b32 s32, 1
s_cbranch_scc0 m_s2_al12
s_waitcnt vmcnt(0)
v_cmp_eq_u32 vcc, -1, v12
s_cbranch_vccz m_s2_ah11
s_cmp_eq_u32 s17, 0
s_cbranch_scc1 m_s2_ah11
s_sub_u32 s17, s17, 1
buffer_load_dwordx4 v[12:15], v56, s[4:7], s19 offen offset:1024 sc1
m_s2_al12:
s_bitcmp1_b32 s32, 2
s_cbranch_scc0 m_s2_al13
s_waitcnt vmcnt(0)
v_cmp_eq_u32 vcc, -1, v16
s_cbranch_vccz m_s2_ah12
s_cmp_eq_u32 s17, 0
s_cbranch_scc1 m_s2_ah12
s_sub_u32 s17, s17, 1
buffer_load_dwordx4 v[16:19], v56, s[4:7], s19 offen offset:2048 sc1
m_s2_al13:
s_bitcmp1_b32 s32, 3
s_cbranch_scc0 m_s2_al10
s_waitcnt vmcnt(0)
v_cmp_eq_u32 vcc, -1, v20
s_cbranch_vccz m_s2_ah13
s_cmp_eq_u32 s17, 0
s_cbranch_scc1 m_s2_ah13
s_sub_u32 s17, s17, 1
buffer_load_dwordx4 v[20:23], v56, s[4:7], s19 offen offset:3072 sc1
s_branch m_s2_al10
m_s2_ah10:
v_smfmac_f32_16x16x64_bf16 v[24:27], v[8:11], a[0:7], v3
v_smfmac_f32_16x16x64_bf16 v[28:31], v[8:11], a[32:39], v3
v_smfmac_f32_16x16x64_bf16 v[32:35], v[8:11], a[64:71], v3
v_smfmac_f32_16x16x64_bf16 v[36:39], v[8:11], a[96:103], v3
s_branch m_s2_ab
m_s2_ah11:
v_smfmac_f32_16x16x64_bf16 v[24:27], v[12:15], a[8:15], v3
v_smfmac_f32_16x16x64_bf16 v[28:31], v[12:15], a[40:47], v3
v_smfmac_f32_16x16x64_bf16 v[32:35], v[12:15], a[72:79], v3
v_smfmac_f32_16x16x64_bf16 v[36:39], v[12:15], a[104:111], v3
s_branch m_s2_ab
m_s2_ah12:
v_smfmac_f32_16x16x64_bf16 v[24:27], v[16:19], a[16:23], v3
v_smfmac_f32_16x16x64_bf16 v[28:31], v[16:19], a[48:55], v3
v_smfmac_f32_16x16x64_bf16 v[32:35], v[16:19], a[80:87], v3
v_smfmac_f32_16x16x64_bf16 v[36:39], v[16:19], a[112:119], v3
s_branch m_s2_ab
m_s2_ah13:
v_smfmac_f32_16x16x64_bf16 v[24:27], v[20:23], a[24:31], v3
v_smfmac_f32_16x16x64_bf16 v[28:31], v[20:23], a[56:63], v3
v_smfmac_f32_16x16x64_bf16 v[32:35], v[20:23], a[88:95], v3
v_smfmac_f32_16x16x64_bf16 v[36:39], v[20:23], a[120:127], v3
s_branch m_s2_ab
m_s2_al20:
s_bitcmp1_b32 s32, 0
s_cbranch_scc0 m_s2_al21
s_waitcnt vmcnt(1)
v_cmp_eq_u32 vcc, -1, v8
s_cbranch_vccz m_s2_ah20
s_cmp_eq_u32 s17, 0
s_cbranch_scc1 m_s2_ah20
s_sub_u32 s17, s17, 1
buffer_load_dwordx4 v[8:11], v56, s[4:7], s19 offen offset:0 sc1
m_s2_al21:
s_bitcmp1_b32 s32, 1
s_cbranch_scc0 m_s2_al22
s_waitcnt vmcnt(1)
v_cmp_eq_u32 vcc, -1, v12
s_cbranch_vccz m_s2_ah21
s_cmp_eq_u32 s17, 0
s_cbranch_scc1 m_s2_ah21
s_sub_u32 s17, s17, 1
buffer_load_dwordx4 v[12:15], v56, s[4:7], s19 offen offset:1024 sc1
m_s2_al22:
s_bitcmp1_b32 s32, 2
s_cbranch_scc0 m_s2_al23
s_waitcnt vmcnt(1)
v_cmp_eq_u32 vcc, -1, v16
s_cbranch_vccz m_s2_ah22
s_cmp_eq_u32 s17, 0
s_cbranch_scc1 m_s2_ah22
s_sub_u32 s17, s17, 1
buffer_load_dwordx4 v[16:19], v56, s[4:7], s19 offen offset:2048 sc1
m_s2_al23:
s_bitcmp1_b32 s32, 3
s_cbranch_scc0 m_s2_al20
s_waitcnt vmcnt(1)
v_cmp_eq_u32 vcc, -1, v20
s_cbranch_vccz m_s2_ah23
s_cmp_eq_u32 s17, 0
s_cbranch_scc1 m_s2_ah23
s_sub_u32 s17, s17, 1
buffer_load_dwordx4 v[20:23], v56, s[4:7], s19 offen offset:3072 sc1
s_branch m_s2_al20
m_s2_ah20:
v_smfmac_f32_16x16x64_bf16 v[24:27], v[8:11], a[0:7], v3
v_smfmac_f32_16x16x64_bf16 v[28:31], v[8:11], a[32:39], v3
v_smfmac_f32_16x16x64_bf16 v[32:35], v[8:11], a[64:71], v3
v_smfmac_f32_16x16x64_bf16 v[36:39], v[8:11], a[96:103], v3
s_bitset0_b32 s32, 0
s_branch m_s2_al11
m_s2_ah21:
v_smfmac_f32_16x16x64_bf16 v[24:27], v[12:15], a[8:15], v3
v_smfmac_f32_16x16x64_bf16 v[28:31], v[12:15], a[40:47], v3
v_smfmac_f32_16x16x64_bf16 v[32:35], v[12:15], a[72:79], v3
v_smfmac_f32_16x16x64_bf16 v[36:39], v[12:15], a[104:111], v3
s_bitset0_b32 s32, 1
s_branch m_s2_al12
m_s2_ah22:
v_smfmac_f32_16x16x64_bf16 v[24:27], v[16:19], a[16:23], v3
v_smfmac_f32_16x16x64_bf16 v[28:31], v[16:19], a[48:55], v3
v_smfmac_f32_16x16x64_bf16 v[32:35], v[16:19], a[80:87], v3
v_smfmac_f32_16x16x64_bf16 v[36:39], v[16:19], a[112:119], v3
s_bitset0_b32 s32, 2
s_branch m_s2_al13
m_s2_ah23:
v_smfmac_f32_16x16x64_bf16 v[24:27], v[20:23], a[24:31], v3
v_smfmac_f32_16x16x64_bf16 v[28:31], v[20:23], a[56:63], v3
v_smfmac_f32_16x16x64_bf16 v[32:35], v[20:23], a[88:95], v3
v_smfmac_f32_16x16x64_bf16 v[36:39], v[20:23], a[120:127], v3
s_bitset0_b32 s32, 3
s_branch m_s2_al10
m_s2_al30:
s_bitcmp1_b32 s32, 0
s_cbranch_scc0 m_s2_al31
s_waitcnt vmcnt(2)
v_cmp_eq_u32 vcc, -1, v8
s_cbranch_vccz m_s2_ah30
s_cmp_eq_u32 s17, 0
s_cbranch_scc1 m_s2_ah30
s_sub_u32 s17, s17, 1
buffer_load_dwordx4 v[8:11], v56, s[4:7], s19 offen offset:0 sc1
m_s2_al31:
s_bitcmp1_b32 s32, 1
s_cbranch_scc0 m_s2_al32
s_waitcnt vmcnt(2)
v_cmp_eq_u32 vcc, -1, v12
s_cbranch_vccz m_s2_ah31
s_cmp_eq_u32 s17, 0
s_cbranch_scc1 m_s2_ah31
s_sub_u32 s17, s17, 1
buffer_load_dwordx4 v[12:15], v56, s[4:7], s19 offen offset:1024 sc1
m_s2_al32:
s_bitcmp1_b32 s32, 2
s_cbranch_scc0 m_s2_al33
s_waitcnt vmcnt(2)
v_cmp_eq_u32 vcc, -1, v16
s_cbranch_vccz m_s2_ah32
s_cmp_eq_u32 s17, 0
s_cbranch_scc1 m_s2_ah32
s_sub_u32 s17, s17, 1
buffer_load_dwordx4 v[16:19], v56, s[4:7], s19 offen offset:2048 sc1
m_s2_al33:
s_bitcmp1_b32 s32, 3
s_cbranch_scc0 m_s2_al30
s_waitcnt vmcnt(2)
v_cmp_eq_u32 vcc, -1, v20
s_cbranch_vccz m_s2_ah33
s_cmp_eq_u32 s17, 0
s_cbranch_scc1 m_s2_ah33
s_sub_u32 s17, s17, 1
buffer_load_dwordx4 v[20:23], v56, s[4:7], s19 offen offset:3072 sc1
s_branch m_s2_al30
m_s2_ah30:
v_smfmac_f32_16x16x64_bf16 v[24:27], v[8:11], a[0:7], v3
v_smfmac_f32_16x16x64_bf16 v[28:31], v[8:11], a[32:39], v3
v_smfmac_f32_16x16x64_bf16 v[32:35], v[8:11], a[64:71], v3
v_smfmac_f32_16x16x64_bf16 v[36:39], v[8:11], a[96:103], v3
s_bitset0_b32 s32, 0
s_branch m_s2_al21
m_s2_ah31:
v_smfmac_f32_16x16x64_bf16 v[24:27], v[12:15], a[8:15], v3
v_smfmac_f32_16x16x64_bf16 v[28:31], v[12:15], a[40:47], v3
v_smfmac_f32_16x16x64_bf16 v[32:35], v[12:15], a[72:79], v3
v_smfmac_f32_16x16x64_bf16 v[36:39], v[12:15], a[104:111], v3
s_bitset0_b32 s32, 1
s_branch m_s2_al22
m_s2_ah32:
v_smfmac_f32_16x16x64_bf16 v[24:27], v[16:19], a[16:23], v3
v_smfmac_f32_16x16x64_bf16 v[28:31], v[16:19], a[48:55], v3
v_smfmac_f32_16x16x64_bf16 v[32:35], v[16:19], a[80:87], v3
v_smfmac_f32_16x16x64_bf16 v[36:39], v[16:19], a[112:119], v3
s_bitset0_b32 s32, 2
s_branch m_s2_al23
m_s2_ah33:
v_smfmac_f32_16x16x64_bf16 v[24:27], v[20:23], a[24:31], v3
v_smfmac_f32_16x16x64_bf16 v[28:31], v[20:23], a[56:63], v3
v_smfmac_f32_16x16x64_bf16 v[32:35], v[20:23], a[88:95], v3
v_smfmac_f32_16x16x64_bf16 v[36:39], v[20:23], a[120:127], v3
s_bitset0_b32 s32, 3
s_branch m_s2_al20
m_s2_al40:
s_waitcnt vmcnt(3)
v_cmp_eq_u32 vcc, -1, v8
s_cbranch_vccz m_s2_ah40
s_cmp_eq_u32 s17, 0
s_cbranch_scc1 m_s2_ah40
s_sub_u32 s17, s17, 1
buffer_load_dwordx4 v[8:11], v56, s[4:7], s19 offen offset:0 sc1
m_s2_al41:
s_waitcnt vmcnt(3)
v_cmp_eq_u32 vcc, -1, v12
s_cbranch_vccz m_s2_ah41
s_cmp_eq_u32 s17, 0
s_cbranch_scc1 m_s2_ah41
s_sub_u32 s17, s17, 1
buffer_load_dwordx4 v[12:15], v56, s[4:7], s19 offen offset:1024 sc1
m_s2_al42:
s_waitcnt vmcnt(3)
v_cmp_eq_u32 vcc, -1, v16
s_cbranch_vccz m_s2_ah42
s_cmp_eq_u32 s17, 0
s_cbranch_scc1 m_s2_ah42
s_sub_u32 s17, s17, 1
buffer_load_dwordx4 v[16:19], v56, s[4:7], s19 offen offset:2048 sc1
m_s2_al43:
s_waitcnt vmcnt(3)
v_cmp_eq_u32 vcc, -1, v20
s_cbranch_vccz m_s2_ah43
s_cmp_eq_u32 s17, 0
s_cbranch_scc1 m_s2_ah43
s_sub_u32 s17, s17, 1
buffer_load_dwordx4 v[20:23], v56, s[4:7], s19 offen offset:3072 sc1
s_branch m_s2_al40
m_s2_ah40:
v_smfmac_f32_16x16x64_bf16 v[24:27], v[8:11], a[0:7], v3
v_smfmac_f32_16x16x64_bf16 v[28:31], v[8:11], a[32:39], v3
v_smfmac_f32_16x16x64_bf16 v[32:35], v[8:11], a[64:71], v3
v_smfmac_f32_16x16x64_bf16 v[36:39], v[8:11], a[96:103], v3
s_bitset0_b32 s32, 0
s_branch m_s2_al31
m_s2_ah41:
v_smfmac_f32_16x16x64_bf16 v[24:27], v[12:15], a[8:15], v3
v_smfmac_f32_16x16x64_bf16 v[28:31], v[12:15], a[40:47], v3
v_smfmac_f32_16x16x64_bf16 v[32:35], v[12:15], a[72:79], v3
v_smfmac_f32_16x16x64_bf16 v[36:39], v[12:15], a[104:111], v3
s_bitset0_b32 s32, 1
s_branch m_s2_al32
m_s2_ah42:
v_smfmac_f32_16x16x64_bf16 v[24:27], v[16:19], a[16:23], v3
v_smfmac_f32_16x16x64_bf16 v[28:31], v[16:19], a[48:55], v3
v_smfmac_f32_16x16x64_bf16 v[32:35], v[16:19], a[80:87], v3
v_smfmac_f32_16x16x64_bf16 v[36:39], v[16:19], a[112:119], v3
s_bitset0_b32 s32, 2
s_branch m_s2_al33
m_s2_ah43:
v_smfmac_f32_16x16x64_bf16 v[24:27], v[20:23], a[24:31], v3
v_smfmac_f32_16x16x64_bf16 v[28:31], v[20:23], a[56:63], v3
v_smfmac_f32_16x16x64_bf16 v[32:35], v[20:23], a[88:95], v3
v_smfmac_f32_16x16x64_bf16 v[36:39], v[20:23], a[120:127], v3
s_bitset0_b32 s32, 3
s_branch m_s2_al30
m_s2_om0:
s_mov_b32 s32, 15
s_cmp_eq_u32 s17, 0
s_cbranch_scc1 m_s2_oh40
s_sub_u32 s17, s17, 1
buffer_load_dwordx4 v[8:11], v57, s[4:7], s19 offen offset:0 sc1
s_branch m_s2_ol41
m_s2_om1:
v_smfmac_f32_16x16x64_bf16 v[52:55], v[8:11], a[224:231], v3
s_mov_b32 s32, 14
s_cmp_eq_u32 s17, 0
s_cbranch_scc1 m_s2_oh31
s_sub_u32 s17, s17, 1
buffer_load_dwordx4 v[12:15], v57, s[4:7], s19 offen offset:1024 sc1
s_branch m_s2_ol32
m_s2_om2:
v_smfmac_f32_16x16x64_bf16 v[52:55], v[12:15], a[232:239], v3
s_mov_b32 s32, 12
s_cmp_eq_u32 s17, 0
s_cbranch_scc1 m_s2_oh22
s_sub_u32 s17, s17, 1
buffer_load_dwordx4 v[16:19], v57, s[4:7], s19 offen offset:2048 sc1
s_branch m_s2_ol23
m_s2_om3:
v_smfmac_f32_16x16x64_bf16 v[52:55], v[16:19], a[240:247], v3
s_mov_b32 s32, 8
s_cmp_eq_u32 s17, 0
s_cbranch_scc1 m_s2_oh13
s_sub_u32 s17, s17, 1
buffer_load_dwordx4 v[20:23], v57, s[4:7], s19 offen offset:3072 sc1
s_branch m_s2_ol10
m_s2_ol10:
s_bitcmp1_b32 s32, 0
s_cbranch_scc0 m_s2_ol11
s_waitcnt vmcnt(0)
v_cmp_eq_u32 vcc, -1, v8
s_cbranch_vccz m_s2_oh10
s_cmp_eq_u32 s17, 0
s_cbranch_scc1 m_s2_oh10
s_sub_u32 s17, s17, 1
buffer_load_dwordx4 v[8:11], v57, s[4:7], s19 offen offset:0 sc1
m_s2_ol11:
s_bitcmp1_b32 s32, 1
s_cbranch_scc0 m_s2_ol12
s_waitcnt vmcnt(0)
v_cmp_eq_u32 vcc, -1, v12
s_cbranch_vccz m_s2_oh11
s_cmp_eq_u32 s17, 0
s_cbranch_scc1 m_s2_oh11
s_sub_u32 s17, s17, 1
buffer_load_dwordx4 v[12:15], v57, s[4:7], s19 offen offset:1024 sc1
m_s2_ol12:
s_bitcmp1_b32 s32, 2
s_cbranch_scc0 m_s2_ol13
s_waitcnt vmcnt(0)
v_cmp_eq_u32 vcc, -1, v16
s_cbranch_vccz m_s2_oh12
s_cmp_eq_u32 s17, 0
s_cbranch_scc1 m_s2_oh12
s_sub_u32 s17, s17, 1
buffer_load_dwordx4 v[16:19], v57, s[4:7], s19 offen offset:2048 sc1
m_s2_ol13:
s_bitcmp1_b32 s32, 3
s_cbranch_scc0 m_s2_ol10
s_waitcnt vmcnt(0)
v_cmp_eq_u32 vcc, -1, v20
s_cbranch_vccz m_s2_oh13
s_cmp_eq_u32 s17, 0
s_cbranch_scc1 m_s2_oh13
s_sub_u32 s17, s17, 1
buffer_load_dwordx4 v[20:23], v57, s[4:7], s19 offen offset:3072 sc1
s_branch m_s2_ol10
m_s2_oh10:
v_smfmac_f32_16x16x64_bf16 v[48:51], v[8:11], a[192:199], v3
v_smfmac_f32_16x16x64_bf16 v[52:55], v[8:11], a[224:231], v3
s_branch m_s2_ob
m_s2_oh11:
v_smfmac_f32_16x16x64_bf16 v[48:51], v[12:15], a[200:207], v3
v_smfmac_f32_16x16x64_bf16 v[52:55], v[12:15], a[232:239], v3
s_branch m_s2_ob
m_s2_oh12:
v_smfmac_f32_16x16x64_bf16 v[48:51], v[16:19], a[208:215], v3
v_smfmac_f32_16x16x64_bf16 v[52:55], v[16:19], a[240:247], v3
s_branch m_s2_ob
m_s2_oh13:
v_smfmac_f32_16x16x64_bf16 v[48:51], v[20:23], a[216:223], v3
v_smfmac_f32_16x16x64_bf16 v[52:55], v[20:23], a[248:255], v3
s_branch m_s2_ob
m_s2_ol20:
s_bitcmp1_b32 s32, 0
s_cbranch_scc0 m_s2_ol21
s_waitcnt vmcnt(1)
v_cmp_eq_u32 vcc, -1, v8
s_cbranch_vccz m_s2_oh20
s_cmp_eq_u32 s17, 0
s_cbranch_scc1 m_s2_oh20
s_sub_u32 s17, s17, 1
buffer_load_dwordx4 v[8:11], v57, s[4:7], s19 offen offset:0 sc1
m_s2_ol21:
s_bitcmp1_b32 s32, 1
s_cbranch_scc0 m_s2_ol22
s_waitcnt vmcnt(1)
v_cmp_eq_u32 vcc, -1, v12
s_cbranch_vccz m_s2_oh21
s_cmp_eq_u32 s17, 0
s_cbranch_scc1 m_s2_oh21
s_sub_u32 s17, s17, 1
buffer_load_dwordx4 v[12:15], v57, s[4:7], s19 offen offset:1024 sc1
m_s2_ol22:
s_bitcmp1_b32 s32, 2
s_cbranch_scc0 m_s2_ol23
s_waitcnt vmcnt(1)
v_cmp_eq_u32 vcc, -1, v16
s_cbranch_vccz m_s2_oh22
s_cmp_eq_u32 s17, 0
s_cbranch_scc1 m_s2_oh22
s_sub_u32 s17, s17, 1
buffer_load_dwordx4 v[16:19], v57, s[4:7], s19 offen offset:2048 sc1
m_s2_ol23:
s_bitcmp1_b32 s32, 3
s_cbranch_scc0 m_s2_ol20
s_waitcnt vmcnt(1)
v_cmp_eq_u32 vcc, -1, v20
s_cbranch_vccz m_s2_oh23
s_cmp_eq_u32 s17, 0
s_cbranch_scc1 m_s2_oh23
s_sub_u32 s17, s17, 1
buffer_load_dwordx4 v[20:23], v57, s[4:7], s19 offen offset:3072 sc1
s_branch m_s2_ol20
m_s2_oh20:
v_smfmac_f32_16x16x64_bf16 v[48:51], v[8:11], a[192:199], v3
v_smfmac_f32_16x16x64_bf16 v[52:55], v[8:11], a[224:231], v3
s_bitset0_b32 s32, 0
s_branch m_s2_ol11
m_s2_oh21:
v_smfmac_f32_16x16x64_bf16 v[48:51], v[12:15], a[200:207], v3
v_smfmac_f32_16x16x64_bf16 v[52:55], v[12:15], a[232:239], v3
s_bitset0_b32 s32, 1
s_branch m_s2_ol12
m_s2_oh22:
v_smfmac_f32_16x16x64_bf16 v[48:51], v[16:19], a[208:215], v3
v_smfmac_f32_16x16x64_bf16 v[52:55], v[16:19], a[240:247], v3
s_bitset0_b32 s32, 2
s_branch m_s2_ol13
m_s2_oh23:
v_smfmac_f32_16x16x64_bf16 v[48:51], v[20:23], a[216:223], v3
v_smfmac_f32_16x16x64_bf16 v[52:55], v[20:23], a[248:255], v3
s_bitset0_b32 s32, 3
s_branch m_s2_ol10
m_s2_ol30:
s_bitcmp1_b32 s32, 0
s_cbranch_scc0 m_s2_ol31
s_waitcnt vmcnt(2)
v_cmp_eq_u32 vcc, -1, v8
s_cbranch_vccz m_s2_oh30
s_cmp_eq_u32 s17, 0
s_cbranch_scc1 m_s2_oh30
s_sub_u32 s17, s17, 1
buffer_load_dwordx4 v[8:11], v57, s[4:7], s19 offen offset:0 sc1
m_s2_ol31:
s_bitcmp1_b32 s32, 1
s_cbranch_scc0 m_s2_ol32
s_waitcnt vmcnt(2)
v_cmp_eq_u32 vcc, -1, v12
s_cbranch_vccz m_s2_oh31
s_cmp_eq_u32 s17, 0
s_cbranch_scc1 m_s2_oh31
s_sub_u32 s17, s17, 1
buffer_load_dwordx4 v[12:15], v57, s[4:7], s19 offen offset:1024 sc1
m_s2_ol32:
s_bitcmp1_b32 s32, 2
s_cbranch_scc0 m_s2_ol33
s_waitcnt vmcnt(2)
v_cmp_eq_u32 vcc, -1, v16
s_cbranch_vccz m_s2_oh32
s_cmp_eq_u32 s17, 0
s_cbranch_scc1 m_s2_oh32
s_sub_u32 s17, s17, 1
buffer_load_dwordx4 v[16:19], v57, s[4:7], s19 offen offset:2048 sc1
m_s2_ol33:
s_bitcmp1_b32 s32, 3
s_cbranch_scc0 m_s2_ol30
s_waitcnt vmcnt(2)
v_cmp_eq_u32 vcc, -1, v20
s_cbranch_vccz m_s2_oh33
s_cmp_eq_u32 s17, 0
s_cbranch_scc1 m_s2_oh33
s_sub_u32 s17, s17, 1
buffer_load_dwordx4 v[20:23], v57, s[4:7], s19 offen offset:3072 sc1
s_branch m_s2_ol30
m_s2_oh30:
v_smfmac_f32_16x16x64_bf16 v[48:51], v[8:11], a[192:199], v3
v_smfmac_f32_16x16x64_bf16 v[52:55], v[8:11], a[224:231], v3
s_bitset0_b32 s32, 0
s_branch m_s2_ol21
m_s2_oh31:
v_smfmac_f32_16x16x64_bf16 v[48:51], v[12:15], a[200:207], v3
v_smfmac_f32_16x16x64_bf16 v[52:55], v[12:15], a[232:239], v3
s_bitset0_b32 s32, 1
s_branch m_s2_ol22
m_s2_oh32:
v_smfmac_f32_16x16x64_bf16 v[48:51], v[16:19], a[208:215], v3
v_smfmac_f32_16x16x64_bf16 v[52:55], v[16:19], a[240:247], v3
s_bitset0_b32 s32, 2
s_branch m_s2_ol23
m_s2_oh33:
v_smfmac_f32_16x16x64_bf16 v[48:51], v[20:23], a[216:223], v3
v_smfmac_f32_16x16x64_bf16 v[52:55], v[20:23], a[248:255], v3
s_bitset0_b32 s32, 3
s_branch m_s2_ol20
m_s2_ol40:
s_waitcnt vmcnt(3)
v_cmp_eq_u32 vcc, -1, v8
s_cbranch_vccz m_s2_oh40
s_cmp_eq_u32 s17, 0
s_cbranch_scc1 m_s2_oh40
s_sub_u32 s17, s17, 1
buffer_load_dwordx4 v[8:11], v57, s[4:7], s19 offen offset:0 sc1
m_s2_ol41:
s_waitcnt vmcnt(3)
v_cmp_eq_u32 vcc, -1, v12
s_cbranch_vccz m_s2_oh41
s_cmp_eq_u32 s17, 0
s_cbranch_scc1 m_s2_oh41
s_sub_u32 s17, s17, 1
buffer_load_dwordx4 v[12:15], v57, s[4:7], s19 offen offset:1024 sc1
m_s2_ol42:
s_waitcnt vmcnt(3)
v_cmp_eq_u32 vcc, -1, v16
s_cbranch_vccz m_s2_oh42
s_cmp_eq_u32 s17, 0
s_cbranch_scc1 m_s2_oh42
s_sub_u32 s17, s17, 1
buffer_load_dwordx4 v[16:19], v57, s[4:7], s19 offen offset:2048 sc1
m_s2_ol43:
s_waitcnt vmcnt(3)
v_cmp_eq_u32 vcc, -1, v20
s_cbranch_vccz m_s2_oh43
s_cmp_eq_u32 s17, 0
s_cbranch_scc1 m_s2_oh43
s_sub_u32 s17, s17, 1
buffer_load_dwordx4 v[20:23], v57, s[4:7], s19 offen offset:3072 sc1
s_branch m_s2_ol40
m_s2_oh40:
v_smfmac_f32_16x16x64_bf16 v[48:51], v[8:11], a[192:199], v3
v_smfmac_f32_16x16x64_bf16 v[52:55], v[8:11], a[224:231], v3
s_bitset0_b32 s32, 0
s_branch m_s2_ol31
m_s2_oh41:
v_smfmac_f32_16x16x64_bf16 v[48:51], v[12:15], a[200:207], v3
v_smfmac_f32_16x16x64_bf16 v[52:55], v[12:15], a[232:239], v3
s_bitset0_b32 s32, 1
s_branch m_s2_ol32
m_s2_oh42:
v_smfmac_f32_16x16x64_bf16 v[48:51], v[16:19], a[208:215], v3
v_smfmac_f32_16x16x64_bf16 v[52:55], v[16:19], a[240:247], v3
s_bitset0_b32 s32, 2
s_branch m_s2_ol33
m_s2_oh43:
v_smfmac_f32_16x16x64_bf16 v[48:51], v[20:23], a[216:223], v3
v_smfmac_f32_16x16x64_bf16 v[52:55], v[20:23], a[248:255], v3
s_bitset0_b32 s32, 3
s_branch m_s2_ol30
m_s2_fin:
s_lshr_b32 s29, s23, 8
s_xor_b32 s29, s29, s65
s_and_b32 s29, s29, 8192
s_add_u32 s29, s29, s23
buffer_store_dwordx4 v[100:103], v66, s[4:7], s29 offen sc1
s_add_u32 s23, s23, 131072
s_waitcnt vmcnt(0)
s_barrier
s_branch m_recdone
m_gemm:
s_cmp_lg_u32 s14, 3
s_cbranch_scc1 m_g0
s_waitcnt vmcnt(0)
v_readfirstlane_b32 s28, v131
s_lshl_b32 s29, s56, 2
s_add_u32 s29, s29, 128
s_add_u32 s28, s28, s57
s_and_b32 s30, s28, 255
s_lshr_b32 s28, s28, 8
s_add_u32 s28, s28, 256
s_lshl_b32 s31, s58, 8
s_or_b32 s30, s30, s31
s_cmp_eq_u32 s30, 32
s_cselect_b32 s29, s29, 2147483648
v_mov_b32 v131, s28
s_cmp_eq_u32 s14, 3
s_cselect_b32 s29, s29, 2147483648
v_mov_b32 v130, 2147483648
v_writelane_b32 v130, s29, 0
buffer_store_dword v131, v130, s[72:75], 0 offen sc1
m_g0:
s_mov_b32 s24, 0
v_lshrrev_b32 v15, 1, v4
v_and_b32 v14, 1, v4
v_lshl_add_u32 v14, v14, 1, v15
v_lshl_add_u32 v14, v14, 9, v7
v_lshl_add_u32 v7, v4, 9, v7
v_cvt_pk_bf16_f32 v16, v64, v65
v_cvt_pk_bf16_f32 v17, v66, v67
v_cvt_pk_bf16_f32 v18, v68, v69
v_cvt_pk_bf16_f32 v19, v70, v71
s_nop 0
v_permlane16_swap_b32 v16, v18
v_permlane16_swap_b32 v17, v19
buffer_store_dwordx4 v[16:19], v7, s[4:7], s24 offen offset:0 sc1
v_cvt_pk_bf16_f32 v20, v72, v73
v_cvt_pk_bf16_f32 v21, v74, v75
v_cvt_pk_bf16_f32 v22, v76, v77
v_cvt_pk_bf16_f32 v23, v78, v79
s_nop 0
v_permlane16_swap_b32 v20, v22
v_permlane16_swap_b32 v21, v23
buffer_store_dwordx4 v[20:23], v7, s[4:7], s24 offen offset:2048 sc1
s_add_u32 s24, s24, 4096
v_cvt_pk_bf16_f32 v24, v80, v81
v_cvt_pk_bf16_f32 v25, v82, v83
v_cvt_pk_bf16_f32 v26, v84, v85
v_cvt_pk_bf16_f32 v27, v86, v87
s_nop 0
v_permlane16_swap_b32 v24, v26
v_permlane16_swap_b32 v25, v27
buffer_store_dwordx4 v[24:27], v7, s[4:7], s24 offen offset:0 sc1
v_cvt_pk_bf16_f32 v28, v88, v89
v_cvt_pk_bf16_f32 v29, v90, v91
v_cvt_pk_bf16_f32 v30, v92, v93
v_cvt_pk_bf16_f32 v31, v94, v95
s_nop 0
v_permlane16_swap_b32 v28, v30
v_permlane16_swap_b32 v29, v31
buffer_store_dwordx4 v[28:31], v7, s[4:7], s24 offen offset:2048 sc1
s_add_u32 s24, s24, 4096
v_cvt_pk_bf16_f32 v32, v96, v97
v_cvt_pk_bf16_f32 v33, v98, v99
v_cvt_pk_bf16_f32 v34, v100, v101
v_cvt_pk_bf16_f32 v35, v102, v103
s_nop 0
v_permlane16_swap_b32 v32, v34
v_permlane16_swap_b32 v33, v35
buffer_store_dwordx4 v[32:35], v7, s[4:7], s24 offen offset:0 sc1
v_cvt_pk_bf16_f32 v36, v104, v105
v_cvt_pk_bf16_f32 v37, v106, v107
v_cvt_pk_bf16_f32 v38, v108, v109
v_cvt_pk_bf16_f32 v39, v110, v111
s_nop 0
v_permlane16_swap_b32 v36, v38
v_permlane16_swap_b32 v37, v39
buffer_store_dwordx4 v[36:39], v7, s[4:7], s24 offen offset:2048 sc1
s_add_u32 s24, s24, 4096
v_cvt_pk_bf16_f32 v40, v112, v113
v_cvt_pk_bf16_f32 v41, v114, v115
v_cvt_pk_bf16_f32 v42, v116, v117
v_cvt_pk_bf16_f32 v43, v118, v119
s_nop 0
v_permlane16_swap_b32 v40, v42
v_permlane16_swap_b32 v41, v43
buffer_store_dwordx4 v[40:43], v7, s[4:7], s24 offen offset:0 sc1
v_cvt_pk_bf16_f32 v44, v120, v121
v_cvt_pk_bf16_f32 v45, v122, v123
v_cvt_pk_bf16_f32 v46, v124, v125
v_cvt_pk_bf16_f32 v47, v126, v127
s_nop 0
v_permlane16_swap_b32 v44, v46
v_permlane16_swap_b32 v45, v47
buffer_store_dwordx4 v[44:47], v7, s[4:7], s24 offen offset:2048 sc1
s_add_u32 s24, s24, 4096
s_sub_u32 s24, s16, 16
s_cmp_ge_u32 s24, 16
s_cbranch_scc1 m_x2
s_mov_b32 s24, 176160768
v_cvt_pk_bf16_f32 v128, v64, v65
v_cvt_pk_bf16_f32 v130, v66, v67
v_cvt_pk_bf16_f32 v129, v68, v69
v_cvt_pk_bf16_f32 v131, v70, v71
s_nop 0
v_permlane32_swap_b32 v128, v129
v_permlane32_swap_b32 v130, v131
buffer_store_dwordx4 v[128:131], v14, s[4:7], s24 offen offset:0 sc1
v_cvt_pk_bf16_f32 v132, v72, v73
v_cvt_pk_bf16_f32 v134, v74, v75
v_cvt_pk_bf16_f32 v133, v76, v77
v_cvt_pk_bf16_f32 v135, v78, v79
s_nop 0
v_permlane32_swap_b32 v132, v133
v_permlane32_swap_b32 v134, v135
buffer_store_dwordx4 v[132:135], v14, s[4:7], s24 offen offset:2048 sc1
s_add_u32 s24, s24, 4096
v_cvt_pk_bf16_f32 v136, v80, v81
v_cvt_pk_bf16_f32 v138, v82, v83
v_cvt_pk_bf16_f32 v137, v84, v85
v_cvt_pk_bf16_f32 v139, v86, v87
s_nop 0
v_permlane32_swap_b32 v136, v137
v_permlane32_swap_b32 v138, v139
buffer_store_dwordx4 v[136:139], v14, s[4:7], s24 offen offset:0 sc1
v_cvt_pk_bf16_f32 v140, v88, v89
v_cvt_pk_bf16_f32 v142, v90, v91
v_cvt_pk_bf16_f32 v141, v92, v93
v_cvt_pk_bf16_f32 v143, v94, v95
s_nop 0
v_permlane32_swap_b32 v140, v141
v_permlane32_swap_b32 v142, v143
buffer_store_dwordx4 v[140:143], v14, s[4:7], s24 offen offset:2048 sc1
s_add_u32 s24, s24, 4096
v_cvt_pk_bf16_f32 v144, v96, v97
v_cvt_pk_bf16_f32 v146, v98, v99
v_cvt_pk_bf16_f32 v145, v100, v101
v_cvt_pk_bf16_f32 v147, v102, v103
s_nop 0
v_permlane32_swap_b32 v144, v145
v_permlane32_swap_b32 v146, v147
buffer_store_dwordx4 v[144:147], v14, s[4:7], s24 offen offset:0 sc1
v_cvt_pk_bf16_f32 v148, v104, v105
v_cvt_pk_bf16_f32 v150, v106, v107
v_cvt_pk_bf16_f32 v149, v108, v109
v_cvt_pk_bf16_f32 v151, v110, v111
s_nop 0
v_permlane32_swap_b32 v148, v149
v_permlane32_swap_b32 v150, v151
buffer_store_dwordx4 v[148:151], v14, s[4:7], s24 offen offset:2048 sc1
s_add_u32 s24, s24, 4096
v_cvt_pk_bf16_f32 v152, v112, v113
v_cvt_pk_bf16_f32 v154, v114, v115
v_cvt_pk_bf16_f32 v153, v116, v117
v_cvt_pk_bf16_f32 v155, v118, v119
s_nop 0
v_permlane32_swap_b32 v152, v153
v_permlane32_swap_b32 v154, v155
buffer_store_dwordx4 v[152:155], v14, s[4:7], s24 offen offset:0 sc1
v_cvt_pk_bf16_f32 v156, v120, v121
v_cvt_pk_bf16_f32 v158, v122, v123
v_cvt_pk_bf16_f32 v157, v124, v125
v_cvt_pk_bf16_f32 v159, v126, v127
s_nop 0
v_permlane32_swap_b32 v156, v157
v_permlane32_swap_b32 v158, v159
buffer_store_dwordx4 v[156:159], v14, s[4:7], s24 offen offset:2048 sc1
s_add_u32 s24, s24, 4096
m_x2:
s_waitcnt vmcnt(0)
s_barrier
s_cmp_lg_u32 s14, 3
s_cbranch_scc1 m_ga
s_cmp_eq_u32 s58, 0
s_cbranch_scc1 m_ga_f
s_mov_b32 s30, 168
v_mov_b32 v97, 1
v_mov_b32 v96, 2147483648
v_writelane_b32 v96, s30, 0
buffer_atomic_add v97, v96, s[72:75], 0 offen sc1
s_branch m_ga
m_ga_f:
s_lshl_b32 s30, s56, 4
s_add_u32 s30, s30, 8
v_mov_b32 v97, 1
v_mov_b32 v96, 2147483648
v_writelane_b32 v96, s30, 0
buffer_atomic_add v97, v96, s[72:75], 0 offen sc0
s_lshl_b32 s29, s12, 2
s_add_u32 s29, s29, 172
s_waitcnt vmcnt(0)
v_readfirstlane_b32 s28, v97
v_mov_b32 v97, 1
s_cmp_eq_u32 s28, 31
s_cselect_b32 s29, s29, 2147483648
v_mov_b32 v96, 2147483648
v_writelane_b32 v96, s29, 0
buffer_store_dword v97, v96, s[72:75], 0 offen sc1
m_ga:
s_sub_u32 s24, s14, 1
s_cmp_ge_u32 s24, 2
s_cbranch_scc1 m_gb
s_lshl_b32 s25, s16, 1
s_add_u32 s24, s24, s25
s_lshl_b32 s24, s24, 15
v_lshlrev_b32 v200, 7, v0
buffer_load_dword v201, v200, s[52:55], s24 offen
s_add_u32 s24, s24, 8192
buffer_load_dword v201, v200, s[52:55], s24 offen
s_add_u32 s24, s24, 8192
buffer_load_dword v201, v200, s[52:55], s24 offen
s_add_u32 s24, s24, 8192
buffer_load_dword v201, v200, s[52:55], s24 offen
s_waitcnt vmcnt(0)
m_gb:
v_mov_b32 v98, 131648
s_cmp_lg_u32 s14, 0
s_cbranch_scc1 m_gm_w
s_cmp_eq_u32 s13, 0
s_cbranch_scc1 m_gm_s
s_cmp_lg_u32 s58, 0
s_cbranch_scc1 m_gm_s
s_lshl_b32 s31, s56, 5
s_add_u32 s31, s31, s13
s_lshl_b32 s31, s31, 7
s_add_u32 s31, s31, 171048960
m_gm_m:
s_mov_b32 s30, 12
m_gm_q:
s_load_dword s59, s[4:5], s31 glc
s_waitcnt lgkmcnt(0)
s_cmp_lg_u32 s59, 0
s_cbranch_scc1 m_gm_d
s_sub_u32 s30, s30, 1
s_cbranch_scc0 m_gm_q
v_mov_b32 v96, 160
buffer_load_dword v97, v96, s[72:75], 0 offen sc1
s_mov_b32 s59, 3
s_waitcnt vmcnt(0)
v_readfirstlane_b32 s30, v97
s_cmp_lg_u32 s30, 0
s_cbranch_scc1 m_gm_d
s_mov_b32 s59, 1
s_cmp_eq_u32 s17, 0
s_cbranch_scc1 m_gm_d
s_sub_u32 s17, s17, 1
s_branch m_gm_m
m_gm_s:
v_lshlrev_b32 v96, 2, v0
v_add_u32 v96, 128, v96
v_mov_b32 v97, 2147483648
v_cmp_gt_u32 vcc, 16, v0
s_nop 1
v_cndmask_b32 v96, v97, v96, vcc
m_gm_l:
buffer_load_dword v97, v96, s[72:75], 0 offen sc1
s_waitcnt vmcnt(0)
v_cmp_ne_u32 vcc, 0, v97
v_readlane_b32 s30, v97, 10
s_mov_b32 s59, 1
s_cmp_eq_u32 s58, 0
s_cbranch_scc1 m_gm_f
s_cmp_ge_u32 s30, 256
s_cbranch_scc1 m_gm_d
s_branch m_gm_a
m_gm_f:
s_mov_b32 s59, 3
s_bitcmp1_b32 vcc_lo, 8
s_cbranch_scc1 m_gm_p
s_and_b32 s29, vcc_lo, 30975
s_cmp_eq_u32 s29, 30975
s_cbranch_scc1 m_gm_v
m_gm_a:
s_mov_b32 s59, 1
s_cmp_eq_u32 s17, 0
s_cbranch_scc1 m_gm_d
s_sub_u32 s17, s17, 1
s_branch m_gm_l
m_gm_v:
v_add_u32_dpp v97, v97, v97 row_shr:1 row_mask:0xf bank_mask:0xf bound_ctrl:0
s_nop 1
v_add_u32_dpp v97, v97, v97 row_shr:2 row_mask:0xf bank_mask:0xf bound_ctrl:0
s_nop 1
v_add_u32_dpp v97, v97, v97 row_shr:4 row_mask:0xf bank_mask:0xf bound_ctrl:0
s_nop 0
v_readlane_b32 s29, v97, 7
s_cmp_gt_u32 s29, 2176
s_cselect_b32 s59, 2, 1
m_gm_p:
v_mov_b32 v97, s59
s_lshl_b32 s31, s56, 5
s_lshl_b32 s31, s31, 7
s_add_u32 s31, s31, 171048960
v_lshl_add_u32 v100, v0, 7, s31
v_mov_b32 v102, 2147483648
v_cmp_gt_u32 vcc, 32, v0
s_nop 1
v_cndmask_b32 v100, v102, v100, vcc
buffer_store_dword v97, v100, s[4:7], 0 offen
m_gm_d:
v_mov_b32 v97, s59
ds_write_b32 v98, v97
s_waitcnt lgkmcnt(0)
m_gm_w:
s_barrier
ds_read_b32 v97, v98
s_xor_b32 s15, s58, 1
s_waitcnt lgkmcnt(0)
v_readfirstlane_b32 s59, v97
s_cmp_eq_u32 s59, 3
s_cbranch_scc1 m_fb
s_barrier
s_load_dwordx2 s[86:87], s[0:1], 24
s_load_dwordx2 s[88:89], s[0:1], 32
s_load_dwordx2 s[90:91], s[0:1], 16
s_load_dwordx2 s[92:93], s[0:1], 64
s_load_dwordx2 s[94:95], s[0:1], 72
s_load_dwordx2 s[96:97], s[0:1], 40
s_load_dwordx2 s[72:73], s[0:1], 80
s_lshr_b32 s35, s16, 5
s_lshr_b32 s32, s14, 1
s_and_b32 s33, s14, 1
s_and_b32 s34, s59, 2
s_lshl_b32 s34, s34, 12
s_mov_b32 s44, s4
s_mov_b32 s45, s5
s_mov_b32 s46, 268435456
s_mov_b32 s47, 0x20000
s_mov_b32 s50, 8388608
s_mov_b32 s51, 0x20000
s_mov_b32 s74, 4194304
s_mov_b32 s75, 0x20000
s_mov_b32 s36, 15
s_mov_b32 s37, 15
s_mov_b32 s38, 15
s_mov_b32 s39, 15
s_mov_b32 s40, 15
s_mov_b32 s41, 15
s_mov_b32 s42, 15
s_mov_b32 s43, 15
s_cmp_ge_u32 s16, 64
s_cbranch_scc1 m_g_ll_64_128
s_cmp_ge_u32 s16, 32
s_cbranch_scc1 m_g_ll_32_64
s_cmp_ge_u32 s16, 16
s_cbranch_scc1 m_g_ll_16_32
s_cmp_ge_u32 s16, 8
s_cbranch_scc1 m_g_ll_8_16
s_cmp_ge_u32 s16, 4
s_cbranch_scc1 m_g_ll_4_8
s_cmp_ge_u32 s16, 2
s_cbranch_scc1 m_g_ll_2_4
s_cmp_ge_u32 s16, 1
s_cbranch_scc1 m_g_ll_1_2
s_mov_b32 s24, 0x23
s_mov_b32 s25, 0x33
s_mov_b32 s36, 0xd3
s_mov_b32 s37, 0x20034
s_mov_b32 s38, 0x20035
s_mov_b32 s39, 0x79
s_branch m_g_ll_d
m_g_ll_1_2:
s_mov_b32 s24, 0xa3
s_mov_b32 s25, 0xb3
s_mov_b32 s36, 0x153
s_mov_b32 s37, 0x200b4
s_mov_b32 s38, 0x200b5
s_mov_b32 s39, 0xf9
s_branch m_g_ll_d
m_g_ll_2_4:
s_cmp_ge_u32 s16, 3
s_cbranch_scc1 m_g_ll_3_4
s_mov_b32 s24, 0x123
s_mov_b32 s25, 0x133
s_mov_b32 s36, 0x63
s_mov_b32 s37, 0x20134
s_mov_b32 s38, 0x20135
s_mov_b32 s39, 0x179
s_branch m_g_ll_d
m_g_ll_3_4:
s_mov_b32 s24, 0x1a3
s_mov_b32 s25, 0x1b3
s_mov_b32 s36, 0xe3
s_mov_b32 s37, 0x201b4
s_mov_b32 s38, 0x201b5
s_mov_b32 s39, 0x1f9
s_branch m_g_ll_d
m_g_ll_4_8:
s_cmp_ge_u32 s16, 6
s_cbranch_scc1 m_g_ll_6_8
s_cmp_ge_u32 s16, 5
s_cbranch_scc1 m_g_ll_5_6
s_mov_b32 s24, 0x30
s_mov_b32 s25, 0x163
s_mov_b32 s36, 0x22
s_mov_b32 s37, 0x18076
s_mov_b32 s38, 0xc00000b
s_mov_b32 s39, 0x400000b
s_mov_b32 s40, 0x300004a
s_branch m_g_ll_d
m_g_ll_5_6:
s_mov_b32 s24, 0xb0
s_mov_b32 s25, 0x73
s_mov_b32 s36, 0xa2
s_mov_b32 s37, 0x180f6
s_mov_b32 s38, 0x4c00000b
s_mov_b32 s39, 0x4400000b
s_mov_b32 s40, 0x300005a
s_branch m_g_ll_d
m_g_ll_6_8:
s_cmp_ge_u32 s16, 7
s_cbranch_scc1 m_g_ll_7_8
s_mov_b32 s24, 0x130
s_mov_b32 s25, 0xf3
s_mov_b32 s36, 0x122
s_mov_b32 s37, 0x18176
s_mov_b32 s38, 0x8c00000b
s_mov_b32 s39, 0x8400000b
s_mov_b32 s40, 0x300006a
s_branch m_g_ll_d
m_g_ll_7_8:
s_mov_b32 s24, 0x1b0
s_mov_b32 s25, 0x173
s_mov_b32 s36, 0x1a2
s_mov_b32 s37, 0x181f6
s_mov_b32 s38, 0xcc00000b
s_mov_b32 s39, 0xc400000b
s_mov_b32 s40, 0x300007a
s_branch m_g_ll_d
m_g_ll_8_16:
s_cmp_ge_u32 s16, 12
s_cbranch_scc1 m_g_ll_12_16
s_cmp_ge_u32 s16, 10
s_cbranch_scc1 m_g_ll_10_12
s_cmp_ge_u32 s16, 9
s_cbranch_scc1 m_g_ll_9_10
s_mov_b32 s24, 0x13
s_mov_b32 s25, 0x2
s_mov_b32 s36, 0x37
s_mov_b32 s37, 0x18066
s_mov_b32 s38, 0x300008a
s_branch m_g_ll_d
m_g_ll_9_10:
s_mov_b32 s24, 0x93
s_mov_b32 s25, 0x82
s_mov_b32 s36, 0xb7
s_mov_b32 s37, 0x180e6
s_mov_b32 s38, 0x300009a
s_branch m_g_ll_d
m_g_ll_10_12:
s_cmp_ge_u32 s16, 11
s_cbranch_scc1 m_g_ll_11_12
s_mov_b32 s24, 0x113
s_mov_b32 s25, 0x102
s_mov_b32 s36, 0x137
s_mov_b32 s37, 0x18166
s_mov_b32 s38, 0x30000aa
s_branch m_g_ll_d
m_g_ll_11_12:
s_mov_b32 s24, 0x193
s_mov_b32 s25, 0x182
s_mov_b32 s36, 0x1b7
s_mov_b32 s37, 0x181e6
s_mov_b32 s38, 0x30000ba
s_branch m_g_ll_d
m_g_ll_12_16:
s_cmp_ge_u32 s16, 14
s_cbranch_scc1 m_g_ll_14_16
s_cmp_ge_u32 s16, 13
s_cbranch_scc1 m_g_ll_13_14
s_mov_b32 s24, 0x20
s_mov_b32 s25, 0x12
s_mov_b32 s36, 0x70
s_mov_b32 s37, 0x47
s_mov_b32 s38, 0x18054
s_mov_b32 s39, 0x20055
s_branch m_g_ll_d
m_g_ll_13_14:
s_mov_b32 s24, 0xa0
s_mov_b32 s25, 0x92
s_mov_b32 s36, 0xf0
s_mov_b32 s37, 0xc7
s_mov_b32 s38, 0x180d4
s_mov_b32 s39, 0x200d5
s_branch m_g_ll_d
m_g_ll_14_16:
s_cmp_ge_u32 s16, 15
s_cbranch_scc1 m_g_ll_15_16
s_mov_b32 s24, 0x120
s_mov_b32 s25, 0x112
s_mov_b32 s36, 0x170
s_mov_b32 s37, 0x147
s_mov_b32 s38, 0x18154
s_mov_b32 s39, 0x20155
s_branch m_g_ll_d
m_g_ll_15_16:
s_mov_b32 s24, 0x1a0
s_mov_b32 s25, 0x192
s_mov_b32 s36, 0x1f0
s_mov_b32 s37, 0x1c7
s_mov_b32 s38, 0x181d4
s_mov_b32 s39, 0x201d5
s_branch m_g_ll_d
m_g_ll_16_32:
s_cmp_ge_u32 s16, 24
s_cbranch_scc1 m_g_ll_24_32
s_cmp_ge_u32 s16, 20
s_cbranch_scc1 m_g_ll_20_24
s_cmp_ge_u32 s16, 18
s_cbranch_scc1 m_g_ll_18_20
s_cmp_ge_u32 s16, 17
s_cbranch_scc1 m_g_ll_17_18
s_mov_b32 s24, 0x3
s_mov_b32 s25, 0x51
s_mov_b32 s36, 0x20004
s_mov_b32 s37, 0x20005
s_mov_b32 s38, 0x69
s_branch m_g_ll_d
m_g_ll_17_18:
s_mov_b32 s24, 0x83
s_mov_b32 s25, 0xd1
s_mov_b32 s36, 0x20084
s_mov_b32 s37, 0x20085
s_mov_b32 s38, 0xe9
s_branch m_g_ll_d
m_g_ll_18_20:
s_cmp_ge_u32 s16, 19
s_cbranch_scc1 m_g_ll_19_20
s_mov_b32 s24, 0x103
s_mov_b32 s25, 0x151
s_mov_b32 s36, 0x20104
s_mov_b32 s37, 0x20105
s_mov_b32 s38, 0x169
s_branch m_g_ll_d
m_g_ll_19_20:
s_mov_b32 s24, 0x183
s_mov_b32 s25, 0x1d1
s_mov_b32 s36, 0x20184
s_mov_b32 s37, 0x20185
s_mov_b32 s38, 0x1e9
s_branch m_g_ll_d
m_g_ll_20_24:
s_cmp_ge_u32 s16, 22
s_cbranch_scc1 m_g_ll_22_24
s_cmp_ge_u32 s16, 21
s_cbranch_scc1 m_g_ll_21_22
s_mov_b32 s24, 0x21
s_mov_b32 s25, 0x43
s_mov_b32 s36, 0x71
s_mov_b32 s37, 0x20024
s_mov_b32 s38, 0x20025
s_mov_b32 s39, 0x1400000b
s_mov_b32 s40, 0x300000a
s_branch m_g_ll_d
m_g_ll_21_22:
s_mov_b32 s24, 0xa1
s_mov_b32 s25, 0xc3
s_mov_b32 s36, 0xf1
s_mov_b32 s37, 0x200a4
s_mov_b32 s38, 0x200a5
s_mov_b32 s39, 0x5400000b
s_mov_b32 s40, 0x300001a
s_branch m_g_ll_d
m_g_ll_22_24:
s_cmp_ge_u32 s16, 23
s_cbranch_scc1 m_g_ll_23_24
s_mov_b32 s24, 0x121
s_mov_b32 s25, 0x143
s_mov_b32 s36, 0x171
s_mov_b32 s37, 0x20124
s_mov_b32 s38, 0x20125
s_mov_b32 s39, 0x9400000b
s_mov_b32 s40, 0x300002a
s_branch m_g_ll_d
m_g_ll_23_24:
s_mov_b32 s24, 0x1a1
s_mov_b32 s25, 0x53
s_mov_b32 s36, 0x1f1
s_mov_b32 s37, 0x201a4
s_mov_b32 s38, 0x201a5
s_mov_b32 s39, 0xd400000b
s_mov_b32 s40, 0x300003a
s_branch m_g_ll_d
m_g_ll_24_32:
s_cmp_ge_u32 s16, 28
s_cbranch_scc1 m_g_ll_28_32
s_cmp_ge_u32 s16, 26
s_cbranch_scc1 m_g_ll_26_28
s_cmp_ge_u32 s16, 25
s_cbranch_scc1 m_g_ll_25_26
s_mov_b32 s24, 0x31
s_mov_b32 s25, 0x61
s_mov_b32 s36, 0x20014
s_mov_b32 s37, 0x20015
s_mov_b32 s38, 0x57
s_mov_b32 s39, 0x30004ca
s_branch m_g_ll_d
m_g_ll_25_26:
s_mov_b32 s24, 0xb1
s_mov_b32 s25, 0xe1
s_mov_b32 s36, 0x20094
s_mov_b32 s37, 0x20095
s_mov_b32 s38, 0xd7
s_mov_b32 s39, 0x30004da
s_branch m_g_ll_d
m_g_ll_26_28:
s_cmp_ge_u32 s16, 27
s_cbranch_scc1 m_g_ll_27_28
s_mov_b32 s24, 0x131
s_mov_b32 s25, 0x161
s_mov_b32 s36, 0x20114
s_mov_b32 s37, 0x20115
s_mov_b32 s38, 0x157
s_mov_b32 s39, 0x30004ea
s_branch m_g_ll_d
m_g_ll_27_28:
s_mov_b32 s24, 0x1b1
s_mov_b32 s25, 0x1e1
s_mov_b32 s36, 0x20194
s_mov_b32 s37, 0x20195
s_mov_b32 s38, 0x1d7
s_mov_b32 s39, 0x30004fa
s_branch m_g_ll_d
m_g_ll_28_32:
s_cmp_ge_u32 s16, 30
s_cbranch_scc1 m_g_ll_30_32
s_cmp_ge_u32 s16, 29
s_cbranch_scc1 m_g_ll_29_30
s_mov_b32 s24, 0x41
s_mov_b32 s25, 0x40
s_mov_b32 s36, 0x50
s_mov_b32 s37, 0x60
s_mov_b32 s38, 0x18044
s_mov_b32 s39, 0x20045
s_mov_b32 s40, 0x1c00000b
s_mov_b32 s41, 0x2400000b
s_mov_b32 s42, 0x2c00000b
s_branch m_g_ll_d
m_g_ll_29_30:
s_mov_b32 s24, 0xc1
s_mov_b32 s25, 0xc0
s_mov_b32 s36, 0xd0
s_mov_b32 s37, 0xe0
s_mov_b32 s38, 0x180c4
s_mov_b32 s39, 0x200c5
s_mov_b32 s40, 0x5c00000b
s_mov_b32 s41, 0x6400000b
s_mov_b32 s42, 0x6c00000b
s_branch m_g_ll_d
m_g_ll_30_32:
s_cmp_ge_u32 s16, 31
s_cbranch_scc1 m_g_ll_31_32
s_mov_b32 s24, 0x141
s_mov_b32 s25, 0x140
s_mov_b32 s36, 0x150
s_mov_b32 s37, 0x160
s_mov_b32 s38, 0x18144
s_mov_b32 s39, 0x20145
s_mov_b32 s40, 0x9c00000b
s_mov_b32 s41, 0xa400000b
s_mov_b32 s42, 0xac00000b
s_branch m_g_ll_d
m_g_ll_31_32:
s_mov_b32 s24, 0x1c1
s_mov_b32 s25, 0x1c0
s_mov_b32 s36, 0x1d0
s_mov_b32 s37, 0x1e0
s_mov_b32 s38, 0x181c4
s_mov_b32 s39, 0x201c5
s_mov_b32 s40, 0xdc00000b
s_mov_b32 s41, 0xe400000b
s_mov_b32 s42, 0xec00000b
s_branch m_g_ll_d
m_g_ll_32_64:
s_cmp_ge_u32 s16, 48
s_cbranch_scc1 m_g_ll_48_64
s_cmp_ge_u32 s16, 40
s_cbranch_scc1 m_g_ll_40_48
s_cmp_ge_u32 s16, 36
s_cbranch_scc1 m_g_ll_36_40
s_cmp_ge_u32 s16, 34
s_cbranch_scc1 m_g_ll_34_36
s_cmp_ge_u32 s16, 33
s_cbranch_scc1 m_g_ll_33_34
s_mov_b32 s24, 0x323
s_mov_b32 s25, 0x1c3
s_mov_b32 s36, 0x1e3
s_mov_b32 s37, 0x1a034
s_mov_b32 s38, 0x22035
s_mov_b32 s39, 0x279
s_branch m_g_ll_d
m_g_ll_33_34:
s_mov_b32 s24, 0x233
s_mov_b32 s25, 0x243
s_mov_b32 s36, 0x263
s_mov_b32 s37, 0x1a0b4
s_mov_b32 s38, 0x220b5
s_mov_b32 s39, 0x2f9
s_branch m_g_ll_d
m_g_ll_34_36:
s_cmp_ge_u32 s16, 35
s_cbranch_scc1 m_g_ll_35_36
s_mov_b32 s24, 0x2b3
s_mov_b32 s25, 0x2c3
s_mov_b32 s36, 0x2e3
s_mov_b32 s37, 0x1a134
s_mov_b32 s38, 0x22135
s_mov_b32 s39, 0x379
s_branch m_g_ll_d
m_g_ll_35_36:
s_mov_b32 s24, 0x333
s_mov_b32 s25, 0x343
s_mov_b32 s36, 0x363
s_mov_b32 s37, 0x1a1b4
s_mov_b32 s38, 0x221b5
s_mov_b32 s39, 0x3f9
s_branch m_g_ll_d
m_g_ll_36_40:
s_cmp_ge_u32 s16, 38
s_cbranch_scc1 m_g_ll_38_40
s_cmp_ge_u32 s16, 37
s_cbranch_scc1 m_g_ll_37_38
s_mov_b32 s24, 0x230
s_mov_b32 s25, 0x1f3
s_mov_b32 s36, 0x222
s_mov_b32 s37, 0x21876
s_mov_b32 s38, 0xc00000b
s_mov_b32 s39, 0x400000b
s_mov_b32 s40, 0x300014a
s_branch m_g_ll_d
m_g_ll_37_38:
s_mov_b32 s24, 0x2b0
s_mov_b32 s25, 0x273
s_mov_b32 s36, 0x2a2
s_mov_b32 s37, 0x218f6
s_mov_b32 s38, 0x4c00000b
s_mov_b32 s39, 0x4400000b
s_mov_b32 s40, 0x300015a
s_branch m_g_ll_d
m_g_ll_38_40:
s_cmp_ge_u32 s16, 39
s_cbranch_scc1 m_g_ll_39_40
s_mov_b32 s24, 0x330
s_mov_b32 s25, 0x2f3
s_mov_b32 s36, 0x322
s_mov_b32 s37, 0x21976
s_mov_b32 s38, 0x8c00000b
s_mov_b32 s39, 0x8400000b
s_mov_b32 s40, 0x300016a
s_branch m_g_ll_d
m_g_ll_39_40:
s_mov_b32 s24, 0x3b0
s_mov_b32 s25, 0x373
s_mov_b32 s36, 0x3a2
s_mov_b32 s37, 0x219f6
s_mov_b32 s38, 0xcc00000b
s_mov_b32 s39, 0xc400000b
s_mov_b32 s40, 0x300017a
s_branch m_g_ll_d
m_g_ll_40_48:
s_cmp_ge_u32 s16, 44
s_cbranch_scc1 m_g_ll_44_48
s_cmp_ge_u32 s16, 42
s_cbranch_scc1 m_g_ll_42_44
s_cmp_ge_u32 s16, 41
s_cbranch_scc1 m_g_ll_41_42
s_mov_b32 s24, 0x293
s_mov_b32 s25, 0x202
s_mov_b32 s36, 0x237
s_mov_b32 s37, 0x21866
s_mov_b32 s38, 0x300018a
s_branch m_g_ll_d
m_g_ll_41_42:
s_mov_b32 s24, 0x313
s_mov_b32 s25, 0x282
s_mov_b32 s36, 0x2b7
s_mov_b32 s37, 0x218e6
s_mov_b32 s38, 0x300019a
s_branch m_g_ll_d
m_g_ll_42_44:
s_cmp_ge_u32 s16, 43
s_cbranch_scc1 m_g_ll_43_44
s_mov_b32 s24, 0x223
s_mov_b32 s25, 0x302
s_mov_b32 s36, 0x337
s_mov_b32 s37, 0x21966
s_mov_b32 s38, 0x30001aa
s_branch m_g_ll_d
m_g_ll_43_44:
s_mov_b32 s24, 0x2a3
s_mov_b32 s25, 0x382
s_mov_b32 s36, 0x3b7
s_mov_b32 s37, 0x219e6
s_mov_b32 s38, 0x30001ba
s_branch m_g_ll_d
m_g_ll_44_48:
s_cmp_ge_u32 s16, 46
s_cbranch_scc1 m_g_ll_46_48
s_cmp_ge_u32 s16, 45
s_cbranch_scc1 m_g_ll_45_46
s_mov_b32 s24, 0x220
s_mov_b32 s25, 0x212
s_mov_b32 s36, 0x270
s_mov_b32 s37, 0x247
s_mov_b32 s38, 0x21854
s_mov_b32 s39, 0x22055
s_branch m_g_ll_d
m_g_ll_45_46:
s_mov_b32 s24, 0x2a0
s_mov_b32 s25, 0x292
s_mov_b32 s36, 0x2f0
s_mov_b32 s37, 0x2c7
s_mov_b32 s38, 0x218d4
s_mov_b32 s39, 0x220d5
s_branch m_g_ll_d
m_g_ll_46_48:
s_cmp_ge_u32 s16, 47
s_cbranch_scc1 m_g_ll_47_48
s_mov_b32 s24, 0x320
s_mov_b32 s25, 0x312
s_mov_b32 s36, 0x370
s_mov_b32 s37, 0x347
s_mov_b32 s38, 0x21954
s_mov_b32 s39, 0x22155
s_branch m_g_ll_d
m_g_ll_47_48:
s_mov_b32 s24, 0x3a0
s_mov_b32 s25, 0x392
s_mov_b32 s36, 0x3f0
s_mov_b32 s37, 0x3c7
s_mov_b32 s38, 0x219d4
s_mov_b32 s39, 0x221d5
s_branch m_g_ll_d
m_g_ll_48_64:
s_cmp_ge_u32 s16, 56
s_cbranch_scc1 m_g_ll_56_64
s_cmp_ge_u32 s16, 52
s_cbranch_scc1 m_g_ll_52_56
s_cmp_ge_u32 s16, 50
s_cbranch_scc1 m_g_ll_50_52
s_cmp_ge_u32 s16, 49
s_cbranch_scc1 m_g_ll_49_50
s_mov_b32 s24, 0x203
s_mov_b32 s25, 0x251
s_mov_b32 s36, 0x1a004
s_mov_b32 s37, 0x22005
s_mov_b32 s38, 0x269
s_branch m_g_ll_d
m_g_ll_49_50:
s_mov_b32 s24, 0x283
s_mov_b32 s25, 0x2d1
s_mov_b32 s36, 0x1a084
s_mov_b32 s37, 0x22085
s_mov_b32 s38, 0x2e9
s_branch m_g_ll_d
m_g_ll_50_52:
s_cmp_ge_u32 s16, 51
s_cbranch_scc1 m_g_ll_51_52
s_mov_b32 s24, 0x303
s_mov_b32 s25, 0x351
s_mov_b32 s36, 0x1a104
s_mov_b32 s37, 0x22105
s_mov_b32 s38, 0x369
s_branch m_g_ll_d
m_g_ll_51_52:
s_mov_b32 s24, 0x213
s_mov_b32 s25, 0x3d1
s_mov_b32 s36, 0x1a184
s_mov_b32 s37, 0x22185
s_mov_b32 s38, 0x3e9
s_branch m_g_ll_d
m_g_ll_52_56:
s_cmp_ge_u32 s16, 54
s_cbranch_scc1 m_g_ll_54_56
s_cmp_ge_u32 s16, 53
s_cbranch_scc1 m_g_ll_53_54
s_mov_b32 s24, 0x221
s_mov_b32 s25, 0x1d3
s_mov_b32 s36, 0x271
s_mov_b32 s37, 0x1a024
s_mov_b32 s38, 0x22025
s_mov_b32 s39, 0x1400000b
s_mov_b32 s40, 0x300010a
s_branch m_g_ll_d
m_g_ll_53_54:
s_mov_b32 s24, 0x2a1
s_mov_b32 s25, 0x253
s_mov_b32 s36, 0x2f1
s_mov_b32 s37, 0x1a0a4
s_mov_b32 s38, 0x220a5
s_mov_b32 s39, 0x5400000b
s_mov_b32 s40, 0x300011a
s_branch m_g_ll_d
m_g_ll_54_56:
s_cmp_ge_u32 s16, 55
s_cbranch_scc1 m_g_ll_55_56
s_mov_b32 s24, 0x321
s_mov_b32 s25, 0x2d3
s_mov_b32 s36, 0x371
s_mov_b32 s37, 0x1a124
s_mov_b32 s38, 0x22125
s_mov_b32 s39, 0x9400000b
s_mov_b32 s40, 0x300012a
s_branch m_g_ll_d
m_g_ll_55_56:
s_mov_b32 s24, 0x3a1
s_mov_b32 s25, 0x353
s_mov_b32 s36, 0x3f1
s_mov_b32 s37, 0x1a1a4
s_mov_b32 s38, 0x221a5
s_mov_b32 s39, 0xd400000b
s_mov_b32 s40, 0x300013a
s_branch m_g_ll_d
m_g_ll_56_64:
s_cmp_ge_u32 s16, 60
s_cbranch_scc1 m_g_ll_60_64
s_cmp_ge_u32 s16, 58
s_cbranch_scc1 m_g_ll_58_60
s_cmp_ge_u32 s16, 57
s_cbranch_scc1 m_g_ll_57_58
s_mov_b32 s24, 0x231
s_mov_b32 s25, 0x261
s_mov_b32 s36, 0x1a014
s_mov_b32 s37, 0x22015
s_mov_b32 s38, 0x257
s_mov_b32 s39, 0x30005ca
s_branch m_g_ll_d
m_g_ll_57_58:
s_mov_b32 s24, 0x2b1
s_mov_b32 s25, 0x2e1
s_mov_b32 s36, 0x1a094
s_mov_b32 s37, 0x22095
s_mov_b32 s38, 0x2d7
s_mov_b32 s39, 0x30005da
s_branch m_g_ll_d
m_g_ll_58_60:
s_cmp_ge_u32 s16, 59
s_cbranch_scc1 m_g_ll_59_60
s_mov_b32 s24, 0x331
s_mov_b32 s25, 0x361
s_mov_b32 s36, 0x1a114
s_mov_b32 s37, 0x22115
s_mov_b32 s38, 0x357
s_mov_b32 s39, 0x30005ea
s_branch m_g_ll_d
m_g_ll_59_60:
s_mov_b32 s24, 0x3b1
s_mov_b32 s25, 0x3e1
s_mov_b32 s36, 0x1a194
s_mov_b32 s37, 0x22195
s_mov_b32 s38, 0x3d7
s_mov_b32 s39, 0x30005fa
s_branch m_g_ll_d
m_g_ll_60_64:
s_cmp_ge_u32 s16, 62
s_cbranch_scc1 m_g_ll_62_64
s_cmp_ge_u32 s16, 61
s_cbranch_scc1 m_g_ll_61_62
s_mov_b32 s24, 0x241
s_mov_b32 s25, 0x240
s_mov_b32 s36, 0x250
s_mov_b32 s37, 0x260
s_mov_b32 s38, 0x21844
s_mov_b32 s39, 0x22045
s_mov_b32 s40, 0x1c00000b
s_mov_b32 s41, 0x2400000b
s_mov_b32 s42, 0x2c00000b
s_branch m_g_ll_d
m_g_ll_61_62:
s_mov_b32 s24, 0x2c1
s_mov_b32 s25, 0x2c0
s_mov_b32 s36, 0x2d0
s_mov_b32 s37, 0x2e0
s_mov_b32 s38, 0x218c4
s_mov_b32 s39, 0x220c5
s_mov_b32 s40, 0x5c00000b
s_mov_b32 s41, 0x6400000b
s_mov_b32 s42, 0x6c00000b
s_branch m_g_ll_d
m_g_ll_62_64:
s_cmp_ge_u32 s16, 63
s_cbranch_scc1 m_g_ll_63_64
s_mov_b32 s24, 0x341
s_mov_b32 s25, 0x340
s_mov_b32 s36, 0x350
s_mov_b32 s37, 0x360
s_mov_b32 s38, 0x21944
s_mov_b32 s39, 0x22145
s_mov_b32 s40, 0x9c00000b
s_mov_b32 s41, 0xa400000b
s_mov_b32 s42, 0xac00000b
s_branch m_g_ll_d
m_g_ll_63_64:
s_mov_b32 s24, 0x3c1
s_mov_b32 s25, 0x3c0
s_mov_b32 s36, 0x3d0
s_mov_b32 s37, 0x3e0
s_mov_b32 s38, 0x219c4
s_mov_b32 s39, 0x221c5
s_mov_b32 s40, 0xdc00000b
s_mov_b32 s41, 0xe400000b
s_mov_b32 s42, 0xec00000b
s_branch m_g_ll_d
m_g_ll_64_128:
s_cmp_ge_u32 s16, 96
s_cbranch_scc1 m_g_ll_96_128
s_cmp_ge_u32 s16, 80
s_cbranch_scc1 m_g_ll_80_96
s_cmp_ge_u32 s16, 72
s_cbranch_scc1 m_g_ll_72_80
s_cmp_ge_u32 s16, 68
s_cbranch_scc1 m_g_ll_68_72
s_cmp_ge_u32 s16, 66
s_cbranch_scc1 m_g_ll_66_68
s_cmp_ge_u32 s16, 65
s_cbranch_scc1 m_g_ll_65_66
s_mov_b32 s24, 0x3a3
s_mov_b32 s25, 0x3b3
s_mov_b32 s36, 0x453
s_mov_b32 s37, 0x23834
s_mov_b32 s38, 0x24035
s_mov_b32 s39, 0x479
s_branch m_g_ll_d
m_g_ll_65_66:
s_mov_b32 s24, 0x423
s_mov_b32 s25, 0x433
s_mov_b32 s36, 0x4d3
s_mov_b32 s37, 0x238b4
s_mov_b32 s38, 0x240b5
s_mov_b32 s39, 0x4f9
s_branch m_g_ll_d
m_g_ll_66_68:
s_cmp_ge_u32 s16, 67
s_cbranch_scc1 m_g_ll_67_68
s_mov_b32 s24, 0x4a3
s_mov_b32 s25, 0x4b3
s_mov_b32 s36, 0x3e3
s_mov_b32 s37, 0x23934
s_mov_b32 s38, 0x24135
s_mov_b32 s39, 0x579
s_branch m_g_ll_d
m_g_ll_67_68:
s_mov_b32 s24, 0x523
s_mov_b32 s25, 0x533
s_mov_b32 s36, 0x463
s_mov_b32 s37, 0x239b4
s_mov_b32 s38, 0x241b5
s_mov_b32 s39, 0x5f9
s_branch m_g_ll_d
m_g_ll_68_72:
s_cmp_ge_u32 s16, 70
s_cbranch_scc1 m_g_ll_70_72
s_cmp_ge_u32 s16, 69
s_cbranch_scc1 m_g_ll_69_70
s_mov_b32 s24, 0x430
s_mov_b32 s25, 0x4e3
s_mov_b32 s36, 0x422
s_mov_b32 s37, 0x1b876
s_mov_b32 s38, 0xc00000b
s_mov_b32 s39, 0x400000b
s_mov_b32 s40, 0x300024a
s_branch m_g_ll_d
m_g_ll_69_70:
s_mov_b32 s24, 0x4b0
s_mov_b32 s25, 0x3f3
s_mov_b32 s36, 0x4a2
s_mov_b32 s37, 0x1b8f6
s_mov_b32 s38, 0x4c00000b
s_mov_b32 s39, 0x4400000b
s_mov_b32 s40, 0x300025a
s_branch m_g_ll_d
m_g_ll_70_72:
s_cmp_ge_u32 s16, 71
s_cbranch_scc1 m_g_ll_71_72
s_mov_b32 s24, 0x530
s_mov_b32 s25, 0x473
s_mov_b32 s36, 0x522
s_mov_b32 s37, 0x1b976
s_mov_b32 s38, 0x8c00000b
s_mov_b32 s39, 0x8400000b
s_mov_b32 s40, 0x300026a
s_branch m_g_ll_d
m_g_ll_71_72:
s_mov_b32 s24, 0x5b0
s_mov_b32 s25, 0x4f3
s_mov_b32 s36, 0x5a2
s_mov_b32 s37, 0x1b9f6
s_mov_b32 s38, 0xcc00000b
s_mov_b32 s39, 0xc400000b
s_mov_b32 s40, 0x300027a
s_branch m_g_ll_d
m_g_ll_72_80:
s_cmp_ge_u32 s16, 76
s_cbranch_scc1 m_g_ll_76_80
s_cmp_ge_u32 s16, 74
s_cbranch_scc1 m_g_ll_74_76
s_cmp_ge_u32 s16, 73
s_cbranch_scc1 m_g_ll_73_74
s_mov_b32 s24, 0x393
s_mov_b32 s25, 0x402
s_mov_b32 s36, 0x437
s_mov_b32 s37, 0x1b866
s_mov_b32 s38, 0x300028a
s_branch m_g_ll_d
m_g_ll_73_74:
s_mov_b32 s24, 0x413
s_mov_b32 s25, 0x482
s_mov_b32 s36, 0x4b7
s_mov_b32 s37, 0x1b8e6
s_mov_b32 s38, 0x300029a
s_branch m_g_ll_d
m_g_ll_74_76:
s_cmp_ge_u32 s16, 75
s_cbranch_scc1 m_g_ll_75_76
s_mov_b32 s24, 0x493
s_mov_b32 s25, 0x502
s_mov_b32 s36, 0x537
s_mov_b32 s37, 0x1b966
s_mov_b32 s38, 0x30002aa
s_branch m_g_ll_d
m_g_ll_75_76:
s_mov_b32 s24, 0x513
s_mov_b32 s25, 0x582
s_mov_b32 s36, 0x5b7
s_mov_b32 s37, 0x1b9e6
s_mov_b32 s38, 0x30002ba
s_branch m_g_ll_d
m_g_ll_76_80:
s_cmp_ge_u32 s16, 78
s_cbranch_scc1 m_g_ll_78_80
s_cmp_ge_u32 s16, 77
s_cbranch_scc1 m_g_ll_77_78
s_mov_b32 s24, 0x420
s_mov_b32 s25, 0x412
s_mov_b32 s36, 0x470
s_mov_b32 s37, 0x447
s_mov_b32 s38, 0x1b854
s_mov_b32 s39, 0x24055
s_branch m_g_ll_d
m_g_ll_77_78:
s_mov_b32 s24, 0x4a0
s_mov_b32 s25, 0x492
s_mov_b32 s36, 0x4f0
s_mov_b32 s37, 0x4c7
s_mov_b32 s38, 0x1b8d4
s_mov_b32 s39, 0x240d5
s_branch m_g_ll_d
m_g_ll_78_80:
s_cmp_ge_u32 s16, 79
s_cbranch_scc1 m_g_ll_79_80
s_mov_b32 s24, 0x520
s_mov_b32 s25, 0x512
s_mov_b32 s36, 0x570
s_mov_b32 s37, 0x547
s_mov_b32 s38, 0x1b954
s_mov_b32 s39, 0x24155
s_branch m_g_ll_d
m_g_ll_79_80:
s_mov_b32 s24, 0x5a0
s_mov_b32 s25, 0x592
s_mov_b32 s36, 0x5f0
s_mov_b32 s37, 0x5c7
s_mov_b32 s38, 0x1b9d4
s_mov_b32 s39, 0x241d5
s_branch m_g_ll_d
m_g_ll_80_96:
s_cmp_ge_u32 s16, 88
s_cbranch_scc1 m_g_ll_88_96
s_cmp_ge_u32 s16, 84
s_cbranch_scc1 m_g_ll_84_88
s_cmp_ge_u32 s16, 82
s_cbranch_scc1 m_g_ll_82_84
s_cmp_ge_u32 s16, 81
s_cbranch_scc1 m_g_ll_81_82
s_mov_b32 s24, 0x383
s_mov_b32 s25, 0x451
s_mov_b32 s36, 0x23804
s_mov_b32 s37, 0x24005
s_mov_b32 s38, 0x469
s_branch m_g_ll_d
m_g_ll_81_82:
s_mov_b32 s24, 0x403
s_mov_b32 s25, 0x4d1
s_mov_b32 s36, 0x23884
s_mov_b32 s37, 0x24085
s_mov_b32 s38, 0x4e9
s_branch m_g_ll_d
m_g_ll_82_84:
s_cmp_ge_u32 s16, 83
s_cbranch_scc1 m_g_ll_83_84
s_mov_b32 s24, 0x483
s_mov_b32 s25, 0x551
s_mov_b32 s36, 0x23904
s_mov_b32 s37, 0x24105
s_mov_b32 s38, 0x569
s_branch m_g_ll_d
m_g_ll_83_84:
s_mov_b32 s24, 0x503
s_mov_b32 s25, 0x5d1
s_mov_b32 s36, 0x23984
s_mov_b32 s37, 0x24185
s_mov_b32 s38, 0x5e9
s_branch m_g_ll_d
m_g_ll_84_88:
s_cmp_ge_u32 s16, 86
s_cbranch_scc1 m_g_ll_86_88
s_cmp_ge_u32 s16, 85
s_cbranch_scc1 m_g_ll_85_86
s_mov_b32 s24, 0x421
s_mov_b32 s25, 0x3c3
s_mov_b32 s36, 0x471
s_mov_b32 s37, 0x23824
s_mov_b32 s38, 0x24025
s_mov_b32 s39, 0x1400000b
s_mov_b32 s40, 0x300020a
s_branch m_g_ll_d
m_g_ll_85_86:
s_mov_b32 s24, 0x4a1
s_mov_b32 s25, 0x443
s_mov_b32 s36, 0x4f1
s_mov_b32 s37, 0x238a4
s_mov_b32 s38, 0x240a5
s_mov_b32 s39, 0x5400000b
s_mov_b32 s40, 0x300021a
s_branch m_g_ll_d
m_g_ll_86_88:
s_cmp_ge_u32 s16, 87
s_cbranch_scc1 m_g_ll_87_88
s_mov_b32 s24, 0x521
s_mov_b32 s25, 0x4c3
s_mov_b32 s36, 0x571
s_mov_b32 s37, 0x23924
s_mov_b32 s38, 0x24125
s_mov_b32 s39, 0x9400000b
s_mov_b32 s40, 0x300022a
s_branch m_g_ll_d
m_g_ll_87_88:
s_mov_b32 s24, 0x5a1
s_mov_b32 s25, 0x3d3
s_mov_b32 s36, 0x5f1
s_mov_b32 s37, 0x239a4
s_mov_b32 s38, 0x241a5
s_mov_b32 s39, 0xd400000b
s_mov_b32 s40, 0x300023a
s_branch m_g_ll_d
m_g_ll_88_96:
s_cmp_ge_u32 s16, 92
s_cbranch_scc1 m_g_ll_92_96
s_cmp_ge_u32 s16, 90
s_cbranch_scc1 m_g_ll_90_92
s_cmp_ge_u32 s16, 89
s_cbranch_scc1 m_g_ll_89_90
s_mov_b32 s24, 0x431
s_mov_b32 s25, 0x461
s_mov_b32 s36, 0x23814
s_mov_b32 s37, 0x24015
s_mov_b32 s38, 0x457
s_mov_b32 s39, 0x30006ca
s_branch m_g_ll_d
m_g_ll_89_90:
s_mov_b32 s24, 0x4b1
s_mov_b32 s25, 0x4e1
s_mov_b32 s36, 0x23894
s_mov_b32 s37, 0x24095
s_mov_b32 s38, 0x4d7
s_mov_b32 s39, 0x30006da
s_branch m_g_ll_d
m_g_ll_90_92:
s_cmp_ge_u32 s16, 91
s_cbranch_scc1 m_g_ll_91_92
s_mov_b32 s24, 0x531
s_mov_b32 s25, 0x561
s_mov_b32 s36, 0x23914
s_mov_b32 s37, 0x24115
s_mov_b32 s38, 0x557
s_mov_b32 s39, 0x30006ea
s_branch m_g_ll_d
m_g_ll_91_92:
s_mov_b32 s24, 0x5b1
s_mov_b32 s25, 0x5e1
s_mov_b32 s36, 0x23994
s_mov_b32 s37, 0x24195
s_mov_b32 s38, 0x5d7
s_mov_b32 s39, 0x30006fa
s_branch m_g_ll_d
m_g_ll_92_96:
s_cmp_ge_u32 s16, 94
s_cbranch_scc1 m_g_ll_94_96
s_cmp_ge_u32 s16, 93
s_cbranch_scc1 m_g_ll_93_94
s_mov_b32 s24, 0x441
s_mov_b32 s25, 0x440
s_mov_b32 s36, 0x450
s_mov_b32 s37, 0x460
s_mov_b32 s38, 0x1b844
s_mov_b32 s39, 0x24045
s_mov_b32 s40, 0x1c00000b
s_mov_b32 s41, 0x2400000b
s_mov_b32 s42, 0x2c00000b
s_branch m_g_ll_d
m_g_ll_93_94:
s_mov_b32 s24, 0x4c1
s_mov_b32 s25, 0x4c0
s_mov_b32 s36, 0x4d0
s_mov_b32 s37, 0x4e0
s_mov_b32 s38, 0x1b8c4
s_mov_b32 s39, 0x240c5
s_mov_b32 s40, 0x5c00000b
s_mov_b32 s41, 0x6400000b
s_mov_b32 s42, 0x6c00000b
s_branch m_g_ll_d
m_g_ll_94_96:
s_cmp_ge_u32 s16, 95
s_cbranch_scc1 m_g_ll_95_96
s_mov_b32 s24, 0x541
s_mov_b32 s25, 0x540
s_mov_b32 s36, 0x550
s_mov_b32 s37, 0x560
s_mov_b32 s38, 0x1b944
s_mov_b32 s39, 0x24145
s_mov_b32 s40, 0x9c00000b
s_mov_b32 s41, 0xa400000b
s_mov_b32 s42, 0xac00000b
s_branch m_g_ll_d
m_g_ll_95_96:
s_mov_b32 s24, 0x5c1
s_mov_b32 s25, 0x5c0
s_mov_b32 s36, 0x5d0
s_mov_b32 s37, 0x5e0
s_mov_b32 s38, 0x1b9c4
s_mov_b32 s39, 0x241c5
s_mov_b32 s40, 0xdc00000b
s_mov_b32 s41, 0xe400000b
s_mov_b32 s42, 0xec00000b
s_branch m_g_ll_d
m_g_ll_96_128:
s_cmp_ge_u32 s16, 112
s_cbranch_scc1 m_g_ll_112_128
s_cmp_ge_u32 s16, 104
s_cbranch_scc1 m_g_ll_104_112
s_cmp_ge_u32 s16, 100
s_cbranch_scc1 m_g_ll_100_104
s_cmp_ge_u32 s16, 98
s_cbranch_scc1 m_g_ll_98_100
s_cmp_ge_u32 s16, 97
s_cbranch_scc1 m_g_ll_97_98
s_mov_b32 s24, 0x6a3
s_mov_b32 s25, 0x543
s_mov_b32 s36, 0x563
s_mov_b32 s37, 0x1d834
s_mov_b32 s38, 0x26035
s_mov_b32 s39, 0x679
s_branch m_g_ll_d
m_g_ll_97_98:
s_mov_b32 s24, 0x5b3
s_mov_b32 s25, 0x5c3
s_mov_b32 s36, 0x5e3
s_mov_b32 s37, 0x1d8b4
s_mov_b32 s38, 0x260b5
s_mov_b32 s39, 0x6f9
s_branch m_g_ll_d
m_g_ll_98_100:
s_cmp_ge_u32 s16, 99
s_cbranch_scc1 m_g_ll_99_100
s_mov_b32 s24, 0x633
s_mov_b32 s25, 0x643
s_mov_b32 s36, 0x663
s_mov_b32 s37, 0x1d934
s_mov_b32 s38, 0x26135
s_mov_b32 s39, 0x779
s_branch m_g_ll_d
m_g_ll_99_100:
s_mov_b32 s24, 0x6b3
s_mov_b32 s25, 0x6c3
s_mov_b32 s36, 0x6e3
s_mov_b32 s37, 0x1d9b4
s_mov_b32 s38, 0x261b5
s_mov_b32 s39, 0x7f9
s_branch m_g_ll_d
m_g_ll_100_104:
s_cmp_ge_u32 s16, 102
s_cbranch_scc1 m_g_ll_102_104
s_cmp_ge_u32 s16, 101
s_cbranch_scc1 m_g_ll_101_102
s_mov_b32 s24, 0x630
s_mov_b32 s25, 0x573
s_mov_b32 s36, 0x622
s_mov_b32 s37, 0x25076
s_mov_b32 s38, 0xc00000b
s_mov_b32 s39, 0x400000b
s_mov_b32 s40, 0x300034a
s_branch m_g_ll_d
m_g_ll_101_102:
s_mov_b32 s24, 0x6b0
s_mov_b32 s25, 0x5f3
s_mov_b32 s36, 0x6a2
s_mov_b32 s37, 0x250f6
s_mov_b32 s38, 0x4c00000b
s_mov_b32 s39, 0x4400000b
s_mov_b32 s40, 0x300035a
s_branch m_g_ll_d
m_g_ll_102_104:
s_cmp_ge_u32 s16, 103
s_cbranch_scc1 m_g_ll_103_104
s_mov_b32 s24, 0x730
s_mov_b32 s25, 0x673
s_mov_b32 s36, 0x722
s_mov_b32 s37, 0x25176
s_mov_b32 s38, 0x8c00000b
s_mov_b32 s39, 0x8400000b
s_mov_b32 s40, 0x300036a
s_branch m_g_ll_d
m_g_ll_103_104:
s_mov_b32 s24, 0x7b0
s_mov_b32 s25, 0x6f3
s_mov_b32 s36, 0x7a2
s_mov_b32 s37, 0x251f6
s_mov_b32 s38, 0xcc00000b
s_mov_b32 s39, 0xc400000b
s_mov_b32 s40, 0x300037a
s_branch m_g_ll_d
m_g_ll_104_112:
s_cmp_ge_u32 s16, 108
s_cbranch_scc1 m_g_ll_108_112
s_cmp_ge_u32 s16, 106
s_cbranch_scc1 m_g_ll_106_108
s_cmp_ge_u32 s16, 105
s_cbranch_scc1 m_g_ll_105_106
s_mov_b32 s24, 0x613
s_mov_b32 s25, 0x602
s_mov_b32 s36, 0x637
s_mov_b32 s37, 0x25066
s_mov_b32 s38, 0x300038a
s_branch m_g_ll_d
m_g_ll_105_106:
s_mov_b32 s24, 0x693
s_mov_b32 s25, 0x682
s_mov_b32 s36, 0x6b7
s_mov_b32 s37, 0x250e6
s_mov_b32 s38, 0x300039a
s_branch m_g_ll_d
m_g_ll_106_108:
s_cmp_ge_u32 s16, 107
s_cbranch_scc1 m_g_ll_107_108
s_mov_b32 s24, 0x5a3
s_mov_b32 s25, 0x702
s_mov_b32 s36, 0x737
s_mov_b32 s37, 0x25166
s_mov_b32 s38, 0x30003aa
s_branch m_g_ll_d
m_g_ll_107_108:
s_mov_b32 s24, 0x623
s_mov_b32 s25, 0x782
s_mov_b32 s36, 0x7b7
s_mov_b32 s37, 0x251e6
s_mov_b32 s38, 0x30003ba
s_branch m_g_ll_d
m_g_ll_108_112:
s_cmp_ge_u32 s16, 110
s_cbranch_scc1 m_g_ll_110_112
s_cmp_ge_u32 s16, 109
s_cbranch_scc1 m_g_ll_109_110
s_mov_b32 s24, 0x620
s_mov_b32 s25, 0x612
s_mov_b32 s36, 0x670
s_mov_b32 s37, 0x647
s_mov_b32 s38, 0x25054
s_mov_b32 s39, 0x26055
s_branch m_g_ll_d
m_g_ll_109_110:
s_mov_b32 s24, 0x6a0
s_mov_b32 s25, 0x692
s_mov_b32 s36, 0x6f0
s_mov_b32 s37, 0x6c7
s_mov_b32 s38, 0x250d4
s_mov_b32 s39, 0x260d5
s_branch m_g_ll_d
m_g_ll_110_112:
s_cmp_ge_u32 s16, 111
s_cbranch_scc1 m_g_ll_111_112
s_mov_b32 s24, 0x720
s_mov_b32 s25, 0x712
s_mov_b32 s36, 0x770
s_mov_b32 s37, 0x747
s_mov_b32 s38, 0x25154
s_mov_b32 s39, 0x26155
s_branch m_g_ll_d
m_g_ll_111_112:
s_mov_b32 s24, 0x7a0
s_mov_b32 s25, 0x792
s_mov_b32 s36, 0x7f0
s_mov_b32 s37, 0x7c7
s_mov_b32 s38, 0x251d4
s_mov_b32 s39, 0x261d5
s_branch m_g_ll_d
m_g_ll_112_128:
s_cmp_ge_u32 s16, 120
s_cbranch_scc1 m_g_ll_120_128
s_cmp_ge_u32 s16, 116
s_cbranch_scc1 m_g_ll_116_120
s_cmp_ge_u32 s16, 114
s_cbranch_scc1 m_g_ll_114_116
s_cmp_ge_u32 s16, 113
s_cbranch_scc1 m_g_ll_113_114
s_mov_b32 s24, 0x583
s_mov_b32 s25, 0x651
s_mov_b32 s36, 0x1d804
s_mov_b32 s37, 0x26005
s_mov_b32 s38, 0x669
s_branch m_g_ll_d
m_g_ll_113_114:
s_mov_b32 s24, 0x603
s_mov_b32 s25, 0x6d1
s_mov_b32 s36, 0x1d884
s_mov_b32 s37, 0x26085
s_mov_b32 s38, 0x6e9
s_branch m_g_ll_d
m_g_ll_114_116:
s_cmp_ge_u32 s16, 115
s_cbranch_scc1 m_g_ll_115_116
s_mov_b32 s24, 0x683
s_mov_b32 s25, 0x751
s_mov_b32 s36, 0x1d904
s_mov_b32 s37, 0x26105
s_mov_b32 s38, 0x769
s_branch m_g_ll_d
m_g_ll_115_116:
s_mov_b32 s24, 0x593
s_mov_b32 s25, 0x7d1
s_mov_b32 s36, 0x1d984
s_mov_b32 s37, 0x26185
s_mov_b32 s38, 0x7e9
s_branch m_g_ll_d
m_g_ll_116_120:
s_cmp_ge_u32 s16, 118
s_cbranch_scc1 m_g_ll_118_120
s_cmp_ge_u32 s16, 117
s_cbranch_scc1 m_g_ll_117_118
s_mov_b32 s24, 0x621
s_mov_b32 s25, 0x553
s_mov_b32 s36, 0x671
s_mov_b32 s37, 0x1d824
s_mov_b32 s38, 0x26025
s_mov_b32 s39, 0x1400000b
s_mov_b32 s40, 0x300030a
s_branch m_g_ll_d
m_g_ll_117_118:
s_mov_b32 s24, 0x6a1
s_mov_b32 s25, 0x5d3
s_mov_b32 s36, 0x6f1
s_mov_b32 s37, 0x1d8a4
s_mov_b32 s38, 0x260a5
s_mov_b32 s39, 0x5400000b
s_mov_b32 s40, 0x300031a
s_branch m_g_ll_d
m_g_ll_118_120:
s_cmp_ge_u32 s16, 119
s_cbranch_scc1 m_g_ll_119_120
s_mov_b32 s24, 0x721
s_mov_b32 s25, 0x653
s_mov_b32 s36, 0x771
s_mov_b32 s37, 0x1d924
s_mov_b32 s38, 0x26125
s_mov_b32 s39, 0x9400000b
s_mov_b32 s40, 0x300032a
s_branch m_g_ll_d
m_g_ll_119_120:
s_mov_b32 s24, 0x7a1
s_mov_b32 s25, 0x6d3
s_mov_b32 s36, 0x7f1
s_mov_b32 s37, 0x1d9a4
s_mov_b32 s38, 0x261a5
s_mov_b32 s39, 0xd400000b
s_mov_b32 s40, 0x300033a
s_branch m_g_ll_d
m_g_ll_120_128:
s_cmp_ge_u32 s16, 124
s_cbranch_scc1 m_g_ll_124_128
s_cmp_ge_u32 s16, 122
s_cbranch_scc1 m_g_ll_122_124
s_cmp_ge_u32 s16, 121
s_cbranch_scc1 m_g_ll_121_122
s_mov_b32 s24, 0x631
s_mov_b32 s25, 0x661
s_mov_b32 s36, 0x1d814
s_mov_b32 s37, 0x26015
s_mov_b32 s38, 0x657
s_mov_b32 s39, 0x30007ca
s_branch m_g_ll_d
m_g_ll_121_122:
s_mov_b32 s24, 0x6b1
s_mov_b32 s25, 0x6e1
s_mov_b32 s36, 0x1d894
s_mov_b32 s37, 0x26095
s_mov_b32 s38, 0x6d7
s_mov_b32 s39, 0x30007da
s_branch m_g_ll_d
m_g_ll_122_124:
s_cmp_ge_u32 s16, 123
s_cbranch_scc1 m_g_ll_123_124
s_mov_b32 s24, 0x731
s_mov_b32 s25, 0x761
s_mov_b32 s36, 0x1d914
s_mov_b32 s37, 0x26115
s_mov_b32 s38, 0x757
s_mov_b32 s39, 0x30007ea
s_branch m_g_ll_d
m_g_ll_123_124:
s_mov_b32 s24, 0x7b1
s_mov_b32 s25, 0x7e1
s_mov_b32 s36, 0x1d994
s_mov_b32 s37, 0x26195
s_mov_b32 s38, 0x7d7
s_mov_b32 s39, 0x30007fa
s_branch m_g_ll_d
m_g_ll_124_128:
s_cmp_ge_u32 s16, 126
s_cbranch_scc1 m_g_ll_126_128
s_cmp_ge_u32 s16, 125
s_cbranch_scc1 m_g_ll_125_126
s_mov_b32 s24, 0x641
s_mov_b32 s25, 0x640
s_mov_b32 s36, 0x650
s_mov_b32 s37, 0x660
s_mov_b32 s38, 0x25044
s_mov_b32 s39, 0x26045
s_mov_b32 s40, 0x1c00000b
s_mov_b32 s41, 0x2400000b
s_mov_b32 s42, 0x2c00000b
s_branch m_g_ll_d
m_g_ll_125_126:
s_mov_b32 s24, 0x6c1
s_mov_b32 s25, 0x6c0
s_mov_b32 s36, 0x6d0
s_mov_b32 s37, 0x6e0
s_mov_b32 s38, 0x250c4
s_mov_b32 s39, 0x260c5
s_mov_b32 s40, 0x5c00000b
s_mov_b32 s41, 0x6400000b
s_mov_b32 s42, 0x6c00000b
s_branch m_g_ll_d
m_g_ll_126_128:
s_cmp_ge_u32 s16, 127
s_cbranch_scc1 m_g_ll_127_128
s_mov_b32 s24, 0x741
s_mov_b32 s25, 0x740
s_mov_b32 s36, 0x750
s_mov_b32 s37, 0x760
s_mov_b32 s38, 0x25144
s_mov_b32 s39, 0x26145
s_mov_b32 s40, 0x9c00000b
s_mov_b32 s41, 0xa400000b
s_mov_b32 s42, 0xac00000b
s_branch m_g_ll_d
m_g_ll_127_128:
s_mov_b32 s24, 0x7c1
s_mov_b32 s25, 0x7c0
s_mov_b32 s36, 0x7d0
s_mov_b32 s37, 0x7e0
s_mov_b32 s38, 0x251c4
s_mov_b32 s39, 0x261c5
s_mov_b32 s40, 0xdc00000b
s_mov_b32 s41, 0xe400000b
s_mov_b32 s42, 0xec00000b
s_branch m_g_ll_d
m_g_ll_d:
s_and_b32 s18, s24, 15
s_bfe_u32 s19, s24, 0x30004
s_bfe_u32 s20, s24, 0x40007
s_bfe_u32 s56, s24, 0x5000f
s_lshl_b32 s56, s56, 1
s_cmp_eq_u32 s56, 0
s_cselect_b32 s56, 8, s56
v_lshrrev_b32 v10, 4, v0
v_and_b32 v11, 15, v0
s_mul_i32 s62, s32, 8192
v_lshl_add_u32 v1, v10, 9, s62
v_lshl_add_u32 v1, v11, 4, v1
v_lshrrev_b32 v11, 5, v0
v_lshlrev_b32 v11, 4, v11
v_and_b32 v10, 1, v10
v_lshl_add_u32 v11, v10, 2, v11
v_bfe_u32 v10, v0, 2, 2
v_add_u32 v11, v11, v10
v_bfe_u32 v12, v0, 1, 1
v_lshlrev_b32 v12, 5, v12
v_and_b32 v13, 1, v0
v_lshl_add_u32 v12, v13, 3, v12
s_mov_b32 s62, 1088
v_lshrrev_b32 v13, 1, v11
v_mad_u32_u24 v12, v13, s62, v12
v_and_b32 v13, 1, v11
v_lshl_add_u32 v12, v13, 9, v12
v_lshl_add_u32 v2, v13, 4, v12
s_lshl_b32 s62, s33, 8
s_add_u32 s62, s62, 16384
v_add_u32 v2, s62, v2
v_xor_b32 v3, 16, v2
s_mul_i32 s60, s14, 4096
s_mul_i32 s54, s14, 4352
s_add_u32 s54, s54, 16384
s_waitcnt lgkmcnt(0)
s_and_b32 s63, s24, 15
s_bfe_u32 s64, s24, 0x30004
s_bfe_u32 s65, s24, 0x40007
s_bfe_u32 s66, s24, 0x4000b
s_mov_b32 s46, 268435456
s_lshl_b32 s53, s65, 9
s_sub_u32 s62, s63, 4
s_cmp_lt_u32 s62, 3
s_cbranch_scc1 m_g_w0_fw
s_lshl_b32 s52, s64, 19
s_mov_b32 s57, 65536
s_mov_b64 s[48:49], s[90:91]
s_cmp_eq_u32 s63, 0
s_cselect_b64 s[48:49], s[86:87], s[48:49]
s_cmp_eq_u32 s63, 1
s_cselect_b64 s[48:49], s[88:89], s[48:49]
s_cmp_eq_u32 s63, 3
s_cselect_b64 s[48:49], s[92:93], s[48:49]
s_cselect_b32 s58, 7168, 0
s_cselect_b32 s62, 0, 8192
s_or_b32 s58, s58, s62
s_lshl_b32 s50, s58, 10
s_branch m_g_w0_l
m_g_w0_fw:
s_lshl_b32 s62, s66, 19
s_add_u32 s53, s53, s62
s_mov_b32 s58, 2048
s_cmp_eq_u32 s63, 5
s_cselect_b64 s[48:49], s[96:97], s[94:95]
s_mov_b32 s50, 7340032
s_cselect_b32 s50, 8388608, s50
s_mov_b32 s57, 229376
s_cselect_b32 s57, 262144, s57
s_mov_b32 s52, 92274688
s_cselect_b32 s52, 109051904, s52
s_mul_i32 s62, s64, s57
s_lshl_b32 s62, s62, 3
s_add_u32 s52, s52, s62
s_lshl_b32 s62, s66, 14
s_add_u32 s52, s52, s62
m_g_w0_l:
s_mul_i32 s62, s14, 2
s_mul_i32 s62, s62, s57
v_lshl_add_u32 v4, v0, 4, s62
s_sub_u32 s62, s57, 2048
v_add_u32 v5, s62, v4
v_lshrrev_b32 v12, 5, v0
v_and_b32 v6, 31, v0
v_xor_b32 v6, v6, v12
v_lshlrev_b32 v6, 4, v6
s_lshl_b32 s62, s14, 3
v_add_u32 v12, s62, v12
v_mad_u32_u24 v6, v12, s58, v6
s_lshl_b32 s62, s58, 1
s_sub_u32 s62, s62, 1088
v_add_u32 v7, s62, v6
v_add_u32 v8, s62, v7
v_add_u32 v9, s62, v8
s_lshl_b32 s55, s58, 5
s_add_u32 m0, s60, 0
s_nop 0
buffer_load_dwordx4 v4, s[44:47], s52 offen offset:0 lds
buffer_load_dwordx4 v4, s[44:47], s52 offen offset:1024 lds
buffer_load_dwordx4 v5, s[44:47], s52 offen offset:2048 lds
buffer_load_dwordx4 v5, s[44:47], s52 offen offset:3072 lds
s_add_u32 s52, s52, 2048
s_add_u32 m0, s54, 0
s_nop 0
buffer_load_dwordx4 v6, s[48:51], s53 offen offset:0 lds
buffer_load_dwordx4 v7, s[48:51], s53 offen offset:1088 lds
buffer_load_dwordx4 v8, s[48:51], s53 offen offset:2176 lds
buffer_load_dwordx4 v9, s[48:51], s53 offen offset:3264 lds
s_add_u32 s53, s53, s55
s_add_u32 m0, s60, 33792
s_nop 0
buffer_load_dwordx4 v4, s[44:47], s52 offen offset:0 lds
buffer_load_dwordx4 v4, s[44:47], s52 offen offset:1024 lds
buffer_load_dwordx4 v5, s[44:47], s52 offen offset:2048 lds
buffer_load_dwordx4 v5, s[44:47], s52 offen offset:3072 lds
s_add_u32 s52, s52, 2048
s_add_u32 m0, s54, 33792
s_nop 0
buffer_load_dwordx4 v6, s[48:51], s53 offen offset:0 lds
buffer_load_dwordx4 v7, s[48:51], s53 offen offset:1088 lds
buffer_load_dwordx4 v8, s[48:51], s53 offen offset:2176 lds
buffer_load_dwordx4 v9, s[48:51], s53 offen offset:3264 lds
s_add_u32 s53, s53, s55
s_add_u32 m0, s60, 67584
s_nop 0
buffer_load_dwordx4 v4, s[44:47], s52 offen offset:0 lds
buffer_load_dwordx4 v4, s[44:47], s52 offen offset:1024 lds
buffer_load_dwordx4 v5, s[44:47], s52 offen offset:2048 lds
buffer_load_dwordx4 v5, s[44:47], s52 offen offset:3072 lds
s_add_u32 s52, s52, 2048
s_add_u32 m0, s54, 67584
s_nop 0
buffer_load_dwordx4 v6, s[48:51], s53 offen offset:0 lds
buffer_load_dwordx4 v7, s[48:51], s53 offen offset:1088 lds
buffer_load_dwordx4 v8, s[48:51], s53 offen offset:2176 lds
buffer_load_dwordx4 v9, s[48:51], s53 offen offset:3264 lds
s_add_u32 s53, s53, s55
s_add_u32 m0, s60, 101376
s_nop 0
buffer_load_dwordx4 v4, s[44:47], s52 offen offset:0 lds
buffer_load_dwordx4 v4, s[44:47], s52 offen offset:1024 lds
buffer_load_dwordx4 v5, s[44:47], s52 offen offset:2048 lds
buffer_load_dwordx4 v5, s[44:47], s52 offen offset:3072 lds
s_add_u32 s52, s52, 2048
s_add_u32 m0, s54, 101376
s_nop 0
buffer_load_dwordx4 v6, s[48:51], s53 offen offset:0 lds
buffer_load_dwordx4 v7, s[48:51], s53 offen offset:1088 lds
buffer_load_dwordx4 v8, s[48:51], s53 offen offset:2176 lds
buffer_load_dwordx4 v9, s[48:51], s53 offen offset:3264 lds
s_add_u32 s53, s53, s55
v_and_b32 v10, 15, v0
v_lshrrev_b32 v11, 4, v0
v_lshrrev_b32 v12, 2, v10
v_and_b32 v13, 1, v0
v_lshlrev_b32 v13, 4, v13
v_mov_b32 v14, 0x3f80
v_lshlrev_b32 v14, v13, v14
v_cmp_eq_u32 vcc, v11, v12
s_nop 1
v_cndmask_b32 v14, 0, v14, vcc
v_bfe_u32 v13, v0, 1, 1
v_cmp_eq_u32 vcc, 0, v13
s_nop 1
v_cndmask_b32 v12, 0, v14, vcc
v_cndmask_b32 v13, v14, 0, vcc
v_mov_b32 v14, 0
v_accvgpr_write_b32 a248, v12
v_accvgpr_write_b32 a249, v13
v_accvgpr_write_b32 a250, v14
v_accvgpr_write_b32 a251, v14
v_accvgpr_write_b32 a252, v14
v_accvgpr_write_b32 a253, v14
v_accvgpr_write_b32 a254, v12
v_accvgpr_write_b32 a255, v13
s_mov_b64 vcc, 0
s_mov_b32 s70, 2
s_waitcnt vmcnt(24)
s_branch m_g_warm
m_g_N_f:
s_waitcnt vmcnt(48) lgkmcnt(0)
s_cbranch_vccnz rx_1
s_waitcnt vmcnt(16)
rx_1:
s_barrier
buffer_load_dword v14, v13, s[4:7], s26 offen sc1
v_mfma_f32_16x16x32_bf16 v[16:19], a[0:3], a[32:35], 0
ds_read_b64_tr_b16 a[96:97], v2 offset:33792
s_add_u32 m0, s60, 0
v_mfma_f32_16x16x32_bf16 v[20:23], a[0:3], a[36:39], 0
buffer_load_dwordx4 v4, s[44:47], s52 offen offset:0 lds
v_mfma_f32_16x16x32_bf16 v[24:27], a[0:3], a[40:43], 0
ds_read_b64_tr_b16 a[98:99], v2 offset:38144
v_mfma_f32_16x16x32_bf16 v[28:31], a[0:3], a[44:47], 0
v_mfma_f32_16x16x32_bf16 v[32:35], a[0:3], a[48:51], 0
ds_read_b128 a[64:67], v1 offset:33792
v_mfma_f32_16x16x32_bf16 v[36:39], a[0:3], a[52:55], 0
v_mfma_f32_16x16x32_bf16 v[40:43], a[0:3], a[56:59], 0
ds_read_b64_tr_b16 a[100:101], v3 offset:33792
v_mfma_f32_16x16x32_bf16 v[44:47], a[0:3], a[60:63], 0
v_mfma_f32_16x16x32_bf16 v[76:79], a[4:7], a[60:63], 0
ds_read_b64_tr_b16 a[102:103], v3 offset:38144
v_mfma_f32_16x16x32_bf16 v[72:75], a[4:7], a[56:59], 0
buffer_load_dwordx4 v4, s[44:47], s52 offen offset:1024 lds
v_mfma_f32_16x16x32_bf16 v[68:71], a[4:7], a[52:55], 0
ds_read_b128 a[68:71], v1 offset:34048
v_mfma_f32_16x16x32_bf16 v[64:67], a[4:7], a[48:51], 0
v_mfma_f32_16x16x32_bf16 v[60:63], a[4:7], a[44:47], 0
ds_read_b64_tr_b16 a[104:105], v2 offset:33856
v_mfma_f32_16x16x32_bf16 v[56:59], a[4:7], a[40:43], 0
v_mfma_f32_16x16x32_bf16 v[52:55], a[4:7], a[36:39], 0
ds_read_b64_tr_b16 a[106:107], v2 offset:38208
v_mfma_f32_16x16x32_bf16 v[48:51], a[4:7], a[32:35], 0
v_mfma_f32_16x16x32_bf16 v[80:83], a[8:11], a[32:35], 0
ds_read_b128 a[72:75], v1 offset:35840
v_mfma_f32_16x16x32_bf16 v[84:87], a[8:11], a[36:39], 0
buffer_load_dwordx4 v5, s[44:47], s52 offen offset:2048 lds
v_mfma_f32_16x16x32_bf16 v[88:91], a[8:11], a[40:43], 0
ds_read_b64_tr_b16 a[108:109], v3 offset:33856
v_mfma_f32_16x16x32_bf16 v[92:95], a[8:11], a[44:47], 0
v_mfma_f32_16x16x32_bf16 v[96:99], a[8:11], a[48:51], 0
ds_read_b64_tr_b16 a[110:111], v3 offset:38208
v_mfma_f32_16x16x32_bf16 v[100:103], a[8:11], a[52:55], 0
v_mfma_f32_16x16x32_bf16 v[104:107], a[8:11], a[56:59], 0
ds_read_b128 a[76:79], v1 offset:36096
v_mfma_f32_16x16x32_bf16 v[108:111], a[8:11], a[60:63], 0
v_mfma_f32_16x16x32_bf16 v[140:143], a[12:15], a[60:63], 0
ds_read_b64_tr_b16 a[112:113], v2 offset:33920
v_mfma_f32_16x16x32_bf16 v[136:139], a[12:15], a[56:59], 0
buffer_load_dwordx4 v5, s[44:47], s52 offen offset:3072 lds
v_mfma_f32_16x16x32_bf16 v[132:135], a[12:15], a[52:55], 0
ds_read_b64_tr_b16 a[114:115], v2 offset:38272
s_add_u32 s52, s52, 2048
v_mfma_f32_16x16x32_bf16 v[128:131], a[12:15], a[48:51], 0
v_mfma_f32_16x16x32_bf16 v[124:127], a[12:15], a[44:47], 0
ds_read_b128 a[80:83], v1 offset:37888
v_mfma_f32_16x16x32_bf16 v[120:123], a[12:15], a[40:43], 0
v_mfma_f32_16x16x32_bf16 v[116:119], a[12:15], a[36:39], 0
ds_read_b64_tr_b16 a[116:117], v3 offset:33920
v_mfma_f32_16x16x32_bf16 v[112:115], a[12:15], a[32:35], 0
v_mfma_f32_16x16x32_bf16 v[144:147], a[16:19], a[32:35], 0
ds_read_b64_tr_b16 a[118:119], v3 offset:38272
s_add_u32 m0, s54, 0
v_mfma_f32_16x16x32_bf16 v[148:151], a[16:19], a[36:39], 0
buffer_load_dwordx4 v6, s[48:51], s53 offen offset:0 lds
v_mfma_f32_16x16x32_bf16 v[152:155], a[16:19], a[40:43], 0
ds_read_b128 a[84:87], v1 offset:38144
v_mfma_f32_16x16x32_bf16 v[156:159], a[16:19], a[44:47], 0
v_mfma_f32_16x16x32_bf16 v[160:163], a[16:19], a[48:51], 0
ds_read_b64_tr_b16 a[120:121], v2 offset:33984
v_mfma_f32_16x16x32_bf16 v[164:167], a[16:19], a[52:55], 0
v_mfma_f32_16x16x32_bf16 v[168:171], a[16:19], a[56:59], 0
ds_read_b64_tr_b16 a[122:123], v2 offset:38336
v_mfma_f32_16x16x32_bf16 v[172:175], a[16:19], a[60:63], 0
v_mfma_f32_16x16x32_bf16 v[204:207], a[20:23], a[60:63], 0
ds_read_b128 a[88:91], v1 offset:39936
v_mfma_f32_16x16x32_bf16 v[200:203], a[20:23], a[56:59], 0
buffer_load_dwordx4 v7, s[48:51], s53 offen offset:1088 lds
v_mfma_f32_16x16x32_bf16 v[196:199], a[20:23], a[52:55], 0
ds_read_b64_tr_b16 a[124:125], v3 offset:33984
v_mfma_f32_16x16x32_bf16 v[192:195], a[20:23], a[48:51], 0
v_mfma_f32_16x16x32_bf16 v[188:191], a[20:23], a[44:47], 0
ds_read_b64_tr_b16 a[126:127], v3 offset:38336
v_mfma_f32_16x16x32_bf16 v[184:187], a[20:23], a[40:43], 0
v_mfma_f32_16x16x32_bf16 v[180:183], a[20:23], a[36:39], 0
ds_read_b128 a[92:95], v1 offset:40192
v_mfma_f32_16x16x32_bf16 v[176:179], a[20:23], a[32:35], 0
v_mfma_f32_16x16x32_bf16 v[208:211], a[24:27], a[32:35], 0
v_add_u32 v1, 67584, v1
v_mfma_f32_16x16x32_bf16 v[212:215], a[24:27], a[36:39], 0
buffer_load_dwordx4 v8, s[48:51], s53 offen offset:2176 lds
v_mfma_f32_16x16x32_bf16 v[216:219], a[24:27], a[40:43], 0
v_add_u32 v2, 67584, v2
v_mfma_f32_16x16x32_bf16 v[220:223], a[24:27], a[44:47], 0
v_mfma_f32_16x16x32_bf16 v[224:227], a[24:27], a[48:51], 0
v_add_u32 v3, 67584, v3
v_mfma_f32_16x16x32_bf16 v[228:231], a[24:27], a[52:55], 0
v_mfma_f32_16x16x32_bf16 v[232:235], a[24:27], a[56:59], 0
v_mfma_f32_16x16x32_bf16 v[236:239], a[24:27], a[60:63], 0
v_mfma_f32_16x16x32_bf16 a[140:143], a[28:31], a[60:63], 0
v_mfma_f32_16x16x32_bf16 a[136:139], a[28:31], a[56:59], 0
buffer_load_dwordx4 v9, s[48:51], s53 offen offset:3264 lds
v_mfma_f32_16x16x32_bf16 a[132:135], a[28:31], a[52:55], 0
s_add_u32 s53, s53, s55
v_mfma_f32_16x16x32_bf16 a[128:131], a[28:31], a[48:51], 0
v_mfma_f32_16x16x32_bf16 v[252:255], a[28:31], a[44:47], 0
v_mfma_f32_16x16x32_bf16 v[248:251], a[28:31], a[40:43], 0
v_mfma_f32_16x16x32_bf16 v[244:247], a[28:31], a[36:39], 0
v_mfma_f32_16x16x32_bf16 v[240:243], a[28:31], a[32:35], 0
.p2align 3
m_g_N_l:
s_waitcnt vmcnt(48) lgkmcnt(0)
s_cbranch_vccnz rx_2
s_waitcnt vmcnt(16)
rx_2:
s_barrier
v_mfma_f32_16x16x32_bf16 v[16:19], a[64:67], a[96:99], v[16:19]
ds_read_b64_tr_b16 a[32:33], v2 offset:0
s_add_u32 m0, s60, 33792
v_mfma_f32_16x16x32_bf16 v[20:23], a[64:67], a[100:103], v[20:23]
buffer_load_dwordx4 v4, s[44:47], s52 offen offset:0 lds
v_mfma_f32_16x16x32_bf16 v[24:27], a[64:67], a[104:107], v[24:27]
ds_read_b64_tr_b16 a[34:35], v2 offset:4352
v_mfma_f32_16x16x32_bf16 v[28:31], a[64:67], a[108:111], v[28:31]
v_mfma_f32_16x16x32_bf16 v[32:35], a[64:67], a[112:115], v[32:35]
ds_read_b128 a[0:3], v1 offset:0
v_mfma_f32_16x16x32_bf16 v[36:39], a[64:67], a[116:119], v[36:39]
v_mfma_f32_16x16x32_bf16 v[40:43], a[64:67], a[120:123], v[40:43]
ds_read_b64_tr_b16 a[36:37], v3 offset:0
v_mfma_f32_16x16x32_bf16 v[44:47], a[64:67], a[124:127], v[44:47]
v_mfma_f32_16x16x32_bf16 v[76:79], a[68:71], a[124:127], v[76:79]
ds_read_b64_tr_b16 a[38:39], v3 offset:4352
v_mfma_f32_16x16x32_bf16 v[72:75], a[68:71], a[120:123], v[72:75]
buffer_load_dwordx4 v4, s[44:47], s52 offen offset:1024 lds
v_mfma_f32_16x16x32_bf16 v[68:71], a[68:71], a[116:119], v[68:71]
ds_read_b128 a[4:7], v1 offset:256
v_mfma_f32_16x16x32_bf16 v[64:67], a[68:71], a[112:115], v[64:67]
v_mfma_f32_16x16x32_bf16 v[60:63], a[68:71], a[108:111], v[60:63]
ds_read_b64_tr_b16 a[40:41], v2 offset:64
v_mfma_f32_16x16x32_bf16 v[56:59], a[68:71], a[104:107], v[56:59]
v_mfma_f32_16x16x32_bf16 v[52:55], a[68:71], a[100:103], v[52:55]
ds_read_b64_tr_b16 a[42:43], v2 offset:4416
v_mfma_f32_16x16x32_bf16 v[48:51], a[68:71], a[96:99], v[48:51]
v_mfma_f32_16x16x32_bf16 v[80:83], a[72:75], a[96:99], v[80:83]
ds_read_b128 a[8:11], v1 offset:2048
v_mfma_f32_16x16x32_bf16 v[84:87], a[72:75], a[100:103], v[84:87]
buffer_load_dwordx4 v5, s[44:47], s52 offen offset:2048 lds
v_mfma_f32_16x16x32_bf16 v[88:91], a[72:75], a[104:107], v[88:91]
ds_read_b64_tr_b16 a[44:45], v3 offset:64
v_mfma_f32_16x16x32_bf16 v[92:95], a[72:75], a[108:111], v[92:95]
v_mfma_f32_16x16x32_bf16 v[96:99], a[72:75], a[112:115], v[96:99]
ds_read_b64_tr_b16 a[46:47], v3 offset:4416
v_mfma_f32_16x16x32_bf16 v[100:103], a[72:75], a[116:119], v[100:103]
v_mfma_f32_16x16x32_bf16 v[104:107], a[72:75], a[120:123], v[104:107]
ds_read_b128 a[12:15], v1 offset:2304
v_mfma_f32_16x16x32_bf16 v[108:111], a[72:75], a[124:127], v[108:111]
v_mfma_f32_16x16x32_bf16 v[140:143], a[76:79], a[124:127], v[140:143]
ds_read_b64_tr_b16 a[48:49], v2 offset:128
v_mfma_f32_16x16x32_bf16 v[136:139], a[76:79], a[120:123], v[136:139]
buffer_load_dwordx4 v5, s[44:47], s52 offen offset:3072 lds
v_mfma_f32_16x16x32_bf16 v[132:135], a[76:79], a[116:119], v[132:135]
ds_read_b64_tr_b16 a[50:51], v2 offset:4480
s_add_u32 s52, s52, 2048
v_mfma_f32_16x16x32_bf16 v[128:131], a[76:79], a[112:115], v[128:131]
v_mfma_f32_16x16x32_bf16 v[124:127], a[76:79], a[108:111], v[124:127]
ds_read_b128 a[16:19], v1 offset:4096
v_mfma_f32_16x16x32_bf16 v[120:123], a[76:79], a[104:107], v[120:123]
v_mfma_f32_16x16x32_bf16 v[116:119], a[76:79], a[100:103], v[116:119]
ds_read_b64_tr_b16 a[52:53], v3 offset:128
v_mfma_f32_16x16x32_bf16 v[112:115], a[76:79], a[96:99], v[112:115]
v_mfma_f32_16x16x32_bf16 v[144:147], a[80:83], a[96:99], v[144:147]
ds_read_b64_tr_b16 a[54:55], v3 offset:4480
s_add_u32 m0, s54, 33792
v_mfma_f32_16x16x32_bf16 v[148:151], a[80:83], a[100:103], v[148:151]
buffer_load_dwordx4 v6, s[48:51], s53 offen offset:0 lds
v_mfma_f32_16x16x32_bf16 v[152:155], a[80:83], a[104:107], v[152:155]
ds_read_b128 a[20:23], v1 offset:4352
v_mfma_f32_16x16x32_bf16 v[156:159], a[80:83], a[108:111], v[156:159]
v_mfma_f32_16x16x32_bf16 v[160:163], a[80:83], a[112:115], v[160:163]
ds_read_b64_tr_b16 a[56:57], v2 offset:192
v_mfma_f32_16x16x32_bf16 v[164:167], a[80:83], a[116:119], v[164:167]
v_mfma_f32_16x16x32_bf16 v[168:171], a[80:83], a[120:123], v[168:171]
ds_read_b64_tr_b16 a[58:59], v2 offset:4544
v_mfma_f32_16x16x32_bf16 v[172:175], a[80:83], a[124:127], v[172:175]
v_mfma_f32_16x16x32_bf16 v[204:207], a[84:87], a[124:127], v[204:207]
ds_read_b128 a[24:27], v1 offset:6144
v_mfma_f32_16x16x32_bf16 v[200:203], a[84:87], a[120:123], v[200:203]
buffer_load_dwordx4 v7, s[48:51], s53 offen offset:1088 lds
v_mfma_f32_16x16x32_bf16 v[196:199], a[84:87], a[116:119], v[196:199]
ds_read_b64_tr_b16 a[60:61], v3 offset:192
v_mfma_f32_16x16x32_bf16 v[192:195], a[84:87], a[112:115], v[192:195]
v_mfma_f32_16x16x32_bf16 v[188:191], a[84:87], a[108:111], v[188:191]
ds_read_b64_tr_b16 a[62:63], v3 offset:4544
v_mfma_f32_16x16x32_bf16 v[184:187], a[84:87], a[104:107], v[184:187]
v_mfma_f32_16x16x32_bf16 v[180:183], a[84:87], a[100:103], v[180:183]
ds_read_b128 a[28:31], v1 offset:6400
v_mfma_f32_16x16x32_bf16 v[176:179], a[84:87], a[96:99], v[176:179]
v_mfma_f32_16x16x32_bf16 v[208:211], a[88:91], a[96:99], v[208:211]
v_mfma_f32_16x16x32_bf16 v[212:215], a[88:91], a[100:103], v[212:215]
buffer_load_dwordx4 v8, s[48:51], s53 offen offset:2176 lds
v_mfma_f32_16x16x32_bf16 v[216:219], a[88:91], a[104:107], v[216:219]
v_mfma_f32_16x16x32_bf16 v[220:223], a[88:91], a[108:111], v[220:223]
v_mfma_f32_16x16x32_bf16 v[224:227], a[88:91], a[112:115], v[224:227]
v_mfma_f32_16x16x32_bf16 v[228:231], a[88:91], a[116:119], v[228:231]
v_mfma_f32_16x16x32_bf16 v[232:235], a[88:91], a[120:123], v[232:235]
v_mfma_f32_16x16x32_bf16 v[236:239], a[88:91], a[124:127], v[236:239]
v_mfma_f32_16x16x32_bf16 a[140:143], a[92:95], a[124:127], a[140:143]
v_mfma_f32_16x16x32_bf16 a[136:139], a[92:95], a[120:123], a[136:139]
buffer_load_dwordx4 v9, s[48:51], s53 offen offset:3264 lds
v_mfma_f32_16x16x32_bf16 a[132:135], a[92:95], a[116:119], a[132:135]
s_add_u32 s53, s53, s55
v_mfma_f32_16x16x32_bf16 a[128:131], a[92:95], a[112:115], a[128:131]
v_mfma_f32_16x16x32_bf16 v[252:255], a[92:95], a[108:111], v[252:255]
v_mfma_f32_16x16x32_bf16 v[248:251], a[92:95], a[104:107], v[248:251]
v_mfma_f32_16x16x32_bf16 v[244:247], a[92:95], a[100:103], v[244:247]
v_mfma_f32_16x16x32_bf16 v[240:243], a[92:95], a[96:99], v[240:243]
s_waitcnt vmcnt(48) lgkmcnt(0)
s_cbranch_vccnz rx_3
s_waitcnt vmcnt(16)
rx_3:
s_barrier
v_mfma_f32_16x16x32_bf16 v[16:19], a[0:3], a[32:35], v[16:19]
ds_read_b64_tr_b16 a[96:97], v2 offset:33792
s_add_u32 m0, s60, 67584
v_mfma_f32_16x16x32_bf16 v[20:23], a[0:3], a[36:39], v[20:23]
buffer_load_dwordx4 v4, s[44:47], s52 offen offset:0 lds
v_mfma_f32_16x16x32_bf16 v[24:27], a[0:3], a[40:43], v[24:27]
ds_read_b64_tr_b16 a[98:99], v2 offset:38144
v_mfma_f32_16x16x32_bf16 v[28:31], a[0:3], a[44:47], v[28:31]
v_mfma_f32_16x16x32_bf16 v[32:35], a[0:3], a[48:51], v[32:35]
ds_read_b128 a[64:67], v1 offset:33792
v_mfma_f32_16x16x32_bf16 v[36:39], a[0:3], a[52:55], v[36:39]
v_mfma_f32_16x16x32_bf16 v[40:43], a[0:3], a[56:59], v[40:43]
ds_read_b64_tr_b16 a[100:101], v3 offset:33792
v_mfma_f32_16x16x32_bf16 v[44:47], a[0:3], a[60:63], v[44:47]
v_mfma_f32_16x16x32_bf16 v[76:79], a[4:7], a[60:63], v[76:79]
ds_read_b64_tr_b16 a[102:103], v3 offset:38144
v_mfma_f32_16x16x32_bf16 v[72:75], a[4:7], a[56:59], v[72:75]
buffer_load_dwordx4 v4, s[44:47], s52 offen offset:1024 lds
v_mfma_f32_16x16x32_bf16 v[68:71], a[4:7], a[52:55], v[68:71]
ds_read_b128 a[68:71], v1 offset:34048
v_mfma_f32_16x16x32_bf16 v[64:67], a[4:7], a[48:51], v[64:67]
v_mfma_f32_16x16x32_bf16 v[60:63], a[4:7], a[44:47], v[60:63]
ds_read_b64_tr_b16 a[104:105], v2 offset:33856
v_mfma_f32_16x16x32_bf16 v[56:59], a[4:7], a[40:43], v[56:59]
v_mfma_f32_16x16x32_bf16 v[52:55], a[4:7], a[36:39], v[52:55]
ds_read_b64_tr_b16 a[106:107], v2 offset:38208
v_mfma_f32_16x16x32_bf16 v[48:51], a[4:7], a[32:35], v[48:51]
v_mfma_f32_16x16x32_bf16 v[80:83], a[8:11], a[32:35], v[80:83]
ds_read_b128 a[72:75], v1 offset:35840
v_mfma_f32_16x16x32_bf16 v[84:87], a[8:11], a[36:39], v[84:87]
buffer_load_dwordx4 v5, s[44:47], s52 offen offset:2048 lds
v_mfma_f32_16x16x32_bf16 v[88:91], a[8:11], a[40:43], v[88:91]
ds_read_b64_tr_b16 a[108:109], v3 offset:33856
v_mfma_f32_16x16x32_bf16 v[92:95], a[8:11], a[44:47], v[92:95]
v_mfma_f32_16x16x32_bf16 v[96:99], a[8:11], a[48:51], v[96:99]
ds_read_b64_tr_b16 a[110:111], v3 offset:38208
v_mfma_f32_16x16x32_bf16 v[100:103], a[8:11], a[52:55], v[100:103]
v_mfma_f32_16x16x32_bf16 v[104:107], a[8:11], a[56:59], v[104:107]
ds_read_b128 a[76:79], v1 offset:36096
v_mfma_f32_16x16x32_bf16 v[108:111], a[8:11], a[60:63], v[108:111]
v_mfma_f32_16x16x32_bf16 v[140:143], a[12:15], a[60:63], v[140:143]
ds_read_b64_tr_b16 a[112:113], v2 offset:33920
v_mfma_f32_16x16x32_bf16 v[136:139], a[12:15], a[56:59], v[136:139]
buffer_load_dwordx4 v5, s[44:47], s52 offen offset:3072 lds
v_mfma_f32_16x16x32_bf16 v[132:135], a[12:15], a[52:55], v[132:135]
ds_read_b64_tr_b16 a[114:115], v2 offset:38272
s_add_u32 s52, s52, 2048
v_mfma_f32_16x16x32_bf16 v[128:131], a[12:15], a[48:51], v[128:131]
v_mfma_f32_16x16x32_bf16 v[124:127], a[12:15], a[44:47], v[124:127]
ds_read_b128 a[80:83], v1 offset:37888
v_mfma_f32_16x16x32_bf16 v[120:123], a[12:15], a[40:43], v[120:123]
v_mfma_f32_16x16x32_bf16 v[116:119], a[12:15], a[36:39], v[116:119]
ds_read_b64_tr_b16 a[116:117], v3 offset:33920
v_mfma_f32_16x16x32_bf16 v[112:115], a[12:15], a[32:35], v[112:115]
v_mfma_f32_16x16x32_bf16 v[144:147], a[16:19], a[32:35], v[144:147]
ds_read_b64_tr_b16 a[118:119], v3 offset:38272
s_add_u32 m0, s54, 67584
v_mfma_f32_16x16x32_bf16 v[148:151], a[16:19], a[36:39], v[148:151]
buffer_load_dwordx4 v6, s[48:51], s53 offen offset:0 lds
v_mfma_f32_16x16x32_bf16 v[152:155], a[16:19], a[40:43], v[152:155]
ds_read_b128 a[84:87], v1 offset:38144
v_mfma_f32_16x16x32_bf16 v[156:159], a[16:19], a[44:47], v[156:159]
v_mfma_f32_16x16x32_bf16 v[160:163], a[16:19], a[48:51], v[160:163]
ds_read_b64_tr_b16 a[120:121], v2 offset:33984
v_mfma_f32_16x16x32_bf16 v[164:167], a[16:19], a[52:55], v[164:167]
v_mfma_f32_16x16x32_bf16 v[168:171], a[16:19], a[56:59], v[168:171]
ds_read_b64_tr_b16 a[122:123], v2 offset:38336
v_mfma_f32_16x16x32_bf16 v[172:175], a[16:19], a[60:63], v[172:175]
v_mfma_f32_16x16x32_bf16 v[204:207], a[20:23], a[60:63], v[204:207]
ds_read_b128 a[88:91], v1 offset:39936
v_mfma_f32_16x16x32_bf16 v[200:203], a[20:23], a[56:59], v[200:203]
buffer_load_dwordx4 v7, s[48:51], s53 offen offset:1088 lds
v_mfma_f32_16x16x32_bf16 v[196:199], a[20:23], a[52:55], v[196:199]
ds_read_b64_tr_b16 a[124:125], v3 offset:33984
v_mfma_f32_16x16x32_bf16 v[192:195], a[20:23], a[48:51], v[192:195]
v_mfma_f32_16x16x32_bf16 v[188:191], a[20:23], a[44:47], v[188:191]
ds_read_b64_tr_b16 a[126:127], v3 offset:38336
v_mfma_f32_16x16x32_bf16 v[184:187], a[20:23], a[40:43], v[184:187]
v_mfma_f32_16x16x32_bf16 v[180:183], a[20:23], a[36:39], v[180:183]
ds_read_b128 a[92:95], v1 offset:40192
v_mfma_f32_16x16x32_bf16 v[176:179], a[20:23], a[32:35], v[176:179]
v_mfma_f32_16x16x32_bf16 v[208:211], a[24:27], a[32:35], v[208:211]
v_add_u32 v1, 4294899712, v1
v_mfma_f32_16x16x32_bf16 v[212:215], a[24:27], a[36:39], v[212:215]
buffer_load_dwordx4 v8, s[48:51], s53 offen offset:2176 lds
v_mfma_f32_16x16x32_bf16 v[216:219], a[24:27], a[40:43], v[216:219]
v_add_u32 v2, 4294899712, v2
v_mfma_f32_16x16x32_bf16 v[220:223], a[24:27], a[44:47], v[220:223]
v_mfma_f32_16x16x32_bf16 v[224:227], a[24:27], a[48:51], v[224:227]
v_add_u32 v3, 4294899712, v3
v_mfma_f32_16x16x32_bf16 v[228:231], a[24:27], a[52:55], v[228:231]
v_mfma_f32_16x16x32_bf16 v[232:235], a[24:27], a[56:59], v[232:235]
v_mfma_f32_16x16x32_bf16 v[236:239], a[24:27], a[60:63], v[236:239]
v_mfma_f32_16x16x32_bf16 a[140:143], a[28:31], a[60:63], a[140:143]
v_mfma_f32_16x16x32_bf16 a[136:139], a[28:31], a[56:59], a[136:139]
buffer_load_dwordx4 v9, s[48:51], s53 offen offset:3264 lds
v_mfma_f32_16x16x32_bf16 a[132:135], a[28:31], a[52:55], a[132:135]
s_add_u32 s53, s53, s55
v_mfma_f32_16x16x32_bf16 a[128:131], a[28:31], a[48:51], a[128:131]
v_mfma_f32_16x16x32_bf16 v[252:255], a[28:31], a[44:47], v[252:255]
v_mfma_f32_16x16x32_bf16 v[248:251], a[28:31], a[40:43], v[248:251]
v_mfma_f32_16x16x32_bf16 v[244:247], a[28:31], a[36:39], v[244:247]
v_mfma_f32_16x16x32_bf16 v[240:243], a[28:31], a[32:35], v[240:243]
s_waitcnt vmcnt(16) lgkmcnt(0)
s_barrier
s_cbranch_vccz pb_4
s_mov_b64 vcc, 0
buffer_atomic_add v11, v10, s[4:7], s29 offen sc1
pb_4:
v_mfma_f32_16x16x32_bf16 v[16:19], a[64:67], a[96:99], v[16:19]
ds_read_b64_tr_b16 a[32:33], v2 offset:0
s_add_u32 m0, s60, 101376
v_mfma_f32_16x16x32_bf16 v[20:23], a[64:67], a[100:103], v[20:23]
buffer_load_dwordx4 v4, s[44:47], s52 offen offset:0 lds
v_mfma_f32_16x16x32_bf16 v[24:27], a[64:67], a[104:107], v[24:27]
ds_read_b64_tr_b16 a[34:35], v2 offset:4352
v_mfma_f32_16x16x32_bf16 v[28:31], a[64:67], a[108:111], v[28:31]
v_mfma_f32_16x16x32_bf16 v[32:35], a[64:67], a[112:115], v[32:35]
ds_read_b128 a[0:3], v1 offset:0
v_mfma_f32_16x16x32_bf16 v[36:39], a[64:67], a[116:119], v[36:39]
v_mfma_f32_16x16x32_bf16 v[40:43], a[64:67], a[120:123], v[40:43]
ds_read_b64_tr_b16 a[36:37], v3 offset:0
v_mfma_f32_16x16x32_bf16 v[44:47], a[64:67], a[124:127], v[44:47]
v_mfma_f32_16x16x32_bf16 v[76:79], a[68:71], a[124:127], v[76:79]
ds_read_b64_tr_b16 a[38:39], v3 offset:4352
v_mfma_f32_16x16x32_bf16 v[72:75], a[68:71], a[120:123], v[72:75]
buffer_load_dwordx4 v4, s[44:47], s52 offen offset:1024 lds
v_mfma_f32_16x16x32_bf16 v[68:71], a[68:71], a[116:119], v[68:71]
ds_read_b128 a[4:7], v1 offset:256
v_mfma_f32_16x16x32_bf16 v[64:67], a[68:71], a[112:115], v[64:67]
v_mfma_f32_16x16x32_bf16 v[60:63], a[68:71], a[108:111], v[60:63]
ds_read_b64_tr_b16 a[40:41], v2 offset:64
v_mfma_f32_16x16x32_bf16 v[56:59], a[68:71], a[104:107], v[56:59]
v_mfma_f32_16x16x32_bf16 v[52:55], a[68:71], a[100:103], v[52:55]
ds_read_b64_tr_b16 a[42:43], v2 offset:4416
v_mfma_f32_16x16x32_bf16 v[48:51], a[68:71], a[96:99], v[48:51]
v_mfma_f32_16x16x32_bf16 v[80:83], a[72:75], a[96:99], v[80:83]
ds_read_b128 a[8:11], v1 offset:2048
v_mfma_f32_16x16x32_bf16 v[84:87], a[72:75], a[100:103], v[84:87]
buffer_load_dwordx4 v5, s[44:47], s52 offen offset:2048 lds
v_mfma_f32_16x16x32_bf16 v[88:91], a[72:75], a[104:107], v[88:91]
ds_read_b64_tr_b16 a[44:45], v3 offset:64
v_mfma_f32_16x16x32_bf16 v[92:95], a[72:75], a[108:111], v[92:95]
v_mfma_f32_16x16x32_bf16 v[96:99], a[72:75], a[112:115], v[96:99]
ds_read_b64_tr_b16 a[46:47], v3 offset:4416
v_mfma_f32_16x16x32_bf16 v[100:103], a[72:75], a[116:119], v[100:103]
v_mfma_f32_16x16x32_bf16 v[104:107], a[72:75], a[120:123], v[104:107]
ds_read_b128 a[12:15], v1 offset:2304
v_mfma_f32_16x16x32_bf16 v[108:111], a[72:75], a[124:127], v[108:111]
v_mfma_f32_16x16x32_bf16 v[140:143], a[76:79], a[124:127], v[140:143]
ds_read_b64_tr_b16 a[48:49], v2 offset:128
v_mfma_f32_16x16x32_bf16 v[136:139], a[76:79], a[120:123], v[136:139]
buffer_load_dwordx4 v5, s[44:47], s52 offen offset:3072 lds
v_mfma_f32_16x16x32_bf16 v[132:135], a[76:79], a[116:119], v[132:135]
ds_read_b64_tr_b16 a[50:51], v2 offset:4480
s_add_u32 s52, s52, 2048
v_mfma_f32_16x16x32_bf16 v[128:131], a[76:79], a[112:115], v[128:131]
v_mfma_f32_16x16x32_bf16 v[124:127], a[76:79], a[108:111], v[124:127]
ds_read_b128 a[16:19], v1 offset:4096
v_mfma_f32_16x16x32_bf16 v[120:123], a[76:79], a[104:107], v[120:123]
v_mfma_f32_16x16x32_bf16 v[116:119], a[76:79], a[100:103], v[116:119]
ds_read_b64_tr_b16 a[52:53], v3 offset:128
v_mfma_f32_16x16x32_bf16 v[112:115], a[76:79], a[96:99], v[112:115]
v_mfma_f32_16x16x32_bf16 v[144:147], a[80:83], a[96:99], v[144:147]
ds_read_b64_tr_b16 a[54:55], v3 offset:4480
s_add_u32 m0, s54, 101376
v_mfma_f32_16x16x32_bf16 v[148:151], a[80:83], a[100:103], v[148:151]
buffer_load_dwordx4 v6, s[48:51], s53 offen offset:0 lds
v_mfma_f32_16x16x32_bf16 v[152:155], a[80:83], a[104:107], v[152:155]
ds_read_b128 a[20:23], v1 offset:4352
v_mfma_f32_16x16x32_bf16 v[156:159], a[80:83], a[108:111], v[156:159]
v_mfma_f32_16x16x32_bf16 v[160:163], a[80:83], a[112:115], v[160:163]
ds_read_b64_tr_b16 a[56:57], v2 offset:192
v_mfma_f32_16x16x32_bf16 v[164:167], a[80:83], a[116:119], v[164:167]
v_mfma_f32_16x16x32_bf16 v[168:171], a[80:83], a[120:123], v[168:171]
ds_read_b64_tr_b16 a[58:59], v2 offset:4544
v_mfma_f32_16x16x32_bf16 v[172:175], a[80:83], a[124:127], v[172:175]
v_mfma_f32_16x16x32_bf16 v[204:207], a[84:87], a[124:127], v[204:207]
ds_read_b128 a[24:27], v1 offset:6144
v_mfma_f32_16x16x32_bf16 v[200:203], a[84:87], a[120:123], v[200:203]
buffer_load_dwordx4 v7, s[48:51], s53 offen offset:1088 lds
v_mfma_f32_16x16x32_bf16 v[196:199], a[84:87], a[116:119], v[196:199]
ds_read_b64_tr_b16 a[60:61], v3 offset:192
v_mfma_f32_16x16x32_bf16 v[192:195], a[84:87], a[112:115], v[192:195]
v_mfma_f32_16x16x32_bf16 v[188:191], a[84:87], a[108:111], v[188:191]
ds_read_b64_tr_b16 a[62:63], v3 offset:4544
v_mfma_f32_16x16x32_bf16 v[184:187], a[84:87], a[104:107], v[184:187]
v_mfma_f32_16x16x32_bf16 v[180:183], a[84:87], a[100:103], v[180:183]
ds_read_b128 a[28:31], v1 offset:6400
v_mfma_f32_16x16x32_bf16 v[176:179], a[84:87], a[96:99], v[176:179]
v_mfma_f32_16x16x32_bf16 v[208:211], a[88:91], a[96:99], v[208:211]
v_mfma_f32_16x16x32_bf16 v[212:215], a[88:91], a[100:103], v[212:215]
buffer_load_dwordx4 v8, s[48:51], s53 offen offset:2176 lds
v_mfma_f32_16x16x32_bf16 v[216:219], a[88:91], a[104:107], v[216:219]
v_mfma_f32_16x16x32_bf16 v[220:223], a[88:91], a[108:111], v[220:223]
v_mfma_f32_16x16x32_bf16 v[224:227], a[88:91], a[112:115], v[224:227]
v_mfma_f32_16x16x32_bf16 v[228:231], a[88:91], a[116:119], v[228:231]
v_mfma_f32_16x16x32_bf16 v[232:235], a[88:91], a[120:123], v[232:235]
v_mfma_f32_16x16x32_bf16 v[236:239], a[88:91], a[124:127], v[236:239]
v_mfma_f32_16x16x32_bf16 a[140:143], a[92:95], a[124:127], a[140:143]
v_mfma_f32_16x16x32_bf16 a[136:139], a[92:95], a[120:123], a[136:139]
buffer_load_dwordx4 v9, s[48:51], s53 offen offset:3264 lds
v_mfma_f32_16x16x32_bf16 a[132:135], a[92:95], a[116:119], a[132:135]
s_add_u32 s53, s53, s55
v_mfma_f32_16x16x32_bf16 a[128:131], a[92:95], a[112:115], a[128:131]
v_mfma_f32_16x16x32_bf16 v[252:255], a[92:95], a[108:111], v[252:255]
v_mfma_f32_16x16x32_bf16 v[248:251], a[92:95], a[104:107], v[248:251]
v_mfma_f32_16x16x32_bf16 v[244:247], a[92:95], a[100:103], v[244:247]
v_mfma_f32_16x16x32_bf16 v[240:243], a[92:95], a[96:99], v[240:243]
s_sub_u32 s56, s56, 1
s_cmp_eq_u32 s56, 0
s_cbranch_scc1 m_g_N_x
m_g_N_c:
s_waitcnt vmcnt(16) lgkmcnt(0)
s_barrier
s_cmp_eq_u32 s56, 1
s_cbranch_scc0 m_g_N_h_s
v_cmp_gt_u32 s[62:63], 4, v14
s_and_b32 s62, s62, s27
s_cselect_b32 s28, 1, s28
s_cmp_eq_u32 s28, 0
s_cbranch_scc1 m_g_N_h_w
s_mov_b32 s46, 0
s_mov_b32 s50, 0
s_branch m_g_N_h_s
m_g_N_h_w:
s_and_b32 s63, s25, 15
s_bfe_u32 s64, s25, 0x30004
s_bfe_u32 s65, s25, 0x40007
s_bfe_u32 s66, s25, 0x4000b
s_mov_b32 s46, 268435456
s_lshl_b32 s53, s65, 9
s_sub_u32 s62, s63, 4
s_cmp_lt_u32 s62, 3
s_cbranch_scc1 m_g_N_h_fw
s_lshl_b32 s52, s64, 19
s_mov_b32 s57, 65536
s_mov_b64 s[48:49], s[90:91]
s_cmp_eq_u32 s63, 0
s_cselect_b64 s[48:49], s[86:87], s[48:49]
s_cmp_eq_u32 s63, 1
s_cselect_b64 s[48:49], s[88:89], s[48:49]
s_cmp_eq_u32 s63, 3
s_cselect_b64 s[48:49], s[92:93], s[48:49]
s_cselect_b32 s58, 7168, 0
s_cselect_b32 s62, 0, 8192
s_or_b32 s58, s58, s62
s_lshl_b32 s50, s58, 10
s_branch m_g_N_h_l
m_g_N_h_fw:
s_lshl_b32 s62, s66, 19
s_add_u32 s53, s53, s62
s_mov_b32 s58, 2048
s_cmp_eq_u32 s63, 5
s_cselect_b64 s[48:49], s[96:97], s[94:95]
s_mov_b32 s50, 7340032
s_cselect_b32 s50, 8388608, s50
s_mov_b32 s57, 229376
s_cselect_b32 s57, 262144, s57
s_mov_b32 s52, 92274688
s_cselect_b32 s52, 109051904, s52
s_mul_i32 s62, s64, s57
s_lshl_b32 s62, s62, 3
s_add_u32 s52, s52, s62
s_lshl_b32 s62, s66, 14
s_add_u32 s52, s52, s62
m_g_N_h_l:
s_mul_i32 s62, s14, 2
s_mul_i32 s62, s62, s57
v_lshl_add_u32 v4, v0, 4, s62
s_sub_u32 s62, s57, 2048
v_add_u32 v5, s62, v4
v_lshrrev_b32 v12, 5, v0
v_and_b32 v6, 31, v0
v_xor_b32 v6, v6, v12
v_lshlrev_b32 v6, 4, v6
s_lshl_b32 s62, s14, 3
v_add_u32 v12, s62, v12
v_mad_u32_u24 v6, v12, s58, v6
s_lshl_b32 s62, s58, 1
s_sub_u32 s62, s62, 1088
v_add_u32 v7, s62, v6
v_add_u32 v8, s62, v7
v_add_u32 v9, s62, v8
s_lshl_b32 s55, s58, 5
m_g_N_h_s:
buffer_load_dword v14, v13, s[4:7], s26 offen sc1
v_mfma_f32_16x16x32_bf16 v[16:19], a[0:3], a[32:35], v[16:19]
ds_read_b64_tr_b16 a[96:97], v2 offset:33792
s_add_u32 m0, s60, 0
v_mfma_f32_16x16x32_bf16 v[20:23], a[0:3], a[36:39], v[20:23]
buffer_load_dwordx4 v4, s[44:47], s52 offen offset:0 lds
v_mfma_f32_16x16x32_bf16 v[24:27], a[0:3], a[40:43], v[24:27]
ds_read_b64_tr_b16 a[98:99], v2 offset:38144
v_mfma_f32_16x16x32_bf16 v[28:31], a[0:3], a[44:47], v[28:31]
v_mfma_f32_16x16x32_bf16 v[32:35], a[0:3], a[48:51], v[32:35]
ds_read_b128 a[64:67], v1 offset:33792
v_mfma_f32_16x16x32_bf16 v[36:39], a[0:3], a[52:55], v[36:39]
v_mfma_f32_16x16x32_bf16 v[40:43], a[0:3], a[56:59], v[40:43]
ds_read_b64_tr_b16 a[100:101], v3 offset:33792
v_mfma_f32_16x16x32_bf16 v[44:47], a[0:3], a[60:63], v[44:47]
v_mfma_f32_16x16x32_bf16 v[76:79], a[4:7], a[60:63], v[76:79]
ds_read_b64_tr_b16 a[102:103], v3 offset:38144
v_mfma_f32_16x16x32_bf16 v[72:75], a[4:7], a[56:59], v[72:75]
buffer_load_dwordx4 v4, s[44:47], s52 offen offset:1024 lds
v_mfma_f32_16x16x32_bf16 v[68:71], a[4:7], a[52:55], v[68:71]
ds_read_b128 a[68:71], v1 offset:34048
v_mfma_f32_16x16x32_bf16 v[64:67], a[4:7], a[48:51], v[64:67]
v_mfma_f32_16x16x32_bf16 v[60:63], a[4:7], a[44:47], v[60:63]
ds_read_b64_tr_b16 a[104:105], v2 offset:33856
v_mfma_f32_16x16x32_bf16 v[56:59], a[4:7], a[40:43], v[56:59]
v_mfma_f32_16x16x32_bf16 v[52:55], a[4:7], a[36:39], v[52:55]
ds_read_b64_tr_b16 a[106:107], v2 offset:38208
v_mfma_f32_16x16x32_bf16 v[48:51], a[4:7], a[32:35], v[48:51]
v_mfma_f32_16x16x32_bf16 v[80:83], a[8:11], a[32:35], v[80:83]
ds_read_b128 a[72:75], v1 offset:35840
v_mfma_f32_16x16x32_bf16 v[84:87], a[8:11], a[36:39], v[84:87]
buffer_load_dwordx4 v5, s[44:47], s52 offen offset:2048 lds
v_mfma_f32_16x16x32_bf16 v[88:91], a[8:11], a[40:43], v[88:91]
ds_read_b64_tr_b16 a[108:109], v3 offset:33856
v_mfma_f32_16x16x32_bf16 v[92:95], a[8:11], a[44:47], v[92:95]
v_mfma_f32_16x16x32_bf16 v[96:99], a[8:11], a[48:51], v[96:99]
ds_read_b64_tr_b16 a[110:111], v3 offset:38208
v_mfma_f32_16x16x32_bf16 v[100:103], a[8:11], a[52:55], v[100:103]
v_mfma_f32_16x16x32_bf16 v[104:107], a[8:11], a[56:59], v[104:107]
ds_read_b128 a[76:79], v1 offset:36096
v_mfma_f32_16x16x32_bf16 v[108:111], a[8:11], a[60:63], v[108:111]
v_mfma_f32_16x16x32_bf16 v[140:143], a[12:15], a[60:63], v[140:143]
ds_read_b64_tr_b16 a[112:113], v2 offset:33920
v_mfma_f32_16x16x32_bf16 v[136:139], a[12:15], a[56:59], v[136:139]
buffer_load_dwordx4 v5, s[44:47], s52 offen offset:3072 lds
v_mfma_f32_16x16x32_bf16 v[132:135], a[12:15], a[52:55], v[132:135]
ds_read_b64_tr_b16 a[114:115], v2 offset:38272
s_add_u32 s52, s52, 2048
v_mfma_f32_16x16x32_bf16 v[128:131], a[12:15], a[48:51], v[128:131]
v_mfma_f32_16x16x32_bf16 v[124:127], a[12:15], a[44:47], v[124:127]
ds_read_b128 a[80:83], v1 offset:37888
v_mfma_f32_16x16x32_bf16 v[120:123], a[12:15], a[40:43], v[120:123]
v_mfma_f32_16x16x32_bf16 v[116:119], a[12:15], a[36:39], v[116:119]
ds_read_b64_tr_b16 a[116:117], v3 offset:33920
v_mfma_f32_16x16x32_bf16 v[112:115], a[12:15], a[32:35], v[112:115]
v_mfma_f32_16x16x32_bf16 v[144:147], a[16:19], a[32:35], v[144:147]
ds_read_b64_tr_b16 a[118:119], v3 offset:38272
s_add_u32 m0, s54, 0
v_mfma_f32_16x16x32_bf16 v[148:151], a[16:19], a[36:39], v[148:151]
buffer_load_dwordx4 v6, s[48:51], s53 offen offset:0 lds
v_mfma_f32_16x16x32_bf16 v[152:155], a[16:19], a[40:43], v[152:155]
ds_read_b128 a[84:87], v1 offset:38144
v_mfma_f32_16x16x32_bf16 v[156:159], a[16:19], a[44:47], v[156:159]
v_mfma_f32_16x16x32_bf16 v[160:163], a[16:19], a[48:51], v[160:163]
ds_read_b64_tr_b16 a[120:121], v2 offset:33984
v_mfma_f32_16x16x32_bf16 v[164:167], a[16:19], a[52:55], v[164:167]
v_mfma_f32_16x16x32_bf16 v[168:171], a[16:19], a[56:59], v[168:171]
ds_read_b64_tr_b16 a[122:123], v2 offset:38336
v_mfma_f32_16x16x32_bf16 v[172:175], a[16:19], a[60:63], v[172:175]
v_mfma_f32_16x16x32_bf16 v[204:207], a[20:23], a[60:63], v[204:207]
ds_read_b128 a[88:91], v1 offset:39936
v_mfma_f32_16x16x32_bf16 v[200:203], a[20:23], a[56:59], v[200:203]
buffer_load_dwordx4 v7, s[48:51], s53 offen offset:1088 lds
v_mfma_f32_16x16x32_bf16 v[196:199], a[20:23], a[52:55], v[196:199]
ds_read_b64_tr_b16 a[124:125], v3 offset:33984
v_mfma_f32_16x16x32_bf16 v[192:195], a[20:23], a[48:51], v[192:195]
v_mfma_f32_16x16x32_bf16 v[188:191], a[20:23], a[44:47], v[188:191]
ds_read_b64_tr_b16 a[126:127], v3 offset:38336
v_mfma_f32_16x16x32_bf16 v[184:187], a[20:23], a[40:43], v[184:187]
v_mfma_f32_16x16x32_bf16 v[180:183], a[20:23], a[36:39], v[180:183]
ds_read_b128 a[92:95], v1 offset:40192
v_mfma_f32_16x16x32_bf16 v[176:179], a[20:23], a[32:35], v[176:179]
v_mfma_f32_16x16x32_bf16 v[208:211], a[24:27], a[32:35], v[208:211]
v_add_u32 v1, 67584, v1
v_mfma_f32_16x16x32_bf16 v[212:215], a[24:27], a[36:39], v[212:215]
buffer_load_dwordx4 v8, s[48:51], s53 offen offset:2176 lds
v_mfma_f32_16x16x32_bf16 v[216:219], a[24:27], a[40:43], v[216:219]
v_add_u32 v2, 67584, v2
v_mfma_f32_16x16x32_bf16 v[220:223], a[24:27], a[44:47], v[220:223]
v_mfma_f32_16x16x32_bf16 v[224:227], a[24:27], a[48:51], v[224:227]
v_add_u32 v3, 67584, v3
v_mfma_f32_16x16x32_bf16 v[228:231], a[24:27], a[52:55], v[228:231]
v_mfma_f32_16x16x32_bf16 v[232:235], a[24:27], a[56:59], v[232:235]
v_mfma_f32_16x16x32_bf16 v[236:239], a[24:27], a[60:63], v[236:239]
v_mfma_f32_16x16x32_bf16 a[140:143], a[28:31], a[60:63], a[140:143]
v_mfma_f32_16x16x32_bf16 a[136:139], a[28:31], a[56:59], a[136:139]
buffer_load_dwordx4 v9, s[48:51], s53 offen offset:3264 lds
v_mfma_f32_16x16x32_bf16 a[132:135], a[28:31], a[52:55], a[132:135]
s_add_u32 s53, s53, s55
v_mfma_f32_16x16x32_bf16 a[128:131], a[28:31], a[48:51], a[128:131]
v_mfma_f32_16x16x32_bf16 v[252:255], a[28:31], a[44:47], v[252:255]
v_mfma_f32_16x16x32_bf16 v[248:251], a[28:31], a[40:43], v[248:251]
v_mfma_f32_16x16x32_bf16 v[244:247], a[28:31], a[36:39], v[244:247]
v_mfma_f32_16x16x32_bf16 v[240:243], a[28:31], a[32:35], v[240:243]
s_branch m_g_N_l
m_g_N_x:
v_readlane_b32 s59, v14, 32
s_lshl_b32 s62, s19, 1
s_add_u32 s62, s62, s32
s_mul_i32 s62, s62, 2097152
s_lshl_b32 s63, s20, 1
s_add_u32 s63, s63, s33
s_lshl_b32 s63, s63, 14
s_add_u32 s23, s62, s63
s_add_u32 s23, s23, 58720256
s_lshl_b32 s62, s32, 13
s_xor_b32 s62, s62, s34
s_add_u32 s23, s23, s62
s_lshl_b32 s21, s19, 4
s_add_u32 s21, s21, s20
s_lshl_b32 s21, s21, 6
s_add_u32 s21, s21, 170926080
v_lshrrev_b32 v10, 4, v0
v_lshlrev_b32 v10, 9, v10
v_bfe_u32 v11, v0, 3, 1
v_lshl_add_u32 v10, v11, 8, v10
v_and_b32 v11, 7, v0
v_lshl_add_u32 v10, v11, 4, v10
s_add_u32 s62, s23, 0
s_xor_b32 s63, s62, 8192
v_cvt_pk_bf16_f32 v16, v16, v17
v_cvt_pk_bf16_f32 v17, v18, v19
v_cvt_pk_bf16_f32 v18, v48, v49
v_cvt_pk_bf16_f32 v19, v50, v51
buffer_store_dwordx4 v[16:19], v10, s[4:7], s62 offen offset:0 sc1
buffer_store_dwordx4 v[16:19], v10, s[4:7], s63 offen offset:0 sc1
v_cvt_pk_bf16_f32 v20, v20, v21
v_cvt_pk_bf16_f32 v21, v22, v23
v_cvt_pk_bf16_f32 v22, v52, v53
v_cvt_pk_bf16_f32 v23, v54, v55
buffer_store_dwordx4 v[20:23], v10, s[4:7], s62 offen offset:128 sc1
buffer_store_dwordx4 v[20:23], v10, s[4:7], s63 offen offset:128 sc1
v_cvt_pk_bf16_f32 v24, v24, v25
v_cvt_pk_bf16_f32 v25, v26, v27
v_cvt_pk_bf16_f32 v26, v56, v57
v_cvt_pk_bf16_f32 v27, v58, v59
buffer_store_dwordx4 v[24:27], v10, s[4:7], s62 offen offset:2048 sc1
buffer_store_dwordx4 v[24:27], v10, s[4:7], s63 offen offset:2048 sc1
v_cvt_pk_bf16_f32 v28, v28, v29
v_cvt_pk_bf16_f32 v29, v30, v31
v_cvt_pk_bf16_f32 v30, v60, v61
v_cvt_pk_bf16_f32 v31, v62, v63
buffer_store_dwordx4 v[28:31], v10, s[4:7], s62 offen offset:2176 sc1
buffer_store_dwordx4 v[28:31], v10, s[4:7], s63 offen offset:2176 sc1
s_add_u32 s62, s23, 4096
s_xor_b32 s63, s62, 8192
v_cvt_pk_bf16_f32 v32, v32, v33
v_cvt_pk_bf16_f32 v33, v34, v35
v_cvt_pk_bf16_f32 v34, v64, v65
v_cvt_pk_bf16_f32 v35, v66, v67
buffer_store_dwordx4 v[32:35], v10, s[4:7], s62 offen offset:0 sc1
buffer_store_dwordx4 v[32:35], v10, s[4:7], s63 offen offset:0 sc1
v_cvt_pk_bf16_f32 v36, v36, v37
v_cvt_pk_bf16_f32 v37, v38, v39
v_cvt_pk_bf16_f32 v38, v68, v69
v_cvt_pk_bf16_f32 v39, v70, v71
buffer_store_dwordx4 v[36:39], v10, s[4:7], s62 offen offset:128 sc1
buffer_store_dwordx4 v[36:39], v10, s[4:7], s63 offen offset:128 sc1
v_cvt_pk_bf16_f32 v40, v40, v41
v_cvt_pk_bf16_f32 v41, v42, v43
v_cvt_pk_bf16_f32 v42, v72, v73
v_cvt_pk_bf16_f32 v43, v74, v75
buffer_store_dwordx4 v[40:43], v10, s[4:7], s62 offen offset:2048 sc1
buffer_store_dwordx4 v[40:43], v10, s[4:7], s63 offen offset:2048 sc1
v_cvt_pk_bf16_f32 v44, v44, v45
v_cvt_pk_bf16_f32 v45, v46, v47
v_cvt_pk_bf16_f32 v46, v76, v77
v_cvt_pk_bf16_f32 v47, v78, v79
buffer_store_dwordx4 v[44:47], v10, s[4:7], s62 offen offset:2176 sc1
buffer_store_dwordx4 v[44:47], v10, s[4:7], s63 offen offset:2176 sc1
s_add_u32 s62, s23, 524288
s_xor_b32 s63, s62, 8192
v_cvt_pk_bf16_f32 v80, v80, v81
v_cvt_pk_bf16_f32 v81, v82, v83
v_cvt_pk_bf16_f32 v82, v112, v113
v_cvt_pk_bf16_f32 v83, v114, v115
buffer_store_dwordx4 v[80:83], v10, s[4:7], s62 offen offset:0 sc1
buffer_store_dwordx4 v[80:83], v10, s[4:7], s63 offen offset:0 sc1
v_cvt_pk_bf16_f32 v84, v84, v85
v_cvt_pk_bf16_f32 v85, v86, v87
v_cvt_pk_bf16_f32 v86, v116, v117
v_cvt_pk_bf16_f32 v87, v118, v119
buffer_store_dwordx4 v[84:87], v10, s[4:7], s62 offen offset:128 sc1
buffer_store_dwordx4 v[84:87], v10, s[4:7], s63 offen offset:128 sc1
v_cvt_pk_bf16_f32 v88, v88, v89
v_cvt_pk_bf16_f32 v89, v90, v91
v_cvt_pk_bf16_f32 v90, v120, v121
v_cvt_pk_bf16_f32 v91, v122, v123
buffer_store_dwordx4 v[88:91], v10, s[4:7], s62 offen offset:2048 sc1
buffer_store_dwordx4 v[88:91], v10, s[4:7], s63 offen offset:2048 sc1
v_cvt_pk_bf16_f32 v92, v92, v93
v_cvt_pk_bf16_f32 v93, v94, v95
v_cvt_pk_bf16_f32 v94, v124, v125
v_cvt_pk_bf16_f32 v95, v126, v127
buffer_store_dwordx4 v[92:95], v10, s[4:7], s62 offen offset:2176 sc1
buffer_store_dwordx4 v[92:95], v10, s[4:7], s63 offen offset:2176 sc1
s_add_u32 s62, s23, 528384
s_xor_b32 s63, s62, 8192
v_cvt_pk_bf16_f32 v96, v96, v97
v_cvt_pk_bf16_f32 v97, v98, v99
v_cvt_pk_bf16_f32 v98, v128, v129
v_cvt_pk_bf16_f32 v99, v130, v131
buffer_store_dwordx4 v[96:99], v10, s[4:7], s62 offen offset:0 sc1
buffer_store_dwordx4 v[96:99], v10, s[4:7], s63 offen offset:0 sc1
v_cvt_pk_bf16_f32 v100, v100, v101
v_cvt_pk_bf16_f32 v101, v102, v103
v_cvt_pk_bf16_f32 v102, v132, v133
v_cvt_pk_bf16_f32 v103, v134, v135
buffer_store_dwordx4 v[100:103], v10, s[4:7], s62 offen offset:128 sc1
buffer_store_dwordx4 v[100:103], v10, s[4:7], s63 offen offset:128 sc1
v_cvt_pk_bf16_f32 v104, v104, v105
v_cvt_pk_bf16_f32 v105, v106, v107
v_cvt_pk_bf16_f32 v106, v136, v137
v_cvt_pk_bf16_f32 v107, v138, v139
buffer_store_dwordx4 v[104:107], v10, s[4:7], s62 offen offset:2048 sc1
buffer_store_dwordx4 v[104:107], v10, s[4:7], s63 offen offset:2048 sc1
v_cvt_pk_bf16_f32 v108, v108, v109
v_cvt_pk_bf16_f32 v109, v110, v111
v_cvt_pk_bf16_f32 v110, v140, v141
v_cvt_pk_bf16_f32 v111, v142, v143
buffer_store_dwordx4 v[108:111], v10, s[4:7], s62 offen offset:2176 sc1
buffer_store_dwordx4 v[108:111], v10, s[4:7], s63 offen offset:2176 sc1
s_add_u32 s62, s23, 1048576
s_xor_b32 s63, s62, 8192
v_cvt_pk_bf16_f32 v144, v144, v145
v_cvt_pk_bf16_f32 v145, v146, v147
v_cvt_pk_bf16_f32 v146, v176, v177
v_cvt_pk_bf16_f32 v147, v178, v179
buffer_store_dwordx4 v[144:147], v10, s[4:7], s62 offen offset:0 sc1
buffer_store_dwordx4 v[144:147], v10, s[4:7], s63 offen offset:0 sc1
v_cvt_pk_bf16_f32 v148, v148, v149
v_cvt_pk_bf16_f32 v149, v150, v151
v_cvt_pk_bf16_f32 v150, v180, v181
v_cvt_pk_bf16_f32 v151, v182, v183
buffer_store_dwordx4 v[148:151], v10, s[4:7], s62 offen offset:128 sc1
buffer_store_dwordx4 v[148:151], v10, s[4:7], s63 offen offset:128 sc1
v_cvt_pk_bf16_f32 v152, v152, v153
v_cvt_pk_bf16_f32 v153, v154, v155
v_cvt_pk_bf16_f32 v154, v184, v185
v_cvt_pk_bf16_f32 v155, v186, v187
buffer_store_dwordx4 v[152:155], v10, s[4:7], s62 offen offset:2048 sc1
buffer_store_dwordx4 v[152:155], v10, s[4:7], s63 offen offset:2048 sc1
v_cvt_pk_bf16_f32 v156, v156, v157
v_cvt_pk_bf16_f32 v157, v158, v159
v_cvt_pk_bf16_f32 v158, v188, v189
v_cvt_pk_bf16_f32 v159, v190, v191
buffer_store_dwordx4 v[156:159], v10, s[4:7], s62 offen offset:2176 sc1
buffer_store_dwordx4 v[156:159], v10, s[4:7], s63 offen offset:2176 sc1
s_add_u32 s62, s23, 1052672
s_xor_b32 s63, s62, 8192
v_cvt_pk_bf16_f32 v160, v160, v161
v_cvt_pk_bf16_f32 v161, v162, v163
v_cvt_pk_bf16_f32 v162, v192, v193
v_cvt_pk_bf16_f32 v163, v194, v195
buffer_store_dwordx4 v[160:163], v10, s[4:7], s62 offen offset:0 sc1
buffer_store_dwordx4 v[160:163], v10, s[4:7], s63 offen offset:0 sc1
v_cvt_pk_bf16_f32 v164, v164, v165
v_cvt_pk_bf16_f32 v165, v166, v167
v_cvt_pk_bf16_f32 v166, v196, v197
v_cvt_pk_bf16_f32 v167, v198, v199
buffer_store_dwordx4 v[164:167], v10, s[4:7], s62 offen offset:128 sc1
buffer_store_dwordx4 v[164:167], v10, s[4:7], s63 offen offset:128 sc1
v_cvt_pk_bf16_f32 v168, v168, v169
v_cvt_pk_bf16_f32 v169, v170, v171
v_cvt_pk_bf16_f32 v170, v200, v201
v_cvt_pk_bf16_f32 v171, v202, v203
buffer_store_dwordx4 v[168:171], v10, s[4:7], s62 offen offset:2048 sc1
buffer_store_dwordx4 v[168:171], v10, s[4:7], s63 offen offset:2048 sc1
v_cvt_pk_bf16_f32 v172, v172, v173
v_cvt_pk_bf16_f32 v173, v174, v175
v_cvt_pk_bf16_f32 v174, v204, v205
v_cvt_pk_bf16_f32 v175, v206, v207
buffer_store_dwordx4 v[172:175], v10, s[4:7], s62 offen offset:2176 sc1
buffer_store_dwordx4 v[172:175], v10, s[4:7], s63 offen offset:2176 sc1
s_add_u32 s62, s23, 1572864
s_xor_b32 s63, s62, 8192
v_cvt_pk_bf16_f32 v208, v208, v209
v_cvt_pk_bf16_f32 v209, v210, v211
v_cvt_pk_bf16_f32 v210, v240, v241
v_cvt_pk_bf16_f32 v211, v242, v243
buffer_store_dwordx4 v[208:211], v10, s[4:7], s62 offen offset:0 sc1
buffer_store_dwordx4 v[208:211], v10, s[4:7], s63 offen offset:0 sc1
v_cvt_pk_bf16_f32 v212, v212, v213
v_cvt_pk_bf16_f32 v213, v214, v215
v_cvt_pk_bf16_f32 v214, v244, v245
v_cvt_pk_bf16_f32 v215, v246, v247
buffer_store_dwordx4 v[212:215], v10, s[4:7], s62 offen offset:128 sc1
buffer_store_dwordx4 v[212:215], v10, s[4:7], s63 offen offset:128 sc1
v_cvt_pk_bf16_f32 v216, v216, v217
v_cvt_pk_bf16_f32 v217, v218, v219
v_cvt_pk_bf16_f32 v218, v248, v249
v_cvt_pk_bf16_f32 v219, v250, v251
buffer_store_dwordx4 v[216:219], v10, s[4:7], s62 offen offset:2048 sc1
buffer_store_dwordx4 v[216:219], v10, s[4:7], s63 offen offset:2048 sc1
v_cvt_pk_bf16_f32 v220, v220, v221
v_cvt_pk_bf16_f32 v221, v222, v223
v_cvt_pk_bf16_f32 v222, v252, v253
v_cvt_pk_bf16_f32 v223, v254, v255
buffer_store_dwordx4 v[220:223], v10, s[4:7], s62 offen offset:2176 sc1
buffer_store_dwordx4 v[220:223], v10, s[4:7], s63 offen offset:2176 sc1
s_add_u32 s62, s23, 1576960
s_xor_b32 s63, s62, 8192
v_accvgpr_read_b32 v20, a128
v_accvgpr_read_b32 v21, a129
v_accvgpr_read_b32 v22, a130
v_accvgpr_read_b32 v23, a131
v_cvt_pk_bf16_f32 v224, v224, v225
v_cvt_pk_bf16_f32 v225, v226, v227
v_cvt_pk_bf16_f32 v226, v20, v21
v_cvt_pk_bf16_f32 v227, v22, v23
buffer_store_dwordx4 v[224:227], v10, s[4:7], s62 offen offset:0 sc1
buffer_store_dwordx4 v[224:227], v10, s[4:7], s63 offen offset:0 sc1
v_accvgpr_read_b32 v20, a132
v_accvgpr_read_b32 v21, a133
v_accvgpr_read_b32 v22, a134
v_accvgpr_read_b32 v23, a135
v_cvt_pk_bf16_f32 v228, v228, v229
v_cvt_pk_bf16_f32 v229, v230, v231
v_cvt_pk_bf16_f32 v230, v20, v21
v_cvt_pk_bf16_f32 v231, v22, v23
buffer_store_dwordx4 v[228:231], v10, s[4:7], s62 offen offset:128 sc1
buffer_store_dwordx4 v[228:231], v10, s[4:7], s63 offen offset:128 sc1
v_accvgpr_read_b32 v20, a136
v_accvgpr_read_b32 v21, a137
v_accvgpr_read_b32 v22, a138
v_accvgpr_read_b32 v23, a139
v_cvt_pk_bf16_f32 v232, v232, v233
v_cvt_pk_bf16_f32 v233, v234, v235
v_cvt_pk_bf16_f32 v234, v20, v21
v_cvt_pk_bf16_f32 v235, v22, v23
buffer_store_dwordx4 v[232:235], v10, s[4:7], s62 offen offset:2048 sc1
buffer_store_dwordx4 v[232:235], v10, s[4:7], s63 offen offset:2048 sc1
v_accvgpr_read_b32 v20, a140
v_accvgpr_read_b32 v21, a141
v_accvgpr_read_b32 v22, a142
v_accvgpr_read_b32 v23, a143
v_cvt_pk_bf16_f32 v236, v236, v237
v_cvt_pk_bf16_f32 v237, v238, v239
v_cvt_pk_bf16_f32 v238, v20, v21
v_cvt_pk_bf16_f32 v239, v22, v23
buffer_store_dwordx4 v[236:239], v10, s[4:7], s62 offen offset:2176 sc1
buffer_store_dwordx4 v[236:239], v10, s[4:7], s63 offen offset:2176 sc1
s_branch m_g_nx0
m_g_T_f:
s_waitcnt vmcnt(48) lgkmcnt(0)
s_cbranch_vccnz rx_6
s_waitcnt vmcnt(16)
rx_6:
s_barrier
buffer_load_dword v14, v13, s[4:7], s26 offen sc1
v_mfma_f32_16x16x32_bf16 v[16:19], a[32:35], a[0:3], 0
ds_read_b64_tr_b16 a[96:97], v2 offset:33792
s_add_u32 m0, s60, 0
v_mfma_f32_16x16x32_bf16 v[20:23], a[36:39], a[0:3], 0
buffer_load_dwordx4 v4, s[44:47], s52 offen offset:0 lds
v_mfma_f32_16x16x32_bf16 v[24:27], a[40:43], a[0:3], 0
ds_read_b64_tr_b16 a[98:99], v2 offset:38144
v_mfma_f32_16x16x32_bf16 v[28:31], a[44:47], a[0:3], 0
v_mfma_f32_16x16x32_bf16 v[32:35], a[48:51], a[0:3], 0
ds_read_b128 a[64:67], v1 offset:33792
v_mfma_f32_16x16x32_bf16 v[36:39], a[52:55], a[0:3], 0
v_mfma_f32_16x16x32_bf16 v[40:43], a[56:59], a[0:3], 0
ds_read_b64_tr_b16 a[100:101], v3 offset:33792
v_mfma_f32_16x16x32_bf16 v[44:47], a[60:63], a[0:3], 0
v_mfma_f32_16x16x32_bf16 v[76:79], a[60:63], a[4:7], 0
ds_read_b64_tr_b16 a[102:103], v3 offset:38144
v_mfma_f32_16x16x32_bf16 v[72:75], a[56:59], a[4:7], 0
buffer_load_dwordx4 v4, s[44:47], s52 offen offset:1024 lds
v_mfma_f32_16x16x32_bf16 v[68:71], a[52:55], a[4:7], 0
ds_read_b128 a[68:71], v1 offset:34048
v_mfma_f32_16x16x32_bf16 v[64:67], a[48:51], a[4:7], 0
v_mfma_f32_16x16x32_bf16 v[60:63], a[44:47], a[4:7], 0
ds_read_b64_tr_b16 a[104:105], v2 offset:33856
v_mfma_f32_16x16x32_bf16 v[56:59], a[40:43], a[4:7], 0
v_mfma_f32_16x16x32_bf16 v[52:55], a[36:39], a[4:7], 0
ds_read_b64_tr_b16 a[106:107], v2 offset:38208
v_mfma_f32_16x16x32_bf16 v[48:51], a[32:35], a[4:7], 0
v_mfma_f32_16x16x32_bf16 v[80:83], a[32:35], a[8:11], 0
ds_read_b128 a[72:75], v1 offset:35840
v_mfma_f32_16x16x32_bf16 v[84:87], a[36:39], a[8:11], 0
buffer_load_dwordx4 v5, s[44:47], s52 offen offset:2048 lds
v_mfma_f32_16x16x32_bf16 v[88:91], a[40:43], a[8:11], 0
ds_read_b64_tr_b16 a[108:109], v3 offset:33856
v_mfma_f32_16x16x32_bf16 v[92:95], a[44:47], a[8:11], 0
v_mfma_f32_16x16x32_bf16 v[96:99], a[48:51], a[8:11], 0
ds_read_b64_tr_b16 a[110:111], v3 offset:38208
v_mfma_f32_16x16x32_bf16 v[100:103], a[52:55], a[8:11], 0
v_mfma_f32_16x16x32_bf16 v[104:107], a[56:59], a[8:11], 0
ds_read_b128 a[76:79], v1 offset:36096
v_mfma_f32_16x16x32_bf16 v[108:111], a[60:63], a[8:11], 0
v_mfma_f32_16x16x32_bf16 v[140:143], a[60:63], a[12:15], 0
ds_read_b64_tr_b16 a[112:113], v2 offset:33920
v_mfma_f32_16x16x32_bf16 v[136:139], a[56:59], a[12:15], 0
buffer_load_dwordx4 v5, s[44:47], s52 offen offset:3072 lds
v_mfma_f32_16x16x32_bf16 v[132:135], a[52:55], a[12:15], 0
ds_read_b64_tr_b16 a[114:115], v2 offset:38272
s_add_u32 s52, s52, 2048
v_mfma_f32_16x16x32_bf16 v[128:131], a[48:51], a[12:15], 0
v_mfma_f32_16x16x32_bf16 v[124:127], a[44:47], a[12:15], 0
ds_read_b128 a[80:83], v1 offset:37888
v_mfma_f32_16x16x32_bf16 v[120:123], a[40:43], a[12:15], 0
v_mfma_f32_16x16x32_bf16 v[116:119], a[36:39], a[12:15], 0
ds_read_b64_tr_b16 a[116:117], v3 offset:33920
v_mfma_f32_16x16x32_bf16 v[112:115], a[32:35], a[12:15], 0
v_mfma_f32_16x16x32_bf16 v[144:147], a[32:35], a[16:19], 0
ds_read_b64_tr_b16 a[118:119], v3 offset:38272
s_add_u32 m0, s54, 0
v_mfma_f32_16x16x32_bf16 v[148:151], a[36:39], a[16:19], 0
buffer_load_dwordx4 v6, s[48:51], s53 offen offset:0 lds
v_mfma_f32_16x16x32_bf16 v[152:155], a[40:43], a[16:19], 0
ds_read_b128 a[84:87], v1 offset:38144
v_mfma_f32_16x16x32_bf16 v[156:159], a[44:47], a[16:19], 0
v_mfma_f32_16x16x32_bf16 v[160:163], a[48:51], a[16:19], 0
ds_read_b64_tr_b16 a[120:121], v2 offset:33984
v_mfma_f32_16x16x32_bf16 v[164:167], a[52:55], a[16:19], 0
v_mfma_f32_16x16x32_bf16 v[168:171], a[56:59], a[16:19], 0
ds_read_b64_tr_b16 a[122:123], v2 offset:38336
v_mfma_f32_16x16x32_bf16 v[172:175], a[60:63], a[16:19], 0
v_mfma_f32_16x16x32_bf16 v[204:207], a[60:63], a[20:23], 0
ds_read_b128 a[88:91], v1 offset:39936
v_mfma_f32_16x16x32_bf16 v[200:203], a[56:59], a[20:23], 0
buffer_load_dwordx4 v7, s[48:51], s53 offen offset:1088 lds
v_mfma_f32_16x16x32_bf16 v[196:199], a[52:55], a[20:23], 0
ds_read_b64_tr_b16 a[124:125], v3 offset:33984
v_mfma_f32_16x16x32_bf16 v[192:195], a[48:51], a[20:23], 0
v_mfma_f32_16x16x32_bf16 v[188:191], a[44:47], a[20:23], 0
ds_read_b64_tr_b16 a[126:127], v3 offset:38336
v_mfma_f32_16x16x32_bf16 v[184:187], a[40:43], a[20:23], 0
v_mfma_f32_16x16x32_bf16 v[180:183], a[36:39], a[20:23], 0
ds_read_b128 a[92:95], v1 offset:40192
v_mfma_f32_16x16x32_bf16 v[176:179], a[32:35], a[20:23], 0
v_mfma_f32_16x16x32_bf16 v[208:211], a[32:35], a[24:27], 0
v_add_u32 v1, 67584, v1
v_mfma_f32_16x16x32_bf16 v[212:215], a[36:39], a[24:27], 0
buffer_load_dwordx4 v8, s[48:51], s53 offen offset:2176 lds
v_mfma_f32_16x16x32_bf16 v[216:219], a[40:43], a[24:27], 0
v_add_u32 v2, 67584, v2
v_mfma_f32_16x16x32_bf16 v[220:223], a[44:47], a[24:27], 0
v_mfma_f32_16x16x32_bf16 v[224:227], a[48:51], a[24:27], 0
v_add_u32 v3, 67584, v3
v_mfma_f32_16x16x32_bf16 v[228:231], a[52:55], a[24:27], 0
v_mfma_f32_16x16x32_bf16 v[232:235], a[56:59], a[24:27], 0
v_mfma_f32_16x16x32_bf16 v[236:239], a[60:63], a[24:27], 0
v_mfma_f32_16x16x32_bf16 a[140:143], a[60:63], a[28:31], 0
v_mfma_f32_16x16x32_bf16 a[136:139], a[56:59], a[28:31], 0
buffer_load_dwordx4 v9, s[48:51], s53 offen offset:3264 lds
v_mfma_f32_16x16x32_bf16 a[132:135], a[52:55], a[28:31], 0
s_add_u32 s53, s53, s55
v_mfma_f32_16x16x32_bf16 a[128:131], a[48:51], a[28:31], 0
v_mfma_f32_16x16x32_bf16 v[252:255], a[44:47], a[28:31], 0
v_mfma_f32_16x16x32_bf16 v[248:251], a[40:43], a[28:31], 0
v_mfma_f32_16x16x32_bf16 v[244:247], a[36:39], a[28:31], 0
v_mfma_f32_16x16x32_bf16 v[240:243], a[32:35], a[28:31], 0
.p2align 3
m_g_T_l:
s_waitcnt vmcnt(48) lgkmcnt(0)
s_cbranch_vccnz rx_7
s_waitcnt vmcnt(16)
rx_7:
s_barrier
v_mfma_f32_16x16x32_bf16 v[16:19], a[96:99], a[64:67], v[16:19]
ds_read_b64_tr_b16 a[32:33], v2 offset:0
s_add_u32 m0, s60, 33792
v_mfma_f32_16x16x32_bf16 v[20:23], a[100:103], a[64:67], v[20:23]
buffer_load_dwordx4 v4, s[44:47], s52 offen offset:0 lds
v_mfma_f32_16x16x32_bf16 v[24:27], a[104:107], a[64:67], v[24:27]
ds_read_b64_tr_b16 a[34:35], v2 offset:4352
v_mfma_f32_16x16x32_bf16 v[28:31], a[108:111], a[64:67], v[28:31]
v_mfma_f32_16x16x32_bf16 v[32:35], a[112:115], a[64:67], v[32:35]
ds_read_b128 a[0:3], v1 offset:0
v_mfma_f32_16x16x32_bf16 v[36:39], a[116:119], a[64:67], v[36:39]
v_mfma_f32_16x16x32_bf16 v[40:43], a[120:123], a[64:67], v[40:43]
ds_read_b64_tr_b16 a[36:37], v3 offset:0
v_mfma_f32_16x16x32_bf16 v[44:47], a[124:127], a[64:67], v[44:47]
v_mfma_f32_16x16x32_bf16 v[76:79], a[124:127], a[68:71], v[76:79]
ds_read_b64_tr_b16 a[38:39], v3 offset:4352
v_mfma_f32_16x16x32_bf16 v[72:75], a[120:123], a[68:71], v[72:75]
buffer_load_dwordx4 v4, s[44:47], s52 offen offset:1024 lds
v_mfma_f32_16x16x32_bf16 v[68:71], a[116:119], a[68:71], v[68:71]
ds_read_b128 a[4:7], v1 offset:256
v_mfma_f32_16x16x32_bf16 v[64:67], a[112:115], a[68:71], v[64:67]
v_mfma_f32_16x16x32_bf16 v[60:63], a[108:111], a[68:71], v[60:63]
ds_read_b64_tr_b16 a[40:41], v2 offset:64
v_mfma_f32_16x16x32_bf16 v[56:59], a[104:107], a[68:71], v[56:59]
v_mfma_f32_16x16x32_bf16 v[52:55], a[100:103], a[68:71], v[52:55]
ds_read_b64_tr_b16 a[42:43], v2 offset:4416
v_mfma_f32_16x16x32_bf16 v[48:51], a[96:99], a[68:71], v[48:51]
v_mfma_f32_16x16x32_bf16 v[80:83], a[96:99], a[72:75], v[80:83]
ds_read_b128 a[8:11], v1 offset:2048
v_mfma_f32_16x16x32_bf16 v[84:87], a[100:103], a[72:75], v[84:87]
buffer_load_dwordx4 v5, s[44:47], s52 offen offset:2048 lds
v_mfma_f32_16x16x32_bf16 v[88:91], a[104:107], a[72:75], v[88:91]
ds_read_b64_tr_b16 a[44:45], v3 offset:64
v_mfma_f32_16x16x32_bf16 v[92:95], a[108:111], a[72:75], v[92:95]
v_mfma_f32_16x16x32_bf16 v[96:99], a[112:115], a[72:75], v[96:99]
ds_read_b64_tr_b16 a[46:47], v3 offset:4416
v_mfma_f32_16x16x32_bf16 v[100:103], a[116:119], a[72:75], v[100:103]
v_mfma_f32_16x16x32_bf16 v[104:107], a[120:123], a[72:75], v[104:107]
ds_read_b128 a[12:15], v1 offset:2304
v_mfma_f32_16x16x32_bf16 v[108:111], a[124:127], a[72:75], v[108:111]
v_mfma_f32_16x16x32_bf16 v[140:143], a[124:127], a[76:79], v[140:143]
ds_read_b64_tr_b16 a[48:49], v2 offset:128
v_mfma_f32_16x16x32_bf16 v[136:139], a[120:123], a[76:79], v[136:139]
buffer_load_dwordx4 v5, s[44:47], s52 offen offset:3072 lds
v_mfma_f32_16x16x32_bf16 v[132:135], a[116:119], a[76:79], v[132:135]
ds_read_b64_tr_b16 a[50:51], v2 offset:4480
s_add_u32 s52, s52, 2048
v_mfma_f32_16x16x32_bf16 v[128:131], a[112:115], a[76:79], v[128:131]
v_mfma_f32_16x16x32_bf16 v[124:127], a[108:111], a[76:79], v[124:127]
ds_read_b128 a[16:19], v1 offset:4096
v_mfma_f32_16x16x32_bf16 v[120:123], a[104:107], a[76:79], v[120:123]
v_mfma_f32_16x16x32_bf16 v[116:119], a[100:103], a[76:79], v[116:119]
ds_read_b64_tr_b16 a[52:53], v3 offset:128
v_mfma_f32_16x16x32_bf16 v[112:115], a[96:99], a[76:79], v[112:115]
v_mfma_f32_16x16x32_bf16 v[144:147], a[96:99], a[80:83], v[144:147]
ds_read_b64_tr_b16 a[54:55], v3 offset:4480
s_add_u32 m0, s54, 33792
v_mfma_f32_16x16x32_bf16 v[148:151], a[100:103], a[80:83], v[148:151]
buffer_load_dwordx4 v6, s[48:51], s53 offen offset:0 lds
v_mfma_f32_16x16x32_bf16 v[152:155], a[104:107], a[80:83], v[152:155]
ds_read_b128 a[20:23], v1 offset:4352
v_mfma_f32_16x16x32_bf16 v[156:159], a[108:111], a[80:83], v[156:159]
v_mfma_f32_16x16x32_bf16 v[160:163], a[112:115], a[80:83], v[160:163]
ds_read_b64_tr_b16 a[56:57], v2 offset:192
v_mfma_f32_16x16x32_bf16 v[164:167], a[116:119], a[80:83], v[164:167]
v_mfma_f32_16x16x32_bf16 v[168:171], a[120:123], a[80:83], v[168:171]
ds_read_b64_tr_b16 a[58:59], v2 offset:4544
v_mfma_f32_16x16x32_bf16 v[172:175], a[124:127], a[80:83], v[172:175]
v_mfma_f32_16x16x32_bf16 v[204:207], a[124:127], a[84:87], v[204:207]
ds_read_b128 a[24:27], v1 offset:6144
v_mfma_f32_16x16x32_bf16 v[200:203], a[120:123], a[84:87], v[200:203]
buffer_load_dwordx4 v7, s[48:51], s53 offen offset:1088 lds
v_mfma_f32_16x16x32_bf16 v[196:199], a[116:119], a[84:87], v[196:199]
ds_read_b64_tr_b16 a[60:61], v3 offset:192
v_mfma_f32_16x16x32_bf16 v[192:195], a[112:115], a[84:87], v[192:195]
v_mfma_f32_16x16x32_bf16 v[188:191], a[108:111], a[84:87], v[188:191]
ds_read_b64_tr_b16 a[62:63], v3 offset:4544
v_mfma_f32_16x16x32_bf16 v[184:187], a[104:107], a[84:87], v[184:187]
v_mfma_f32_16x16x32_bf16 v[180:183], a[100:103], a[84:87], v[180:183]
ds_read_b128 a[28:31], v1 offset:6400
v_mfma_f32_16x16x32_bf16 v[176:179], a[96:99], a[84:87], v[176:179]
v_mfma_f32_16x16x32_bf16 v[208:211], a[96:99], a[88:91], v[208:211]
v_mfma_f32_16x16x32_bf16 v[212:215], a[100:103], a[88:91], v[212:215]
buffer_load_dwordx4 v8, s[48:51], s53 offen offset:2176 lds
v_mfma_f32_16x16x32_bf16 v[216:219], a[104:107], a[88:91], v[216:219]
v_mfma_f32_16x16x32_bf16 v[220:223], a[108:111], a[88:91], v[220:223]
v_mfma_f32_16x16x32_bf16 v[224:227], a[112:115], a[88:91], v[224:227]
v_mfma_f32_16x16x32_bf16 v[228:231], a[116:119], a[88:91], v[228:231]
v_mfma_f32_16x16x32_bf16 v[232:235], a[120:123], a[88:91], v[232:235]
v_mfma_f32_16x16x32_bf16 v[236:239], a[124:127], a[88:91], v[236:239]
v_mfma_f32_16x16x32_bf16 a[140:143], a[124:127], a[92:95], a[140:143]
v_mfma_f32_16x16x32_bf16 a[136:139], a[120:123], a[92:95], a[136:139]
buffer_load_dwordx4 v9, s[48:51], s53 offen offset:3264 lds
v_mfma_f32_16x16x32_bf16 a[132:135], a[116:119], a[92:95], a[132:135]
s_add_u32 s53, s53, s55
v_mfma_f32_16x16x32_bf16 a[128:131], a[112:115], a[92:95], a[128:131]
v_mfma_f32_16x16x32_bf16 v[252:255], a[108:111], a[92:95], v[252:255]
v_mfma_f32_16x16x32_bf16 v[248:251], a[104:107], a[92:95], v[248:251]
v_mfma_f32_16x16x32_bf16 v[244:247], a[100:103], a[92:95], v[244:247]
v_mfma_f32_16x16x32_bf16 v[240:243], a[96:99], a[92:95], v[240:243]
s_waitcnt vmcnt(48) lgkmcnt(0)
s_cbranch_vccnz rx_8
s_waitcnt vmcnt(16)
rx_8:
s_barrier
v_mfma_f32_16x16x32_bf16 v[16:19], a[32:35], a[0:3], v[16:19]
ds_read_b64_tr_b16 a[96:97], v2 offset:33792
s_add_u32 m0, s60, 67584
v_mfma_f32_16x16x32_bf16 v[20:23], a[36:39], a[0:3], v[20:23]
buffer_load_dwordx4 v4, s[44:47], s52 offen offset:0 lds
v_mfma_f32_16x16x32_bf16 v[24:27], a[40:43], a[0:3], v[24:27]
ds_read_b64_tr_b16 a[98:99], v2 offset:38144
v_mfma_f32_16x16x32_bf16 v[28:31], a[44:47], a[0:3], v[28:31]
v_mfma_f32_16x16x32_bf16 v[32:35], a[48:51], a[0:3], v[32:35]
ds_read_b128 a[64:67], v1 offset:33792
v_mfma_f32_16x16x32_bf16 v[36:39], a[52:55], a[0:3], v[36:39]
v_mfma_f32_16x16x32_bf16 v[40:43], a[56:59], a[0:3], v[40:43]
ds_read_b64_tr_b16 a[100:101], v3 offset:33792
v_mfma_f32_16x16x32_bf16 v[44:47], a[60:63], a[0:3], v[44:47]
v_mfma_f32_16x16x32_bf16 v[76:79], a[60:63], a[4:7], v[76:79]
ds_read_b64_tr_b16 a[102:103], v3 offset:38144
v_mfma_f32_16x16x32_bf16 v[72:75], a[56:59], a[4:7], v[72:75]
buffer_load_dwordx4 v4, s[44:47], s52 offen offset:1024 lds
v_mfma_f32_16x16x32_bf16 v[68:71], a[52:55], a[4:7], v[68:71]
ds_read_b128 a[68:71], v1 offset:34048
v_mfma_f32_16x16x32_bf16 v[64:67], a[48:51], a[4:7], v[64:67]
v_mfma_f32_16x16x32_bf16 v[60:63], a[44:47], a[4:7], v[60:63]
ds_read_b64_tr_b16 a[104:105], v2 offset:33856
v_mfma_f32_16x16x32_bf16 v[56:59], a[40:43], a[4:7], v[56:59]
v_mfma_f32_16x16x32_bf16 v[52:55], a[36:39], a[4:7], v[52:55]
ds_read_b64_tr_b16 a[106:107], v2 offset:38208
v_mfma_f32_16x16x32_bf16 v[48:51], a[32:35], a[4:7], v[48:51]
v_mfma_f32_16x16x32_bf16 v[80:83], a[32:35], a[8:11], v[80:83]
ds_read_b128 a[72:75], v1 offset:35840
v_mfma_f32_16x16x32_bf16 v[84:87], a[36:39], a[8:11], v[84:87]
buffer_load_dwordx4 v5, s[44:47], s52 offen offset:2048 lds
v_mfma_f32_16x16x32_bf16 v[88:91], a[40:43], a[8:11], v[88:91]
ds_read_b64_tr_b16 a[108:109], v3 offset:33856
v_mfma_f32_16x16x32_bf16 v[92:95], a[44:47], a[8:11], v[92:95]
v_mfma_f32_16x16x32_bf16 v[96:99], a[48:51], a[8:11], v[96:99]
ds_read_b64_tr_b16 a[110:111], v3 offset:38208
v_mfma_f32_16x16x32_bf16 v[100:103], a[52:55], a[8:11], v[100:103]
v_mfma_f32_16x16x32_bf16 v[104:107], a[56:59], a[8:11], v[104:107]
ds_read_b128 a[76:79], v1 offset:36096
v_mfma_f32_16x16x32_bf16 v[108:111], a[60:63], a[8:11], v[108:111]
v_mfma_f32_16x16x32_bf16 v[140:143], a[60:63], a[12:15], v[140:143]
ds_read_b64_tr_b16 a[112:113], v2 offset:33920
v_mfma_f32_16x16x32_bf16 v[136:139], a[56:59], a[12:15], v[136:139]
buffer_load_dwordx4 v5, s[44:47], s52 offen offset:3072 lds
v_mfma_f32_16x16x32_bf16 v[132:135], a[52:55], a[12:15], v[132:135]
ds_read_b64_tr_b16 a[114:115], v2 offset:38272
s_add_u32 s52, s52, 2048
v_mfma_f32_16x16x32_bf16 v[128:131], a[48:51], a[12:15], v[128:131]
v_mfma_f32_16x16x32_bf16 v[124:127], a[44:47], a[12:15], v[124:127]
ds_read_b128 a[80:83], v1 offset:37888
v_mfma_f32_16x16x32_bf16 v[120:123], a[40:43], a[12:15], v[120:123]
v_mfma_f32_16x16x32_bf16 v[116:119], a[36:39], a[12:15], v[116:119]
ds_read_b64_tr_b16 a[116:117], v3 offset:33920
v_mfma_f32_16x16x32_bf16 v[112:115], a[32:35], a[12:15], v[112:115]
v_mfma_f32_16x16x32_bf16 v[144:147], a[32:35], a[16:19], v[144:147]
ds_read_b64_tr_b16 a[118:119], v3 offset:38272
s_add_u32 m0, s54, 67584
v_mfma_f32_16x16x32_bf16 v[148:151], a[36:39], a[16:19], v[148:151]
buffer_load_dwordx4 v6, s[48:51], s53 offen offset:0 lds
v_mfma_f32_16x16x32_bf16 v[152:155], a[40:43], a[16:19], v[152:155]
ds_read_b128 a[84:87], v1 offset:38144
v_mfma_f32_16x16x32_bf16 v[156:159], a[44:47], a[16:19], v[156:159]
v_mfma_f32_16x16x32_bf16 v[160:163], a[48:51], a[16:19], v[160:163]
ds_read_b64_tr_b16 a[120:121], v2 offset:33984
v_mfma_f32_16x16x32_bf16 v[164:167], a[52:55], a[16:19], v[164:167]
v_mfma_f32_16x16x32_bf16 v[168:171], a[56:59], a[16:19], v[168:171]
ds_read_b64_tr_b16 a[122:123], v2 offset:38336
v_mfma_f32_16x16x32_bf16 v[172:175], a[60:63], a[16:19], v[172:175]
v_mfma_f32_16x16x32_bf16 v[204:207], a[60:63], a[20:23], v[204:207]
ds_read_b128 a[88:91], v1 offset:39936
v_mfma_f32_16x16x32_bf16 v[200:203], a[56:59], a[20:23], v[200:203]
buffer_load_dwordx4 v7, s[48:51], s53 offen offset:1088 lds
v_mfma_f32_16x16x32_bf16 v[196:199], a[52:55], a[20:23], v[196:199]
ds_read_b64_tr_b16 a[124:125], v3 offset:33984
v_mfma_f32_16x16x32_bf16 v[192:195], a[48:51], a[20:23], v[192:195]
v_mfma_f32_16x16x32_bf16 v[188:191], a[44:47], a[20:23], v[188:191]
ds_read_b64_tr_b16 a[126:127], v3 offset:38336
v_mfma_f32_16x16x32_bf16 v[184:187], a[40:43], a[20:23], v[184:187]
v_mfma_f32_16x16x32_bf16 v[180:183], a[36:39], a[20:23], v[180:183]
ds_read_b128 a[92:95], v1 offset:40192
v_mfma_f32_16x16x32_bf16 v[176:179], a[32:35], a[20:23], v[176:179]
v_mfma_f32_16x16x32_bf16 v[208:211], a[32:35], a[24:27], v[208:211]
v_add_u32 v1, 4294899712, v1
v_mfma_f32_16x16x32_bf16 v[212:215], a[36:39], a[24:27], v[212:215]
buffer_load_dwordx4 v8, s[48:51], s53 offen offset:2176 lds
v_mfma_f32_16x16x32_bf16 v[216:219], a[40:43], a[24:27], v[216:219]
v_add_u32 v2, 4294899712, v2
v_mfma_f32_16x16x32_bf16 v[220:223], a[44:47], a[24:27], v[220:223]
v_mfma_f32_16x16x32_bf16 v[224:227], a[48:51], a[24:27], v[224:227]
v_add_u32 v3, 4294899712, v3
v_mfma_f32_16x16x32_bf16 v[228:231], a[52:55], a[24:27], v[228:231]
v_mfma_f32_16x16x32_bf16 v[232:235], a[56:59], a[24:27], v[232:235]
v_mfma_f32_16x16x32_bf16 v[236:239], a[60:63], a[24:27], v[236:239]
v_mfma_f32_16x16x32_bf16 a[140:143], a[60:63], a[28:31], a[140:143]
v_mfma_f32_16x16x32_bf16 a[136:139], a[56:59], a[28:31], a[136:139]
buffer_load_dwordx4 v9, s[48:51], s53 offen offset:3264 lds
v_mfma_f32_16x16x32_bf16 a[132:135], a[52:55], a[28:31], a[132:135]
s_add_u32 s53, s53, s55
v_mfma_f32_16x16x32_bf16 a[128:131], a[48:51], a[28:31], a[128:131]
v_mfma_f32_16x16x32_bf16 v[252:255], a[44:47], a[28:31], v[252:255]
v_mfma_f32_16x16x32_bf16 v[248:251], a[40:43], a[28:31], v[248:251]
v_mfma_f32_16x16x32_bf16 v[244:247], a[36:39], a[28:31], v[244:247]
v_mfma_f32_16x16x32_bf16 v[240:243], a[32:35], a[28:31], v[240:243]
s_waitcnt vmcnt(16) lgkmcnt(0)
s_barrier
s_cbranch_vccz pb_9
s_mov_b64 vcc, 0
buffer_atomic_add v11, v10, s[4:7], s29 offen sc1
pb_9:
v_mfma_f32_16x16x32_bf16 v[16:19], a[96:99], a[64:67], v[16:19]
ds_read_b64_tr_b16 a[32:33], v2 offset:0
s_add_u32 m0, s60, 101376
v_mfma_f32_16x16x32_bf16 v[20:23], a[100:103], a[64:67], v[20:23]
buffer_load_dwordx4 v4, s[44:47], s52 offen offset:0 lds
v_mfma_f32_16x16x32_bf16 v[24:27], a[104:107], a[64:67], v[24:27]
ds_read_b64_tr_b16 a[34:35], v2 offset:4352
v_mfma_f32_16x16x32_bf16 v[28:31], a[108:111], a[64:67], v[28:31]
v_mfma_f32_16x16x32_bf16 v[32:35], a[112:115], a[64:67], v[32:35]
ds_read_b128 a[0:3], v1 offset:0
v_mfma_f32_16x16x32_bf16 v[36:39], a[116:119], a[64:67], v[36:39]
v_mfma_f32_16x16x32_bf16 v[40:43], a[120:123], a[64:67], v[40:43]
ds_read_b64_tr_b16 a[36:37], v3 offset:0
v_mfma_f32_16x16x32_bf16 v[44:47], a[124:127], a[64:67], v[44:47]
v_mfma_f32_16x16x32_bf16 v[76:79], a[124:127], a[68:71], v[76:79]
ds_read_b64_tr_b16 a[38:39], v3 offset:4352
v_mfma_f32_16x16x32_bf16 v[72:75], a[120:123], a[68:71], v[72:75]
buffer_load_dwordx4 v4, s[44:47], s52 offen offset:1024 lds
v_mfma_f32_16x16x32_bf16 v[68:71], a[116:119], a[68:71], v[68:71]
ds_read_b128 a[4:7], v1 offset:256
v_mfma_f32_16x16x32_bf16 v[64:67], a[112:115], a[68:71], v[64:67]
v_mfma_f32_16x16x32_bf16 v[60:63], a[108:111], a[68:71], v[60:63]
ds_read_b64_tr_b16 a[40:41], v2 offset:64
v_mfma_f32_16x16x32_bf16 v[56:59], a[104:107], a[68:71], v[56:59]
v_mfma_f32_16x16x32_bf16 v[52:55], a[100:103], a[68:71], v[52:55]
ds_read_b64_tr_b16 a[42:43], v2 offset:4416
v_mfma_f32_16x16x32_bf16 v[48:51], a[96:99], a[68:71], v[48:51]
v_mfma_f32_16x16x32_bf16 v[80:83], a[96:99], a[72:75], v[80:83]
ds_read_b128 a[8:11], v1 offset:2048
v_mfma_f32_16x16x32_bf16 v[84:87], a[100:103], a[72:75], v[84:87]
buffer_load_dwordx4 v5, s[44:47], s52 offen offset:2048 lds
v_mfma_f32_16x16x32_bf16 v[88:91], a[104:107], a[72:75], v[88:91]
ds_read_b64_tr_b16 a[44:45], v3 offset:64
v_mfma_f32_16x16x32_bf16 v[92:95], a[108:111], a[72:75], v[92:95]
v_mfma_f32_16x16x32_bf16 v[96:99], a[112:115], a[72:75], v[96:99]
ds_read_b64_tr_b16 a[46:47], v3 offset:4416
v_mfma_f32_16x16x32_bf16 v[100:103], a[116:119], a[72:75], v[100:103]
v_mfma_f32_16x16x32_bf16 v[104:107], a[120:123], a[72:75], v[104:107]
ds_read_b128 a[12:15], v1 offset:2304
v_mfma_f32_16x16x32_bf16 v[108:111], a[124:127], a[72:75], v[108:111]
v_mfma_f32_16x16x32_bf16 v[140:143], a[124:127], a[76:79], v[140:143]
ds_read_b64_tr_b16 a[48:49], v2 offset:128
v_mfma_f32_16x16x32_bf16 v[136:139], a[120:123], a[76:79], v[136:139]
buffer_load_dwordx4 v5, s[44:47], s52 offen offset:3072 lds
v_mfma_f32_16x16x32_bf16 v[132:135], a[116:119], a[76:79], v[132:135]
ds_read_b64_tr_b16 a[50:51], v2 offset:4480
s_add_u32 s52, s52, 2048
v_mfma_f32_16x16x32_bf16 v[128:131], a[112:115], a[76:79], v[128:131]
v_mfma_f32_16x16x32_bf16 v[124:127], a[108:111], a[76:79], v[124:127]
ds_read_b128 a[16:19], v1 offset:4096
v_mfma_f32_16x16x32_bf16 v[120:123], a[104:107], a[76:79], v[120:123]
v_mfma_f32_16x16x32_bf16 v[116:119], a[100:103], a[76:79], v[116:119]
ds_read_b64_tr_b16 a[52:53], v3 offset:128
v_mfma_f32_16x16x32_bf16 v[112:115], a[96:99], a[76:79], v[112:115]
v_mfma_f32_16x16x32_bf16 v[144:147], a[96:99], a[80:83], v[144:147]
ds_read_b64_tr_b16 a[54:55], v3 offset:4480
s_add_u32 m0, s54, 101376
v_mfma_f32_16x16x32_bf16 v[148:151], a[100:103], a[80:83], v[148:151]
buffer_load_dwordx4 v6, s[48:51], s53 offen offset:0 lds
v_mfma_f32_16x16x32_bf16 v[152:155], a[104:107], a[80:83], v[152:155]
ds_read_b128 a[20:23], v1 offset:4352
v_mfma_f32_16x16x32_bf16 v[156:159], a[108:111], a[80:83], v[156:159]
v_mfma_f32_16x16x32_bf16 v[160:163], a[112:115], a[80:83], v[160:163]
ds_read_b64_tr_b16 a[56:57], v2 offset:192
v_mfma_f32_16x16x32_bf16 v[164:167], a[116:119], a[80:83], v[164:167]
v_mfma_f32_16x16x32_bf16 v[168:171], a[120:123], a[80:83], v[168:171]
ds_read_b64_tr_b16 a[58:59], v2 offset:4544
v_mfma_f32_16x16x32_bf16 v[172:175], a[124:127], a[80:83], v[172:175]
v_mfma_f32_16x16x32_bf16 v[204:207], a[124:127], a[84:87], v[204:207]
ds_read_b128 a[24:27], v1 offset:6144
v_mfma_f32_16x16x32_bf16 v[200:203], a[120:123], a[84:87], v[200:203]
buffer_load_dwordx4 v7, s[48:51], s53 offen offset:1088 lds
v_mfma_f32_16x16x32_bf16 v[196:199], a[116:119], a[84:87], v[196:199]
ds_read_b64_tr_b16 a[60:61], v3 offset:192
v_mfma_f32_16x16x32_bf16 v[192:195], a[112:115], a[84:87], v[192:195]
v_mfma_f32_16x16x32_bf16 v[188:191], a[108:111], a[84:87], v[188:191]
ds_read_b64_tr_b16 a[62:63], v3 offset:4544
v_mfma_f32_16x16x32_bf16 v[184:187], a[104:107], a[84:87], v[184:187]
v_mfma_f32_16x16x32_bf16 v[180:183], a[100:103], a[84:87], v[180:183]
ds_read_b128 a[28:31], v1 offset:6400
v_mfma_f32_16x16x32_bf16 v[176:179], a[96:99], a[84:87], v[176:179]
v_mfma_f32_16x16x32_bf16 v[208:211], a[96:99], a[88:91], v[208:211]
v_mfma_f32_16x16x32_bf16 v[212:215], a[100:103], a[88:91], v[212:215]
buffer_load_dwordx4 v8, s[48:51], s53 offen offset:2176 lds
v_mfma_f32_16x16x32_bf16 v[216:219], a[104:107], a[88:91], v[216:219]
v_mfma_f32_16x16x32_bf16 v[220:223], a[108:111], a[88:91], v[220:223]
v_mfma_f32_16x16x32_bf16 v[224:227], a[112:115], a[88:91], v[224:227]
v_mfma_f32_16x16x32_bf16 v[228:231], a[116:119], a[88:91], v[228:231]
v_mfma_f32_16x16x32_bf16 v[232:235], a[120:123], a[88:91], v[232:235]
v_mfma_f32_16x16x32_bf16 v[236:239], a[124:127], a[88:91], v[236:239]
v_mfma_f32_16x16x32_bf16 a[140:143], a[124:127], a[92:95], a[140:143]
v_mfma_f32_16x16x32_bf16 a[136:139], a[120:123], a[92:95], a[136:139]
buffer_load_dwordx4 v9, s[48:51], s53 offen offset:3264 lds
v_mfma_f32_16x16x32_bf16 a[132:135], a[116:119], a[92:95], a[132:135]
s_add_u32 s53, s53, s55
v_mfma_f32_16x16x32_bf16 a[128:131], a[112:115], a[92:95], a[128:131]
v_mfma_f32_16x16x32_bf16 v[252:255], a[108:111], a[92:95], v[252:255]
v_mfma_f32_16x16x32_bf16 v[248:251], a[104:107], a[92:95], v[248:251]
v_mfma_f32_16x16x32_bf16 v[244:247], a[100:103], a[92:95], v[244:247]
v_mfma_f32_16x16x32_bf16 v[240:243], a[96:99], a[92:95], v[240:243]
s_sub_u32 s56, s56, 1
s_cmp_eq_u32 s56, 0
s_cbranch_scc1 m_g_T_x
m_g_T_c:
s_waitcnt vmcnt(16) lgkmcnt(0)
s_barrier
s_cmp_eq_u32 s56, 1
s_cbranch_scc0 m_g_T_h_s
v_cmp_gt_u32 s[62:63], 4, v14
s_and_b32 s62, s62, s27
s_cselect_b32 s28, 1, s28
s_cmp_eq_u32 s28, 0
s_cbranch_scc1 m_g_T_h_w
s_mov_b32 s46, 0
s_mov_b32 s50, 0
s_branch m_g_T_h_s
m_g_T_h_w:
s_and_b32 s63, s25, 15
s_bfe_u32 s64, s25, 0x30004
s_bfe_u32 s65, s25, 0x40007
s_bfe_u32 s66, s25, 0x4000b
s_mov_b32 s46, 268435456
s_lshl_b32 s53, s65, 9
s_sub_u32 s62, s63, 4
s_cmp_lt_u32 s62, 3
s_cbranch_scc1 m_g_T_h_fw
s_lshl_b32 s52, s64, 19
s_mov_b32 s57, 65536
s_mov_b64 s[48:49], s[90:91]
s_cmp_eq_u32 s63, 0
s_cselect_b64 s[48:49], s[86:87], s[48:49]
s_cmp_eq_u32 s63, 1
s_cselect_b64 s[48:49], s[88:89], s[48:49]
s_cmp_eq_u32 s63, 3
s_cselect_b64 s[48:49], s[92:93], s[48:49]
s_cselect_b32 s58, 7168, 0
s_cselect_b32 s62, 0, 8192
s_or_b32 s58, s58, s62
s_lshl_b32 s50, s58, 10
s_branch m_g_T_h_l
m_g_T_h_fw:
s_lshl_b32 s62, s66, 19
s_add_u32 s53, s53, s62
s_mov_b32 s58, 2048
s_cmp_eq_u32 s63, 5
s_cselect_b64 s[48:49], s[96:97], s[94:95]
s_mov_b32 s50, 7340032
s_cselect_b32 s50, 8388608, s50
s_mov_b32 s57, 229376
s_cselect_b32 s57, 262144, s57
s_mov_b32 s52, 92274688
s_cselect_b32 s52, 109051904, s52
s_mul_i32 s62, s64, s57
s_lshl_b32 s62, s62, 3
s_add_u32 s52, s52, s62
s_lshl_b32 s62, s66, 14
s_add_u32 s52, s52, s62
m_g_T_h_l:
s_mul_i32 s62, s14, 2
s_mul_i32 s62, s62, s57
v_lshl_add_u32 v4, v0, 4, s62
s_sub_u32 s62, s57, 2048
v_add_u32 v5, s62, v4
v_lshrrev_b32 v12, 5, v0
v_and_b32 v6, 31, v0
v_xor_b32 v6, v6, v12
v_lshlrev_b32 v6, 4, v6
s_lshl_b32 s62, s14, 3
v_add_u32 v12, s62, v12
v_mad_u32_u24 v6, v12, s58, v6
s_lshl_b32 s62, s58, 1
s_sub_u32 s62, s62, 1088
v_add_u32 v7, s62, v6
v_add_u32 v8, s62, v7
v_add_u32 v9, s62, v8
s_lshl_b32 s55, s58, 5
m_g_T_h_s:
buffer_load_dword v14, v13, s[4:7], s26 offen sc1
v_mfma_f32_16x16x32_bf16 v[16:19], a[32:35], a[0:3], v[16:19]
ds_read_b64_tr_b16 a[96:97], v2 offset:33792
s_add_u32 m0, s60, 0
v_mfma_f32_16x16x32_bf16 v[20:23], a[36:39], a[0:3], v[20:23]
buffer_load_dwordx4 v4, s[44:47], s52 offen offset:0 lds
v_mfma_f32_16x16x32_bf16 v[24:27], a[40:43], a[0:3], v[24:27]
ds_read_b64_tr_b16 a[98:99], v2 offset:38144
v_mfma_f32_16x16x32_bf16 v[28:31], a[44:47], a[0:3], v[28:31]
v_mfma_f32_16x16x32_bf16 v[32:35], a[48:51], a[0:3], v[32:35]
ds_read_b128 a[64:67], v1 offset:33792
v_mfma_f32_16x16x32_bf16 v[36:39], a[52:55], a[0:3], v[36:39]
v_mfma_f32_16x16x32_bf16 v[40:43], a[56:59], a[0:3], v[40:43]
ds_read_b64_tr_b16 a[100:101], v3 offset:33792
v_mfma_f32_16x16x32_bf16 v[44:47], a[60:63], a[0:3], v[44:47]
v_mfma_f32_16x16x32_bf16 v[76:79], a[60:63], a[4:7], v[76:79]
ds_read_b64_tr_b16 a[102:103], v3 offset:38144
v_mfma_f32_16x16x32_bf16 v[72:75], a[56:59], a[4:7], v[72:75]
buffer_load_dwordx4 v4, s[44:47], s52 offen offset:1024 lds
v_mfma_f32_16x16x32_bf16 v[68:71], a[52:55], a[4:7], v[68:71]
ds_read_b128 a[68:71], v1 offset:34048
v_mfma_f32_16x16x32_bf16 v[64:67], a[48:51], a[4:7], v[64:67]
v_mfma_f32_16x16x32_bf16 v[60:63], a[44:47], a[4:7], v[60:63]
ds_read_b64_tr_b16 a[104:105], v2 offset:33856
v_mfma_f32_16x16x32_bf16 v[56:59], a[40:43], a[4:7], v[56:59]
v_mfma_f32_16x16x32_bf16 v[52:55], a[36:39], a[4:7], v[52:55]
ds_read_b64_tr_b16 a[106:107], v2 offset:38208
v_mfma_f32_16x16x32_bf16 v[48:51], a[32:35], a[4:7], v[48:51]
v_mfma_f32_16x16x32_bf16 v[80:83], a[32:35], a[8:11], v[80:83]
ds_read_b128 a[72:75], v1 offset:35840
v_mfma_f32_16x16x32_bf16 v[84:87], a[36:39], a[8:11], v[84:87]
buffer_load_dwordx4 v5, s[44:47], s52 offen offset:2048 lds
v_mfma_f32_16x16x32_bf16 v[88:91], a[40:43], a[8:11], v[88:91]
ds_read_b64_tr_b16 a[108:109], v3 offset:33856
v_mfma_f32_16x16x32_bf16 v[92:95], a[44:47], a[8:11], v[92:95]
v_mfma_f32_16x16x32_bf16 v[96:99], a[48:51], a[8:11], v[96:99]
ds_read_b64_tr_b16 a[110:111], v3 offset:38208
v_mfma_f32_16x16x32_bf16 v[100:103], a[52:55], a[8:11], v[100:103]
v_mfma_f32_16x16x32_bf16 v[104:107], a[56:59], a[8:11], v[104:107]
ds_read_b128 a[76:79], v1 offset:36096
v_mfma_f32_16x16x32_bf16 v[108:111], a[60:63], a[8:11], v[108:111]
v_mfma_f32_16x16x32_bf16 v[140:143], a[60:63], a[12:15], v[140:143]
ds_read_b64_tr_b16 a[112:113], v2 offset:33920
v_mfma_f32_16x16x32_bf16 v[136:139], a[56:59], a[12:15], v[136:139]
buffer_load_dwordx4 v5, s[44:47], s52 offen offset:3072 lds
v_mfma_f32_16x16x32_bf16 v[132:135], a[52:55], a[12:15], v[132:135]
ds_read_b64_tr_b16 a[114:115], v2 offset:38272
s_add_u32 s52, s52, 2048
v_mfma_f32_16x16x32_bf16 v[128:131], a[48:51], a[12:15], v[128:131]
v_mfma_f32_16x16x32_bf16 v[124:127], a[44:47], a[12:15], v[124:127]
ds_read_b128 a[80:83], v1 offset:37888
v_mfma_f32_16x16x32_bf16 v[120:123], a[40:43], a[12:15], v[120:123]
v_mfma_f32_16x16x32_bf16 v[116:119], a[36:39], a[12:15], v[116:119]
ds_read_b64_tr_b16 a[116:117], v3 offset:33920
v_mfma_f32_16x16x32_bf16 v[112:115], a[32:35], a[12:15], v[112:115]
v_mfma_f32_16x16x32_bf16 v[144:147], a[32:35], a[16:19], v[144:147]
ds_read_b64_tr_b16 a[118:119], v3 offset:38272
s_add_u32 m0, s54, 0
v_mfma_f32_16x16x32_bf16 v[148:151], a[36:39], a[16:19], v[148:151]
buffer_load_dwordx4 v6, s[48:51], s53 offen offset:0 lds
v_mfma_f32_16x16x32_bf16 v[152:155], a[40:43], a[16:19], v[152:155]
ds_read_b128 a[84:87], v1 offset:38144
v_mfma_f32_16x16x32_bf16 v[156:159], a[44:47], a[16:19], v[156:159]
v_mfma_f32_16x16x32_bf16 v[160:163], a[48:51], a[16:19], v[160:163]
ds_read_b64_tr_b16 a[120:121], v2 offset:33984
v_mfma_f32_16x16x32_bf16 v[164:167], a[52:55], a[16:19], v[164:167]
v_mfma_f32_16x16x32_bf16 v[168:171], a[56:59], a[16:19], v[168:171]
ds_read_b64_tr_b16 a[122:123], v2 offset:38336
v_mfma_f32_16x16x32_bf16 v[172:175], a[60:63], a[16:19], v[172:175]
v_mfma_f32_16x16x32_bf16 v[204:207], a[60:63], a[20:23], v[204:207]
ds_read_b128 a[88:91], v1 offset:39936
v_mfma_f32_16x16x32_bf16 v[200:203], a[56:59], a[20:23], v[200:203]
buffer_load_dwordx4 v7, s[48:51], s53 offen offset:1088 lds
v_mfma_f32_16x16x32_bf16 v[196:199], a[52:55], a[20:23], v[196:199]
ds_read_b64_tr_b16 a[124:125], v3 offset:33984
v_mfma_f32_16x16x32_bf16 v[192:195], a[48:51], a[20:23], v[192:195]
v_mfma_f32_16x16x32_bf16 v[188:191], a[44:47], a[20:23], v[188:191]
ds_read_b64_tr_b16 a[126:127], v3 offset:38336
v_mfma_f32_16x16x32_bf16 v[184:187], a[40:43], a[20:23], v[184:187]
v_mfma_f32_16x16x32_bf16 v[180:183], a[36:39], a[20:23], v[180:183]
ds_read_b128 a[92:95], v1 offset:40192
v_mfma_f32_16x16x32_bf16 v[176:179], a[32:35], a[20:23], v[176:179]
v_mfma_f32_16x16x32_bf16 v[208:211], a[32:35], a[24:27], v[208:211]
v_add_u32 v1, 67584, v1
v_mfma_f32_16x16x32_bf16 v[212:215], a[36:39], a[24:27], v[212:215]
buffer_load_dwordx4 v8, s[48:51], s53 offen offset:2176 lds
v_mfma_f32_16x16x32_bf16 v[216:219], a[40:43], a[24:27], v[216:219]
v_add_u32 v2, 67584, v2
v_mfma_f32_16x16x32_bf16 v[220:223], a[44:47], a[24:27], v[220:223]
v_mfma_f32_16x16x32_bf16 v[224:227], a[48:51], a[24:27], v[224:227]
v_add_u32 v3, 67584, v3
v_mfma_f32_16x16x32_bf16 v[228:231], a[52:55], a[24:27], v[228:231]
v_mfma_f32_16x16x32_bf16 v[232:235], a[56:59], a[24:27], v[232:235]
v_mfma_f32_16x16x32_bf16 v[236:239], a[60:63], a[24:27], v[236:239]
v_mfma_f32_16x16x32_bf16 a[140:143], a[60:63], a[28:31], a[140:143]
v_mfma_f32_16x16x32_bf16 a[136:139], a[56:59], a[28:31], a[136:139]
buffer_load_dwordx4 v9, s[48:51], s53 offen offset:3264 lds
v_mfma_f32_16x16x32_bf16 a[132:135], a[52:55], a[28:31], a[132:135]
s_add_u32 s53, s53, s55
v_mfma_f32_16x16x32_bf16 a[128:131], a[48:51], a[28:31], a[128:131]
v_mfma_f32_16x16x32_bf16 v[252:255], a[44:47], a[28:31], v[252:255]
v_mfma_f32_16x16x32_bf16 v[248:251], a[40:43], a[28:31], v[248:251]
v_mfma_f32_16x16x32_bf16 v[244:247], a[36:39], a[28:31], v[244:247]
v_mfma_f32_16x16x32_bf16 v[240:243], a[32:35], a[28:31], v[240:243]
s_branch m_g_T_l
m_g_T_x:
v_readlane_b32 s59, v14, 32
s_cmp_eq_u32 s18, 4
s_cbranch_scc1 m_g_nx2
s_cmp_eq_u32 s18, 0
s_cbranch_scc1 m_g_ek
s_cmp_eq_u32 s18, 3
s_cbranch_scc1 m_g_ef
s_cmp_eq_u32 s18, 2
s_cbranch_scc1 m_g_eq
s_cmp_ge_u32 s18, 7
s_cbranch_scc1 m_g_es
s_lshl_b32 s62, s19, 1
s_add_u32 s62, s62, s32
s_mul_i32 s62, s62, 262144
s_lshl_b32 s63, s20, 1
s_add_u32 s63, s63, s33
s_lshl_b32 s63, s63, 13
s_add_u32 s23, s62, s63
s_add_u32 s23, s23, 125829120
s_lshl_b32 s62, s35, 22
s_add_u32 s23, s23, s62
s_lshl_b32 s21, s19, 2
s_add_u32 s21, s21, s20
s_lshl_b32 s21, s21, 2
s_add_u32 s21, s21, s14
s_lshl_b32 s21, s21, 6
s_add_u32 s21, s21, 170950656
v_lshrrev_b32 v10, 4, v0
v_lshlrev_b32 v10, 9, v10
v_and_b32 v11, 15, v0
v_lshl_add_u32 v10, v11, 4, v10
s_add_u32 s62, s23, 0
v_cvt_pk_bf16_f32 v16, v16, v17
v_cvt_pk_bf16_f32 v17, v18, v19
v_cvt_pk_bf16_f32 v18, v20, v21
v_cvt_pk_bf16_f32 v19, v22, v23
buffer_store_dwordx4 v[16:19], v10, s[4:7], s62 offen offset:0 sc1
v_cvt_pk_bf16_f32 v24, v24, v25
v_cvt_pk_bf16_f32 v25, v26, v27
v_cvt_pk_bf16_f32 v26, v28, v29
v_cvt_pk_bf16_f32 v27, v30, v31
buffer_store_dwordx4 v[24:27], v10, s[4:7], s62 offen offset:2048 sc1
v_cvt_pk_bf16_f32 v48, v48, v49
v_cvt_pk_bf16_f32 v49, v50, v51
v_cvt_pk_bf16_f32 v50, v52, v53
v_cvt_pk_bf16_f32 v51, v54, v55
buffer_store_dwordx4 v[48:51], v10, s[4:7], s62 offen offset:256 sc1
v_cvt_pk_bf16_f32 v56, v56, v57
v_cvt_pk_bf16_f32 v57, v58, v59
v_cvt_pk_bf16_f32 v58, v60, v61
v_cvt_pk_bf16_f32 v59, v62, v63
buffer_store_dwordx4 v[56:59], v10, s[4:7], s62 offen offset:2304 sc1
s_add_u32 s62, s23, 4096
v_cvt_pk_bf16_f32 v32, v32, v33
v_cvt_pk_bf16_f32 v33, v34, v35
v_cvt_pk_bf16_f32 v34, v36, v37
v_cvt_pk_bf16_f32 v35, v38, v39
buffer_store_dwordx4 v[32:35], v10, s[4:7], s62 offen offset:0 sc1
v_cvt_pk_bf16_f32 v40, v40, v41
v_cvt_pk_bf16_f32 v41, v42, v43
v_cvt_pk_bf16_f32 v42, v44, v45
v_cvt_pk_bf16_f32 v43, v46, v47
buffer_store_dwordx4 v[40:43], v10, s[4:7], s62 offen offset:2048 sc1
v_cvt_pk_bf16_f32 v64, v64, v65
v_cvt_pk_bf16_f32 v65, v66, v67
v_cvt_pk_bf16_f32 v66, v68, v69
v_cvt_pk_bf16_f32 v67, v70, v71
buffer_store_dwordx4 v[64:67], v10, s[4:7], s62 offen offset:256 sc1
v_cvt_pk_bf16_f32 v72, v72, v73
v_cvt_pk_bf16_f32 v73, v74, v75
v_cvt_pk_bf16_f32 v74, v76, v77
v_cvt_pk_bf16_f32 v75, v78, v79
buffer_store_dwordx4 v[72:75], v10, s[4:7], s62 offen offset:2304 sc1
s_add_u32 s62, s23, 65536
v_cvt_pk_bf16_f32 v80, v80, v81
v_cvt_pk_bf16_f32 v81, v82, v83
v_cvt_pk_bf16_f32 v82, v84, v85
v_cvt_pk_bf16_f32 v83, v86, v87
buffer_store_dwordx4 v[80:83], v10, s[4:7], s62 offen offset:0 sc1
v_cvt_pk_bf16_f32 v88, v88, v89
v_cvt_pk_bf16_f32 v89, v90, v91
v_cvt_pk_bf16_f32 v90, v92, v93
v_cvt_pk_bf16_f32 v91, v94, v95
buffer_store_dwordx4 v[88:91], v10, s[4:7], s62 offen offset:2048 sc1
v_cvt_pk_bf16_f32 v112, v112, v113
v_cvt_pk_bf16_f32 v113, v114, v115
v_cvt_pk_bf16_f32 v114, v116, v117
v_cvt_pk_bf16_f32 v115, v118, v119
buffer_store_dwordx4 v[112:115], v10, s[4:7], s62 offen offset:256 sc1
v_cvt_pk_bf16_f32 v120, v120, v121
v_cvt_pk_bf16_f32 v121, v122, v123
v_cvt_pk_bf16_f32 v122, v124, v125
v_cvt_pk_bf16_f32 v123, v126, v127
buffer_store_dwordx4 v[120:123], v10, s[4:7], s62 offen offset:2304 sc1
s_add_u32 s62, s23, 69632
v_cvt_pk_bf16_f32 v96, v96, v97
v_cvt_pk_bf16_f32 v97, v98, v99
v_cvt_pk_bf16_f32 v98, v100, v101
v_cvt_pk_bf16_f32 v99, v102, v103
buffer_store_dwordx4 v[96:99], v10, s[4:7], s62 offen offset:0 sc1
v_cvt_pk_bf16_f32 v104, v104, v105
v_cvt_pk_bf16_f32 v105, v106, v107
v_cvt_pk_bf16_f32 v106, v108, v109
v_cvt_pk_bf16_f32 v107, v110, v111
buffer_store_dwordx4 v[104:107], v10, s[4:7], s62 offen offset:2048 sc1
v_cvt_pk_bf16_f32 v128, v128, v129
v_cvt_pk_bf16_f32 v129, v130, v131
v_cvt_pk_bf16_f32 v130, v132, v133
v_cvt_pk_bf16_f32 v131, v134, v135
buffer_store_dwordx4 v[128:131], v10, s[4:7], s62 offen offset:256 sc1
v_cvt_pk_bf16_f32 v136, v136, v137
v_cvt_pk_bf16_f32 v137, v138, v139
v_cvt_pk_bf16_f32 v138, v140, v141
v_cvt_pk_bf16_f32 v139, v142, v143
buffer_store_dwordx4 v[136:139], v10, s[4:7], s62 offen offset:2304 sc1
s_add_u32 s62, s23, 131072
v_cvt_pk_bf16_f32 v144, v144, v145
v_cvt_pk_bf16_f32 v145, v146, v147
v_cvt_pk_bf16_f32 v146, v148, v149
v_cvt_pk_bf16_f32 v147, v150, v151
buffer_store_dwordx4 v[144:147], v10, s[4:7], s62 offen offset:0 sc1
v_cvt_pk_bf16_f32 v152, v152, v153
v_cvt_pk_bf16_f32 v153, v154, v155
v_cvt_pk_bf16_f32 v154, v156, v157
v_cvt_pk_bf16_f32 v155, v158, v159
buffer_store_dwordx4 v[152:155], v10, s[4:7], s62 offen offset:2048 sc1
v_cvt_pk_bf16_f32 v176, v176, v177
v_cvt_pk_bf16_f32 v177, v178, v179
v_cvt_pk_bf16_f32 v178, v180, v181
v_cvt_pk_bf16_f32 v179, v182, v183
buffer_store_dwordx4 v[176:179], v10, s[4:7], s62 offen offset:256 sc1
v_cvt_pk_bf16_f32 v184, v184, v185
v_cvt_pk_bf16_f32 v185, v186, v187
v_cvt_pk_bf16_f32 v186, v188, v189
v_cvt_pk_bf16_f32 v187, v190, v191
buffer_store_dwordx4 v[184:187], v10, s[4:7], s62 offen offset:2304 sc1
s_add_u32 s62, s23, 135168
v_cvt_pk_bf16_f32 v160, v160, v161
v_cvt_pk_bf16_f32 v161, v162, v163
v_cvt_pk_bf16_f32 v162, v164, v165
v_cvt_pk_bf16_f32 v163, v166, v167
buffer_store_dwordx4 v[160:163], v10, s[4:7], s62 offen offset:0 sc1
v_cvt_pk_bf16_f32 v168, v168, v169
v_cvt_pk_bf16_f32 v169, v170, v171
v_cvt_pk_bf16_f32 v170, v172, v173
v_cvt_pk_bf16_f32 v171, v174, v175
buffer_store_dwordx4 v[168:171], v10, s[4:7], s62 offen offset:2048 sc1
v_cvt_pk_bf16_f32 v192, v192, v193
v_cvt_pk_bf16_f32 v193, v194, v195
v_cvt_pk_bf16_f32 v194, v196, v197
v_cvt_pk_bf16_f32 v195, v198, v199
buffer_store_dwordx4 v[192:195], v10, s[4:7], s62 offen offset:256 sc1
v_cvt_pk_bf16_f32 v200, v200, v201
v_cvt_pk_bf16_f32 v201, v202, v203
v_cvt_pk_bf16_f32 v202, v204, v205
v_cvt_pk_bf16_f32 v203, v206, v207
buffer_store_dwordx4 v[200:203], v10, s[4:7], s62 offen offset:2304 sc1
s_add_u32 s62, s23, 196608
v_cvt_pk_bf16_f32 v208, v208, v209
v_cvt_pk_bf16_f32 v209, v210, v211
v_cvt_pk_bf16_f32 v210, v212, v213
v_cvt_pk_bf16_f32 v211, v214, v215
buffer_store_dwordx4 v[208:211], v10, s[4:7], s62 offen offset:0 sc1
v_cvt_pk_bf16_f32 v216, v216, v217
v_cvt_pk_bf16_f32 v217, v218, v219
v_cvt_pk_bf16_f32 v218, v220, v221
v_cvt_pk_bf16_f32 v219, v222, v223
buffer_store_dwordx4 v[216:219], v10, s[4:7], s62 offen offset:2048 sc1
v_cvt_pk_bf16_f32 v240, v240, v241
v_cvt_pk_bf16_f32 v241, v242, v243
v_cvt_pk_bf16_f32 v242, v244, v245
v_cvt_pk_bf16_f32 v243, v246, v247
buffer_store_dwordx4 v[240:243], v10, s[4:7], s62 offen offset:256 sc1
v_cvt_pk_bf16_f32 v248, v248, v249
v_cvt_pk_bf16_f32 v249, v250, v251
v_cvt_pk_bf16_f32 v250, v252, v253
v_cvt_pk_bf16_f32 v251, v254, v255
buffer_store_dwordx4 v[248:251], v10, s[4:7], s62 offen offset:2304 sc1
s_add_u32 s62, s23, 200704
v_cvt_pk_bf16_f32 v224, v224, v225
v_cvt_pk_bf16_f32 v225, v226, v227
v_cvt_pk_bf16_f32 v226, v228, v229
v_cvt_pk_bf16_f32 v227, v230, v231
buffer_store_dwordx4 v[224:227], v10, s[4:7], s62 offen offset:0 sc1
v_cvt_pk_bf16_f32 v232, v232, v233
v_cvt_pk_bf16_f32 v233, v234, v235
v_cvt_pk_bf16_f32 v234, v236, v237
v_cvt_pk_bf16_f32 v235, v238, v239
buffer_store_dwordx4 v[232:235], v10, s[4:7], s62 offen offset:2048 sc1
v_accvgpr_read_b32 v16, a128
v_accvgpr_read_b32 v17, a129
v_accvgpr_read_b32 v18, a130
v_accvgpr_read_b32 v19, a131
v_accvgpr_read_b32 v20, a132
v_accvgpr_read_b32 v21, a133
v_accvgpr_read_b32 v22, a134
v_accvgpr_read_b32 v23, a135
v_cvt_pk_bf16_f32 v16, v16, v17
v_cvt_pk_bf16_f32 v17, v18, v19
v_cvt_pk_bf16_f32 v18, v20, v21
v_cvt_pk_bf16_f32 v19, v22, v23
buffer_store_dwordx4 v[16:19], v10, s[4:7], s62 offen offset:256 sc1
s_nop 1
v_accvgpr_read_b32 v16, a136
v_accvgpr_read_b32 v17, a137
v_accvgpr_read_b32 v18, a138
v_accvgpr_read_b32 v19, a139
v_accvgpr_read_b32 v20, a140
v_accvgpr_read_b32 v21, a141
v_accvgpr_read_b32 v22, a142
v_accvgpr_read_b32 v23, a143
v_cvt_pk_bf16_f32 v16, v16, v17
v_cvt_pk_bf16_f32 v17, v18, v19
v_cvt_pk_bf16_f32 v18, v20, v21
v_cvt_pk_bf16_f32 v19, v22, v23
buffer_store_dwordx4 v[16:19], v10, s[4:7], s62 offen offset:2304 sc1
s_branch m_g_nx1
m_g_eq:
s_waitcnt lgkmcnt(0)
v_accvgpr_write_b32 a240, v2
v_accvgpr_write_b32 a241, v3
v_accvgpr_write_b32 a242, v4
v_accvgpr_write_b32 a243, v5
v_accvgpr_write_b32 a244, v6
v_accvgpr_write_b32 a245, v7
v_accvgpr_write_b32 a246, v8
v_accvgpr_write_b32 a247, v9
s_lshl_b32 s62, s19, 1
s_add_u32 s62, s62, s32
s_mul_i32 s62, s62, 1048576
s_lshl_b32 s63, s20, 1
s_add_u32 s63, s63, s33
s_lshl_b32 s63, s63, 13
s_add_u32 s23, s62, s63
s_add_u32 s23, s23, 109051904
s_lshl_b32 s21, s19, 4
s_add_u32 s21, s21, s20
s_lshl_b32 s21, s21, 2
s_add_u32 s21, s21, 170936320
s_lshl_b32 s62, s35, 9
s_add_u32 s21, s21, s62
s_lshl_b32 s62, s20, 1
s_add_u32 s62, s62, s33
s_lshl_b32 s63, s19, 1
s_add_u32 s63, s63, s32
s_and_b32 s30, s35, 1
s_lshr_b32 s64, s35, 1
s_lshl_b32 s64, s64, 2
s_add_u32 s30, s30, s64
s_lshl_b32 s30, s30, 12
s_xor_b32 s64, s34, 8192
s_add_u32 s30, s30, s64
s_add_u32 s30, s30, 170983424
s_and_b32 s64, s16, 31
s_lshl_b32 s64, s64, 7
s_add_u32 s30, s30, s64
s_lshl_b32 s31, s63, 2
s_add_u32 s65, s31, 4
v_mov_b32 v10, 0
m_g_qa_pp:
buffer_load_dword v12, v10, s[4:7], s30 offen sc1
s_waitcnt vmcnt(0)
v_readfirstlane_b32 s71, v12
s_cmp_ge_u32 s71, s65
s_cbranch_scc1 m_g_qa_pp_d
s_cmp_eq_u32 s17, 0
s_cbranch_scc1 m_g_qa_pp_d
s_sub_u32 s17, s17, 1
s_branch m_g_qa_pp
m_g_qa_pp_d:
s_lshl_b32 s64, s63, 19
s_lshr_b32 s65, s62, 2
s_lshl_b32 s65, s65, 14
s_add_u32 s64, s64, s65
s_and_b32 s65, s62, 3
s_lshl_b32 s65, s65, 11
s_add_u32 s64, s64, s65
s_lshl_b32 s65, s19, 12
s_xor_b32 s65, s65, s34
s_and_b32 s65, s65, 8192
s_add_u32 s64, s64, s65
s_add_u32 s66, s64, 8388608
s_add_u32 s67, s64, 16777216
s_lshl_b32 s63, s63, 21
s_lshl_b32 s62, s62, 14
s_add_u32 s62, s62, s63
s_lshl_b32 s63, s32, 13
s_xor_b32 s63, s63, s34
s_xor_b32 s63, s63, 8192
s_add_u32 s62, s62, s63
s_add_u32 s64, s62, 58720256
s_add_u32 s65, s64, 4096
s_add_u32 s62, s62, 25165824
s_add_u32 s63, s62, 4096
s_mov_b32 s68, 1040356334
s_mov_b32 s69, 1040356334
v_lshrrev_b32 v2, 4, v0
v_lshlrev_b32 v2, 9, v2
v_and_b32 v10, 15, v0
v_lshl_add_u32 v2, v10, 4, v2
v_lshrrev_b32 v3, 4, v0
v_lshlrev_b32 v3, 9, v3
v_bfe_u32 v10, v0, 3, 1
v_lshl_add_u32 v3, v10, 8, v3
v_and_b32 v10, 7, v0
v_lshl_add_u32 v3, v10, 4, v3
v_lshrrev_b32 v10, 4, v0
v_and_b32 v11, 15, v0
v_lshlrev_b32 v4, 7, v10
v_lshl_add_u32 v4, v11, 4, v4
v_mov_b32 v12, 2147483648
v_cmp_gt_u32 vcc, 8, v11
s_nop 1
v_cndmask_b32 v4, v12, v4, vcc
v_lshrrev_b32 v13, 3, v11
v_lshlrev_b32 v13, 8, v13
v_lshl_add_u32 v13, v10, 3, v13
v_and_b32 v14, 7, v0
v_lshl_add_u32 v5, v14, 4, v13
v_cmp_gt_u32 vcc, 2, v10
s_nop 1
v_cndmask_b32 v5, v12, v5, vcc
buffer_load_dwordx4 a[176:179], v4, s[4:7], s66 offen offset:0 sc1
buffer_load_dwordx4 a[180:183], v4, s[4:7], s66 offen offset:512 sc1
buffer_load_dwordx4 a[184:187], v4, s[4:7], s66 offen offset:1024 sc1
buffer_load_dwordx4 a[188:191], v4, s[4:7], s66 offen offset:1536 sc1
s_add_u32 s66, s66, 131072
buffer_load_dwordx4 a[144:147], v2, s[4:7], s62 offen offset:0
buffer_load_dwordx4 a[160:163], v2, s[4:7], s62 offen offset:256
buffer_load_dwordx4 a[148:151], v2, s[4:7], s62 offen offset:2048
buffer_load_dwordx4 a[164:167], v2, s[4:7], s62 offen offset:2304
buffer_load_dwordx4 a[152:155], v2, s[4:7], s63 offen offset:0
buffer_load_dwordx4 a[168:171], v2, s[4:7], s63 offen offset:256
buffer_load_dwordx4 a[156:159], v2, s[4:7], s63 offen offset:2048
buffer_load_dwordx4 a[172:175], v2, s[4:7], s63 offen offset:2304
s_add_u32 s62, s62, 524288
s_add_u32 s63, s63, 524288
buffer_load_dwordx2 a[192:193], v5, s[4:7], s67 offen offset:0 sc1
buffer_load_dwordx2 a[198:199], v5, s[4:7], s67 offen offset:128 sc1
buffer_load_dwordx2 a[204:205], v5, s[4:7], s67 offen offset:512 sc1
buffer_load_dwordx2 a[210:211], v5, s[4:7], s67 offen offset:640 sc1
buffer_load_dwordx2 a[216:217], v5, s[4:7], s67 offen offset:1024 sc1
buffer_load_dwordx2 a[222:223], v5, s[4:7], s67 offen offset:1152 sc1
buffer_load_dwordx2 a[228:229], v5, s[4:7], s67 offen offset:1536 sc1
buffer_load_dwordx2 a[234:235], v5, s[4:7], s67 offen offset:1664 sc1
s_add_u32 s67, s67, 131072
buffer_load_dwordx4 a[194:197], v3, s[4:7], s64 offen offset:0
buffer_load_dwordx4 a[200:203], v3, s[4:7], s64 offen offset:128
buffer_load_dwordx4 a[206:209], v3, s[4:7], s64 offen offset:2048
buffer_load_dwordx4 a[212:215], v3, s[4:7], s64 offen offset:2176
buffer_load_dwordx4 a[218:221], v3, s[4:7], s65 offen offset:0
buffer_load_dwordx4 a[224:227], v3, s[4:7], s65 offen offset:128
buffer_load_dwordx4 a[230:233], v3, s[4:7], s65 offen offset:2048
buffer_load_dwordx4 a[236:239], v3, s[4:7], s65 offen offset:2176
s_add_u32 s64, s64, 524288
s_add_u32 s65, s65, 524288
v_mov_b32 v12, 4284592614
v_lshlrev_b32 v13, 2, v10
v_add_u32 v14, 0, v13
v_cmp_gt_u32 vcc, v14, v11
s_nop 1
v_cndmask_b32 v6, 0, v12, vcc
v_add_u32 v14, 1, v13
v_cmp_gt_u32 vcc, v14, v11
s_nop 1
v_cndmask_b32 v7, 0, v12, vcc
v_add_u32 v14, 2, v13
v_cmp_gt_u32 vcc, v14, v11
s_nop 1
v_cndmask_b32 v8, 0, v12, vcc
v_add_u32 v14, 3, v13
v_cmp_gt_u32 vcc, v14, v11
s_nop 1
v_cndmask_b32 v9, 0, v12, vcc
v_cmp_le_u32 vcc, 2, v10
s_nop 1
v_cndmask_b32 v12, 0, v12, vcc
v_mov_b32 v13, v12
v_mov_b32 v14, v12
v_mov_b32 v15, v12
v_cvt_pk_bf16_f32 v16, v16, v17
v_cvt_pk_bf16_f32 v17, v18, v19
v_cvt_pk_bf16_f32 v18, v20, v21
v_cvt_pk_bf16_f32 v19, v22, v23
v_cvt_pk_bf16_f32 v24, v24, v25
v_cvt_pk_bf16_f32 v25, v26, v27
v_cvt_pk_bf16_f32 v26, v28, v29
v_cvt_pk_bf16_f32 v27, v30, v31
v_cvt_pk_bf16_f32 v32, v32, v33
v_cvt_pk_bf16_f32 v33, v34, v35
v_cvt_pk_bf16_f32 v34, v36, v37
v_cvt_pk_bf16_f32 v35, v38, v39
v_cvt_pk_bf16_f32 v40, v40, v41
v_cvt_pk_bf16_f32 v41, v42, v43
v_cvt_pk_bf16_f32 v42, v44, v45
v_cvt_pk_bf16_f32 v43, v46, v47
v_cvt_pk_bf16_f32 v48, v48, v49
v_cvt_pk_bf16_f32 v49, v50, v51
v_cvt_pk_bf16_f32 v50, v52, v53
v_cvt_pk_bf16_f32 v51, v54, v55
buffer_load_dwordx4 a[32:35], v4, s[4:7], s66 offen offset:0 sc1
v_cvt_pk_bf16_f32 v56, v56, v57
v_cvt_pk_bf16_f32 v57, v58, v59
v_cvt_pk_bf16_f32 v58, v60, v61
v_cvt_pk_bf16_f32 v59, v62, v63
buffer_load_dwordx4 a[36:39], v4, s[4:7], s66 offen offset:512 sc1
v_cvt_pk_bf16_f32 v64, v64, v65
v_cvt_pk_bf16_f32 v65, v66, v67
v_cvt_pk_bf16_f32 v66, v68, v69
v_cvt_pk_bf16_f32 v67, v70, v71
buffer_load_dwordx4 a[40:43], v4, s[4:7], s66 offen offset:1024 sc1
v_cvt_pk_bf16_f32 v72, v72, v73
v_cvt_pk_bf16_f32 v73, v74, v75
v_cvt_pk_bf16_f32 v74, v76, v77
v_cvt_pk_bf16_f32 v75, v78, v79
buffer_load_dwordx4 a[44:47], v4, s[4:7], s66 offen offset:1536 sc1
v_cvt_pk_bf16_f32 v80, v80, v81
v_cvt_pk_bf16_f32 v81, v82, v83
v_cvt_pk_bf16_f32 v82, v84, v85
v_cvt_pk_bf16_f32 v83, v86, v87
s_add_u32 s66, s66, 131072
v_cvt_pk_bf16_f32 v88, v88, v89
v_cvt_pk_bf16_f32 v89, v90, v91
v_cvt_pk_bf16_f32 v90, v92, v93
v_cvt_pk_bf16_f32 v91, v94, v95
buffer_load_dwordx4 a[0:3], v2, s[4:7], s62 offen offset:0
v_cvt_pk_bf16_f32 v96, v96, v97
v_cvt_pk_bf16_f32 v97, v98, v99
v_cvt_pk_bf16_f32 v98, v100, v101
v_cvt_pk_bf16_f32 v99, v102, v103
buffer_load_dwordx4 a[16:19], v2, s[4:7], s62 offen offset:256
v_cvt_pk_bf16_f32 v104, v104, v105
v_cvt_pk_bf16_f32 v105, v106, v107
v_cvt_pk_bf16_f32 v106, v108, v109
v_cvt_pk_bf16_f32 v107, v110, v111
buffer_load_dwordx4 a[4:7], v2, s[4:7], s62 offen offset:2048
v_cvt_pk_bf16_f32 v112, v112, v113
v_cvt_pk_bf16_f32 v113, v114, v115
v_cvt_pk_bf16_f32 v114, v116, v117
v_cvt_pk_bf16_f32 v115, v118, v119
buffer_load_dwordx4 a[20:23], v2, s[4:7], s62 offen offset:2304
v_cvt_pk_bf16_f32 v120, v120, v121
v_cvt_pk_bf16_f32 v121, v122, v123
v_cvt_pk_bf16_f32 v122, v124, v125
v_cvt_pk_bf16_f32 v123, v126, v127
buffer_load_dwordx4 a[8:11], v2, s[4:7], s63 offen offset:0
v_cvt_pk_bf16_f32 v128, v128, v129
v_cvt_pk_bf16_f32 v129, v130, v131
v_cvt_pk_bf16_f32 v130, v132, v133
v_cvt_pk_bf16_f32 v131, v134, v135
buffer_load_dwordx4 a[24:27], v2, s[4:7], s63 offen offset:256
v_cvt_pk_bf16_f32 v136, v136, v137
v_cvt_pk_bf16_f32 v137, v138, v139
v_cvt_pk_bf16_f32 v138, v140, v141
v_cvt_pk_bf16_f32 v139, v142, v143
buffer_load_dwordx4 a[12:15], v2, s[4:7], s63 offen offset:2048
v_cvt_pk_bf16_f32 v144, v144, v145
v_cvt_pk_bf16_f32 v145, v146, v147
v_cvt_pk_bf16_f32 v146, v148, v149
v_cvt_pk_bf16_f32 v147, v150, v151
buffer_load_dwordx4 a[28:31], v2, s[4:7], s63 offen offset:2304
s_add_u32 s62, s62, 524288
s_add_u32 s63, s63, 524288
v_cvt_pk_bf16_f32 v152, v152, v153
v_cvt_pk_bf16_f32 v153, v154, v155
v_cvt_pk_bf16_f32 v154, v156, v157
v_cvt_pk_bf16_f32 v155, v158, v159
buffer_load_dwordx2 a[48:49], v5, s[4:7], s67 offen offset:0 sc1
buffer_load_dwordx2 a[54:55], v5, s[4:7], s67 offen offset:128 sc1
v_cvt_pk_bf16_f32 v160, v160, v161
v_cvt_pk_bf16_f32 v161, v162, v163
v_cvt_pk_bf16_f32 v162, v164, v165
v_cvt_pk_bf16_f32 v163, v166, v167
buffer_load_dwordx2 a[60:61], v5, s[4:7], s67 offen offset:512 sc1
buffer_load_dwordx2 a[66:67], v5, s[4:7], s67 offen offset:640 sc1
v_cvt_pk_bf16_f32 v168, v168, v169
v_cvt_pk_bf16_f32 v169, v170, v171
v_cvt_pk_bf16_f32 v170, v172, v173
v_cvt_pk_bf16_f32 v171, v174, v175
buffer_load_dwordx2 a[72:73], v5, s[4:7], s67 offen offset:1024 sc1
buffer_load_dwordx2 a[78:79], v5, s[4:7], s67 offen offset:1152 sc1
v_cvt_pk_bf16_f32 v176, v176, v177
v_cvt_pk_bf16_f32 v177, v178, v179
v_cvt_pk_bf16_f32 v178, v180, v181
v_cvt_pk_bf16_f32 v179, v182, v183
buffer_load_dwordx2 a[84:85], v5, s[4:7], s67 offen offset:1536 sc1
buffer_load_dwordx2 a[90:91], v5, s[4:7], s67 offen offset:1664 sc1
v_cvt_pk_bf16_f32 v184, v184, v185
v_cvt_pk_bf16_f32 v185, v186, v187
v_cvt_pk_bf16_f32 v186, v188, v189
v_cvt_pk_bf16_f32 v187, v190, v191
s_add_u32 s67, s67, 131072
buffer_load_dwordx4 a[50:53], v3, s[4:7], s64 offen offset:0
v_cvt_pk_bf16_f32 v192, v192, v193
v_cvt_pk_bf16_f32 v193, v194, v195
v_cvt_pk_bf16_f32 v194, v196, v197
v_cvt_pk_bf16_f32 v195, v198, v199
buffer_load_dwordx4 a[56:59], v3, s[4:7], s64 offen offset:128
buffer_load_dwordx4 a[62:65], v3, s[4:7], s64 offen offset:2048
v_cvt_pk_bf16_f32 v200, v200, v201
v_cvt_pk_bf16_f32 v201, v202, v203
v_cvt_pk_bf16_f32 v202, v204, v205
v_cvt_pk_bf16_f32 v203, v206, v207
buffer_load_dwordx4 a[68:71], v3, s[4:7], s64 offen offset:2176
buffer_load_dwordx4 a[74:77], v3, s[4:7], s65 offen offset:0
v_cvt_pk_bf16_f32 v208, v208, v209
v_cvt_pk_bf16_f32 v209, v210, v211
v_cvt_pk_bf16_f32 v210, v212, v213
v_cvt_pk_bf16_f32 v211, v214, v215
buffer_load_dwordx4 a[80:83], v3, s[4:7], s65 offen offset:128
buffer_load_dwordx4 a[86:89], v3, s[4:7], s65 offen offset:2048
v_cvt_pk_bf16_f32 v216, v216, v217
v_cvt_pk_bf16_f32 v217, v218, v219
v_cvt_pk_bf16_f32 v218, v220, v221
v_cvt_pk_bf16_f32 v219, v222, v223
buffer_load_dwordx4 a[92:95], v3, s[4:7], s65 offen offset:2176
s_add_u32 s64, s64, 524288
s_add_u32 s65, s65, 524288
v_cvt_pk_bf16_f32 v224, v224, v225
v_cvt_pk_bf16_f32 v225, v226, v227
v_cvt_pk_bf16_f32 v226, v228, v229
v_cvt_pk_bf16_f32 v227, v230, v231
v_cvt_pk_bf16_f32 v232, v232, v233
v_cvt_pk_bf16_f32 v233, v234, v235
v_cvt_pk_bf16_f32 v234, v236, v237
v_cvt_pk_bf16_f32 v235, v238, v239
v_cvt_pk_bf16_f32 v240, v240, v241
v_cvt_pk_bf16_f32 v241, v242, v243
v_cvt_pk_bf16_f32 v242, v244, v245
v_cvt_pk_bf16_f32 v243, v246, v247
v_cvt_pk_bf16_f32 v248, v248, v249
v_cvt_pk_bf16_f32 v249, v250, v251
v_cvt_pk_bf16_f32 v250, v252, v253
v_cvt_pk_bf16_f32 v251, v254, v255
v_accvgpr_read_b32 v20, a128
v_accvgpr_read_b32 v21, a129
v_accvgpr_read_b32 v22, a130
v_accvgpr_read_b32 v23, a131
v_accvgpr_read_b32 v28, a132
v_accvgpr_read_b32 v29, a133
v_accvgpr_read_b32 v30, a134
v_accvgpr_read_b32 v31, a135
v_cvt_pk_bf16_f32 v20, v20, v21
v_cvt_pk_bf16_f32 v21, v22, v23
v_cvt_pk_bf16_f32 v22, v28, v29
v_cvt_pk_bf16_f32 v23, v30, v31
v_accvgpr_read_b32 v36, a136
v_accvgpr_read_b32 v37, a137
v_accvgpr_read_b32 v38, a138
v_accvgpr_read_b32 v39, a139
v_accvgpr_read_b32 v44, a140
v_accvgpr_read_b32 v45, a141
v_accvgpr_read_b32 v46, a142
v_accvgpr_read_b32 v47, a143
v_cvt_pk_bf16_f32 v36, v36, v37
v_cvt_pk_bf16_f32 v37, v38, v39
v_cvt_pk_bf16_f32 v38, v44, v45
v_cvt_pk_bf16_f32 v39, v46, v47
s_waitcnt vmcnt(44)
v_mfma_f32_16x16x32_bf16 v[52:55], a[144:147], v[16:19], v[6:9]
v_mfma_f32_16x16x32_bf16 v[60:63], a[176:179], v[16:19], v[12:15]
v_mfma_f32_16x16x32_bf16 v[68:71], a[144:147], v[48:51], 0
v_mfma_f32_16x16x32_bf16 v[76:79], a[160:163], v[48:51], v[6:9]
v_mfma_f32_16x16x32_bf16 v[84:87], a[176:179], v[48:51], v[12:15]
v_mfma_f32_16x16x32_bf16 v[52:55], a[148:151], v[24:27], v[52:55]
v_mfma_f32_16x16x32_bf16 v[60:63], a[180:183], v[24:27], v[60:63]
v_mfma_f32_16x16x32_bf16 v[68:71], a[148:151], v[56:59], v[68:71]
v_mfma_f32_16x16x32_bf16 v[76:79], a[164:167], v[56:59], v[76:79]
v_mfma_f32_16x16x32_bf16 v[84:87], a[180:183], v[56:59], v[84:87]
v_mfma_f32_16x16x32_bf16 v[52:55], a[152:155], v[32:35], v[52:55]
v_mfma_f32_16x16x32_bf16 v[60:63], a[184:187], v[32:35], v[60:63]
v_mfma_f32_16x16x32_bf16 v[68:71], a[152:155], v[64:67], v[68:71]
v_mfma_f32_16x16x32_bf16 v[76:79], a[168:171], v[64:67], v[76:79]
v_mfma_f32_16x16x32_bf16 v[84:87], a[184:187], v[64:67], v[84:87]
v_mfma_f32_16x16x32_bf16 v[52:55], a[156:159], v[40:43], v[52:55]
v_mfma_f32_16x16x32_bf16 v[60:63], a[188:191], v[40:43], v[60:63]
v_mfma_f32_16x16x32_bf16 v[68:71], a[156:159], v[72:75], v[68:71]
v_mfma_f32_16x16x32_bf16 v[76:79], a[172:175], v[72:75], v[76:79]
v_mfma_f32_16x16x32_bf16 v[84:87], a[188:191], v[72:75], v[84:87]
buffer_load_dwordx4 a[176:179], v4, s[4:7], s66 offen offset:0 sc1
buffer_load_dwordx4 a[180:183], v4, s[4:7], s66 offen offset:512 sc1
buffer_load_dwordx4 a[184:187], v4, s[4:7], s66 offen offset:1024 sc1
buffer_load_dwordx4 a[188:191], v4, s[4:7], s66 offen offset:1536 sc1
s_add_u32 s66, s66, 131072
buffer_load_dwordx4 a[144:147], v2, s[4:7], s62 offen offset:0
buffer_load_dwordx4 a[160:163], v2, s[4:7], s62 offen offset:256
buffer_load_dwordx4 a[148:151], v2, s[4:7], s62 offen offset:2048
buffer_load_dwordx4 a[164:167], v2, s[4:7], s62 offen offset:2304
buffer_load_dwordx4 a[152:155], v2, s[4:7], s63 offen offset:0
buffer_load_dwordx4 a[168:171], v2, s[4:7], s63 offen offset:256
buffer_load_dwordx4 a[156:159], v2, s[4:7], s63 offen offset:2048
buffer_load_dwordx4 a[172:175], v2, s[4:7], s63 offen offset:2304
s_add_u32 s62, s62, 524288
s_add_u32 s63, s63, 524288
v_max3_f32 v10, v52, v53, v54
v_max3_f32 v10, v10, v55, v60
v_max3_f32 v10, v10, v61, v62
v_max_f32 v10, v10, v63
v_max3_f32 v11, v68, v69, v70
v_max3_f32 v11, v11, v71, v76
v_max3_f32 v11, v11, v77, v78
v_max3_f32 v11, v11, v79, v84
v_max3_f32 v11, v11, v85, v86
v_max_f32 v11, v11, v87
s_nop 1
v_permlane32_swap_b32 v10, v11
v_max_f32 v10, v10, v11
v_mov_b32 v11, v10
s_nop 1
v_permlane16_swap_b32 v10, v11
v_max_f32 v10, v10, v11
v_mul_f32 v10, s68, v10
v_mov_b32 v11, v10
s_nop 1
v_permlane32_swap_b32 v10, v11
v_pk_fma_f32 v[52:53], v[52:53], s[68:69], v[10:11] op_sel:[0,0,0] op_sel_hi:[1,1,0] neg_lo:[0,0,1] neg_hi:[0,0,1]
v_pk_fma_f32 v[54:55], v[54:55], s[68:69], v[10:11] op_sel:[0,0,0] op_sel_hi:[1,1,0] neg_lo:[0,0,1] neg_hi:[0,0,1]
v_pk_fma_f32 v[60:61], v[60:61], s[68:69], v[10:11] op_sel:[0,0,0] op_sel_hi:[1,1,0] neg_lo:[0,0,1] neg_hi:[0,0,1]
v_pk_fma_f32 v[62:63], v[62:63], s[68:69], v[10:11] op_sel:[0,0,0] op_sel_hi:[1,1,0] neg_lo:[0,0,1] neg_hi:[0,0,1]
v_pk_fma_f32 v[68:69], v[68:69], s[68:69], v[10:11] op_sel:[0,0,1] op_sel_hi:[1,1,1] neg_lo:[0,0,1] neg_hi:[0,0,1]
v_pk_fma_f32 v[70:71], v[70:71], s[68:69], v[10:11] op_sel:[0,0,1] op_sel_hi:[1,1,1] neg_lo:[0,0,1] neg_hi:[0,0,1]
v_pk_fma_f32 v[76:77], v[76:77], s[68:69], v[10:11] op_sel:[0,0,1] op_sel_hi:[1,1,1] neg_lo:[0,0,1] neg_hi:[0,0,1]
v_pk_fma_f32 v[78:79], v[78:79], s[68:69], v[10:11] op_sel:[0,0,1] op_sel_hi:[1,1,1] neg_lo:[0,0,1] neg_hi:[0,0,1]
v_pk_fma_f32 v[84:85], v[84:85], s[68:69], v[10:11] op_sel:[0,0,1] op_sel_hi:[1,1,1] neg_lo:[0,0,1] neg_hi:[0,0,1]
v_pk_fma_f32 v[86:87], v[86:87], s[68:69], v[10:11] op_sel:[0,0,1] op_sel_hi:[1,1,1] neg_lo:[0,0,1] neg_hi:[0,0,1]
v_exp_f32 v52, v52
v_exp_f32 v53, v53
v_exp_f32 v54, v54
v_exp_f32 v55, v55
v_exp_f32 v60, v60
v_exp_f32 v61, v61
v_exp_f32 v62, v62
v_exp_f32 v63, v63
v_exp_f32 v68, v68
v_exp_f32 v69, v69
v_exp_f32 v70, v70
v_exp_f32 v71, v71
v_exp_f32 v76, v76
v_exp_f32 v77, v77
v_exp_f32 v78, v78
v_exp_f32 v79, v79
v_exp_f32 v84, v84
v_exp_f32 v85, v85
v_exp_f32 v86, v86
v_exp_f32 v87, v87
v_pk_add_f32 v[92:93], v[52:53], v[54:55]
v_pk_add_f32 v[94:95], v[60:61], v[62:63]
v_pk_add_f32 v[100:101], v[68:69], v[70:71]
v_pk_add_f32 v[102:103], v[76:77], v[78:79]
v_pk_add_f32 v[92:93], v[92:93], v[94:95]
v_pk_add_f32 v[100:101], v[100:101], v[102:103]
v_pk_add_f32 v[102:103], v[84:85], v[86:87]
v_add_f32 v10, v92, v93
v_pk_add_f32 v[100:101], v[100:101], v[102:103]
v_add_f32 v11, v100, v101
s_nop 1
v_permlane32_swap_b32 v10, v11
v_add_f32 v10, v10, v11
v_mov_b32 v11, v10
s_nop 1
v_permlane16_swap_b32 v10, v11
v_add_f32 v10, v10, v11
v_rcp_f32 v10, v10
s_nop 0
v_mov_b32 v11, v10
s_nop 1
v_permlane32_swap_b32 v10, v11
v_pk_mul_f32 v[52:53], v[52:53], v[10:11] op_sel:[0,0] op_sel_hi:[1,0]
v_pk_mul_f32 v[54:55], v[54:55], v[10:11] op_sel:[0,0] op_sel_hi:[1,0]
v_pk_mul_f32 v[60:61], v[60:61], v[10:11] op_sel:[0,0] op_sel_hi:[1,0]
v_pk_mul_f32 v[62:63], v[62:63], v[10:11] op_sel:[0,0] op_sel_hi:[1,0]
v_pk_mul_f32 v[68:69], v[68:69], v[10:11] op_sel:[0,1] op_sel_hi:[1,1]
v_pk_mul_f32 v[70:71], v[70:71], v[10:11] op_sel:[0,1] op_sel_hi:[1,1]
v_pk_mul_f32 v[76:77], v[76:77], v[10:11] op_sel:[0,1] op_sel_hi:[1,1]
v_pk_mul_f32 v[78:79], v[78:79], v[10:11] op_sel:[0,1] op_sel_hi:[1,1]
v_pk_mul_f32 v[84:85], v[84:85], v[10:11] op_sel:[0,1] op_sel_hi:[1,1]
v_pk_mul_f32 v[86:87], v[86:87], v[10:11] op_sel:[0,1] op_sel_hi:[1,1]
v_cvt_pk_bf16_f32 v92, v60, v61
v_cvt_pk_bf16_f32 v93, v62, v63
v_cvt_pk_bf16_f32 v94, v52, v53
v_cvt_pk_bf16_f32 v95, v54, v55
v_cvt_pk_bf16_f32 v100, v68, v69
v_cvt_pk_bf16_f32 v101, v70, v71
v_cvt_pk_bf16_f32 v102, v76, v77
v_cvt_pk_bf16_f32 v103, v78, v79
v_cvt_pk_bf16_f32 v84, v84, v85
v_cvt_pk_bf16_f32 v85, v86, v87
s_waitcnt vmcnt(40)
s_nop 0
v_mfma_f32_16x16x16_bf16 v[116:119], a[192:193], v[84:85], 0
v_mfma_f32_16x16x16_bf16 v[132:135], a[198:199], v[84:85], 0
v_mfma_f32_16x16x16_bf16 v[148:151], a[204:205], v[84:85], 0
v_mfma_f32_16x16x16_bf16 v[164:167], a[210:211], v[84:85], 0
v_mfma_f32_16x16x16_bf16 v[180:183], a[216:217], v[84:85], 0
v_mfma_f32_16x16x16_bf16 v[196:199], a[222:223], v[84:85], 0
v_mfma_f32_16x16x16_bf16 v[212:215], a[228:229], v[84:85], 0
v_mfma_f32_16x16x16_bf16 v[228:231], a[234:235], v[84:85], 0
v_mfma_f32_16x16x32_bf16 v[108:111], a[192:195], v[92:95], 0
v_mfma_f32_16x16x32_bf16 v[124:127], a[198:201], v[92:95], 0
v_mfma_f32_16x16x32_bf16 v[140:143], a[204:207], v[92:95], 0
v_mfma_f32_16x16x32_bf16 v[156:159], a[210:213], v[92:95], 0
v_mfma_f32_16x16x32_bf16 v[172:175], a[216:219], v[92:95], 0
v_mfma_f32_16x16x32_bf16 v[188:191], a[222:225], v[92:95], 0
v_mfma_f32_16x16x32_bf16 v[204:207], a[228:231], v[92:95], 0
v_mfma_f32_16x16x32_bf16 v[220:223], a[234:237], v[92:95], 0
s_add_u32 s70, s23, 0
s_add_u32 s71, s23, 4096
v_mfma_f32_16x16x32_bf16 v[116:119], a[194:197], v[100:103], v[116:119]
v_mfma_f32_16x16x32_bf16 v[132:135], a[200:203], v[100:103], v[132:135]
v_mfma_f32_16x16x32_bf16 v[148:151], a[206:209], v[100:103], v[148:151]
v_mfma_f32_16x16x32_bf16 v[164:167], a[212:215], v[100:103], v[164:167]
v_cvt_pk_bf16_f32 v108, v108, v109
v_cvt_pk_bf16_f32 v109, v110, v111
v_cvt_pk_bf16_f32 v110, v124, v125
v_cvt_pk_bf16_f32 v111, v126, v127
buffer_store_dwordx4 v[108:111], v2, s[4:7], s70 offen offset:0 sc1
v_mfma_f32_16x16x32_bf16 v[180:183], a[218:221], v[100:103], v[180:183]
v_mfma_f32_16x16x32_bf16 v[196:199], a[224:227], v[100:103], v[196:199]
v_cvt_pk_bf16_f32 v140, v140, v141
v_cvt_pk_bf16_f32 v141, v142, v143
v_cvt_pk_bf16_f32 v142, v156, v157
v_cvt_pk_bf16_f32 v143, v158, v159
buffer_store_dwordx4 v[140:143], v2, s[4:7], s70 offen offset:2048 sc1
v_mfma_f32_16x16x32_bf16 v[212:215], a[230:233], v[100:103], v[212:215]
v_mfma_f32_16x16x32_bf16 v[228:231], a[236:239], v[100:103], v[228:231]
v_cvt_pk_bf16_f32 v172, v172, v173
v_cvt_pk_bf16_f32 v173, v174, v175
v_cvt_pk_bf16_f32 v174, v188, v189
v_cvt_pk_bf16_f32 v175, v190, v191
buffer_store_dwordx4 v[172:175], v2, s[4:7], s71 offen offset:0 sc1
buffer_load_dwordx2 a[192:193], v5, s[4:7], s67 offen offset:0 sc1
buffer_load_dwordx2 a[198:199], v5, s[4:7], s67 offen offset:128 sc1
buffer_load_dwordx2 a[204:205], v5, s[4:7], s67 offen offset:512 sc1
buffer_load_dwordx2 a[210:211], v5, s[4:7], s67 offen offset:640 sc1
buffer_load_dwordx2 a[216:217], v5, s[4:7], s67 offen offset:1024 sc1
buffer_load_dwordx2 a[222:223], v5, s[4:7], s67 offen offset:1152 sc1
buffer_load_dwordx2 a[228:229], v5, s[4:7], s67 offen offset:1536 sc1
buffer_load_dwordx2 a[234:235], v5, s[4:7], s67 offen offset:1664 sc1
s_add_u32 s67, s67, 131072
buffer_load_dwordx4 a[194:197], v3, s[4:7], s64 offen offset:0
buffer_load_dwordx4 a[200:203], v3, s[4:7], s64 offen offset:128
buffer_load_dwordx4 a[206:209], v3, s[4:7], s64 offen offset:2048
buffer_load_dwordx4 a[212:215], v3, s[4:7], s64 offen offset:2176
buffer_load_dwordx4 a[218:221], v3, s[4:7], s65 offen offset:0
buffer_load_dwordx4 a[224:227], v3, s[4:7], s65 offen offset:128
buffer_load_dwordx4 a[230:233], v3, s[4:7], s65 offen offset:2048
buffer_load_dwordx4 a[236:239], v3, s[4:7], s65 offen offset:2176
s_add_u32 s64, s64, 524288
s_add_u32 s65, s65, 524288
v_cvt_pk_bf16_f32 v204, v204, v205
v_cvt_pk_bf16_f32 v205, v206, v207
v_cvt_pk_bf16_f32 v206, v220, v221
v_cvt_pk_bf16_f32 v207, v222, v223
buffer_store_dwordx4 v[204:207], v2, s[4:7], s71 offen offset:2048 sc1
v_cvt_pk_bf16_f32 v116, v116, v117
v_cvt_pk_bf16_f32 v117, v118, v119
v_cvt_pk_bf16_f32 v118, v132, v133
v_cvt_pk_bf16_f32 v119, v134, v135
buffer_store_dwordx4 v[116:119], v2, s[4:7], s70 offen offset:256 sc1
v_cvt_pk_bf16_f32 v148, v148, v149
v_cvt_pk_bf16_f32 v149, v150, v151
v_cvt_pk_bf16_f32 v150, v164, v165
v_cvt_pk_bf16_f32 v151, v166, v167
buffer_store_dwordx4 v[148:151], v2, s[4:7], s70 offen offset:2304 sc1
v_cvt_pk_bf16_f32 v180, v180, v181
v_cvt_pk_bf16_f32 v181, v182, v183
v_cvt_pk_bf16_f32 v182, v196, v197
v_cvt_pk_bf16_f32 v183, v198, v199
buffer_store_dwordx4 v[180:183], v2, s[4:7], s71 offen offset:256 sc1
v_cvt_pk_bf16_f32 v212, v212, v213
v_cvt_pk_bf16_f32 v213, v214, v215
v_cvt_pk_bf16_f32 v214, v228, v229
v_cvt_pk_bf16_f32 v215, v230, v231
buffer_store_dwordx4 v[212:215], v2, s[4:7], s71 offen offset:2304 sc1
s_waitcnt vmcnt(52)
v_mfma_f32_16x16x32_bf16 v[236:239], a[0:3], v[80:83], v[6:9]
v_mfma_f32_16x16x32_bf16 v[244:247], a[32:35], v[80:83], v[12:15]
v_mfma_f32_16x16x32_bf16 v[252:255], a[0:3], v[112:115], 0
v_mfma_f32_16x16x32_bf16 v[28:31], a[16:19], v[112:115], v[6:9]
v_mfma_f32_16x16x32_bf16 v[44:47], a[32:35], v[112:115], v[12:15]
v_mfma_f32_16x16x32_bf16 v[236:239], a[4:7], v[88:91], v[236:239]
v_mfma_f32_16x16x32_bf16 v[244:247], a[36:39], v[88:91], v[244:247]
v_mfma_f32_16x16x32_bf16 v[252:255], a[4:7], v[120:123], v[252:255]
v_mfma_f32_16x16x32_bf16 v[28:31], a[20:23], v[120:123], v[28:31]
v_mfma_f32_16x16x32_bf16 v[44:47], a[36:39], v[120:123], v[44:47]
v_mfma_f32_16x16x32_bf16 v[236:239], a[8:11], v[96:99], v[236:239]
v_mfma_f32_16x16x32_bf16 v[244:247], a[40:43], v[96:99], v[244:247]
v_mfma_f32_16x16x32_bf16 v[252:255], a[8:11], v[128:131], v[252:255]
v_mfma_f32_16x16x32_bf16 v[28:31], a[24:27], v[128:131], v[28:31]
v_mfma_f32_16x16x32_bf16 v[44:47], a[40:43], v[128:131], v[44:47]
v_mfma_f32_16x16x32_bf16 v[236:239], a[12:15], v[104:107], v[236:239]
v_mfma_f32_16x16x32_bf16 v[244:247], a[44:47], v[104:107], v[244:247]
v_mfma_f32_16x16x32_bf16 v[252:255], a[12:15], v[136:139], v[252:255]
v_mfma_f32_16x16x32_bf16 v[28:31], a[28:31], v[136:139], v[28:31]
v_mfma_f32_16x16x32_bf16 v[44:47], a[44:47], v[136:139], v[44:47]
buffer_load_dwordx4 a[32:35], v4, s[4:7], s66 offen offset:0 sc1
buffer_load_dwordx4 a[36:39], v4, s[4:7], s66 offen offset:512 sc1
buffer_load_dwordx4 a[40:43], v4, s[4:7], s66 offen offset:1024 sc1
buffer_load_dwordx4 a[44:47], v4, s[4:7], s66 offen offset:1536 sc1
s_add_u32 s66, s66, 131072
buffer_load_dwordx4 a[0:3], v2, s[4:7], s62 offen offset:0
buffer_load_dwordx4 a[16:19], v2, s[4:7], s62 offen offset:256
buffer_load_dwordx4 a[4:7], v2, s[4:7], s62 offen offset:2048
buffer_load_dwordx4 a[20:23], v2, s[4:7], s62 offen offset:2304
buffer_load_dwordx4 a[8:11], v2, s[4:7], s63 offen offset:0
buffer_load_dwordx4 a[24:27], v2, s[4:7], s63 offen offset:256
buffer_load_dwordx4 a[12:15], v2, s[4:7], s63 offen offset:2048
buffer_load_dwordx4 a[28:31], v2, s[4:7], s63 offen offset:2304
s_add_u32 s62, s62, 524288
s_add_u32 s63, s63, 524288
v_max3_f32 v10, v236, v237, v238
v_max3_f32 v10, v10, v239, v244
v_max3_f32 v10, v10, v245, v246
v_max_f32 v10, v10, v247
v_max3_f32 v11, v252, v253, v254
v_max3_f32 v11, v11, v255, v28
v_max3_f32 v11, v11, v29, v30
v_max3_f32 v11, v11, v31, v44
v_max3_f32 v11, v11, v45, v46
v_max_f32 v11, v11, v47
s_nop 1
v_permlane32_swap_b32 v10, v11
v_max_f32 v10, v10, v11
v_mov_b32 v11, v10
s_nop 1
v_permlane16_swap_b32 v10, v11
v_max_f32 v10, v10, v11
v_mul_f32 v10, s68, v10
v_mov_b32 v11, v10
s_nop 1
v_permlane32_swap_b32 v10, v11
v_pk_fma_f32 v[236:237], v[236:237], s[68:69], v[10:11] op_sel:[0,0,0] op_sel_hi:[1,1,0] neg_lo:[0,0,1] neg_hi:[0,0,1]
v_pk_fma_f32 v[238:239], v[238:239], s[68:69], v[10:11] op_sel:[0,0,0] op_sel_hi:[1,1,0] neg_lo:[0,0,1] neg_hi:[0,0,1]
v_pk_fma_f32 v[244:245], v[244:245], s[68:69], v[10:11] op_sel:[0,0,0] op_sel_hi:[1,1,0] neg_lo:[0,0,1] neg_hi:[0,0,1]
v_pk_fma_f32 v[246:247], v[246:247], s[68:69], v[10:11] op_sel:[0,0,0] op_sel_hi:[1,1,0] neg_lo:[0,0,1] neg_hi:[0,0,1]
v_pk_fma_f32 v[252:253], v[252:253], s[68:69], v[10:11] op_sel:[0,0,1] op_sel_hi:[1,1,1] neg_lo:[0,0,1] neg_hi:[0,0,1]
v_pk_fma_f32 v[254:255], v[254:255], s[68:69], v[10:11] op_sel:[0,0,1] op_sel_hi:[1,1,1] neg_lo:[0,0,1] neg_hi:[0,0,1]
v_pk_fma_f32 v[28:29], v[28:29], s[68:69], v[10:11] op_sel:[0,0,1] op_sel_hi:[1,1,1] neg_lo:[0,0,1] neg_hi:[0,0,1]
v_pk_fma_f32 v[30:31], v[30:31], s[68:69], v[10:11] op_sel:[0,0,1] op_sel_hi:[1,1,1] neg_lo:[0,0,1] neg_hi:[0,0,1]
v_pk_fma_f32 v[44:45], v[44:45], s[68:69], v[10:11] op_sel:[0,0,1] op_sel_hi:[1,1,1] neg_lo:[0,0,1] neg_hi:[0,0,1]
v_pk_fma_f32 v[46:47], v[46:47], s[68:69], v[10:11] op_sel:[0,0,1] op_sel_hi:[1,1,1] neg_lo:[0,0,1] neg_hi:[0,0,1]
v_exp_f32 v236, v236
v_exp_f32 v237, v237
v_exp_f32 v238, v238
v_exp_f32 v239, v239
v_exp_f32 v244, v244
v_exp_f32 v245, v245
v_exp_f32 v246, v246
v_exp_f32 v247, v247
v_exp_f32 v252, v252
v_exp_f32 v253, v253
v_exp_f32 v254, v254
v_exp_f32 v255, v255
v_exp_f32 v28, v28
v_exp_f32 v29, v29
v_exp_f32 v30, v30
v_exp_f32 v31, v31
v_exp_f32 v44, v44
v_exp_f32 v45, v45
v_exp_f32 v46, v46
v_exp_f32 v47, v47
v_pk_add_f32 v[16:17], v[236:237], v[238:239]
v_pk_add_f32 v[18:19], v[244:245], v[246:247]
v_pk_add_f32 v[48:49], v[252:253], v[254:255]
v_pk_add_f32 v[50:51], v[28:29], v[30:31]
v_pk_add_f32 v[16:17], v[16:17], v[18:19]
v_pk_add_f32 v[48:49], v[48:49], v[50:51]
v_pk_add_f32 v[50:51], v[44:45], v[46:47]
v_add_f32 v10, v16, v17
v_pk_add_f32 v[48:49], v[48:49], v[50:51]
v_add_f32 v11, v48, v49
s_nop 1
v_permlane32_swap_b32 v10, v11
v_add_f32 v10, v10, v11
v_mov_b32 v11, v10
s_nop 1
v_permlane16_swap_b32 v10, v11
v_add_f32 v10, v10, v11
v_rcp_f32 v10, v10
s_nop 0
v_mov_b32 v11, v10
s_nop 1
v_permlane32_swap_b32 v10, v11
v_pk_mul_f32 v[236:237], v[236:237], v[10:11] op_sel:[0,0] op_sel_hi:[1,0]
v_pk_mul_f32 v[238:239], v[238:239], v[10:11] op_sel:[0,0] op_sel_hi:[1,0]
v_pk_mul_f32 v[244:245], v[244:245], v[10:11] op_sel:[0,0] op_sel_hi:[1,0]
v_pk_mul_f32 v[246:247], v[246:247], v[10:11] op_sel:[0,0] op_sel_hi:[1,0]
v_pk_mul_f32 v[252:253], v[252:253], v[10:11] op_sel:[0,1] op_sel_hi:[1,1]
v_pk_mul_f32 v[254:255], v[254:255], v[10:11] op_sel:[0,1] op_sel_hi:[1,1]
v_pk_mul_f32 v[28:29], v[28:29], v[10:11] op_sel:[0,1] op_sel_hi:[1,1]
v_pk_mul_f32 v[30:31], v[30:31], v[10:11] op_sel:[0,1] op_sel_hi:[1,1]
v_pk_mul_f32 v[44:45], v[44:45], v[10:11] op_sel:[0,1] op_sel_hi:[1,1]
v_pk_mul_f32 v[46:47], v[46:47], v[10:11] op_sel:[0,1] op_sel_hi:[1,1]
v_cvt_pk_bf16_f32 v16, v244, v245
v_cvt_pk_bf16_f32 v17, v246, v247
v_cvt_pk_bf16_f32 v18, v236, v237
v_cvt_pk_bf16_f32 v19, v238, v239
v_cvt_pk_bf16_f32 v48, v252, v253
v_cvt_pk_bf16_f32 v49, v254, v255
v_cvt_pk_bf16_f32 v50, v28, v29
v_cvt_pk_bf16_f32 v51, v30, v31
v_cvt_pk_bf16_f32 v44, v44, v45
v_cvt_pk_bf16_f32 v45, v46, v47
s_waitcnt vmcnt(48)
s_nop 0
v_mfma_f32_16x16x16_bf16 v[56:59], a[48:49], v[44:45], 0
v_mfma_f32_16x16x16_bf16 v[64:67], a[54:55], v[44:45], 0
v_mfma_f32_16x16x16_bf16 v[72:75], a[60:61], v[44:45], 0
v_mfma_f32_16x16x16_bf16 v[60:63], a[66:67], v[44:45], 0
v_mfma_f32_16x16x16_bf16 v[76:79], a[72:73], v[44:45], 0
v_mfma_f32_16x16x16_bf16 v[100:103], a[78:79], v[44:45], 0
v_mfma_f32_16x16x16_bf16 v[108:111], a[84:85], v[44:45], 0
v_mfma_f32_16x16x16_bf16 v[124:127], a[90:91], v[44:45], 0
v_mfma_f32_16x16x32_bf16 v[24:27], a[48:51], v[16:19], 0
v_mfma_f32_16x16x32_bf16 v[32:35], a[54:57], v[16:19], 0
v_mfma_f32_16x16x32_bf16 v[40:43], a[60:63], v[16:19], 0
v_mfma_f32_16x16x32_bf16 v[52:55], a[66:69], v[16:19], 0
v_mfma_f32_16x16x32_bf16 v[68:71], a[72:75], v[16:19], 0
v_mfma_f32_16x16x32_bf16 v[92:95], a[78:81], v[16:19], 0
v_mfma_f32_16x16x32_bf16 v[84:87], a[84:87], v[16:19], 0
v_mfma_f32_16x16x32_bf16 v[116:119], a[90:93], v[16:19], 0
s_add_u32 s70, s23, 262144
s_add_u32 s71, s23, 266240
v_mfma_f32_16x16x32_bf16 v[56:59], a[50:53], v[48:51], v[56:59]
v_mfma_f32_16x16x32_bf16 v[64:67], a[56:59], v[48:51], v[64:67]
v_mfma_f32_16x16x32_bf16 v[72:75], a[62:65], v[48:51], v[72:75]
v_mfma_f32_16x16x32_bf16 v[60:63], a[68:71], v[48:51], v[60:63]
v_cvt_pk_bf16_f32 v24, v24, v25
v_cvt_pk_bf16_f32 v25, v26, v27
v_cvt_pk_bf16_f32 v26, v32, v33
v_cvt_pk_bf16_f32 v27, v34, v35
buffer_store_dwordx4 v[24:27], v2, s[4:7], s70 offen offset:0 sc1
v_mfma_f32_16x16x32_bf16 v[76:79], a[74:77], v[48:51], v[76:79]
v_mfma_f32_16x16x32_bf16 v[100:103], a[80:83], v[48:51], v[100:103]
v_cvt_pk_bf16_f32 v40, v40, v41
v_cvt_pk_bf16_f32 v41, v42, v43
v_cvt_pk_bf16_f32 v42, v52, v53
v_cvt_pk_bf16_f32 v43, v54, v55
buffer_store_dwordx4 v[40:43], v2, s[4:7], s70 offen offset:2048 sc1
v_mfma_f32_16x16x32_bf16 v[108:111], a[86:89], v[48:51], v[108:111]
v_mfma_f32_16x16x32_bf16 v[124:127], a[92:95], v[48:51], v[124:127]
v_cvt_pk_bf16_f32 v68, v68, v69
v_cvt_pk_bf16_f32 v69, v70, v71
v_cvt_pk_bf16_f32 v70, v92, v93
v_cvt_pk_bf16_f32 v71, v94, v95
buffer_store_dwordx4 v[68:71], v2, s[4:7], s71 offen offset:0 sc1
buffer_load_dwordx2 a[48:49], v5, s[4:7], s67 offen offset:0 sc1
buffer_load_dwordx2 a[54:55], v5, s[4:7], s67 offen offset:128 sc1
buffer_load_dwordx2 a[60:61], v5, s[4:7], s67 offen offset:512 sc1
buffer_load_dwordx2 a[66:67], v5, s[4:7], s67 offen offset:640 sc1
buffer_load_dwordx2 a[72:73], v5, s[4:7], s67 offen offset:1024 sc1
buffer_load_dwordx2 a[78:79], v5, s[4:7], s67 offen offset:1152 sc1
buffer_load_dwordx2 a[84:85], v5, s[4:7], s67 offen offset:1536 sc1
buffer_load_dwordx2 a[90:91], v5, s[4:7], s67 offen offset:1664 sc1
s_add_u32 s67, s67, 131072
buffer_load_dwordx4 a[50:53], v3, s[4:7], s64 offen offset:0
buffer_load_dwordx4 a[56:59], v3, s[4:7], s64 offen offset:128
buffer_load_dwordx4 a[62:65], v3, s[4:7], s64 offen offset:2048
buffer_load_dwordx4 a[68:71], v3, s[4:7], s64 offen offset:2176
buffer_load_dwordx4 a[74:77], v3, s[4:7], s65 offen offset:0
buffer_load_dwordx4 a[80:83], v3, s[4:7], s65 offen offset:128
buffer_load_dwordx4 a[86:89], v3, s[4:7], s65 offen offset:2048
buffer_load_dwordx4 a[92:95], v3, s[4:7], s65 offen offset:2176
s_add_u32 s64, s64, 524288
s_add_u32 s65, s65, 524288
v_cvt_pk_bf16_f32 v84, v84, v85
v_cvt_pk_bf16_f32 v85, v86, v87
v_cvt_pk_bf16_f32 v86, v116, v117
v_cvt_pk_bf16_f32 v87, v118, v119
buffer_store_dwordx4 v[84:87], v2, s[4:7], s71 offen offset:2048 sc1
v_cvt_pk_bf16_f32 v56, v56, v57
v_cvt_pk_bf16_f32 v57, v58, v59
v_cvt_pk_bf16_f32 v58, v64, v65
v_cvt_pk_bf16_f32 v59, v66, v67
buffer_store_dwordx4 v[56:59], v2, s[4:7], s70 offen offset:256 sc1
v_cvt_pk_bf16_f32 v72, v72, v73
v_cvt_pk_bf16_f32 v73, v74, v75
v_cvt_pk_bf16_f32 v74, v60, v61
v_cvt_pk_bf16_f32 v75, v62, v63
buffer_store_dwordx4 v[72:75], v2, s[4:7], s70 offen offset:2304 sc1
v_cvt_pk_bf16_f32 v76, v76, v77
v_cvt_pk_bf16_f32 v77, v78, v79
v_cvt_pk_bf16_f32 v78, v100, v101
v_cvt_pk_bf16_f32 v79, v102, v103
buffer_store_dwordx4 v[76:79], v2, s[4:7], s71 offen offset:256 sc1
v_cvt_pk_bf16_f32 v108, v108, v109
v_cvt_pk_bf16_f32 v109, v110, v111
v_cvt_pk_bf16_f32 v110, v124, v125
v_cvt_pk_bf16_f32 v111, v126, v127
buffer_store_dwordx4 v[108:111], v2, s[4:7], s71 offen offset:2304 sc1
s_waitcnt vmcnt(60)
v_mfma_f32_16x16x32_bf16 v[132:135], a[144:147], v[144:147], v[6:9]
v_mfma_f32_16x16x32_bf16 v[140:143], a[176:179], v[144:147], v[12:15]
v_mfma_f32_16x16x32_bf16 v[148:151], a[144:147], v[176:179], 0
v_mfma_f32_16x16x32_bf16 v[156:159], a[160:163], v[176:179], v[6:9]
v_mfma_f32_16x16x32_bf16 v[164:167], a[176:179], v[176:179], v[12:15]
v_mfma_f32_16x16x32_bf16 v[132:135], a[148:151], v[152:155], v[132:135]
v_mfma_f32_16x16x32_bf16 v[140:143], a[180:183], v[152:155], v[140:143]
v_mfma_f32_16x16x32_bf16 v[148:151], a[148:151], v[184:187], v[148:151]
v_mfma_f32_16x16x32_bf16 v[156:159], a[164:167], v[184:187], v[156:159]
v_mfma_f32_16x16x32_bf16 v[164:167], a[180:183], v[184:187], v[164:167]
v_mfma_f32_16x16x32_bf16 v[132:135], a[152:155], v[160:163], v[132:135]
v_mfma_f32_16x16x32_bf16 v[140:143], a[184:187], v[160:163], v[140:143]
v_mfma_f32_16x16x32_bf16 v[148:151], a[152:155], v[192:195], v[148:151]
v_mfma_f32_16x16x32_bf16 v[156:159], a[168:171], v[192:195], v[156:159]
v_mfma_f32_16x16x32_bf16 v[164:167], a[184:187], v[192:195], v[164:167]
v_mfma_f32_16x16x32_bf16 v[132:135], a[156:159], v[168:171], v[132:135]
v_mfma_f32_16x16x32_bf16 v[140:143], a[188:191], v[168:171], v[140:143]
v_mfma_f32_16x16x32_bf16 v[148:151], a[156:159], v[200:203], v[148:151]
v_mfma_f32_16x16x32_bf16 v[156:159], a[172:175], v[200:203], v[156:159]
v_mfma_f32_16x16x32_bf16 v[164:167], a[188:191], v[200:203], v[164:167]
v_max3_f32 v10, v132, v133, v134
v_max3_f32 v10, v10, v135, v140
v_max3_f32 v10, v10, v141, v142
v_max_f32 v10, v10, v143
v_max3_f32 v11, v148, v149, v150
v_max3_f32 v11, v11, v151, v156
v_max3_f32 v11, v11, v157, v158
s_nop 0
v_max3_f32 v11, v11, v159, v164
v_max3_f32 v11, v11, v165, v166
v_max_f32 v11, v11, v167
s_nop 1
v_permlane32_swap_b32 v10, v11
v_max_f32 v10, v10, v11
v_mov_b32 v11, v10
s_nop 1
v_permlane16_swap_b32 v10, v11
v_max_f32 v10, v10, v11
v_mul_f32 v10, s68, v10
v_mov_b32 v11, v10
s_nop 1
v_permlane32_swap_b32 v10, v11
v_pk_fma_f32 v[132:133], v[132:133], s[68:69], v[10:11] op_sel:[0,0,0] op_sel_hi:[1,1,0] neg_lo:[0,0,1] neg_hi:[0,0,1]
v_pk_fma_f32 v[134:135], v[134:135], s[68:69], v[10:11] op_sel:[0,0,0] op_sel_hi:[1,1,0] neg_lo:[0,0,1] neg_hi:[0,0,1]
v_pk_fma_f32 v[140:141], v[140:141], s[68:69], v[10:11] op_sel:[0,0,0] op_sel_hi:[1,1,0] neg_lo:[0,0,1] neg_hi:[0,0,1]
v_pk_fma_f32 v[142:143], v[142:143], s[68:69], v[10:11] op_sel:[0,0,0] op_sel_hi:[1,1,0] neg_lo:[0,0,1] neg_hi:[0,0,1]
v_pk_fma_f32 v[148:149], v[148:149], s[68:69], v[10:11] op_sel:[0,0,1] op_sel_hi:[1,1,1] neg_lo:[0,0,1] neg_hi:[0,0,1]
v_pk_fma_f32 v[150:151], v[150:151], s[68:69], v[10:11] op_sel:[0,0,1] op_sel_hi:[1,1,1] neg_lo:[0,0,1] neg_hi:[0,0,1]
v_pk_fma_f32 v[156:157], v[156:157], s[68:69], v[10:11] op_sel:[0,0,1] op_sel_hi:[1,1,1] neg_lo:[0,0,1] neg_hi:[0,0,1]
v_pk_fma_f32 v[158:159], v[158:159], s[68:69], v[10:11] op_sel:[0,0,1] op_sel_hi:[1,1,1] neg_lo:[0,0,1] neg_hi:[0,0,1]
v_pk_fma_f32 v[164:165], v[164:165], s[68:69], v[10:11] op_sel:[0,0,1] op_sel_hi:[1,1,1] neg_lo:[0,0,1] neg_hi:[0,0,1]
v_pk_fma_f32 v[166:167], v[166:167], s[68:69], v[10:11] op_sel:[0,0,1] op_sel_hi:[1,1,1] neg_lo:[0,0,1] neg_hi:[0,0,1]
v_exp_f32 v132, v132
v_exp_f32 v133, v133
v_exp_f32 v134, v134
v_exp_f32 v135, v135
v_exp_f32 v140, v140
v_exp_f32 v141, v141
v_exp_f32 v142, v142
v_exp_f32 v143, v143
v_exp_f32 v148, v148
v_exp_f32 v149, v149
v_exp_f32 v150, v150
v_exp_f32 v151, v151
v_exp_f32 v156, v156
v_exp_f32 v157, v157
v_exp_f32 v158, v158
v_exp_f32 v159, v159
v_exp_f32 v164, v164
v_exp_f32 v165, v165
v_exp_f32 v166, v166
v_exp_f32 v167, v167
v_pk_add_f32 v[172:173], v[132:133], v[134:135]
v_pk_add_f32 v[174:175], v[140:141], v[142:143]
v_pk_add_f32 v[180:181], v[148:149], v[150:151]
v_pk_add_f32 v[182:183], v[156:157], v[158:159]
v_pk_add_f32 v[172:173], v[172:173], v[174:175]
v_pk_add_f32 v[180:181], v[180:181], v[182:183]
v_pk_add_f32 v[182:183], v[164:165], v[166:167]
v_add_f32 v10, v172, v173
v_pk_add_f32 v[180:181], v[180:181], v[182:183]
v_add_f32 v11, v180, v181
s_nop 1
v_permlane32_swap_b32 v10, v11
v_add_f32 v10, v10, v11
v_mov_b32 v11, v10
s_nop 1
v_permlane16_swap_b32 v10, v11
v_add_f32 v10, v10, v11
v_rcp_f32 v10, v10
s_nop 0
v_mov_b32 v11, v10
s_nop 1
v_permlane32_swap_b32 v10, v11
v_pk_mul_f32 v[132:133], v[132:133], v[10:11] op_sel:[0,0] op_sel_hi:[1,0]
v_pk_mul_f32 v[134:135], v[134:135], v[10:11] op_sel:[0,0] op_sel_hi:[1,0]
v_pk_mul_f32 v[140:141], v[140:141], v[10:11] op_sel:[0,0] op_sel_hi:[1,0]
v_pk_mul_f32 v[142:143], v[142:143], v[10:11] op_sel:[0,0] op_sel_hi:[1,0]
v_pk_mul_f32 v[148:149], v[148:149], v[10:11] op_sel:[0,1] op_sel_hi:[1,1]
v_pk_mul_f32 v[150:151], v[150:151], v[10:11] op_sel:[0,1] op_sel_hi:[1,1]
v_pk_mul_f32 v[156:157], v[156:157], v[10:11] op_sel:[0,1] op_sel_hi:[1,1]
v_pk_mul_f32 v[158:159], v[158:159], v[10:11] op_sel:[0,1] op_sel_hi:[1,1]
v_pk_mul_f32 v[164:165], v[164:165], v[10:11] op_sel:[0,1] op_sel_hi:[1,1]
v_pk_mul_f32 v[166:167], v[166:167], v[10:11] op_sel:[0,1] op_sel_hi:[1,1]
v_cvt_pk_bf16_f32 v172, v140, v141
v_cvt_pk_bf16_f32 v173, v142, v143
v_cvt_pk_bf16_f32 v174, v132, v133
v_cvt_pk_bf16_f32 v175, v134, v135
v_cvt_pk_bf16_f32 v180, v148, v149
v_cvt_pk_bf16_f32 v181, v150, v151
v_cvt_pk_bf16_f32 v182, v156, v157
v_cvt_pk_bf16_f32 v183, v158, v159
v_cvt_pk_bf16_f32 v164, v164, v165
v_cvt_pk_bf16_f32 v165, v166, v167
s_waitcnt vmcnt(41)
s_nop 0
v_mfma_f32_16x16x16_bf16 v[196:199], a[192:193], v[164:165], 0
v_mfma_f32_16x16x16_bf16 v[212:215], a[198:199], v[164:165], 0
v_mfma_f32_16x16x16_bf16 v[228:231], a[204:205], v[164:165], 0
v_mfma_f32_16x16x16_bf16 v[112:115], a[210:211], v[164:165], 0
v_mfma_f32_16x16x16_bf16 v[120:123], a[216:217], v[164:165], 0
v_mfma_f32_16x16x16_bf16 v[128:131], a[222:223], v[164:165], 0
v_mfma_f32_16x16x16_bf16 v[136:139], a[228:229], v[164:165], 0
v_mfma_f32_16x16x16_bf16 v[244:247], a[234:235], v[164:165], 0
v_mfma_f32_16x16x32_bf16 v[188:191], a[192:195], v[172:175], 0
v_mfma_f32_16x16x32_bf16 v[204:207], a[198:201], v[172:175], 0
v_mfma_f32_16x16x32_bf16 v[220:223], a[204:207], v[172:175], 0
v_mfma_f32_16x16x32_bf16 v[80:83], a[210:213], v[172:175], 0
v_mfma_f32_16x16x32_bf16 v[88:91], a[216:219], v[172:175], 0
v_mfma_f32_16x16x32_bf16 v[96:99], a[222:225], v[172:175], 0
v_mfma_f32_16x16x32_bf16 v[104:107], a[228:231], v[172:175], 0
v_mfma_f32_16x16x32_bf16 v[236:239], a[234:237], v[172:175], 0
s_add_u32 s70, s23, 524288
s_add_u32 s71, s23, 528384
v_mfma_f32_16x16x32_bf16 v[196:199], a[194:197], v[180:183], v[196:199]
v_mfma_f32_16x16x32_bf16 v[212:215], a[200:203], v[180:183], v[212:215]
v_mfma_f32_16x16x32_bf16 v[228:231], a[206:209], v[180:183], v[228:231]
v_mfma_f32_16x16x32_bf16 v[112:115], a[212:215], v[180:183], v[112:115]
v_cvt_pk_bf16_f32 v188, v188, v189
v_cvt_pk_bf16_f32 v189, v190, v191
v_cvt_pk_bf16_f32 v190, v204, v205
v_cvt_pk_bf16_f32 v191, v206, v207
buffer_store_dwordx4 v[188:191], v2, s[4:7], s70 offen offset:0 sc1
v_mfma_f32_16x16x32_bf16 v[120:123], a[218:221], v[180:183], v[120:123]
v_mfma_f32_16x16x32_bf16 v[128:131], a[224:227], v[180:183], v[128:131]
v_cvt_pk_bf16_f32 v220, v220, v221
v_cvt_pk_bf16_f32 v221, v222, v223
v_cvt_pk_bf16_f32 v222, v80, v81
v_cvt_pk_bf16_f32 v223, v82, v83
buffer_store_dwordx4 v[220:223], v2, s[4:7], s70 offen offset:2048 sc1
v_mfma_f32_16x16x32_bf16 v[136:139], a[230:233], v[180:183], v[136:139]
v_mfma_f32_16x16x32_bf16 v[244:247], a[236:239], v[180:183], v[244:247]
v_cvt_pk_bf16_f32 v88, v88, v89
v_cvt_pk_bf16_f32 v89, v90, v91
v_cvt_pk_bf16_f32 v90, v96, v97
v_cvt_pk_bf16_f32 v91, v98, v99
buffer_store_dwordx4 v[88:91], v2, s[4:7], s71 offen offset:0 sc1
v_cvt_pk_bf16_f32 v104, v104, v105
v_cvt_pk_bf16_f32 v105, v106, v107
v_cvt_pk_bf16_f32 v106, v236, v237
v_cvt_pk_bf16_f32 v107, v238, v239
buffer_store_dwordx4 v[104:107], v2, s[4:7], s71 offen offset:2048 sc1
v_cvt_pk_bf16_f32 v196, v196, v197
v_cvt_pk_bf16_f32 v197, v198, v199
v_cvt_pk_bf16_f32 v198, v212, v213
v_cvt_pk_bf16_f32 v199, v214, v215
buffer_store_dwordx4 v[196:199], v2, s[4:7], s70 offen offset:256 sc1
v_cvt_pk_bf16_f32 v228, v228, v229
v_cvt_pk_bf16_f32 v229, v230, v231
v_cvt_pk_bf16_f32 v230, v112, v113
v_cvt_pk_bf16_f32 v231, v114, v115
buffer_store_dwordx4 v[228:231], v2, s[4:7], s70 offen offset:2304 sc1
v_cvt_pk_bf16_f32 v120, v120, v121
v_cvt_pk_bf16_f32 v121, v122, v123
v_cvt_pk_bf16_f32 v122, v128, v129
v_cvt_pk_bf16_f32 v123, v130, v131
buffer_store_dwordx4 v[120:123], v2, s[4:7], s71 offen offset:256 sc1
v_cvt_pk_bf16_f32 v136, v136, v137
v_cvt_pk_bf16_f32 v137, v138, v139
v_cvt_pk_bf16_f32 v138, v244, v245
v_cvt_pk_bf16_f32 v139, v246, v247
buffer_store_dwordx4 v[136:139], v2, s[4:7], s71 offen offset:2304 sc1
s_waitcnt vmcnt(32)
v_mfma_f32_16x16x32_bf16 v[252:255], a[0:3], v[208:211], v[6:9]
v_mfma_f32_16x16x32_bf16 v[28:31], a[32:35], v[208:211], v[12:15]
v_mfma_f32_16x16x32_bf16 v[16:19], a[0:3], v[240:243], 0
v_mfma_f32_16x16x32_bf16 v[48:51], a[16:19], v[240:243], v[6:9]
v_mfma_f32_16x16x32_bf16 v[44:47], a[32:35], v[240:243], v[12:15]
v_mfma_f32_16x16x32_bf16 v[252:255], a[4:7], v[216:219], v[252:255]
v_mfma_f32_16x16x32_bf16 v[28:31], a[36:39], v[216:219], v[28:31]
v_mfma_f32_16x16x32_bf16 v[16:19], a[4:7], v[248:251], v[16:19]
v_mfma_f32_16x16x32_bf16 v[48:51], a[20:23], v[248:251], v[48:51]
v_mfma_f32_16x16x32_bf16 v[44:47], a[36:39], v[248:251], v[44:47]
v_mfma_f32_16x16x32_bf16 v[252:255], a[8:11], v[224:227], v[252:255]
v_mfma_f32_16x16x32_bf16 v[28:31], a[40:43], v[224:227], v[28:31]
v_mfma_f32_16x16x32_bf16 v[16:19], a[8:11], v[20:23], v[16:19]
v_mfma_f32_16x16x32_bf16 v[48:51], a[24:27], v[20:23], v[48:51]
v_mfma_f32_16x16x32_bf16 v[44:47], a[40:43], v[20:23], v[44:47]
v_mfma_f32_16x16x32_bf16 v[252:255], a[12:15], v[232:235], v[252:255]
v_mfma_f32_16x16x32_bf16 v[28:31], a[44:47], v[232:235], v[28:31]
v_mfma_f32_16x16x32_bf16 v[16:19], a[12:15], v[36:39], v[16:19]
v_mfma_f32_16x16x32_bf16 v[48:51], a[28:31], v[36:39], v[48:51]
v_mfma_f32_16x16x32_bf16 v[44:47], a[44:47], v[36:39], v[44:47]
v_max3_f32 v10, v252, v253, v254
v_max3_f32 v10, v10, v255, v28
v_max3_f32 v10, v10, v29, v30
v_max_f32 v10, v10, v31
v_max3_f32 v11, v16, v17, v18
v_max3_f32 v11, v11, v19, v48
v_max3_f32 v11, v11, v49, v50
s_nop 0
v_max3_f32 v11, v11, v51, v44
v_max3_f32 v11, v11, v45, v46
v_max_f32 v11, v11, v47
s_nop 1
v_permlane32_swap_b32 v10, v11
v_max_f32 v10, v10, v11
v_mov_b32 v11, v10
s_nop 1
v_permlane16_swap_b32 v10, v11
v_max_f32 v10, v10, v11
v_mul_f32 v10, s68, v10
v_mov_b32 v11, v10
s_nop 1
v_permlane32_swap_b32 v10, v11
v_pk_fma_f32 v[252:253], v[252:253], s[68:69], v[10:11] op_sel:[0,0,0] op_sel_hi:[1,1,0] neg_lo:[0,0,1] neg_hi:[0,0,1]
v_pk_fma_f32 v[254:255], v[254:255], s[68:69], v[10:11] op_sel:[0,0,0] op_sel_hi:[1,1,0] neg_lo:[0,0,1] neg_hi:[0,0,1]
v_pk_fma_f32 v[28:29], v[28:29], s[68:69], v[10:11] op_sel:[0,0,0] op_sel_hi:[1,1,0] neg_lo:[0,0,1] neg_hi:[0,0,1]
v_pk_fma_f32 v[30:31], v[30:31], s[68:69], v[10:11] op_sel:[0,0,0] op_sel_hi:[1,1,0] neg_lo:[0,0,1] neg_hi:[0,0,1]
v_pk_fma_f32 v[16:17], v[16:17], s[68:69], v[10:11] op_sel:[0,0,1] op_sel_hi:[1,1,1] neg_lo:[0,0,1] neg_hi:[0,0,1]
v_pk_fma_f32 v[18:19], v[18:19], s[68:69], v[10:11] op_sel:[0,0,1] op_sel_hi:[1,1,1] neg_lo:[0,0,1] neg_hi:[0,0,1]
v_pk_fma_f32 v[48:49], v[48:49], s[68:69], v[10:11] op_sel:[0,0,1] op_sel_hi:[1,1,1] neg_lo:[0,0,1] neg_hi:[0,0,1]
v_pk_fma_f32 v[50:51], v[50:51], s[68:69], v[10:11] op_sel:[0,0,1] op_sel_hi:[1,1,1] neg_lo:[0,0,1] neg_hi:[0,0,1]
v_pk_fma_f32 v[44:45], v[44:45], s[68:69], v[10:11] op_sel:[0,0,1] op_sel_hi:[1,1,1] neg_lo:[0,0,1] neg_hi:[0,0,1]
v_pk_fma_f32 v[46:47], v[46:47], s[68:69], v[10:11] op_sel:[0,0,1] op_sel_hi:[1,1,1] neg_lo:[0,0,1] neg_hi:[0,0,1]
v_exp_f32 v252, v252
v_exp_f32 v253, v253
v_exp_f32 v254, v254
v_exp_f32 v255, v255
v_exp_f32 v28, v28
v_exp_f32 v29, v29
v_exp_f32 v30, v30
v_exp_f32 v31, v31
v_exp_f32 v16, v16
v_exp_f32 v17, v17
v_exp_f32 v18, v18
v_exp_f32 v19, v19
v_exp_f32 v48, v48
v_exp_f32 v49, v49
v_exp_f32 v50, v50
v_exp_f32 v51, v51
v_exp_f32 v44, v44
v_exp_f32 v45, v45
v_exp_f32 v46, v46
v_exp_f32 v47, v47
v_pk_add_f32 v[24:25], v[252:253], v[254:255]
v_pk_add_f32 v[26:27], v[28:29], v[30:31]
v_pk_add_f32 v[56:57], v[16:17], v[18:19]
v_pk_add_f32 v[58:59], v[48:49], v[50:51]
v_pk_add_f32 v[24:25], v[24:25], v[26:27]
v_pk_add_f32 v[56:57], v[56:57], v[58:59]
v_pk_add_f32 v[58:59], v[44:45], v[46:47]
v_add_f32 v10, v24, v25
v_pk_add_f32 v[56:57], v[56:57], v[58:59]
v_add_f32 v11, v56, v57
s_nop 1
v_permlane32_swap_b32 v10, v11
v_add_f32 v10, v10, v11
v_mov_b32 v11, v10
s_nop 1
v_permlane16_swap_b32 v10, v11
v_add_f32 v10, v10, v11
v_rcp_f32 v10, v10
s_nop 0
v_mov_b32 v11, v10
s_nop 1
v_permlane32_swap_b32 v10, v11
v_pk_mul_f32 v[252:253], v[252:253], v[10:11] op_sel:[0,0] op_sel_hi:[1,0]
v_pk_mul_f32 v[254:255], v[254:255], v[10:11] op_sel:[0,0] op_sel_hi:[1,0]
v_pk_mul_f32 v[28:29], v[28:29], v[10:11] op_sel:[0,0] op_sel_hi:[1,0]
v_pk_mul_f32 v[30:31], v[30:31], v[10:11] op_sel:[0,0] op_sel_hi:[1,0]
v_pk_mul_f32 v[16:17], v[16:17], v[10:11] op_sel:[0,1] op_sel_hi:[1,1]
v_pk_mul_f32 v[18:19], v[18:19], v[10:11] op_sel:[0,1] op_sel_hi:[1,1]
v_pk_mul_f32 v[48:49], v[48:49], v[10:11] op_sel:[0,1] op_sel_hi:[1,1]
v_pk_mul_f32 v[50:51], v[50:51], v[10:11] op_sel:[0,1] op_sel_hi:[1,1]
v_pk_mul_f32 v[44:45], v[44:45], v[10:11] op_sel:[0,1] op_sel_hi:[1,1]
v_pk_mul_f32 v[46:47], v[46:47], v[10:11] op_sel:[0,1] op_sel_hi:[1,1]
v_cvt_pk_bf16_f32 v24, v28, v29
v_cvt_pk_bf16_f32 v25, v30, v31
v_cvt_pk_bf16_f32 v26, v252, v253
v_cvt_pk_bf16_f32 v27, v254, v255
v_cvt_pk_bf16_f32 v56, v16, v17
v_cvt_pk_bf16_f32 v57, v18, v19
v_cvt_pk_bf16_f32 v58, v48, v49
v_cvt_pk_bf16_f32 v59, v50, v51
v_cvt_pk_bf16_f32 v44, v44, v45
v_cvt_pk_bf16_f32 v45, v46, v47
s_waitcnt vmcnt(13)
s_nop 0
v_mfma_f32_16x16x16_bf16 v[64:67], a[48:49], v[44:45], 0
v_mfma_f32_16x16x16_bf16 v[72:75], a[54:55], v[44:45], 0
v_mfma_f32_16x16x16_bf16 v[60:63], a[60:61], v[44:45], 0
v_mfma_f32_16x16x16_bf16 v[76:79], a[66:67], v[44:45], 0
v_mfma_f32_16x16x16_bf16 v[100:103], a[72:73], v[44:45], 0
v_mfma_f32_16x16x16_bf16 v[108:111], a[78:79], v[44:45], 0
v_mfma_f32_16x16x16_bf16 v[124:127], a[84:85], v[44:45], 0
v_mfma_f32_16x16x16_bf16 v[176:179], a[90:91], v[44:45], 0
v_mfma_f32_16x16x32_bf16 v[32:35], a[48:51], v[24:27], 0
v_mfma_f32_16x16x32_bf16 v[40:43], a[54:57], v[24:27], 0
v_mfma_f32_16x16x32_bf16 v[52:55], a[60:63], v[24:27], 0
v_mfma_f32_16x16x32_bf16 v[68:71], a[66:69], v[24:27], 0
v_mfma_f32_16x16x32_bf16 v[92:95], a[72:75], v[24:27], 0
v_mfma_f32_16x16x32_bf16 v[84:87], a[78:81], v[24:27], 0
v_mfma_f32_16x16x32_bf16 v[116:119], a[84:87], v[24:27], 0
v_mfma_f32_16x16x32_bf16 v[144:147], a[90:93], v[24:27], 0
s_add_u32 s70, s23, 786432
s_add_u32 s71, s23, 790528
v_mfma_f32_16x16x32_bf16 v[64:67], a[50:53], v[56:59], v[64:67]
v_mfma_f32_16x16x32_bf16 v[72:75], a[56:59], v[56:59], v[72:75]
v_mfma_f32_16x16x32_bf16 v[60:63], a[62:65], v[56:59], v[60:63]
v_mfma_f32_16x16x32_bf16 v[76:79], a[68:71], v[56:59], v[76:79]
v_cvt_pk_bf16_f32 v32, v32, v33
v_cvt_pk_bf16_f32 v33, v34, v35
v_cvt_pk_bf16_f32 v34, v40, v41
v_cvt_pk_bf16_f32 v35, v42, v43
buffer_store_dwordx4 v[32:35], v2, s[4:7], s70 offen offset:0 sc1
v_mfma_f32_16x16x32_bf16 v[100:103], a[74:77], v[56:59], v[100:103]
v_mfma_f32_16x16x32_bf16 v[108:111], a[80:83], v[56:59], v[108:111]
v_cvt_pk_bf16_f32 v52, v52, v53
v_cvt_pk_bf16_f32 v53, v54, v55
v_cvt_pk_bf16_f32 v54, v68, v69
v_cvt_pk_bf16_f32 v55, v70, v71
buffer_store_dwordx4 v[52:55], v2, s[4:7], s70 offen offset:2048 sc1
v_mfma_f32_16x16x32_bf16 v[124:127], a[86:89], v[56:59], v[124:127]
v_mfma_f32_16x16x32_bf16 v[176:179], a[92:95], v[56:59], v[176:179]
v_cvt_pk_bf16_f32 v92, v92, v93
v_cvt_pk_bf16_f32 v93, v94, v95
v_cvt_pk_bf16_f32 v94, v84, v85
v_cvt_pk_bf16_f32 v95, v86, v87
buffer_store_dwordx4 v[92:95], v2, s[4:7], s71 offen offset:0 sc1
v_cvt_pk_bf16_f32 v116, v116, v117
v_cvt_pk_bf16_f32 v117, v118, v119
v_cvt_pk_bf16_f32 v118, v144, v145
v_cvt_pk_bf16_f32 v119, v146, v147
buffer_store_dwordx4 v[116:119], v2, s[4:7], s71 offen offset:2048 sc1
v_cvt_pk_bf16_f32 v64, v64, v65
v_cvt_pk_bf16_f32 v65, v66, v67
v_cvt_pk_bf16_f32 v66, v72, v73
v_cvt_pk_bf16_f32 v67, v74, v75
buffer_store_dwordx4 v[64:67], v2, s[4:7], s70 offen offset:256 sc1
v_cvt_pk_bf16_f32 v60, v60, v61
v_cvt_pk_bf16_f32 v61, v62, v63
v_cvt_pk_bf16_f32 v62, v76, v77
v_cvt_pk_bf16_f32 v63, v78, v79
buffer_store_dwordx4 v[60:63], v2, s[4:7], s70 offen offset:2304 sc1
v_cvt_pk_bf16_f32 v100, v100, v101
v_cvt_pk_bf16_f32 v101, v102, v103
v_cvt_pk_bf16_f32 v102, v108, v109
v_cvt_pk_bf16_f32 v103, v110, v111
buffer_store_dwordx4 v[100:103], v2, s[4:7], s71 offen offset:256 sc1
v_cvt_pk_bf16_f32 v124, v124, v125
v_cvt_pk_bf16_f32 v125, v126, v127
v_cvt_pk_bf16_f32 v126, v176, v177
v_cvt_pk_bf16_f32 v127, v178, v179
buffer_store_dwordx4 v[124:127], v2, s[4:7], s71 offen offset:2304 sc1
v_accvgpr_read_b32 v2, a240
v_accvgpr_read_b32 v3, a241
v_accvgpr_read_b32 v4, a242
v_accvgpr_read_b32 v5, a243
v_accvgpr_read_b32 v6, a244
v_accvgpr_read_b32 v7, a245
v_accvgpr_read_b32 v8, a246
v_accvgpr_read_b32 v9, a247
s_branch m_g_nx1
m_g_es:
s_waitcnt lgkmcnt(0)
s_barrier
s_waitcnt lgkmcnt(0)
v_accvgpr_write_b32 a240, v2
v_accvgpr_write_b32 a241, v3
v_accvgpr_write_b32 a242, v4
v_accvgpr_write_b32 a243, v5
v_accvgpr_write_b32 a244, v6
v_accvgpr_write_b32 a245, v7
v_accvgpr_write_b32 a246, v8
v_accvgpr_write_b32 a247, v9
s_lshl_b32 s62, s19, 1
s_add_u32 s62, s62, s32
s_mul_i32 s62, s62, 1048576
s_lshl_b32 s63, s20, 1
s_add_u32 s63, s63, s33
s_lshl_b32 s63, s63, 13
s_add_u32 s23, s62, s63
s_add_u32 s23, s23, 109051904
s_lshl_b32 s62, s20, 1
s_add_u32 s62, s62, s33
s_lshl_b32 s63, s19, 1
s_add_u32 s63, s63, s32
s_and_b32 s30, s35, 1
s_lshr_b32 s64, s35, 1
s_lshl_b32 s64, s64, 2
s_add_u32 s30, s30, s64
s_lshl_b32 s30, s30, 12
s_xor_b32 s64, s34, 8192
s_add_u32 s30, s30, s64
s_add_u32 s30, s30, 170983424
s_and_b32 s64, s16, 31
s_lshl_b32 s64, s64, 7
s_add_u32 s30, s30, s64
s_lshl_b32 s31, s63, 2
s_and_b32 s21, s63, 3
s_lshl_b32 s21, s21, 3
s_and_b32 s65, s62, 7
s_add_u32 s21, s21, s65
s_lshr_b32 s65, s62, 3
s_lshl_b32 s65, s65, 5
s_add_u32 s21, s21, s65
s_lshl_b32 s21, s21, 2
s_add_u32 s21, s21, 171016192
s_lshl_b32 s65, s19, 3
s_sub_u32 s65, s65, 1
v_mov_b32 v10, 0
m_g_qs_pp:
buffer_load_dword v12, v10, s[4:7], s30 offen sc1
s_waitcnt vmcnt(0)
v_readfirstlane_b32 s71, v12
s_cmp_ge_u32 s71, s65
s_cbranch_scc1 m_g_qs_pp_d
s_cmp_eq_u32 s17, 0
s_cbranch_scc1 m_g_qs_pp_d
s_sub_u32 s17, s17, 1
s_branch m_g_qs_pp
m_g_qs_pp_d:
s_lshl_b32 s64, s63, 19
s_lshr_b32 s65, s62, 2
s_lshl_b32 s65, s65, 14
s_add_u32 s64, s64, s65
s_and_b32 s65, s62, 3
s_lshl_b32 s65, s65, 11
s_add_u32 s64, s64, s65
s_lshl_b32 s65, s19, 12
s_xor_b32 s65, s65, s34
s_and_b32 s65, s65, 8192
s_add_u32 s64, s64, s65
s_add_u32 s66, s64, 8388608
s_add_u32 s67, s64, 16777216
s_lshl_b32 s63, s63, 21
s_lshl_b32 s62, s62, 14
s_add_u32 s62, s62, s63
s_lshl_b32 s63, s32, 13
s_xor_b32 s63, s63, s34
s_xor_b32 s63, s63, 8192
s_add_u32 s62, s62, s63
s_add_u32 s64, s62, 58720256
s_add_u32 s65, s64, 4096
s_add_u32 s62, s62, 25165824
s_add_u32 s63, s62, 4096
s_mov_b32 s68, 1040356334
s_mov_b32 s69, 1040356334
v_lshrrev_b32 v2, 4, v0
v_lshlrev_b32 v2, 9, v2
v_and_b32 v10, 15, v0
v_lshl_add_u32 v2, v10, 4, v2
v_lshrrev_b32 v3, 4, v0
v_lshlrev_b32 v3, 9, v3
v_bfe_u32 v10, v0, 3, 1
v_lshl_add_u32 v3, v10, 8, v3
v_and_b32 v10, 7, v0
v_lshl_add_u32 v3, v10, 4, v3
v_lshrrev_b32 v10, 4, v0
v_and_b32 v11, 15, v0
v_lshlrev_b32 v4, 7, v10
v_lshl_add_u32 v4, v11, 4, v4
v_mov_b32 v12, 2147483648
v_cmp_gt_u32 vcc, 8, v11
s_nop 1
v_cndmask_b32 v4, v12, v4, vcc
v_lshrrev_b32 v13, 3, v11
v_lshlrev_b32 v13, 8, v13
v_lshl_add_u32 v13, v10, 3, v13
v_and_b32 v14, 7, v0
v_lshl_add_u32 v5, v14, 4, v13
v_cmp_gt_u32 vcc, 2, v10
s_nop 1
v_cndmask_b32 v5, v12, v5, vcc
buffer_load_dwordx4 a[144:147], v2, s[4:7], s62 offen offset:0
buffer_load_dwordx4 a[160:163], v2, s[4:7], s62 offen offset:256
buffer_load_dwordx4 a[148:151], v2, s[4:7], s62 offen offset:2048
buffer_load_dwordx4 a[164:167], v2, s[4:7], s62 offen offset:2304
buffer_load_dwordx4 a[152:155], v2, s[4:7], s63 offen offset:0
buffer_load_dwordx4 a[168:171], v2, s[4:7], s63 offen offset:256
buffer_load_dwordx4 a[156:159], v2, s[4:7], s63 offen offset:2048
buffer_load_dwordx4 a[172:175], v2, s[4:7], s63 offen offset:2304
s_add_u32 s62, s62, 524288
s_add_u32 s63, s63, 524288
buffer_load_dwordx4 a[194:197], v3, s[4:7], s64 offen offset:0
buffer_load_dwordx4 a[200:203], v3, s[4:7], s64 offen offset:128
buffer_load_dwordx4 a[206:209], v3, s[4:7], s64 offen offset:2048
buffer_load_dwordx4 a[212:215], v3, s[4:7], s64 offen offset:2176
buffer_load_dwordx4 a[218:221], v3, s[4:7], s65 offen offset:0
buffer_load_dwordx4 a[224:227], v3, s[4:7], s65 offen offset:128
buffer_load_dwordx4 a[230:233], v3, s[4:7], s65 offen offset:2048
buffer_load_dwordx4 a[236:239], v3, s[4:7], s65 offen offset:2176
s_add_u32 s64, s64, 524288
s_add_u32 s65, s65, 524288
v_mov_b32 v12, 4284592614
v_lshlrev_b32 v13, 2, v10
v_add_u32 v14, 0, v13
v_cmp_gt_u32 vcc, v14, v11
s_nop 1
v_cndmask_b32 v6, 0, v12, vcc
v_add_u32 v14, 1, v13
v_cmp_gt_u32 vcc, v14, v11
s_nop 1
v_cndmask_b32 v7, 0, v12, vcc
v_add_u32 v14, 2, v13
v_cmp_gt_u32 vcc, v14, v11
s_nop 1
v_cndmask_b32 v8, 0, v12, vcc
v_add_u32 v14, 3, v13
v_cmp_gt_u32 vcc, v14, v11
s_nop 1
v_cndmask_b32 v9, 0, v12, vcc
v_cmp_le_u32 vcc, 2, v10
s_nop 1
v_cndmask_b32 v12, 0, v12, vcc
v_mov_b32 v13, v12
v_mov_b32 v14, v12
v_mov_b32 v15, v12
v_cvt_pk_bf16_f32 v16, v16, v17
v_cvt_pk_bf16_f32 v17, v18, v19
v_cvt_pk_bf16_f32 v18, v20, v21
v_cvt_pk_bf16_f32 v19, v22, v23
v_cvt_pk_bf16_f32 v24, v24, v25
v_cvt_pk_bf16_f32 v25, v26, v27
v_cvt_pk_bf16_f32 v26, v28, v29
v_cvt_pk_bf16_f32 v27, v30, v31
v_cvt_pk_bf16_f32 v32, v32, v33
v_cvt_pk_bf16_f32 v33, v34, v35
v_cvt_pk_bf16_f32 v34, v36, v37
v_cvt_pk_bf16_f32 v35, v38, v39
v_cvt_pk_bf16_f32 v40, v40, v41
v_cvt_pk_bf16_f32 v41, v42, v43
v_cvt_pk_bf16_f32 v42, v44, v45
v_cvt_pk_bf16_f32 v43, v46, v47
v_cvt_pk_bf16_f32 v48, v48, v49
v_cvt_pk_bf16_f32 v49, v50, v51
v_cvt_pk_bf16_f32 v50, v52, v53
v_cvt_pk_bf16_f32 v51, v54, v55
buffer_load_dwordx4 a[0:3], v2, s[4:7], s62 offen offset:0
v_cvt_pk_bf16_f32 v56, v56, v57
v_cvt_pk_bf16_f32 v57, v58, v59
v_cvt_pk_bf16_f32 v58, v60, v61
v_cvt_pk_bf16_f32 v59, v62, v63
buffer_load_dwordx4 a[16:19], v2, s[4:7], s62 offen offset:256
v_cvt_pk_bf16_f32 v64, v64, v65
v_cvt_pk_bf16_f32 v65, v66, v67
v_cvt_pk_bf16_f32 v66, v68, v69
v_cvt_pk_bf16_f32 v67, v70, v71
buffer_load_dwordx4 a[4:7], v2, s[4:7], s62 offen offset:2048
v_cvt_pk_bf16_f32 v72, v72, v73
v_cvt_pk_bf16_f32 v73, v74, v75
v_cvt_pk_bf16_f32 v74, v76, v77
v_cvt_pk_bf16_f32 v75, v78, v79
buffer_load_dwordx4 a[20:23], v2, s[4:7], s62 offen offset:2304
v_cvt_pk_bf16_f32 v80, v80, v81
v_cvt_pk_bf16_f32 v81, v82, v83
v_cvt_pk_bf16_f32 v82, v84, v85
v_cvt_pk_bf16_f32 v83, v86, v87
buffer_load_dwordx4 a[8:11], v2, s[4:7], s63 offen offset:0
v_cvt_pk_bf16_f32 v88, v88, v89
v_cvt_pk_bf16_f32 v89, v90, v91
v_cvt_pk_bf16_f32 v90, v92, v93
v_cvt_pk_bf16_f32 v91, v94, v95
buffer_load_dwordx4 a[24:27], v2, s[4:7], s63 offen offset:256
v_cvt_pk_bf16_f32 v96, v96, v97
v_cvt_pk_bf16_f32 v97, v98, v99
v_cvt_pk_bf16_f32 v98, v100, v101
v_cvt_pk_bf16_f32 v99, v102, v103
buffer_load_dwordx4 a[12:15], v2, s[4:7], s63 offen offset:2048
v_cvt_pk_bf16_f32 v104, v104, v105
v_cvt_pk_bf16_f32 v105, v106, v107
v_cvt_pk_bf16_f32 v106, v108, v109
v_cvt_pk_bf16_f32 v107, v110, v111
buffer_load_dwordx4 a[28:31], v2, s[4:7], s63 offen offset:2304
v_cvt_pk_bf16_f32 v112, v112, v113
v_cvt_pk_bf16_f32 v113, v114, v115
v_cvt_pk_bf16_f32 v114, v116, v117
v_cvt_pk_bf16_f32 v115, v118, v119
s_add_u32 s62, s62, 524288
s_add_u32 s63, s63, 524288
v_cvt_pk_bf16_f32 v120, v120, v121
v_cvt_pk_bf16_f32 v121, v122, v123
v_cvt_pk_bf16_f32 v122, v124, v125
v_cvt_pk_bf16_f32 v123, v126, v127
buffer_load_dwordx4 a[50:53], v3, s[4:7], s64 offen offset:0
v_cvt_pk_bf16_f32 v128, v128, v129
v_cvt_pk_bf16_f32 v129, v130, v131
v_cvt_pk_bf16_f32 v130, v132, v133
v_cvt_pk_bf16_f32 v131, v134, v135
buffer_load_dwordx4 a[56:59], v3, s[4:7], s64 offen offset:128
v_cvt_pk_bf16_f32 v136, v136, v137
v_cvt_pk_bf16_f32 v137, v138, v139
v_cvt_pk_bf16_f32 v138, v140, v141
v_cvt_pk_bf16_f32 v139, v142, v143
buffer_load_dwordx4 a[62:65], v3, s[4:7], s64 offen offset:2048
v_cvt_pk_bf16_f32 v144, v144, v145
v_cvt_pk_bf16_f32 v145, v146, v147
v_cvt_pk_bf16_f32 v146, v148, v149
v_cvt_pk_bf16_f32 v147, v150, v151
buffer_load_dwordx4 a[68:71], v3, s[4:7], s64 offen offset:2176
buffer_load_dwordx4 a[74:77], v3, s[4:7], s65 offen offset:0
v_cvt_pk_bf16_f32 v152, v152, v153
v_cvt_pk_bf16_f32 v153, v154, v155
v_cvt_pk_bf16_f32 v154, v156, v157
v_cvt_pk_bf16_f32 v155, v158, v159
buffer_load_dwordx4 a[80:83], v3, s[4:7], s65 offen offset:128
buffer_load_dwordx4 a[86:89], v3, s[4:7], s65 offen offset:2048
v_cvt_pk_bf16_f32 v160, v160, v161
v_cvt_pk_bf16_f32 v161, v162, v163
v_cvt_pk_bf16_f32 v162, v164, v165
v_cvt_pk_bf16_f32 v163, v166, v167
buffer_load_dwordx4 a[92:95], v3, s[4:7], s65 offen offset:2176
s_add_u32 s64, s64, 524288
s_add_u32 s65, s65, 524288
v_cvt_pk_bf16_f32 v168, v168, v169
v_cvt_pk_bf16_f32 v169, v170, v171
v_cvt_pk_bf16_f32 v170, v172, v173
v_cvt_pk_bf16_f32 v171, v174, v175
v_cvt_pk_bf16_f32 v176, v176, v177
v_cvt_pk_bf16_f32 v177, v178, v179
v_cvt_pk_bf16_f32 v178, v180, v181
v_cvt_pk_bf16_f32 v179, v182, v183
v_cvt_pk_bf16_f32 v184, v184, v185
v_cvt_pk_bf16_f32 v185, v186, v187
v_cvt_pk_bf16_f32 v186, v188, v189
v_cvt_pk_bf16_f32 v187, v190, v191
v_cvt_pk_bf16_f32 v192, v192, v193
v_cvt_pk_bf16_f32 v193, v194, v195
v_cvt_pk_bf16_f32 v194, v196, v197
v_cvt_pk_bf16_f32 v195, v198, v199
v_cvt_pk_bf16_f32 v200, v200, v201
v_cvt_pk_bf16_f32 v201, v202, v203
v_cvt_pk_bf16_f32 v202, v204, v205
v_cvt_pk_bf16_f32 v203, v206, v207
v_cvt_pk_bf16_f32 v208, v208, v209
v_cvt_pk_bf16_f32 v209, v210, v211
v_cvt_pk_bf16_f32 v210, v212, v213
v_cvt_pk_bf16_f32 v211, v214, v215
v_cvt_pk_bf16_f32 v216, v216, v217
v_cvt_pk_bf16_f32 v217, v218, v219
v_cvt_pk_bf16_f32 v218, v220, v221
v_cvt_pk_bf16_f32 v219, v222, v223
v_cvt_pk_bf16_f32 v224, v224, v225
v_cvt_pk_bf16_f32 v225, v226, v227
v_cvt_pk_bf16_f32 v226, v228, v229
v_cvt_pk_bf16_f32 v227, v230, v231
v_cvt_pk_bf16_f32 v232, v232, v233
v_cvt_pk_bf16_f32 v233, v234, v235
v_cvt_pk_bf16_f32 v234, v236, v237
v_cvt_pk_bf16_f32 v235, v238, v239
v_cvt_pk_bf16_f32 v240, v240, v241
v_cvt_pk_bf16_f32 v241, v242, v243
v_cvt_pk_bf16_f32 v242, v244, v245
v_cvt_pk_bf16_f32 v243, v246, v247
v_cvt_pk_bf16_f32 v248, v248, v249
v_cvt_pk_bf16_f32 v249, v250, v251
v_cvt_pk_bf16_f32 v250, v252, v253
v_cvt_pk_bf16_f32 v251, v254, v255
v_accvgpr_read_b32 v20, a128
v_accvgpr_read_b32 v21, a129
v_accvgpr_read_b32 v22, a130
v_accvgpr_read_b32 v23, a131
v_accvgpr_read_b32 v28, a132
v_accvgpr_read_b32 v29, a133
v_accvgpr_read_b32 v30, a134
v_accvgpr_read_b32 v31, a135
v_cvt_pk_bf16_f32 v20, v20, v21
v_cvt_pk_bf16_f32 v21, v22, v23
v_cvt_pk_bf16_f32 v22, v28, v29
v_cvt_pk_bf16_f32 v23, v30, v31
v_accvgpr_read_b32 v36, a136
v_accvgpr_read_b32 v37, a137
v_accvgpr_read_b32 v38, a138
v_accvgpr_read_b32 v39, a139
v_accvgpr_read_b32 v44, a140
v_accvgpr_read_b32 v45, a141
v_accvgpr_read_b32 v46, a142
v_accvgpr_read_b32 v47, a143
v_cvt_pk_bf16_f32 v36, v36, v37
v_cvt_pk_bf16_f32 v37, v38, v39
v_cvt_pk_bf16_f32 v38, v44, v45
v_cvt_pk_bf16_f32 v39, v46, v47
s_cmp_eq_u32 s18, 7
s_cselect_b32 s70, 2147483648, 0
v_lshl_add_u32 v45, v0, 9, s70
v_mov_b32 v28, 1
s_add_u32 s31, s31, 1
s_cmp_ge_u32 s31, 57
s_cselect_b32 s70, 2, 0
s_sub_u32 s70, s31, s70
v_mov_b32 v44, 0
m_g_qs_p0:
buffer_load_dword v46, v44, s[4:7], s30 offen sc1
s_waitcnt vmcnt(0)
v_readfirstlane_b32 s71, v46
s_cmp_ge_u32 s71, s70
s_cbranch_scc1 m_g_qs_p0_d
s_cmp_eq_u32 s17, 0
s_cbranch_scc1 m_g_qs_p0_d
s_sub_u32 s17, s17, 1
s_branch m_g_qs_p0
m_g_qs_p0_d:
s_mov_b32 s22, s71
buffer_load_dwordx4 a[176:179], v4, s[4:7], s66 offen offset:0 sc1
buffer_load_dwordx4 a[180:183], v4, s[4:7], s66 offen offset:512 sc1
buffer_load_dwordx4 a[184:187], v4, s[4:7], s66 offen offset:1024 sc1
buffer_load_dwordx4 a[188:191], v4, s[4:7], s66 offen offset:1536 sc1
s_add_u32 s66, s66, 131072
buffer_load_dwordx2 a[192:193], v5, s[4:7], s67 offen offset:0 sc1
buffer_load_dwordx2 a[198:199], v5, s[4:7], s67 offen offset:128 sc1
buffer_load_dwordx2 a[204:205], v5, s[4:7], s67 offen offset:512 sc1
buffer_load_dwordx2 a[210:211], v5, s[4:7], s67 offen offset:640 sc1
buffer_load_dwordx2 a[216:217], v5, s[4:7], s67 offen offset:1024 sc1
buffer_load_dwordx2 a[222:223], v5, s[4:7], s67 offen offset:1152 sc1
buffer_load_dwordx2 a[228:229], v5, s[4:7], s67 offen offset:1536 sc1
buffer_load_dwordx2 a[234:235], v5, s[4:7], s67 offen offset:1664 sc1
s_add_u32 s67, s67, 131072
s_cmp_lt_u32 s31, 57
s_cbranch_scc1 m_g_qs_f0
s_waitcnt vmcnt(0)
s_branch m_g_qs_c0
m_g_qs_r0:
s_sub_u32 s66, s66, 131072
s_sub_u32 s67, s67, 131072
buffer_load_dwordx4 a[176:179], v4, s[4:7], s66 offen offset:0 sc1
buffer_load_dwordx4 a[180:183], v4, s[4:7], s66 offen offset:512 sc1
buffer_load_dwordx4 a[184:187], v4, s[4:7], s66 offen offset:1024 sc1
buffer_load_dwordx4 a[188:191], v4, s[4:7], s66 offen offset:1536 sc1
s_add_u32 s66, s66, 131072
buffer_load_dwordx2 a[192:193], v5, s[4:7], s67 offen offset:0 sc1
buffer_load_dwordx2 a[198:199], v5, s[4:7], s67 offen offset:128 sc1
buffer_load_dwordx2 a[204:205], v5, s[4:7], s67 offen offset:512 sc1
buffer_load_dwordx2 a[210:211], v5, s[4:7], s67 offen offset:640 sc1
buffer_load_dwordx2 a[216:217], v5, s[4:7], s67 offen offset:1024 sc1
buffer_load_dwordx2 a[222:223], v5, s[4:7], s67 offen offset:1152 sc1
buffer_load_dwordx2 a[228:229], v5, s[4:7], s67 offen offset:1536 sc1
buffer_load_dwordx2 a[234:235], v5, s[4:7], s67 offen offset:1664 sc1
s_add_u32 s67, s67, 131072
s_waitcnt vmcnt(0)
m_g_qs_c0:
v_accvgpr_read_b32 v46, a176
v_accvgpr_read_b32 v44, a180
v_max_u32 v46, v46, v44
v_accvgpr_read_b32 v44, a184
v_accvgpr_read_b32 v47, a188
v_max3_u32 v46, v46, v44, v47
v_accvgpr_read_b32 v44, a192
v_accvgpr_read_b32 v47, a198
v_max3_u32 v46, v46, v44, v47
v_accvgpr_read_b32 v44, a204
v_accvgpr_read_b32 v47, a210
v_max3_u32 v46, v46, v44, v47
v_accvgpr_read_b32 v44, a216
v_accvgpr_read_b32 v47, a222
v_max3_u32 v46, v46, v44, v47
v_accvgpr_read_b32 v44, a228
v_accvgpr_read_b32 v47, a234
v_max3_u32 v46, v46, v44, v47
v_cmp_eq_u32 vcc, -1, v46
s_cbranch_vccz m_g_qs_f0
s_cmp_eq_u32 s17, 0
s_cbranch_scc1 m_g_qs_f0
s_sub_u32 s17, s17, 1
s_branch m_g_qs_r0
m_g_qs_f0:
s_waitcnt vmcnt(8)
v_mfma_f32_16x16x32_bf16 v[52:55], a[144:147], v[16:19], v[6:9]
v_mfma_f32_16x16x32_bf16 v[60:63], a[176:179], v[16:19], v[12:15]
v_mfma_f32_16x16x32_bf16 v[68:71], a[144:147], v[48:51], 0
v_mfma_f32_16x16x32_bf16 v[76:79], a[160:163], v[48:51], v[6:9]
v_mfma_f32_16x16x32_bf16 v[84:87], a[176:179], v[48:51], v[12:15]
v_mfma_f32_16x16x32_bf16 v[52:55], a[148:151], v[24:27], v[52:55]
v_mfma_f32_16x16x32_bf16 v[60:63], a[180:183], v[24:27], v[60:63]
v_mfma_f32_16x16x32_bf16 v[68:71], a[148:151], v[56:59], v[68:71]
v_mfma_f32_16x16x32_bf16 v[76:79], a[164:167], v[56:59], v[76:79]
v_mfma_f32_16x16x32_bf16 v[84:87], a[180:183], v[56:59], v[84:87]
v_mfma_f32_16x16x32_bf16 v[52:55], a[152:155], v[32:35], v[52:55]
v_mfma_f32_16x16x32_bf16 v[60:63], a[184:187], v[32:35], v[60:63]
v_mfma_f32_16x16x32_bf16 v[68:71], a[152:155], v[64:67], v[68:71]
v_mfma_f32_16x16x32_bf16 v[76:79], a[168:171], v[64:67], v[76:79]
v_mfma_f32_16x16x32_bf16 v[84:87], a[184:187], v[64:67], v[84:87]
v_mfma_f32_16x16x32_bf16 v[52:55], a[156:159], v[40:43], v[52:55]
v_mfma_f32_16x16x32_bf16 v[60:63], a[188:191], v[40:43], v[60:63]
v_mfma_f32_16x16x32_bf16 v[68:71], a[156:159], v[72:75], v[68:71]
v_mfma_f32_16x16x32_bf16 v[76:79], a[172:175], v[72:75], v[76:79]
v_mfma_f32_16x16x32_bf16 v[84:87], a[188:191], v[72:75], v[84:87]
buffer_load_dwordx4 a[144:147], v2, s[4:7], s62 offen offset:0
buffer_load_dwordx4 a[160:163], v2, s[4:7], s62 offen offset:256
buffer_load_dwordx4 a[148:151], v2, s[4:7], s62 offen offset:2048
buffer_load_dwordx4 a[164:167], v2, s[4:7], s62 offen offset:2304
buffer_load_dwordx4 a[152:155], v2, s[4:7], s63 offen offset:0
buffer_load_dwordx4 a[168:171], v2, s[4:7], s63 offen offset:256
buffer_load_dwordx4 a[156:159], v2, s[4:7], s63 offen offset:2048
buffer_load_dwordx4 a[172:175], v2, s[4:7], s63 offen offset:2304
s_add_u32 s62, s62, 524288
s_add_u32 s63, s63, 524288
v_max3_f32 v10, v52, v53, v54
v_max3_f32 v10, v10, v55, v60
v_max3_f32 v10, v10, v61, v62
v_max_f32 v10, v10, v63
v_max3_f32 v11, v68, v69, v70
v_max3_f32 v11, v11, v71, v76
v_max3_f32 v11, v11, v77, v78
v_max3_f32 v11, v11, v79, v84
v_max3_f32 v11, v11, v85, v86
v_max_f32 v11, v11, v87
s_nop 1
v_permlane32_swap_b32 v10, v11
v_max_f32 v10, v10, v11
v_mov_b32 v11, v10
s_nop 1
v_permlane16_swap_b32 v10, v11
v_max_f32 v10, v10, v11
v_mul_f32 v10, s68, v10
v_mov_b32 v11, v10
s_nop 1
v_permlane32_swap_b32 v10, v11
v_pk_fma_f32 v[52:53], v[52:53], s[68:69], v[10:11] op_sel:[0,0,0] op_sel_hi:[1,1,0] neg_lo:[0,0,1] neg_hi:[0,0,1]
v_pk_fma_f32 v[54:55], v[54:55], s[68:69], v[10:11] op_sel:[0,0,0] op_sel_hi:[1,1,0] neg_lo:[0,0,1] neg_hi:[0,0,1]
v_pk_fma_f32 v[60:61], v[60:61], s[68:69], v[10:11] op_sel:[0,0,0] op_sel_hi:[1,1,0] neg_lo:[0,0,1] neg_hi:[0,0,1]
v_pk_fma_f32 v[62:63], v[62:63], s[68:69], v[10:11] op_sel:[0,0,0] op_sel_hi:[1,1,0] neg_lo:[0,0,1] neg_hi:[0,0,1]
v_pk_fma_f32 v[68:69], v[68:69], s[68:69], v[10:11] op_sel:[0,0,1] op_sel_hi:[1,1,1] neg_lo:[0,0,1] neg_hi:[0,0,1]
v_pk_fma_f32 v[70:71], v[70:71], s[68:69], v[10:11] op_sel:[0,0,1] op_sel_hi:[1,1,1] neg_lo:[0,0,1] neg_hi:[0,0,1]
v_pk_fma_f32 v[76:77], v[76:77], s[68:69], v[10:11] op_sel:[0,0,1] op_sel_hi:[1,1,1] neg_lo:[0,0,1] neg_hi:[0,0,1]
v_pk_fma_f32 v[78:79], v[78:79], s[68:69], v[10:11] op_sel:[0,0,1] op_sel_hi:[1,1,1] neg_lo:[0,0,1] neg_hi:[0,0,1]
v_pk_fma_f32 v[84:85], v[84:85], s[68:69], v[10:11] op_sel:[0,0,1] op_sel_hi:[1,1,1] neg_lo:[0,0,1] neg_hi:[0,0,1]
v_pk_fma_f32 v[86:87], v[86:87], s[68:69], v[10:11] op_sel:[0,0,1] op_sel_hi:[1,1,1] neg_lo:[0,0,1] neg_hi:[0,0,1]
v_exp_f32 v52, v52
v_exp_f32 v53, v53
v_exp_f32 v54, v54
v_exp_f32 v55, v55
v_exp_f32 v60, v60
v_exp_f32 v61, v61
v_exp_f32 v62, v62
v_exp_f32 v63, v63
v_exp_f32 v68, v68
v_exp_f32 v69, v69
v_exp_f32 v70, v70
v_exp_f32 v71, v71
v_exp_f32 v76, v76
v_exp_f32 v77, v77
v_exp_f32 v78, v78
v_exp_f32 v79, v79
v_exp_f32 v84, v84
v_exp_f32 v85, v85
v_exp_f32 v86, v86
v_exp_f32 v87, v87
v_pk_add_f32 v[92:93], v[52:53], v[54:55]
v_pk_add_f32 v[94:95], v[60:61], v[62:63]
v_pk_add_f32 v[100:101], v[68:69], v[70:71]
v_pk_add_f32 v[102:103], v[76:77], v[78:79]
v_pk_add_f32 v[92:93], v[92:93], v[94:95]
v_pk_add_f32 v[100:101], v[100:101], v[102:103]
v_pk_add_f32 v[102:103], v[84:85], v[86:87]
v_add_f32 v10, v92, v93
v_pk_add_f32 v[100:101], v[100:101], v[102:103]
v_add_f32 v11, v100, v101
s_nop 1
v_permlane32_swap_b32 v10, v11
v_add_f32 v10, v10, v11
v_mov_b32 v11, v10
s_nop 1
v_permlane16_swap_b32 v10, v11
v_add_f32 v10, v10, v11
v_rcp_f32 v10, v10
s_nop 0
v_mov_b32 v11, v10
s_nop 1
v_permlane32_swap_b32 v10, v11
v_pk_mul_f32 v[52:53], v[52:53], v[10:11] op_sel:[0,0] op_sel_hi:[1,0]
v_pk_mul_f32 v[54:55], v[54:55], v[10:11] op_sel:[0,0] op_sel_hi:[1,0]
v_pk_mul_f32 v[60:61], v[60:61], v[10:11] op_sel:[0,0] op_sel_hi:[1,0]
v_pk_mul_f32 v[62:63], v[62:63], v[10:11] op_sel:[0,0] op_sel_hi:[1,0]
v_pk_mul_f32 v[68:69], v[68:69], v[10:11] op_sel:[0,1] op_sel_hi:[1,1]
v_pk_mul_f32 v[70:71], v[70:71], v[10:11] op_sel:[0,1] op_sel_hi:[1,1]
v_pk_mul_f32 v[76:77], v[76:77], v[10:11] op_sel:[0,1] op_sel_hi:[1,1]
v_pk_mul_f32 v[78:79], v[78:79], v[10:11] op_sel:[0,1] op_sel_hi:[1,1]
v_pk_mul_f32 v[84:85], v[84:85], v[10:11] op_sel:[0,1] op_sel_hi:[1,1]
v_pk_mul_f32 v[86:87], v[86:87], v[10:11] op_sel:[0,1] op_sel_hi:[1,1]
v_cvt_pk_bf16_f32 v92, v60, v61
v_cvt_pk_bf16_f32 v93, v62, v63
v_cvt_pk_bf16_f32 v94, v52, v53
v_cvt_pk_bf16_f32 v95, v54, v55
v_cvt_pk_bf16_f32 v100, v68, v69
v_cvt_pk_bf16_f32 v101, v70, v71
v_cvt_pk_bf16_f32 v102, v76, v77
v_cvt_pk_bf16_f32 v103, v78, v79
v_cvt_pk_bf16_f32 v84, v84, v85
v_cvt_pk_bf16_f32 v85, v86, v87
s_waitcnt vmcnt(8)
s_nop 0
v_mfma_f32_16x16x16_bf16 v[116:119], a[192:193], v[84:85], 0
v_mfma_f32_16x16x16_bf16 v[132:135], a[198:199], v[84:85], 0
v_mfma_f32_16x16x16_bf16 v[148:151], a[204:205], v[84:85], 0
v_mfma_f32_16x16x16_bf16 v[164:167], a[210:211], v[84:85], 0
v_mfma_f32_16x16x16_bf16 v[180:183], a[216:217], v[84:85], 0
v_mfma_f32_16x16x16_bf16 v[196:199], a[222:223], v[84:85], 0
v_mfma_f32_16x16x16_bf16 v[212:215], a[228:229], v[84:85], 0
v_mfma_f32_16x16x16_bf16 v[228:231], a[234:235], v[84:85], 0
v_mfma_f32_16x16x32_bf16 v[108:111], a[192:195], v[92:95], 0
v_mfma_f32_16x16x32_bf16 v[124:127], a[198:201], v[92:95], 0
v_mfma_f32_16x16x32_bf16 v[140:143], a[204:207], v[92:95], 0
v_mfma_f32_16x16x32_bf16 v[156:159], a[210:213], v[92:95], 0
v_mfma_f32_16x16x32_bf16 v[172:175], a[216:219], v[92:95], 0
v_mfma_f32_16x16x32_bf16 v[188:191], a[222:225], v[92:95], 0
v_mfma_f32_16x16x32_bf16 v[204:207], a[228:231], v[92:95], 0
v_mfma_f32_16x16x32_bf16 v[220:223], a[234:237], v[92:95], 0
s_add_u32 s70, s23, 0
s_add_u32 s71, s23, 4096
v_mfma_f32_16x16x32_bf16 v[116:119], a[194:197], v[100:103], v[116:119]
v_mfma_f32_16x16x32_bf16 v[132:135], a[200:203], v[100:103], v[132:135]
v_mfma_f32_16x16x32_bf16 v[148:151], a[206:209], v[100:103], v[148:151]
v_mfma_f32_16x16x32_bf16 v[164:167], a[212:215], v[100:103], v[164:167]
v_cvt_pk_bf16_f32 v108, v108, v109
v_cvt_pk_bf16_f32 v109, v110, v111
v_cvt_pk_bf16_f32 v110, v124, v125
v_cvt_pk_bf16_f32 v111, v126, v127
buffer_store_dwordx4 v[108:111], v2, s[4:7], s70 offen offset:0 sc1
v_mfma_f32_16x16x32_bf16 v[180:183], a[218:221], v[100:103], v[180:183]
v_mfma_f32_16x16x32_bf16 v[196:199], a[224:227], v[100:103], v[196:199]
v_cvt_pk_bf16_f32 v140, v140, v141
v_cvt_pk_bf16_f32 v141, v142, v143
v_cvt_pk_bf16_f32 v142, v156, v157
v_cvt_pk_bf16_f32 v143, v158, v159
buffer_store_dwordx4 v[140:143], v2, s[4:7], s70 offen offset:2048 sc1
v_mfma_f32_16x16x32_bf16 v[212:215], a[230:233], v[100:103], v[212:215]
v_mfma_f32_16x16x32_bf16 v[228:231], a[236:239], v[100:103], v[228:231]
v_cvt_pk_bf16_f32 v172, v172, v173
v_cvt_pk_bf16_f32 v173, v174, v175
v_cvt_pk_bf16_f32 v174, v188, v189
v_cvt_pk_bf16_f32 v175, v190, v191
buffer_store_dwordx4 v[172:175], v2, s[4:7], s71 offen offset:0 sc1
buffer_load_dwordx4 a[194:197], v3, s[4:7], s64 offen offset:0
buffer_load_dwordx4 a[200:203], v3, s[4:7], s64 offen offset:128
buffer_load_dwordx4 a[206:209], v3, s[4:7], s64 offen offset:2048
buffer_load_dwordx4 a[212:215], v3, s[4:7], s64 offen offset:2176
buffer_load_dwordx4 a[218:221], v3, s[4:7], s65 offen offset:0
buffer_load_dwordx4 a[224:227], v3, s[4:7], s65 offen offset:128
buffer_load_dwordx4 a[230:233], v3, s[4:7], s65 offen offset:2048
buffer_load_dwordx4 a[236:239], v3, s[4:7], s65 offen offset:2176
s_add_u32 s64, s64, 524288
s_add_u32 s65, s65, 524288
v_cvt_pk_bf16_f32 v204, v204, v205
v_cvt_pk_bf16_f32 v205, v206, v207
v_cvt_pk_bf16_f32 v206, v220, v221
v_cvt_pk_bf16_f32 v207, v222, v223
buffer_store_dwordx4 v[204:207], v2, s[4:7], s71 offen offset:2048 sc1
v_cvt_pk_bf16_f32 v116, v116, v117
v_cvt_pk_bf16_f32 v117, v118, v119
v_cvt_pk_bf16_f32 v118, v132, v133
v_cvt_pk_bf16_f32 v119, v134, v135
buffer_store_dwordx4 v[116:119], v2, s[4:7], s70 offen offset:256 sc1
v_cvt_pk_bf16_f32 v148, v148, v149
v_cvt_pk_bf16_f32 v149, v150, v151
v_cvt_pk_bf16_f32 v150, v164, v165
v_cvt_pk_bf16_f32 v151, v166, v167
buffer_store_dwordx4 v[148:151], v2, s[4:7], s70 offen offset:2304 sc1
v_cvt_pk_bf16_f32 v180, v180, v181
v_cvt_pk_bf16_f32 v181, v182, v183
v_cvt_pk_bf16_f32 v182, v196, v197
v_cvt_pk_bf16_f32 v183, v198, v199
buffer_store_dwordx4 v[180:183], v2, s[4:7], s71 offen offset:256 sc1
v_cvt_pk_bf16_f32 v212, v212, v213
v_cvt_pk_bf16_f32 v213, v214, v215
v_cvt_pk_bf16_f32 v214, v228, v229
v_cvt_pk_bf16_f32 v215, v230, v231
buffer_store_dwordx4 v[212:215], v2, s[4:7], s71 offen offset:2304 sc1
s_add_u32 s31, s31, 1
s_cmp_ge_u32 s31, 58
s_cbranch_scc1 m_g_qs_d0
s_cmp_ge_u32 s22, s31
s_cbranch_scc0 m_g_qs_w0
buffer_load_dwordx4 a[32:35], v4, s[4:7], s66 offen offset:0 sc1
buffer_load_dwordx4 a[36:39], v4, s[4:7], s66 offen offset:512 sc1
buffer_load_dwordx4 a[40:43], v4, s[4:7], s66 offen offset:1024 sc1
buffer_load_dwordx4 a[44:47], v4, s[4:7], s66 offen offset:1536 sc1
s_add_u32 s66, s66, 131072
buffer_load_dwordx2 a[48:49], v5, s[4:7], s67 offen offset:0 sc1
buffer_load_dwordx2 a[54:55], v5, s[4:7], s67 offen offset:128 sc1
buffer_load_dwordx2 a[60:61], v5, s[4:7], s67 offen offset:512 sc1
buffer_load_dwordx2 a[66:67], v5, s[4:7], s67 offen offset:640 sc1
buffer_load_dwordx2 a[72:73], v5, s[4:7], s67 offen offset:1024 sc1
buffer_load_dwordx2 a[78:79], v5, s[4:7], s67 offen offset:1152 sc1
buffer_load_dwordx2 a[84:85], v5, s[4:7], s67 offen offset:1536 sc1
buffer_load_dwordx2 a[90:91], v5, s[4:7], s67 offen offset:1664 sc1
s_add_u32 s67, s67, 131072
s_waitcnt vmcnt(12)
v_mov_b32 v28, 1
buffer_store_dword v28, v45, s[4:7], s21 offen sc1
s_branch m_g_qs_j0
m_g_qs_d0:
buffer_load_dwordx4 a[32:35], v4, s[4:7], s66 offen offset:0 sc1
buffer_load_dwordx4 a[36:39], v4, s[4:7], s66 offen offset:512 sc1
buffer_load_dwordx4 a[40:43], v4, s[4:7], s66 offen offset:1024 sc1
buffer_load_dwordx4 a[44:47], v4, s[4:7], s66 offen offset:1536 sc1
s_add_u32 s66, s66, 131072
buffer_load_dwordx2 a[48:49], v5, s[4:7], s67 offen offset:0 sc1
buffer_load_dwordx2 a[54:55], v5, s[4:7], s67 offen offset:128 sc1
buffer_load_dwordx2 a[60:61], v5, s[4:7], s67 offen offset:512 sc1
buffer_load_dwordx2 a[66:67], v5, s[4:7], s67 offen offset:640 sc1
buffer_load_dwordx2 a[72:73], v5, s[4:7], s67 offen offset:1024 sc1
buffer_load_dwordx2 a[78:79], v5, s[4:7], s67 offen offset:1152 sc1
buffer_load_dwordx2 a[84:85], v5, s[4:7], s67 offen offset:1536 sc1
buffer_load_dwordx2 a[90:91], v5, s[4:7], s67 offen offset:1664 sc1
s_add_u32 s67, s67, 131072
s_waitcnt vmcnt(12)
v_mov_b32 v28, 1
buffer_store_dword v28, v45, s[4:7], s21 offen sc1
s_waitcnt vmcnt(1)
s_branch m_g_qs_c1
m_g_qs_r1:
s_sub_u32 s66, s66, 131072
s_sub_u32 s67, s67, 131072
buffer_load_dwordx4 a[32:35], v4, s[4:7], s66 offen offset:0 sc1
buffer_load_dwordx4 a[36:39], v4, s[4:7], s66 offen offset:512 sc1
buffer_load_dwordx4 a[40:43], v4, s[4:7], s66 offen offset:1024 sc1
buffer_load_dwordx4 a[44:47], v4, s[4:7], s66 offen offset:1536 sc1
s_add_u32 s66, s66, 131072
buffer_load_dwordx2 a[48:49], v5, s[4:7], s67 offen offset:0 sc1
buffer_load_dwordx2 a[54:55], v5, s[4:7], s67 offen offset:128 sc1
buffer_load_dwordx2 a[60:61], v5, s[4:7], s67 offen offset:512 sc1
buffer_load_dwordx2 a[66:67], v5, s[4:7], s67 offen offset:640 sc1
buffer_load_dwordx2 a[72:73], v5, s[4:7], s67 offen offset:1024 sc1
buffer_load_dwordx2 a[78:79], v5, s[4:7], s67 offen offset:1152 sc1
buffer_load_dwordx2 a[84:85], v5, s[4:7], s67 offen offset:1536 sc1
buffer_load_dwordx2 a[90:91], v5, s[4:7], s67 offen offset:1664 sc1
s_add_u32 s67, s67, 131072
s_waitcnt vmcnt(0)
m_g_qs_c1:
v_accvgpr_read_b32 v46, a32
v_accvgpr_read_b32 v44, a36
v_max_u32 v46, v46, v44
v_accvgpr_read_b32 v44, a40
v_accvgpr_read_b32 v47, a44
v_max3_u32 v46, v46, v44, v47
v_accvgpr_read_b32 v44, a48
v_accvgpr_read_b32 v47, a54
v_max3_u32 v46, v46, v44, v47
v_accvgpr_read_b32 v44, a60
v_accvgpr_read_b32 v47, a66
v_max3_u32 v46, v46, v44, v47
v_accvgpr_read_b32 v44, a72
v_accvgpr_read_b32 v47, a78
v_max3_u32 v46, v46, v44, v47
v_accvgpr_read_b32 v44, a84
v_accvgpr_read_b32 v47, a90
v_max3_u32 v46, v46, v44, v47
v_cmp_eq_u32 vcc, -1, v46
s_cbranch_vccz m_g_qs_j0
s_cmp_eq_u32 s17, 0
s_cbranch_scc1 m_g_qs_j0
s_sub_u32 s17, s17, 1
s_branch m_g_qs_r1
m_g_qs_w0:
s_waitcnt vmcnt(0)
v_mov_b32 v28, 1
buffer_store_dword v28, v45, s[4:7], s21 offen sc1
v_mov_b32 v44, 0
m_g_qs_p1:
buffer_load_dword v46, v44, s[4:7], s30 offen sc1
s_waitcnt vmcnt(0)
v_readfirstlane_b32 s71, v46
s_cmp_ge_u32 s71, s31
s_cbranch_scc1 m_g_qs_p1_d
s_cmp_eq_u32 s17, 0
s_cbranch_scc1 m_g_qs_p1_d
s_sub_u32 s17, s17, 1
s_branch m_g_qs_p1
m_g_qs_p1_d:
s_mov_b32 s22, s71
buffer_load_dwordx4 a[32:35], v4, s[4:7], s66 offen offset:0 sc1
buffer_load_dwordx4 a[36:39], v4, s[4:7], s66 offen offset:512 sc1
buffer_load_dwordx4 a[40:43], v4, s[4:7], s66 offen offset:1024 sc1
buffer_load_dwordx4 a[44:47], v4, s[4:7], s66 offen offset:1536 sc1
s_add_u32 s66, s66, 131072
buffer_load_dwordx2 a[48:49], v5, s[4:7], s67 offen offset:0 sc1
buffer_load_dwordx2 a[54:55], v5, s[4:7], s67 offen offset:128 sc1
buffer_load_dwordx2 a[60:61], v5, s[4:7], s67 offen offset:512 sc1
buffer_load_dwordx2 a[66:67], v5, s[4:7], s67 offen offset:640 sc1
buffer_load_dwordx2 a[72:73], v5, s[4:7], s67 offen offset:1024 sc1
buffer_load_dwordx2 a[78:79], v5, s[4:7], s67 offen offset:1152 sc1
buffer_load_dwordx2 a[84:85], v5, s[4:7], s67 offen offset:1536 sc1
buffer_load_dwordx2 a[90:91], v5, s[4:7], s67 offen offset:1664 sc1
s_add_u32 s67, s67, 131072
m_g_qs_j0:
s_waitcnt vmcnt(8)
v_mfma_f32_16x16x32_bf16 v[236:239], a[0:3], v[80:83], v[6:9]
v_mfma_f32_16x16x32_bf16 v[244:247], a[32:35], v[80:83], v[12:15]
v_mfma_f32_16x16x32_bf16 v[252:255], a[0:3], v[112:115], 0
v_mfma_f32_16x16x32_bf16 v[16:19], a[16:19], v[112:115], v[6:9]
v_mfma_f32_16x16x32_bf16 v[48:51], a[32:35], v[112:115], v[12:15]
v_mfma_f32_16x16x32_bf16 v[236:239], a[4:7], v[88:91], v[236:239]
v_mfma_f32_16x16x32_bf16 v[244:247], a[36:39], v[88:91], v[244:247]
v_mfma_f32_16x16x32_bf16 v[252:255], a[4:7], v[120:123], v[252:255]
v_mfma_f32_16x16x32_bf16 v[16:19], a[20:23], v[120:123], v[16:19]
v_mfma_f32_16x16x32_bf16 v[48:51], a[36:39], v[120:123], v[48:51]
v_mfma_f32_16x16x32_bf16 v[236:239], a[8:11], v[96:99], v[236:239]
v_mfma_f32_16x16x32_bf16 v[244:247], a[40:43], v[96:99], v[244:247]
v_mfma_f32_16x16x32_bf16 v[252:255], a[8:11], v[128:131], v[252:255]
v_mfma_f32_16x16x32_bf16 v[16:19], a[24:27], v[128:131], v[16:19]
v_mfma_f32_16x16x32_bf16 v[48:51], a[40:43], v[128:131], v[48:51]
v_mfma_f32_16x16x32_bf16 v[236:239], a[12:15], v[104:107], v[236:239]
v_mfma_f32_16x16x32_bf16 v[244:247], a[44:47], v[104:107], v[244:247]
v_mfma_f32_16x16x32_bf16 v[252:255], a[12:15], v[136:139], v[252:255]
v_mfma_f32_16x16x32_bf16 v[16:19], a[28:31], v[136:139], v[16:19]
v_mfma_f32_16x16x32_bf16 v[48:51], a[44:47], v[136:139], v[48:51]
buffer_load_dwordx4 a[0:3], v2, s[4:7], s62 offen offset:0
buffer_load_dwordx4 a[16:19], v2, s[4:7], s62 offen offset:256
buffer_load_dwordx4 a[4:7], v2, s[4:7], s62 offen offset:2048
buffer_load_dwordx4 a[20:23], v2, s[4:7], s62 offen offset:2304
buffer_load_dwordx4 a[8:11], v2, s[4:7], s63 offen offset:0
buffer_load_dwordx4 a[24:27], v2, s[4:7], s63 offen offset:256
buffer_load_dwordx4 a[12:15], v2, s[4:7], s63 offen offset:2048
buffer_load_dwordx4 a[28:31], v2, s[4:7], s63 offen offset:2304
s_add_u32 s62, s62, 524288
s_add_u32 s63, s63, 524288
v_max3_f32 v10, v236, v237, v238
v_max3_f32 v10, v10, v239, v244
v_max3_f32 v10, v10, v245, v246
v_max_f32 v10, v10, v247
v_max3_f32 v11, v252, v253, v254
v_max3_f32 v11, v11, v255, v16
v_max3_f32 v11, v11, v17, v18
v_max3_f32 v11, v11, v19, v48
v_max3_f32 v11, v11, v49, v50
v_max_f32 v11, v11, v51
s_nop 1
v_permlane32_swap_b32 v10, v11
v_max_f32 v10, v10, v11
v_mov_b32 v11, v10
s_nop 1
v_permlane16_swap_b32 v10, v11
v_max_f32 v10, v10, v11
v_mul_f32 v10, s68, v10
v_mov_b32 v11, v10
s_nop 1
v_permlane32_swap_b32 v10, v11
v_pk_fma_f32 v[236:237], v[236:237], s[68:69], v[10:11] op_sel:[0,0,0] op_sel_hi:[1,1,0] neg_lo:[0,0,1] neg_hi:[0,0,1]
v_pk_fma_f32 v[238:239], v[238:239], s[68:69], v[10:11] op_sel:[0,0,0] op_sel_hi:[1,1,0] neg_lo:[0,0,1] neg_hi:[0,0,1]
v_pk_fma_f32 v[244:245], v[244:245], s[68:69], v[10:11] op_sel:[0,0,0] op_sel_hi:[1,1,0] neg_lo:[0,0,1] neg_hi:[0,0,1]
v_pk_fma_f32 v[246:247], v[246:247], s[68:69], v[10:11] op_sel:[0,0,0] op_sel_hi:[1,1,0] neg_lo:[0,0,1] neg_hi:[0,0,1]
v_pk_fma_f32 v[252:253], v[252:253], s[68:69], v[10:11] op_sel:[0,0,1] op_sel_hi:[1,1,1] neg_lo:[0,0,1] neg_hi:[0,0,1]
v_pk_fma_f32 v[254:255], v[254:255], s[68:69], v[10:11] op_sel:[0,0,1] op_sel_hi:[1,1,1] neg_lo:[0,0,1] neg_hi:[0,0,1]
v_pk_fma_f32 v[16:17], v[16:17], s[68:69], v[10:11] op_sel:[0,0,1] op_sel_hi:[1,1,1] neg_lo:[0,0,1] neg_hi:[0,0,1]
v_pk_fma_f32 v[18:19], v[18:19], s[68:69], v[10:11] op_sel:[0,0,1] op_sel_hi:[1,1,1] neg_lo:[0,0,1] neg_hi:[0,0,1]
v_pk_fma_f32 v[48:49], v[48:49], s[68:69], v[10:11] op_sel:[0,0,1] op_sel_hi:[1,1,1] neg_lo:[0,0,1] neg_hi:[0,0,1]
v_pk_fma_f32 v[50:51], v[50:51], s[68:69], v[10:11] op_sel:[0,0,1] op_sel_hi:[1,1,1] neg_lo:[0,0,1] neg_hi:[0,0,1]
v_exp_f32 v236, v236
v_exp_f32 v237, v237
v_exp_f32 v238, v238
v_exp_f32 v239, v239
v_exp_f32 v244, v244
v_exp_f32 v245, v245
v_exp_f32 v246, v246
v_exp_f32 v247, v247
v_exp_f32 v252, v252
v_exp_f32 v253, v253
v_exp_f32 v254, v254
v_exp_f32 v255, v255
v_exp_f32 v16, v16
v_exp_f32 v17, v17
v_exp_f32 v18, v18
v_exp_f32 v19, v19
v_exp_f32 v48, v48
v_exp_f32 v49, v49
v_exp_f32 v50, v50
v_exp_f32 v51, v51
v_pk_add_f32 v[24:25], v[236:237], v[238:239]
v_pk_add_f32 v[26:27], v[244:245], v[246:247]
v_pk_add_f32 v[56:57], v[252:253], v[254:255]
v_pk_add_f32 v[58:59], v[16:17], v[18:19]
v_pk_add_f32 v[24:25], v[24:25], v[26:27]
v_pk_add_f32 v[56:57], v[56:57], v[58:59]
v_pk_add_f32 v[58:59], v[48:49], v[50:51]
v_add_f32 v10, v24, v25
v_pk_add_f32 v[56:57], v[56:57], v[58:59]
v_add_f32 v11, v56, v57
s_nop 1
v_permlane32_swap_b32 v10, v11
v_add_f32 v10, v10, v11
v_mov_b32 v11, v10
s_nop 1
v_permlane16_swap_b32 v10, v11
v_add_f32 v10, v10, v11
v_rcp_f32 v10, v10
s_nop 0
v_mov_b32 v11, v10
s_nop 1
v_permlane32_swap_b32 v10, v11
v_pk_mul_f32 v[236:237], v[236:237], v[10:11] op_sel:[0,0] op_sel_hi:[1,0]
v_pk_mul_f32 v[238:239], v[238:239], v[10:11] op_sel:[0,0] op_sel_hi:[1,0]
v_pk_mul_f32 v[244:245], v[244:245], v[10:11] op_sel:[0,0] op_sel_hi:[1,0]
v_pk_mul_f32 v[246:247], v[246:247], v[10:11] op_sel:[0,0] op_sel_hi:[1,0]
v_pk_mul_f32 v[252:253], v[252:253], v[10:11] op_sel:[0,1] op_sel_hi:[1,1]
v_pk_mul_f32 v[254:255], v[254:255], v[10:11] op_sel:[0,1] op_sel_hi:[1,1]
v_pk_mul_f32 v[16:17], v[16:17], v[10:11] op_sel:[0,1] op_sel_hi:[1,1]
v_pk_mul_f32 v[18:19], v[18:19], v[10:11] op_sel:[0,1] op_sel_hi:[1,1]
v_pk_mul_f32 v[48:49], v[48:49], v[10:11] op_sel:[0,1] op_sel_hi:[1,1]
v_pk_mul_f32 v[50:51], v[50:51], v[10:11] op_sel:[0,1] op_sel_hi:[1,1]
v_cvt_pk_bf16_f32 v24, v244, v245
v_cvt_pk_bf16_f32 v25, v246, v247
v_cvt_pk_bf16_f32 v26, v236, v237
v_cvt_pk_bf16_f32 v27, v238, v239
v_cvt_pk_bf16_f32 v56, v252, v253
v_cvt_pk_bf16_f32 v57, v254, v255
v_cvt_pk_bf16_f32 v58, v16, v17
v_cvt_pk_bf16_f32 v59, v18, v19
v_cvt_pk_bf16_f32 v48, v48, v49
v_cvt_pk_bf16_f32 v49, v50, v51
s_waitcnt vmcnt(8)
s_nop 0
v_mfma_f32_16x16x16_bf16 v[64:67], a[48:49], v[48:49], 0
v_mfma_f32_16x16x16_bf16 v[72:75], a[54:55], v[48:49], 0
v_mfma_f32_16x16x16_bf16 v[60:63], a[60:61], v[48:49], 0
v_mfma_f32_16x16x16_bf16 v[76:79], a[66:67], v[48:49], 0
v_mfma_f32_16x16x16_bf16 v[100:103], a[72:73], v[48:49], 0
v_mfma_f32_16x16x16_bf16 v[108:111], a[78:79], v[48:49], 0
v_mfma_f32_16x16x16_bf16 v[124:127], a[84:85], v[48:49], 0
v_mfma_f32_16x16x16_bf16 v[140:143], a[90:91], v[48:49], 0
v_mfma_f32_16x16x32_bf16 v[32:35], a[48:51], v[24:27], 0
v_mfma_f32_16x16x32_bf16 v[40:43], a[54:57], v[24:27], 0
v_mfma_f32_16x16x32_bf16 v[52:55], a[60:63], v[24:27], 0
v_mfma_f32_16x16x32_bf16 v[68:71], a[66:69], v[24:27], 0
v_mfma_f32_16x16x32_bf16 v[92:95], a[72:75], v[24:27], 0
v_mfma_f32_16x16x32_bf16 v[84:87], a[78:81], v[24:27], 0
v_mfma_f32_16x16x32_bf16 v[116:119], a[84:87], v[24:27], 0
v_mfma_f32_16x16x32_bf16 v[132:135], a[90:93], v[24:27], 0
s_add_u32 s70, s23, 262144
s_add_u32 s71, s23, 266240
v_mfma_f32_16x16x32_bf16 v[64:67], a[50:53], v[56:59], v[64:67]
v_mfma_f32_16x16x32_bf16 v[72:75], a[56:59], v[56:59], v[72:75]
v_mfma_f32_16x16x32_bf16 v[60:63], a[62:65], v[56:59], v[60:63]
v_mfma_f32_16x16x32_bf16 v[76:79], a[68:71], v[56:59], v[76:79]
v_cvt_pk_bf16_f32 v32, v32, v33
v_cvt_pk_bf16_f32 v33, v34, v35
v_cvt_pk_bf16_f32 v34, v40, v41
v_cvt_pk_bf16_f32 v35, v42, v43
buffer_store_dwordx4 v[32:35], v2, s[4:7], s70 offen offset:0 sc1
v_mfma_f32_16x16x32_bf16 v[100:103], a[74:77], v[56:59], v[100:103]
v_mfma_f32_16x16x32_bf16 v[108:111], a[80:83], v[56:59], v[108:111]
v_cvt_pk_bf16_f32 v52, v52, v53
v_cvt_pk_bf16_f32 v53, v54, v55
v_cvt_pk_bf16_f32 v54, v68, v69
v_cvt_pk_bf16_f32 v55, v70, v71
buffer_store_dwordx4 v[52:55], v2, s[4:7], s70 offen offset:2048 sc1
v_mfma_f32_16x16x32_bf16 v[124:127], a[86:89], v[56:59], v[124:127]
v_mfma_f32_16x16x32_bf16 v[140:143], a[92:95], v[56:59], v[140:143]
v_cvt_pk_bf16_f32 v92, v92, v93
v_cvt_pk_bf16_f32 v93, v94, v95
v_cvt_pk_bf16_f32 v94, v84, v85
v_cvt_pk_bf16_f32 v95, v86, v87
buffer_store_dwordx4 v[92:95], v2, s[4:7], s71 offen offset:0 sc1
buffer_load_dwordx4 a[50:53], v3, s[4:7], s64 offen offset:0
buffer_load_dwordx4 a[56:59], v3, s[4:7], s64 offen offset:128
buffer_load_dwordx4 a[62:65], v3, s[4:7], s64 offen offset:2048
buffer_load_dwordx4 a[68:71], v3, s[4:7], s64 offen offset:2176
buffer_load_dwordx4 a[74:77], v3, s[4:7], s65 offen offset:0
buffer_load_dwordx4 a[80:83], v3, s[4:7], s65 offen offset:128
buffer_load_dwordx4 a[86:89], v3, s[4:7], s65 offen offset:2048
buffer_load_dwordx4 a[92:95], v3, s[4:7], s65 offen offset:2176
s_add_u32 s64, s64, 524288
s_add_u32 s65, s65, 524288
v_cvt_pk_bf16_f32 v116, v116, v117
v_cvt_pk_bf16_f32 v117, v118, v119
v_cvt_pk_bf16_f32 v118, v132, v133
v_cvt_pk_bf16_f32 v119, v134, v135
buffer_store_dwordx4 v[116:119], v2, s[4:7], s71 offen offset:2048 sc1
v_cvt_pk_bf16_f32 v64, v64, v65
v_cvt_pk_bf16_f32 v65, v66, v67
v_cvt_pk_bf16_f32 v66, v72, v73
v_cvt_pk_bf16_f32 v67, v74, v75
buffer_store_dwordx4 v[64:67], v2, s[4:7], s70 offen offset:256 sc1
v_cvt_pk_bf16_f32 v60, v60, v61
v_cvt_pk_bf16_f32 v61, v62, v63
v_cvt_pk_bf16_f32 v62, v76, v77
v_cvt_pk_bf16_f32 v63, v78, v79
buffer_store_dwordx4 v[60:63], v2, s[4:7], s70 offen offset:2304 sc1
v_cvt_pk_bf16_f32 v100, v100, v101
v_cvt_pk_bf16_f32 v101, v102, v103
v_cvt_pk_bf16_f32 v102, v108, v109
v_cvt_pk_bf16_f32 v103, v110, v111
buffer_store_dwordx4 v[100:103], v2, s[4:7], s71 offen offset:256 sc1
v_cvt_pk_bf16_f32 v124, v124, v125
v_cvt_pk_bf16_f32 v125, v126, v127
v_cvt_pk_bf16_f32 v126, v140, v141
v_cvt_pk_bf16_f32 v127, v142, v143
buffer_store_dwordx4 v[124:127], v2, s[4:7], s71 offen offset:2304 sc1
s_add_u32 s31, s31, 1
s_cmp_ge_u32 s31, 58
s_cbranch_scc1 m_g_qs_d1
s_cmp_ge_u32 s22, s31
s_cbranch_scc0 m_g_qs_w1
buffer_load_dwordx4 a[176:179], v4, s[4:7], s66 offen offset:0 sc1
buffer_load_dwordx4 a[180:183], v4, s[4:7], s66 offen offset:512 sc1
buffer_load_dwordx4 a[184:187], v4, s[4:7], s66 offen offset:1024 sc1
buffer_load_dwordx4 a[188:191], v4, s[4:7], s66 offen offset:1536 sc1
s_add_u32 s66, s66, 131072
buffer_load_dwordx2 a[192:193], v5, s[4:7], s67 offen offset:0 sc1
buffer_load_dwordx2 a[198:199], v5, s[4:7], s67 offen offset:128 sc1
buffer_load_dwordx2 a[204:205], v5, s[4:7], s67 offen offset:512 sc1
buffer_load_dwordx2 a[210:211], v5, s[4:7], s67 offen offset:640 sc1
buffer_load_dwordx2 a[216:217], v5, s[4:7], s67 offen offset:1024 sc1
buffer_load_dwordx2 a[222:223], v5, s[4:7], s67 offen offset:1152 sc1
buffer_load_dwordx2 a[228:229], v5, s[4:7], s67 offen offset:1536 sc1
buffer_load_dwordx2 a[234:235], v5, s[4:7], s67 offen offset:1664 sc1
s_add_u32 s67, s67, 131072
s_waitcnt vmcnt(12)
v_mov_b32 v28, 2
buffer_store_dword v28, v45, s[4:7], s21 offen sc1
s_branch m_g_qs_j1
m_g_qs_d1:
buffer_load_dwordx4 a[176:179], v4, s[4:7], s66 offen offset:0 sc1
buffer_load_dwordx4 a[180:183], v4, s[4:7], s66 offen offset:512 sc1
buffer_load_dwordx4 a[184:187], v4, s[4:7], s66 offen offset:1024 sc1
buffer_load_dwordx4 a[188:191], v4, s[4:7], s66 offen offset:1536 sc1
s_add_u32 s66, s66, 131072
buffer_load_dwordx2 a[192:193], v5, s[4:7], s67 offen offset:0 sc1
buffer_load_dwordx2 a[198:199], v5, s[4:7], s67 offen offset:128 sc1
buffer_load_dwordx2 a[204:205], v5, s[4:7], s67 offen offset:512 sc1
buffer_load_dwordx2 a[210:211], v5, s[4:7], s67 offen offset:640 sc1
buffer_load_dwordx2 a[216:217], v5, s[4:7], s67 offen offset:1024 sc1
buffer_load_dwordx2 a[222:223], v5, s[4:7], s67 offen offset:1152 sc1
buffer_load_dwordx2 a[228:229], v5, s[4:7], s67 offen offset:1536 sc1
buffer_load_dwordx2 a[234:235], v5, s[4:7], s67 offen offset:1664 sc1
s_add_u32 s67, s67, 131072
s_waitcnt vmcnt(12)
v_mov_b32 v28, 2
buffer_store_dword v28, v45, s[4:7], s21 offen sc1
s_waitcnt vmcnt(1)
s_branch m_g_qs_c2
m_g_qs_r2:
s_sub_u32 s66, s66, 131072
s_sub_u32 s67, s67, 131072
buffer_load_dwordx4 a[176:179], v4, s[4:7], s66 offen offset:0 sc1
buffer_load_dwordx4 a[180:183], v4, s[4:7], s66 offen offset:512 sc1
buffer_load_dwordx4 a[184:187], v4, s[4:7], s66 offen offset:1024 sc1
buffer_load_dwordx4 a[188:191], v4, s[4:7], s66 offen offset:1536 sc1
s_add_u32 s66, s66, 131072
buffer_load_dwordx2 a[192:193], v5, s[4:7], s67 offen offset:0 sc1
buffer_load_dwordx2 a[198:199], v5, s[4:7], s67 offen offset:128 sc1
buffer_load_dwordx2 a[204:205], v5, s[4:7], s67 offen offset:512 sc1
buffer_load_dwordx2 a[210:211], v5, s[4:7], s67 offen offset:640 sc1
buffer_load_dwordx2 a[216:217], v5, s[4:7], s67 offen offset:1024 sc1
buffer_load_dwordx2 a[222:223], v5, s[4:7], s67 offen offset:1152 sc1
buffer_load_dwordx2 a[228:229], v5, s[4:7], s67 offen offset:1536 sc1
buffer_load_dwordx2 a[234:235], v5, s[4:7], s67 offen offset:1664 sc1
s_add_u32 s67, s67, 131072
s_waitcnt vmcnt(0)
m_g_qs_c2:
v_accvgpr_read_b32 v46, a176
v_accvgpr_read_b32 v44, a180
v_max_u32 v46, v46, v44
v_accvgpr_read_b32 v44, a184
v_accvgpr_read_b32 v47, a188
v_max3_u32 v46, v46, v44, v47
v_accvgpr_read_b32 v44, a192
v_accvgpr_read_b32 v47, a198
v_max3_u32 v46, v46, v44, v47
v_accvgpr_read_b32 v44, a204
v_accvgpr_read_b32 v47, a210
v_max3_u32 v46, v46, v44, v47
v_accvgpr_read_b32 v44, a216
v_accvgpr_read_b32 v47, a222
v_max3_u32 v46, v46, v44, v47
v_accvgpr_read_b32 v44, a228
v_accvgpr_read_b32 v47, a234
v_max3_u32 v46, v46, v44, v47
v_cmp_eq_u32 vcc, -1, v46
s_cbranch_vccz m_g_qs_j1
s_cmp_eq_u32 s17, 0
s_cbranch_scc1 m_g_qs_j1
s_sub_u32 s17, s17, 1
s_branch m_g_qs_r2
m_g_qs_w1:
s_waitcnt vmcnt(0)
v_mov_b32 v28, 2
buffer_store_dword v28, v45, s[4:7], s21 offen sc1
v_mov_b32 v44, 0
m_g_qs_p2:
buffer_load_dword v46, v44, s[4:7], s30 offen sc1
s_waitcnt vmcnt(0)
v_readfirstlane_b32 s71, v46
s_cmp_ge_u32 s71, s31
s_cbranch_scc1 m_g_qs_p2_d
s_cmp_eq_u32 s17, 0
s_cbranch_scc1 m_g_qs_p2_d
s_sub_u32 s17, s17, 1
s_branch m_g_qs_p2
m_g_qs_p2_d:
s_mov_b32 s22, s71
buffer_load_dwordx4 a[176:179], v4, s[4:7], s66 offen offset:0 sc1
buffer_load_dwordx4 a[180:183], v4, s[4:7], s66 offen offset:512 sc1
buffer_load_dwordx4 a[184:187], v4, s[4:7], s66 offen offset:1024 sc1
buffer_load_dwordx4 a[188:191], v4, s[4:7], s66 offen offset:1536 sc1
s_add_u32 s66, s66, 131072
buffer_load_dwordx2 a[192:193], v5, s[4:7], s67 offen offset:0 sc1
buffer_load_dwordx2 a[198:199], v5, s[4:7], s67 offen offset:128 sc1
buffer_load_dwordx2 a[204:205], v5, s[4:7], s67 offen offset:512 sc1
buffer_load_dwordx2 a[210:211], v5, s[4:7], s67 offen offset:640 sc1
buffer_load_dwordx2 a[216:217], v5, s[4:7], s67 offen offset:1024 sc1
buffer_load_dwordx2 a[222:223], v5, s[4:7], s67 offen offset:1152 sc1
buffer_load_dwordx2 a[228:229], v5, s[4:7], s67 offen offset:1536 sc1
buffer_load_dwordx2 a[234:235], v5, s[4:7], s67 offen offset:1664 sc1
s_add_u32 s67, s67, 131072
m_g_qs_j1:
s_waitcnt vmcnt(8)
v_mfma_f32_16x16x32_bf16 v[148:151], a[144:147], v[144:147], v[6:9]
v_mfma_f32_16x16x32_bf16 v[156:159], a[176:179], v[144:147], v[12:15]
v_mfma_f32_16x16x32_bf16 v[164:167], a[144:147], v[176:179], 0
v_mfma_f32_16x16x32_bf16 v[172:175], a[160:163], v[176:179], v[6:9]
v_mfma_f32_16x16x32_bf16 v[180:183], a[176:179], v[176:179], v[12:15]
v_mfma_f32_16x16x32_bf16 v[148:151], a[148:151], v[152:155], v[148:151]
v_mfma_f32_16x16x32_bf16 v[156:159], a[180:183], v[152:155], v[156:159]
v_mfma_f32_16x16x32_bf16 v[164:167], a[148:151], v[184:187], v[164:167]
v_mfma_f32_16x16x32_bf16 v[172:175], a[164:167], v[184:187], v[172:175]
v_mfma_f32_16x16x32_bf16 v[180:183], a[180:183], v[184:187], v[180:183]
v_mfma_f32_16x16x32_bf16 v[148:151], a[152:155], v[160:163], v[148:151]
v_mfma_f32_16x16x32_bf16 v[156:159], a[184:187], v[160:163], v[156:159]
v_mfma_f32_16x16x32_bf16 v[164:167], a[152:155], v[192:195], v[164:167]
v_mfma_f32_16x16x32_bf16 v[172:175], a[168:171], v[192:195], v[172:175]
v_mfma_f32_16x16x32_bf16 v[180:183], a[184:187], v[192:195], v[180:183]
v_mfma_f32_16x16x32_bf16 v[148:151], a[156:159], v[168:171], v[148:151]
v_mfma_f32_16x16x32_bf16 v[156:159], a[188:191], v[168:171], v[156:159]
v_mfma_f32_16x16x32_bf16 v[164:167], a[156:159], v[200:203], v[164:167]
v_mfma_f32_16x16x32_bf16 v[172:175], a[172:175], v[200:203], v[172:175]
v_mfma_f32_16x16x32_bf16 v[180:183], a[188:191], v[200:203], v[180:183]
v_max3_f32 v10, v148, v149, v150
v_max3_f32 v10, v10, v151, v156
v_max3_f32 v10, v10, v157, v158
v_max_f32 v10, v10, v159
v_max3_f32 v11, v164, v165, v166
v_max3_f32 v11, v11, v167, v172
v_max3_f32 v11, v11, v173, v174
s_nop 0
v_max3_f32 v11, v11, v175, v180
v_max3_f32 v11, v11, v181, v182
v_max_f32 v11, v11, v183
s_nop 1
v_permlane32_swap_b32 v10, v11
v_max_f32 v10, v10, v11
v_mov_b32 v11, v10
s_nop 1
v_permlane16_swap_b32 v10, v11
v_max_f32 v10, v10, v11
v_mul_f32 v10, s68, v10
v_mov_b32 v11, v10
s_nop 1
v_permlane32_swap_b32 v10, v11
v_pk_fma_f32 v[148:149], v[148:149], s[68:69], v[10:11] op_sel:[0,0,0] op_sel_hi:[1,1,0] neg_lo:[0,0,1] neg_hi:[0,0,1]
v_pk_fma_f32 v[150:151], v[150:151], s[68:69], v[10:11] op_sel:[0,0,0] op_sel_hi:[1,1,0] neg_lo:[0,0,1] neg_hi:[0,0,1]
v_pk_fma_f32 v[156:157], v[156:157], s[68:69], v[10:11] op_sel:[0,0,0] op_sel_hi:[1,1,0] neg_lo:[0,0,1] neg_hi:[0,0,1]
v_pk_fma_f32 v[158:159], v[158:159], s[68:69], v[10:11] op_sel:[0,0,0] op_sel_hi:[1,1,0] neg_lo:[0,0,1] neg_hi:[0,0,1]
v_pk_fma_f32 v[164:165], v[164:165], s[68:69], v[10:11] op_sel:[0,0,1] op_sel_hi:[1,1,1] neg_lo:[0,0,1] neg_hi:[0,0,1]
v_pk_fma_f32 v[166:167], v[166:167], s[68:69], v[10:11] op_sel:[0,0,1] op_sel_hi:[1,1,1] neg_lo:[0,0,1] neg_hi:[0,0,1]
v_pk_fma_f32 v[172:173], v[172:173], s[68:69], v[10:11] op_sel:[0,0,1] op_sel_hi:[1,1,1] neg_lo:[0,0,1] neg_hi:[0,0,1]
v_pk_fma_f32 v[174:175], v[174:175], s[68:69], v[10:11] op_sel:[0,0,1] op_sel_hi:[1,1,1] neg_lo:[0,0,1] neg_hi:[0,0,1]
v_pk_fma_f32 v[180:181], v[180:181], s[68:69], v[10:11] op_sel:[0,0,1] op_sel_hi:[1,1,1] neg_lo:[0,0,1] neg_hi:[0,0,1]
v_pk_fma_f32 v[182:183], v[182:183], s[68:69], v[10:11] op_sel:[0,0,1] op_sel_hi:[1,1,1] neg_lo:[0,0,1] neg_hi:[0,0,1]
v_exp_f32 v148, v148
v_exp_f32 v149, v149
v_exp_f32 v150, v150
v_exp_f32 v151, v151
v_exp_f32 v156, v156
v_exp_f32 v157, v157
v_exp_f32 v158, v158
v_exp_f32 v159, v159
v_exp_f32 v164, v164
v_exp_f32 v165, v165
v_exp_f32 v166, v166
v_exp_f32 v167, v167
v_exp_f32 v172, v172
v_exp_f32 v173, v173
v_exp_f32 v174, v174
v_exp_f32 v175, v175
v_exp_f32 v180, v180
v_exp_f32 v181, v181
v_exp_f32 v182, v182
v_exp_f32 v183, v183
v_pk_add_f32 v[188:189], v[148:149], v[150:151]
v_pk_add_f32 v[190:191], v[156:157], v[158:159]
v_pk_add_f32 v[196:197], v[164:165], v[166:167]
v_pk_add_f32 v[198:199], v[172:173], v[174:175]
v_pk_add_f32 v[188:189], v[188:189], v[190:191]
v_pk_add_f32 v[196:197], v[196:197], v[198:199]
v_pk_add_f32 v[198:199], v[180:181], v[182:183]
v_add_f32 v10, v188, v189
v_pk_add_f32 v[196:197], v[196:197], v[198:199]
v_add_f32 v11, v196, v197
s_nop 1
v_permlane32_swap_b32 v10, v11
v_add_f32 v10, v10, v11
v_mov_b32 v11, v10
s_nop 1
v_permlane16_swap_b32 v10, v11
v_add_f32 v10, v10, v11
v_rcp_f32 v10, v10
s_nop 0
v_mov_b32 v11, v10
s_nop 1
v_permlane32_swap_b32 v10, v11
v_pk_mul_f32 v[148:149], v[148:149], v[10:11] op_sel:[0,0] op_sel_hi:[1,0]
v_pk_mul_f32 v[150:151], v[150:151], v[10:11] op_sel:[0,0] op_sel_hi:[1,0]
v_pk_mul_f32 v[156:157], v[156:157], v[10:11] op_sel:[0,0] op_sel_hi:[1,0]
v_pk_mul_f32 v[158:159], v[158:159], v[10:11] op_sel:[0,0] op_sel_hi:[1,0]
v_pk_mul_f32 v[164:165], v[164:165], v[10:11] op_sel:[0,1] op_sel_hi:[1,1]
v_pk_mul_f32 v[166:167], v[166:167], v[10:11] op_sel:[0,1] op_sel_hi:[1,1]
v_pk_mul_f32 v[172:173], v[172:173], v[10:11] op_sel:[0,1] op_sel_hi:[1,1]
v_pk_mul_f32 v[174:175], v[174:175], v[10:11] op_sel:[0,1] op_sel_hi:[1,1]
v_pk_mul_f32 v[180:181], v[180:181], v[10:11] op_sel:[0,1] op_sel_hi:[1,1]
v_pk_mul_f32 v[182:183], v[182:183], v[10:11] op_sel:[0,1] op_sel_hi:[1,1]
v_cvt_pk_bf16_f32 v188, v156, v157
v_cvt_pk_bf16_f32 v189, v158, v159
v_cvt_pk_bf16_f32 v190, v148, v149
v_cvt_pk_bf16_f32 v191, v150, v151
v_cvt_pk_bf16_f32 v196, v164, v165
v_cvt_pk_bf16_f32 v197, v166, v167
v_cvt_pk_bf16_f32 v198, v172, v173
v_cvt_pk_bf16_f32 v199, v174, v175
v_cvt_pk_bf16_f32 v180, v180, v181
v_cvt_pk_bf16_f32 v181, v182, v183
s_waitcnt vmcnt(0)
s_nop 0
v_mfma_f32_16x16x16_bf16 v[212:215], a[192:193], v[180:181], 0
v_mfma_f32_16x16x16_bf16 v[228:231], a[198:199], v[180:181], 0
v_mfma_f32_16x16x16_bf16 v[112:115], a[204:205], v[180:181], 0
v_mfma_f32_16x16x16_bf16 v[120:123], a[210:211], v[180:181], 0
v_mfma_f32_16x16x16_bf16 v[128:131], a[216:217], v[180:181], 0
v_mfma_f32_16x16x16_bf16 v[136:139], a[222:223], v[180:181], 0
v_mfma_f32_16x16x16_bf16 v[244:247], a[228:229], v[180:181], 0
v_mfma_f32_16x16x16_bf16 v[16:19], a[234:235], v[180:181], 0
v_mfma_f32_16x16x32_bf16 v[204:207], a[192:195], v[188:191], 0
v_mfma_f32_16x16x32_bf16 v[220:223], a[198:201], v[188:191], 0
v_mfma_f32_16x16x32_bf16 v[80:83], a[204:207], v[188:191], 0
v_mfma_f32_16x16x32_bf16 v[88:91], a[210:213], v[188:191], 0
v_mfma_f32_16x16x32_bf16 v[96:99], a[216:219], v[188:191], 0
v_mfma_f32_16x16x32_bf16 v[104:107], a[222:225], v[188:191], 0
v_mfma_f32_16x16x32_bf16 v[236:239], a[228:231], v[188:191], 0
v_mfma_f32_16x16x32_bf16 v[252:255], a[234:237], v[188:191], 0
s_add_u32 s70, s23, 524288
s_add_u32 s71, s23, 528384
v_mfma_f32_16x16x32_bf16 v[212:215], a[194:197], v[196:199], v[212:215]
v_mfma_f32_16x16x32_bf16 v[228:231], a[200:203], v[196:199], v[228:231]
v_mfma_f32_16x16x32_bf16 v[112:115], a[206:209], v[196:199], v[112:115]
v_mfma_f32_16x16x32_bf16 v[120:123], a[212:215], v[196:199], v[120:123]
v_cvt_pk_bf16_f32 v204, v204, v205
v_cvt_pk_bf16_f32 v205, v206, v207
v_cvt_pk_bf16_f32 v206, v220, v221
v_cvt_pk_bf16_f32 v207, v222, v223
buffer_store_dwordx4 v[204:207], v2, s[4:7], s70 offen offset:0 sc1
v_mfma_f32_16x16x32_bf16 v[128:131], a[218:221], v[196:199], v[128:131]
v_mfma_f32_16x16x32_bf16 v[136:139], a[224:227], v[196:199], v[136:139]
v_cvt_pk_bf16_f32 v80, v80, v81
v_cvt_pk_bf16_f32 v81, v82, v83
v_cvt_pk_bf16_f32 v82, v88, v89
v_cvt_pk_bf16_f32 v83, v90, v91
buffer_store_dwordx4 v[80:83], v2, s[4:7], s70 offen offset:2048 sc1
v_mfma_f32_16x16x32_bf16 v[244:247], a[230:233], v[196:199], v[244:247]
v_mfma_f32_16x16x32_bf16 v[16:19], a[236:239], v[196:199], v[16:19]
v_cvt_pk_bf16_f32 v96, v96, v97
v_cvt_pk_bf16_f32 v97, v98, v99
v_cvt_pk_bf16_f32 v98, v104, v105
v_cvt_pk_bf16_f32 v99, v106, v107
buffer_store_dwordx4 v[96:99], v2, s[4:7], s71 offen offset:0 sc1
v_cvt_pk_bf16_f32 v236, v236, v237
v_cvt_pk_bf16_f32 v237, v238, v239
v_cvt_pk_bf16_f32 v238, v252, v253
v_cvt_pk_bf16_f32 v239, v254, v255
buffer_store_dwordx4 v[236:239], v2, s[4:7], s71 offen offset:2048 sc1
v_cvt_pk_bf16_f32 v212, v212, v213
v_cvt_pk_bf16_f32 v213, v214, v215
v_cvt_pk_bf16_f32 v214, v228, v229
v_cvt_pk_bf16_f32 v215, v230, v231
buffer_store_dwordx4 v[212:215], v2, s[4:7], s70 offen offset:256 sc1
v_cvt_pk_bf16_f32 v112, v112, v113
v_cvt_pk_bf16_f32 v113, v114, v115
v_cvt_pk_bf16_f32 v114, v120, v121
v_cvt_pk_bf16_f32 v115, v122, v123
buffer_store_dwordx4 v[112:115], v2, s[4:7], s70 offen offset:2304 sc1
v_cvt_pk_bf16_f32 v128, v128, v129
v_cvt_pk_bf16_f32 v129, v130, v131
v_cvt_pk_bf16_f32 v130, v136, v137
v_cvt_pk_bf16_f32 v131, v138, v139
buffer_store_dwordx4 v[128:131], v2, s[4:7], s71 offen offset:256 sc1
v_cvt_pk_bf16_f32 v244, v244, v245
v_cvt_pk_bf16_f32 v245, v246, v247
v_cvt_pk_bf16_f32 v246, v16, v17
v_cvt_pk_bf16_f32 v247, v18, v19
buffer_store_dwordx4 v[244:247], v2, s[4:7], s71 offen offset:2304 sc1
s_add_u32 s31, s31, 1
s_cmp_ge_u32 s31, 58
s_cbranch_scc1 m_g_qs_d2
s_cmp_ge_u32 s22, s31
s_cbranch_scc0 m_g_qs_w2
buffer_load_dwordx4 a[32:35], v4, s[4:7], s66 offen offset:0 sc1
buffer_load_dwordx4 a[36:39], v4, s[4:7], s66 offen offset:512 sc1
buffer_load_dwordx4 a[40:43], v4, s[4:7], s66 offen offset:1024 sc1
buffer_load_dwordx4 a[44:47], v4, s[4:7], s66 offen offset:1536 sc1
s_add_u32 s66, s66, 131072
buffer_load_dwordx2 a[48:49], v5, s[4:7], s67 offen offset:0 sc1
buffer_load_dwordx2 a[54:55], v5, s[4:7], s67 offen offset:128 sc1
buffer_load_dwordx2 a[60:61], v5, s[4:7], s67 offen offset:512 sc1
buffer_load_dwordx2 a[66:67], v5, s[4:7], s67 offen offset:640 sc1
buffer_load_dwordx2 a[72:73], v5, s[4:7], s67 offen offset:1024 sc1
buffer_load_dwordx2 a[78:79], v5, s[4:7], s67 offen offset:1152 sc1
buffer_load_dwordx2 a[84:85], v5, s[4:7], s67 offen offset:1536 sc1
buffer_load_dwordx2 a[90:91], v5, s[4:7], s67 offen offset:1664 sc1
s_add_u32 s67, s67, 131072
s_waitcnt vmcnt(12)
v_mov_b32 v28, 3
buffer_store_dword v28, v45, s[4:7], s21 offen sc1
s_branch m_g_qs_j2
m_g_qs_d2:
buffer_load_dwordx4 a[32:35], v4, s[4:7], s66 offen offset:0 sc1
buffer_load_dwordx4 a[36:39], v4, s[4:7], s66 offen offset:512 sc1
buffer_load_dwordx4 a[40:43], v4, s[4:7], s66 offen offset:1024 sc1
buffer_load_dwordx4 a[44:47], v4, s[4:7], s66 offen offset:1536 sc1
s_add_u32 s66, s66, 131072
buffer_load_dwordx2 a[48:49], v5, s[4:7], s67 offen offset:0 sc1
buffer_load_dwordx2 a[54:55], v5, s[4:7], s67 offen offset:128 sc1
buffer_load_dwordx2 a[60:61], v5, s[4:7], s67 offen offset:512 sc1
buffer_load_dwordx2 a[66:67], v5, s[4:7], s67 offen offset:640 sc1
buffer_load_dwordx2 a[72:73], v5, s[4:7], s67 offen offset:1024 sc1
buffer_load_dwordx2 a[78:79], v5, s[4:7], s67 offen offset:1152 sc1
buffer_load_dwordx2 a[84:85], v5, s[4:7], s67 offen offset:1536 sc1
buffer_load_dwordx2 a[90:91], v5, s[4:7], s67 offen offset:1664 sc1
s_add_u32 s67, s67, 131072
s_waitcnt vmcnt(12)
v_mov_b32 v28, 3
buffer_store_dword v28, v45, s[4:7], s21 offen sc1
s_waitcnt vmcnt(1)
s_branch m_g_qs_c3
m_g_qs_r3:
s_sub_u32 s66, s66, 131072
s_sub_u32 s67, s67, 131072
buffer_load_dwordx4 a[32:35], v4, s[4:7], s66 offen offset:0 sc1
buffer_load_dwordx4 a[36:39], v4, s[4:7], s66 offen offset:512 sc1
buffer_load_dwordx4 a[40:43], v4, s[4:7], s66 offen offset:1024 sc1
buffer_load_dwordx4 a[44:47], v4, s[4:7], s66 offen offset:1536 sc1
s_add_u32 s66, s66, 131072
buffer_load_dwordx2 a[48:49], v5, s[4:7], s67 offen offset:0 sc1
buffer_load_dwordx2 a[54:55], v5, s[4:7], s67 offen offset:128 sc1
buffer_load_dwordx2 a[60:61], v5, s[4:7], s67 offen offset:512 sc1
buffer_load_dwordx2 a[66:67], v5, s[4:7], s67 offen offset:640 sc1
buffer_load_dwordx2 a[72:73], v5, s[4:7], s67 offen offset:1024 sc1
buffer_load_dwordx2 a[78:79], v5, s[4:7], s67 offen offset:1152 sc1
buffer_load_dwordx2 a[84:85], v5, s[4:7], s67 offen offset:1536 sc1
buffer_load_dwordx2 a[90:91], v5, s[4:7], s67 offen offset:1664 sc1
s_add_u32 s67, s67, 131072
s_waitcnt vmcnt(0)
m_g_qs_c3:
v_accvgpr_read_b32 v46, a32
v_accvgpr_read_b32 v44, a36
v_max_u32 v46, v46, v44
v_accvgpr_read_b32 v44, a40
v_accvgpr_read_b32 v47, a44
v_max3_u32 v46, v46, v44, v47
v_accvgpr_read_b32 v44, a48
v_accvgpr_read_b32 v47, a54
v_max3_u32 v46, v46, v44, v47
v_accvgpr_read_b32 v44, a60
v_accvgpr_read_b32 v47, a66
v_max3_u32 v46, v46, v44, v47
v_accvgpr_read_b32 v44, a72
v_accvgpr_read_b32 v47, a78
v_max3_u32 v46, v46, v44, v47
v_accvgpr_read_b32 v44, a84
v_accvgpr_read_b32 v47, a90
v_max3_u32 v46, v46, v44, v47
v_cmp_eq_u32 vcc, -1, v46
s_cbranch_vccz m_g_qs_j2
s_cmp_eq_u32 s17, 0
s_cbranch_scc1 m_g_qs_j2
s_sub_u32 s17, s17, 1
s_branch m_g_qs_r3
m_g_qs_w2:
s_waitcnt vmcnt(0)
v_mov_b32 v28, 3
buffer_store_dword v28, v45, s[4:7], s21 offen sc1
v_mov_b32 v44, 0
m_g_qs_p3:
buffer_load_dword v46, v44, s[4:7], s30 offen sc1
s_waitcnt vmcnt(0)
v_readfirstlane_b32 s71, v46
s_cmp_ge_u32 s71, s31
s_cbranch_scc1 m_g_qs_p3_d
s_cmp_eq_u32 s17, 0
s_cbranch_scc1 m_g_qs_p3_d
s_sub_u32 s17, s17, 1
s_branch m_g_qs_p3
m_g_qs_p3_d:
s_mov_b32 s22, s71
buffer_load_dwordx4 a[32:35], v4, s[4:7], s66 offen offset:0 sc1
buffer_load_dwordx4 a[36:39], v4, s[4:7], s66 offen offset:512 sc1
buffer_load_dwordx4 a[40:43], v4, s[4:7], s66 offen offset:1024 sc1
buffer_load_dwordx4 a[44:47], v4, s[4:7], s66 offen offset:1536 sc1
s_add_u32 s66, s66, 131072
buffer_load_dwordx2 a[48:49], v5, s[4:7], s67 offen offset:0 sc1
buffer_load_dwordx2 a[54:55], v5, s[4:7], s67 offen offset:128 sc1
buffer_load_dwordx2 a[60:61], v5, s[4:7], s67 offen offset:512 sc1
buffer_load_dwordx2 a[66:67], v5, s[4:7], s67 offen offset:640 sc1
buffer_load_dwordx2 a[72:73], v5, s[4:7], s67 offen offset:1024 sc1
buffer_load_dwordx2 a[78:79], v5, s[4:7], s67 offen offset:1152 sc1
buffer_load_dwordx2 a[84:85], v5, s[4:7], s67 offen offset:1536 sc1
buffer_load_dwordx2 a[90:91], v5, s[4:7], s67 offen offset:1664 sc1
s_add_u32 s67, s67, 131072
m_g_qs_j2:
s_waitcnt vmcnt(8)
v_mfma_f32_16x16x32_bf16 v[24:27], a[0:3], v[208:211], v[6:9]
v_mfma_f32_16x16x32_bf16 v[56:59], a[32:35], v[208:211], v[12:15]
v_mfma_f32_16x16x32_bf16 v[48:51], a[0:3], v[240:243], 0
v_mfma_f32_16x16x32_bf16 v[32:35], a[16:19], v[240:243], v[6:9]
v_mfma_f32_16x16x32_bf16 v[64:67], a[32:35], v[240:243], v[12:15]
v_mfma_f32_16x16x32_bf16 v[24:27], a[4:7], v[216:219], v[24:27]
v_mfma_f32_16x16x32_bf16 v[56:59], a[36:39], v[216:219], v[56:59]
v_mfma_f32_16x16x32_bf16 v[48:51], a[4:7], v[248:251], v[48:51]
v_mfma_f32_16x16x32_bf16 v[32:35], a[20:23], v[248:251], v[32:35]
v_mfma_f32_16x16x32_bf16 v[64:67], a[36:39], v[248:251], v[64:67]
v_mfma_f32_16x16x32_bf16 v[24:27], a[8:11], v[224:227], v[24:27]
v_mfma_f32_16x16x32_bf16 v[56:59], a[40:43], v[224:227], v[56:59]
v_mfma_f32_16x16x32_bf16 v[48:51], a[8:11], v[20:23], v[48:51]
v_mfma_f32_16x16x32_bf16 v[32:35], a[24:27], v[20:23], v[32:35]
v_mfma_f32_16x16x32_bf16 v[64:67], a[40:43], v[20:23], v[64:67]
v_mfma_f32_16x16x32_bf16 v[24:27], a[12:15], v[232:235], v[24:27]
v_mfma_f32_16x16x32_bf16 v[56:59], a[44:47], v[232:235], v[56:59]
v_mfma_f32_16x16x32_bf16 v[48:51], a[12:15], v[36:39], v[48:51]
v_mfma_f32_16x16x32_bf16 v[32:35], a[28:31], v[36:39], v[32:35]
v_mfma_f32_16x16x32_bf16 v[64:67], a[44:47], v[36:39], v[64:67]
v_max3_f32 v10, v24, v25, v26
v_max3_f32 v10, v10, v27, v56
v_max3_f32 v10, v10, v57, v58
v_max_f32 v10, v10, v59
v_max3_f32 v11, v48, v49, v50
v_max3_f32 v11, v11, v51, v32
v_max3_f32 v11, v11, v33, v34
s_nop 0
v_max3_f32 v11, v11, v35, v64
v_max3_f32 v11, v11, v65, v66
v_max_f32 v11, v11, v67
s_nop 1
v_permlane32_swap_b32 v10, v11
v_max_f32 v10, v10, v11
v_mov_b32 v11, v10
s_nop 1
v_permlane16_swap_b32 v10, v11
v_max_f32 v10, v10, v11
v_mul_f32 v10, s68, v10
v_mov_b32 v11, v10
s_nop 1
v_permlane32_swap_b32 v10, v11
v_pk_fma_f32 v[24:25], v[24:25], s[68:69], v[10:11] op_sel:[0,0,0] op_sel_hi:[1,1,0] neg_lo:[0,0,1] neg_hi:[0,0,1]
v_pk_fma_f32 v[26:27], v[26:27], s[68:69], v[10:11] op_sel:[0,0,0] op_sel_hi:[1,1,0] neg_lo:[0,0,1] neg_hi:[0,0,1]
v_pk_fma_f32 v[56:57], v[56:57], s[68:69], v[10:11] op_sel:[0,0,0] op_sel_hi:[1,1,0] neg_lo:[0,0,1] neg_hi:[0,0,1]
v_pk_fma_f32 v[58:59], v[58:59], s[68:69], v[10:11] op_sel:[0,0,0] op_sel_hi:[1,1,0] neg_lo:[0,0,1] neg_hi:[0,0,1]
v_pk_fma_f32 v[48:49], v[48:49], s[68:69], v[10:11] op_sel:[0,0,1] op_sel_hi:[1,1,1] neg_lo:[0,0,1] neg_hi:[0,0,1]
v_pk_fma_f32 v[50:51], v[50:51], s[68:69], v[10:11] op_sel:[0,0,1] op_sel_hi:[1,1,1] neg_lo:[0,0,1] neg_hi:[0,0,1]
v_pk_fma_f32 v[32:33], v[32:33], s[68:69], v[10:11] op_sel:[0,0,1] op_sel_hi:[1,1,1] neg_lo:[0,0,1] neg_hi:[0,0,1]
v_pk_fma_f32 v[34:35], v[34:35], s[68:69], v[10:11] op_sel:[0,0,1] op_sel_hi:[1,1,1] neg_lo:[0,0,1] neg_hi:[0,0,1]
v_pk_fma_f32 v[64:65], v[64:65], s[68:69], v[10:11] op_sel:[0,0,1] op_sel_hi:[1,1,1] neg_lo:[0,0,1] neg_hi:[0,0,1]
v_pk_fma_f32 v[66:67], v[66:67], s[68:69], v[10:11] op_sel:[0,0,1] op_sel_hi:[1,1,1] neg_lo:[0,0,1] neg_hi:[0,0,1]
v_exp_f32 v24, v24
v_exp_f32 v25, v25
v_exp_f32 v26, v26
v_exp_f32 v27, v27
v_exp_f32 v56, v56
v_exp_f32 v57, v57
v_exp_f32 v58, v58
v_exp_f32 v59, v59
v_exp_f32 v48, v48
v_exp_f32 v49, v49
v_exp_f32 v50, v50
v_exp_f32 v51, v51
v_exp_f32 v32, v32
v_exp_f32 v33, v33
v_exp_f32 v34, v34
v_exp_f32 v35, v35
v_exp_f32 v64, v64
v_exp_f32 v65, v65
v_exp_f32 v66, v66
v_exp_f32 v67, v67
v_pk_add_f32 v[40:41], v[24:25], v[26:27]
v_pk_add_f32 v[42:43], v[56:57], v[58:59]
v_pk_add_f32 v[72:73], v[48:49], v[50:51]
v_pk_add_f32 v[74:75], v[32:33], v[34:35]
v_pk_add_f32 v[40:41], v[40:41], v[42:43]
v_pk_add_f32 v[72:73], v[72:73], v[74:75]
v_pk_add_f32 v[74:75], v[64:65], v[66:67]
v_add_f32 v10, v40, v41
v_pk_add_f32 v[72:73], v[72:73], v[74:75]
v_add_f32 v11, v72, v73
s_nop 1
v_permlane32_swap_b32 v10, v11
v_add_f32 v10, v10, v11
v_mov_b32 v11, v10
s_nop 1
v_permlane16_swap_b32 v10, v11
v_add_f32 v10, v10, v11
v_rcp_f32 v10, v10
s_nop 0
v_mov_b32 v11, v10
s_nop 1
v_permlane32_swap_b32 v10, v11
v_pk_mul_f32 v[24:25], v[24:25], v[10:11] op_sel:[0,0] op_sel_hi:[1,0]
v_pk_mul_f32 v[26:27], v[26:27], v[10:11] op_sel:[0,0] op_sel_hi:[1,0]
v_pk_mul_f32 v[56:57], v[56:57], v[10:11] op_sel:[0,0] op_sel_hi:[1,0]
v_pk_mul_f32 v[58:59], v[58:59], v[10:11] op_sel:[0,0] op_sel_hi:[1,0]
v_pk_mul_f32 v[48:49], v[48:49], v[10:11] op_sel:[0,1] op_sel_hi:[1,1]
v_pk_mul_f32 v[50:51], v[50:51], v[10:11] op_sel:[0,1] op_sel_hi:[1,1]
v_pk_mul_f32 v[32:33], v[32:33], v[10:11] op_sel:[0,1] op_sel_hi:[1,1]
v_pk_mul_f32 v[34:35], v[34:35], v[10:11] op_sel:[0,1] op_sel_hi:[1,1]
v_pk_mul_f32 v[64:65], v[64:65], v[10:11] op_sel:[0,1] op_sel_hi:[1,1]
v_pk_mul_f32 v[66:67], v[66:67], v[10:11] op_sel:[0,1] op_sel_hi:[1,1]
v_cvt_pk_bf16_f32 v40, v56, v57
v_cvt_pk_bf16_f32 v41, v58, v59
v_cvt_pk_bf16_f32 v42, v24, v25
v_cvt_pk_bf16_f32 v43, v26, v27
v_cvt_pk_bf16_f32 v72, v48, v49
v_cvt_pk_bf16_f32 v73, v50, v51
v_cvt_pk_bf16_f32 v74, v32, v33
v_cvt_pk_bf16_f32 v75, v34, v35
v_cvt_pk_bf16_f32 v64, v64, v65
v_cvt_pk_bf16_f32 v65, v66, v67
s_waitcnt vmcnt(0)
s_nop 0
v_mfma_f32_16x16x16_bf16 v[60:63], a[48:49], v[64:65], 0
v_mfma_f32_16x16x16_bf16 v[76:79], a[54:55], v[64:65], 0
v_mfma_f32_16x16x16_bf16 v[100:103], a[60:61], v[64:65], 0
v_mfma_f32_16x16x16_bf16 v[108:111], a[66:67], v[64:65], 0
v_mfma_f32_16x16x16_bf16 v[124:127], a[72:73], v[64:65], 0
v_mfma_f32_16x16x16_bf16 v[140:143], a[78:79], v[64:65], 0
v_mfma_f32_16x16x16_bf16 v[176:179], a[84:85], v[64:65], 0
v_mfma_f32_16x16x16_bf16 v[184:187], a[90:91], v[64:65], 0
v_mfma_f32_16x16x32_bf16 v[52:55], a[48:51], v[40:43], 0
v_mfma_f32_16x16x32_bf16 v[68:71], a[54:57], v[40:43], 0
v_mfma_f32_16x16x32_bf16 v[92:95], a[60:63], v[40:43], 0
v_mfma_f32_16x16x32_bf16 v[84:87], a[66:69], v[40:43], 0
v_mfma_f32_16x16x32_bf16 v[116:119], a[72:75], v[40:43], 0
v_mfma_f32_16x16x32_bf16 v[132:135], a[78:81], v[40:43], 0
v_mfma_f32_16x16x32_bf16 v[144:147], a[84:87], v[40:43], 0
v_mfma_f32_16x16x32_bf16 v[152:155], a[90:93], v[40:43], 0
s_add_u32 s70, s23, 786432
s_add_u32 s71, s23, 790528
v_mfma_f32_16x16x32_bf16 v[60:63], a[50:53], v[72:75], v[60:63]
v_mfma_f32_16x16x32_bf16 v[76:79], a[56:59], v[72:75], v[76:79]
v_mfma_f32_16x16x32_bf16 v[100:103], a[62:65], v[72:75], v[100:103]
v_mfma_f32_16x16x32_bf16 v[108:111], a[68:71], v[72:75], v[108:111]
v_cvt_pk_bf16_f32 v52, v52, v53
v_cvt_pk_bf16_f32 v53, v54, v55
v_cvt_pk_bf16_f32 v54, v68, v69
v_cvt_pk_bf16_f32 v55, v70, v71
buffer_store_dwordx4 v[52:55], v2, s[4:7], s70 offen offset:0 sc1
v_mfma_f32_16x16x32_bf16 v[124:127], a[74:77], v[72:75], v[124:127]
v_mfma_f32_16x16x32_bf16 v[140:143], a[80:83], v[72:75], v[140:143]
v_cvt_pk_bf16_f32 v92, v92, v93
v_cvt_pk_bf16_f32 v93, v94, v95
v_cvt_pk_bf16_f32 v94, v84, v85
v_cvt_pk_bf16_f32 v95, v86, v87
buffer_store_dwordx4 v[92:95], v2, s[4:7], s70 offen offset:2048 sc1
v_mfma_f32_16x16x32_bf16 v[176:179], a[86:89], v[72:75], v[176:179]
v_mfma_f32_16x16x32_bf16 v[184:187], a[92:95], v[72:75], v[184:187]
v_cvt_pk_bf16_f32 v116, v116, v117
v_cvt_pk_bf16_f32 v117, v118, v119
v_cvt_pk_bf16_f32 v118, v132, v133
v_cvt_pk_bf16_f32 v119, v134, v135
buffer_store_dwordx4 v[116:119], v2, s[4:7], s71 offen offset:0 sc1
v_cvt_pk_bf16_f32 v144, v144, v145
v_cvt_pk_bf16_f32 v145, v146, v147
v_cvt_pk_bf16_f32 v146, v152, v153
v_cvt_pk_bf16_f32 v147, v154, v155
buffer_store_dwordx4 v[144:147], v2, s[4:7], s71 offen offset:2048 sc1
v_cvt_pk_bf16_f32 v60, v60, v61
v_cvt_pk_bf16_f32 v61, v62, v63
v_cvt_pk_bf16_f32 v62, v76, v77
v_cvt_pk_bf16_f32 v63, v78, v79
buffer_store_dwordx4 v[60:63], v2, s[4:7], s70 offen offset:256 sc1
v_cvt_pk_bf16_f32 v100, v100, v101
v_cvt_pk_bf16_f32 v101, v102, v103
v_cvt_pk_bf16_f32 v102, v108, v109
v_cvt_pk_bf16_f32 v103, v110, v111
buffer_store_dwordx4 v[100:103], v2, s[4:7], s70 offen offset:2304 sc1
v_cvt_pk_bf16_f32 v124, v124, v125
v_cvt_pk_bf16_f32 v125, v126, v127
v_cvt_pk_bf16_f32 v126, v140, v141
v_cvt_pk_bf16_f32 v127, v142, v143
buffer_store_dwordx4 v[124:127], v2, s[4:7], s71 offen offset:256 sc1
v_cvt_pk_bf16_f32 v176, v176, v177
v_cvt_pk_bf16_f32 v177, v178, v179
v_cvt_pk_bf16_f32 v178, v184, v185
v_cvt_pk_bf16_f32 v179, v186, v187
buffer_store_dwordx4 v[176:179], v2, s[4:7], s71 offen offset:2304 sc1
s_waitcnt vmcnt(0)
v_mov_b32 v28, 4
buffer_store_dword v28, v45, s[4:7], s21 offen sc1
v_accvgpr_read_b32 v2, a240
v_accvgpr_read_b32 v3, a241
v_accvgpr_read_b32 v4, a242
v_accvgpr_read_b32 v5, a243
v_accvgpr_read_b32 v6, a244
v_accvgpr_read_b32 v7, a245
v_accvgpr_read_b32 v8, a246
v_accvgpr_read_b32 v9, a247
s_lshl_b32 s21, s19, 4
s_add_u32 s21, s21, s20
s_lshl_b32 s21, s21, 2
s_add_u32 s21, s21, 170936320
s_lshl_b32 s62, s35, 9
s_add_u32 s21, s21, s62
s_cmp_eq_u32 s18, 7
s_cselect_b32 s61, 1, 0
s_branch m_g_nx3
m_g_ef:
s_lshl_b32 s62, s19, 1
s_add_u32 s62, s62, s32
s_mul_i32 s62, s62, 917504
s_lshl_b32 s63, s20, 1
s_add_u32 s63, s63, s33
s_lshl_b32 s63, s63, 13
s_add_u32 s23, s62, s63
s_add_u32 s23, s23, 92274688
s_lshl_b32 s21, s19, 4
s_add_u32 s21, s21, s20
s_lshl_b32 s21, s21, 2
s_add_u32 s21, s21, 170934272
s_lshl_b32 s62, s35, 9
s_add_u32 s21, s21, s62
v_lshrrev_b32 v10, 4, v0
v_lshlrev_b32 v10, 9, v10
v_and_b32 v11, 15, v0
v_lshl_add_u32 v10, v11, 4, v10
s_mov_b32 s64, 0xbfb8aa3b
s_mov_b32 s65, 0xbfb8aa3b
s_mov_b32 s66, 1.0
s_mov_b32 s67, 1.0
s_add_u32 s62, s23, 0
v_pk_mul_f32 v[12:13], v[16:17], s[64:65]
v_pk_mul_f32 v[14:15], v[18:19], s[64:65]
v_exp_f32 v12, v12
v_exp_f32 v13, v13
v_exp_f32 v14, v14
v_exp_f32 v15, v15
v_pk_add_f32 v[12:13], v[12:13], s[66:67]
v_pk_add_f32 v[14:15], v[14:15], s[66:67]
v_rcp_f32 v12, v12
v_rcp_f32 v13, v13
v_rcp_f32 v14, v14
v_rcp_f32 v15, v15
v_pk_mul_f32 v[16:17], v[16:17], v[12:13]
v_pk_mul_f32 v[18:19], v[18:19], v[14:15]
v_pk_mul_f32 v[12:13], v[20:21], s[64:65]
v_pk_mul_f32 v[14:15], v[22:23], s[64:65]
v_exp_f32 v12, v12
v_exp_f32 v13, v13
v_exp_f32 v14, v14
v_exp_f32 v15, v15
v_pk_add_f32 v[12:13], v[12:13], s[66:67]
v_pk_add_f32 v[14:15], v[14:15], s[66:67]
v_rcp_f32 v12, v12
v_rcp_f32 v13, v13
v_rcp_f32 v14, v14
v_rcp_f32 v15, v15
v_pk_mul_f32 v[20:21], v[20:21], v[12:13]
v_pk_mul_f32 v[22:23], v[22:23], v[14:15]
v_cvt_pk_bf16_f32 v16, v16, v17
v_cvt_pk_bf16_f32 v17, v18, v19
v_cvt_pk_bf16_f32 v18, v20, v21
v_cvt_pk_bf16_f32 v19, v22, v23
buffer_store_dwordx4 v[16:19], v10, s[4:7], s62 offen offset:0 sc1
v_pk_mul_f32 v[12:13], v[24:25], s[64:65]
v_pk_mul_f32 v[14:15], v[26:27], s[64:65]
v_exp_f32 v12, v12
v_exp_f32 v13, v13
v_exp_f32 v14, v14
v_exp_f32 v15, v15
v_pk_add_f32 v[12:13], v[12:13], s[66:67]
v_pk_add_f32 v[14:15], v[14:15], s[66:67]
v_rcp_f32 v12, v12
v_rcp_f32 v13, v13
v_rcp_f32 v14, v14
v_rcp_f32 v15, v15
v_pk_mul_f32 v[24:25], v[24:25], v[12:13]
v_pk_mul_f32 v[26:27], v[26:27], v[14:15]
v_pk_mul_f32 v[12:13], v[28:29], s[64:65]
v_pk_mul_f32 v[14:15], v[30:31], s[64:65]
v_exp_f32 v12, v12
v_exp_f32 v13, v13
v_exp_f32 v14, v14
v_exp_f32 v15, v15
v_pk_add_f32 v[12:13], v[12:13], s[66:67]
v_pk_add_f32 v[14:15], v[14:15], s[66:67]
v_rcp_f32 v12, v12
v_rcp_f32 v13, v13
v_rcp_f32 v14, v14
v_rcp_f32 v15, v15
v_pk_mul_f32 v[28:29], v[28:29], v[12:13]
v_pk_mul_f32 v[30:31], v[30:31], v[14:15]
v_cvt_pk_bf16_f32 v24, v24, v25
v_cvt_pk_bf16_f32 v25, v26, v27
v_cvt_pk_bf16_f32 v26, v28, v29
v_cvt_pk_bf16_f32 v27, v30, v31
buffer_store_dwordx4 v[24:27], v10, s[4:7], s62 offen offset:2048 sc1
v_pk_mul_f32 v[12:13], v[48:49], s[64:65]
v_pk_mul_f32 v[14:15], v[50:51], s[64:65]
v_exp_f32 v12, v12
v_exp_f32 v13, v13
v_exp_f32 v14, v14
v_exp_f32 v15, v15
v_pk_add_f32 v[12:13], v[12:13], s[66:67]
v_pk_add_f32 v[14:15], v[14:15], s[66:67]
v_rcp_f32 v12, v12
v_rcp_f32 v13, v13
v_rcp_f32 v14, v14
v_rcp_f32 v15, v15
v_pk_mul_f32 v[48:49], v[48:49], v[12:13]
v_pk_mul_f32 v[50:51], v[50:51], v[14:15]
v_pk_mul_f32 v[12:13], v[52:53], s[64:65]
v_pk_mul_f32 v[14:15], v[54:55], s[64:65]
v_exp_f32 v12, v12
v_exp_f32 v13, v13
v_exp_f32 v14, v14
v_exp_f32 v15, v15
v_pk_add_f32 v[12:13], v[12:13], s[66:67]
v_pk_add_f32 v[14:15], v[14:15], s[66:67]
v_rcp_f32 v12, v12
v_rcp_f32 v13, v13
v_rcp_f32 v14, v14
v_rcp_f32 v15, v15
v_pk_mul_f32 v[52:53], v[52:53], v[12:13]
v_pk_mul_f32 v[54:55], v[54:55], v[14:15]
v_cvt_pk_bf16_f32 v48, v48, v49
v_cvt_pk_bf16_f32 v49, v50, v51
v_cvt_pk_bf16_f32 v50, v52, v53
v_cvt_pk_bf16_f32 v51, v54, v55
buffer_store_dwordx4 v[48:51], v10, s[4:7], s62 offen offset:256 sc1
v_pk_mul_f32 v[12:13], v[56:57], s[64:65]
v_pk_mul_f32 v[14:15], v[58:59], s[64:65]
v_exp_f32 v12, v12
v_exp_f32 v13, v13
v_exp_f32 v14, v14
v_exp_f32 v15, v15
v_pk_add_f32 v[12:13], v[12:13], s[66:67]
v_pk_add_f32 v[14:15], v[14:15], s[66:67]
v_rcp_f32 v12, v12
v_rcp_f32 v13, v13
v_rcp_f32 v14, v14
v_rcp_f32 v15, v15
v_pk_mul_f32 v[56:57], v[56:57], v[12:13]
v_pk_mul_f32 v[58:59], v[58:59], v[14:15]
v_pk_mul_f32 v[12:13], v[60:61], s[64:65]
v_pk_mul_f32 v[14:15], v[62:63], s[64:65]
v_exp_f32 v12, v12
v_exp_f32 v13, v13
v_exp_f32 v14, v14
v_exp_f32 v15, v15
v_pk_add_f32 v[12:13], v[12:13], s[66:67]
v_pk_add_f32 v[14:15], v[14:15], s[66:67]
v_rcp_f32 v12, v12
v_rcp_f32 v13, v13
v_rcp_f32 v14, v14
v_rcp_f32 v15, v15
v_pk_mul_f32 v[60:61], v[60:61], v[12:13]
v_pk_mul_f32 v[62:63], v[62:63], v[14:15]
v_cvt_pk_bf16_f32 v56, v56, v57
v_cvt_pk_bf16_f32 v57, v58, v59
v_cvt_pk_bf16_f32 v58, v60, v61
v_cvt_pk_bf16_f32 v59, v62, v63
buffer_store_dwordx4 v[56:59], v10, s[4:7], s62 offen offset:2304 sc1
s_add_u32 s62, s23, 4096
v_pk_mul_f32 v[12:13], v[32:33], s[64:65]
v_pk_mul_f32 v[14:15], v[34:35], s[64:65]
v_exp_f32 v12, v12
v_exp_f32 v13, v13
v_exp_f32 v14, v14
v_exp_f32 v15, v15
v_pk_add_f32 v[12:13], v[12:13], s[66:67]
v_pk_add_f32 v[14:15], v[14:15], s[66:67]
v_rcp_f32 v12, v12
v_rcp_f32 v13, v13
v_rcp_f32 v14, v14
v_rcp_f32 v15, v15
v_pk_mul_f32 v[32:33], v[32:33], v[12:13]
v_pk_mul_f32 v[34:35], v[34:35], v[14:15]
v_pk_mul_f32 v[12:13], v[36:37], s[64:65]
v_pk_mul_f32 v[14:15], v[38:39], s[64:65]
v_exp_f32 v12, v12
v_exp_f32 v13, v13
v_exp_f32 v14, v14
v_exp_f32 v15, v15
v_pk_add_f32 v[12:13], v[12:13], s[66:67]
v_pk_add_f32 v[14:15], v[14:15], s[66:67]
v_rcp_f32 v12, v12
v_rcp_f32 v13, v13
v_rcp_f32 v14, v14
v_rcp_f32 v15, v15
v_pk_mul_f32 v[36:37], v[36:37], v[12:13]
v_pk_mul_f32 v[38:39], v[38:39], v[14:15]
v_cvt_pk_bf16_f32 v32, v32, v33
v_cvt_pk_bf16_f32 v33, v34, v35
v_cvt_pk_bf16_f32 v34, v36, v37
v_cvt_pk_bf16_f32 v35, v38, v39
buffer_store_dwordx4 v[32:35], v10, s[4:7], s62 offen offset:0 sc1
v_pk_mul_f32 v[12:13], v[40:41], s[64:65]
v_pk_mul_f32 v[14:15], v[42:43], s[64:65]
v_exp_f32 v12, v12
v_exp_f32 v13, v13
v_exp_f32 v14, v14
v_exp_f32 v15, v15
v_pk_add_f32 v[12:13], v[12:13], s[66:67]
v_pk_add_f32 v[14:15], v[14:15], s[66:67]
v_rcp_f32 v12, v12
v_rcp_f32 v13, v13
v_rcp_f32 v14, v14
v_rcp_f32 v15, v15
v_pk_mul_f32 v[40:41], v[40:41], v[12:13]
v_pk_mul_f32 v[42:43], v[42:43], v[14:15]
v_pk_mul_f32 v[12:13], v[44:45], s[64:65]
v_pk_mul_f32 v[14:15], v[46:47], s[64:65]
v_exp_f32 v12, v12
v_exp_f32 v13, v13
v_exp_f32 v14, v14
v_exp_f32 v15, v15
v_pk_add_f32 v[12:13], v[12:13], s[66:67]
v_pk_add_f32 v[14:15], v[14:15], s[66:67]
v_rcp_f32 v12, v12
v_rcp_f32 v13, v13
v_rcp_f32 v14, v14
v_rcp_f32 v15, v15
v_pk_mul_f32 v[44:45], v[44:45], v[12:13]
v_pk_mul_f32 v[46:47], v[46:47], v[14:15]
v_cvt_pk_bf16_f32 v40, v40, v41
v_cvt_pk_bf16_f32 v41, v42, v43
v_cvt_pk_bf16_f32 v42, v44, v45
v_cvt_pk_bf16_f32 v43, v46, v47
buffer_store_dwordx4 v[40:43], v10, s[4:7], s62 offen offset:2048 sc1
v_pk_mul_f32 v[12:13], v[64:65], s[64:65]
v_pk_mul_f32 v[14:15], v[66:67], s[64:65]
v_exp_f32 v12, v12
v_exp_f32 v13, v13
v_exp_f32 v14, v14
v_exp_f32 v15, v15
v_pk_add_f32 v[12:13], v[12:13], s[66:67]
v_pk_add_f32 v[14:15], v[14:15], s[66:67]
v_rcp_f32 v12, v12
v_rcp_f32 v13, v13
v_rcp_f32 v14, v14
v_rcp_f32 v15, v15
v_pk_mul_f32 v[64:65], v[64:65], v[12:13]
v_pk_mul_f32 v[66:67], v[66:67], v[14:15]
v_pk_mul_f32 v[12:13], v[68:69], s[64:65]
v_pk_mul_f32 v[14:15], v[70:71], s[64:65]
v_exp_f32 v12, v12
v_exp_f32 v13, v13
v_exp_f32 v14, v14
v_exp_f32 v15, v15
v_pk_add_f32 v[12:13], v[12:13], s[66:67]
v_pk_add_f32 v[14:15], v[14:15], s[66:67]
v_rcp_f32 v12, v12
v_rcp_f32 v13, v13
v_rcp_f32 v14, v14
v_rcp_f32 v15, v15
v_pk_mul_f32 v[68:69], v[68:69], v[12:13]
v_pk_mul_f32 v[70:71], v[70:71], v[14:15]
v_cvt_pk_bf16_f32 v64, v64, v65
v_cvt_pk_bf16_f32 v65, v66, v67
v_cvt_pk_bf16_f32 v66, v68, v69
v_cvt_pk_bf16_f32 v67, v70, v71
buffer_store_dwordx4 v[64:67], v10, s[4:7], s62 offen offset:256 sc1
v_pk_mul_f32 v[12:13], v[72:73], s[64:65]
v_pk_mul_f32 v[14:15], v[74:75], s[64:65]
v_exp_f32 v12, v12
v_exp_f32 v13, v13
v_exp_f32 v14, v14
v_exp_f32 v15, v15
v_pk_add_f32 v[12:13], v[12:13], s[66:67]
v_pk_add_f32 v[14:15], v[14:15], s[66:67]
v_rcp_f32 v12, v12
v_rcp_f32 v13, v13
v_rcp_f32 v14, v14
v_rcp_f32 v15, v15
v_pk_mul_f32 v[72:73], v[72:73], v[12:13]
v_pk_mul_f32 v[74:75], v[74:75], v[14:15]
v_pk_mul_f32 v[12:13], v[76:77], s[64:65]
v_pk_mul_f32 v[14:15], v[78:79], s[64:65]
v_exp_f32 v12, v12
v_exp_f32 v13, v13
v_exp_f32 v14, v14
v_exp_f32 v15, v15
v_pk_add_f32 v[12:13], v[12:13], s[66:67]
v_pk_add_f32 v[14:15], v[14:15], s[66:67]
v_rcp_f32 v12, v12
v_rcp_f32 v13, v13
v_rcp_f32 v14, v14
v_rcp_f32 v15, v15
v_pk_mul_f32 v[76:77], v[76:77], v[12:13]
v_pk_mul_f32 v[78:79], v[78:79], v[14:15]
v_cvt_pk_bf16_f32 v72, v72, v73
v_cvt_pk_bf16_f32 v73, v74, v75
v_cvt_pk_bf16_f32 v74, v76, v77
v_cvt_pk_bf16_f32 v75, v78, v79
buffer_store_dwordx4 v[72:75], v10, s[4:7], s62 offen offset:2304 sc1
s_add_u32 s62, s23, 229376
v_pk_mul_f32 v[12:13], v[80:81], s[64:65]
v_pk_mul_f32 v[14:15], v[82:83], s[64:65]
v_exp_f32 v12, v12
v_exp_f32 v13, v13
v_exp_f32 v14, v14
v_exp_f32 v15, v15
v_pk_add_f32 v[12:13], v[12:13], s[66:67]
v_pk_add_f32 v[14:15], v[14:15], s[66:67]
v_rcp_f32 v12, v12
v_rcp_f32 v13, v13
v_rcp_f32 v14, v14
v_rcp_f32 v15, v15
v_pk_mul_f32 v[80:81], v[80:81], v[12:13]
v_pk_mul_f32 v[82:83], v[82:83], v[14:15]
v_pk_mul_f32 v[12:13], v[84:85], s[64:65]
v_pk_mul_f32 v[14:15], v[86:87], s[64:65]
v_exp_f32 v12, v12
v_exp_f32 v13, v13
v_exp_f32 v14, v14
v_exp_f32 v15, v15
v_pk_add_f32 v[12:13], v[12:13], s[66:67]
v_pk_add_f32 v[14:15], v[14:15], s[66:67]
v_rcp_f32 v12, v12
v_rcp_f32 v13, v13
v_rcp_f32 v14, v14
v_rcp_f32 v15, v15
v_pk_mul_f32 v[84:85], v[84:85], v[12:13]
v_pk_mul_f32 v[86:87], v[86:87], v[14:15]
v_cvt_pk_bf16_f32 v80, v80, v81
v_cvt_pk_bf16_f32 v81, v82, v83
v_cvt_pk_bf16_f32 v82, v84, v85
v_cvt_pk_bf16_f32 v83, v86, v87
buffer_store_dwordx4 v[80:83], v10, s[4:7], s62 offen offset:0 sc1
v_pk_mul_f32 v[12:13], v[88:89], s[64:65]
v_pk_mul_f32 v[14:15], v[90:91], s[64:65]
v_exp_f32 v12, v12
v_exp_f32 v13, v13
v_exp_f32 v14, v14
v_exp_f32 v15, v15
v_pk_add_f32 v[12:13], v[12:13], s[66:67]
v_pk_add_f32 v[14:15], v[14:15], s[66:67]
v_rcp_f32 v12, v12
v_rcp_f32 v13, v13
v_rcp_f32 v14, v14
v_rcp_f32 v15, v15
v_pk_mul_f32 v[88:89], v[88:89], v[12:13]
v_pk_mul_f32 v[90:91], v[90:91], v[14:15]
v_pk_mul_f32 v[12:13], v[92:93], s[64:65]
v_pk_mul_f32 v[14:15], v[94:95], s[64:65]
v_exp_f32 v12, v12
v_exp_f32 v13, v13
v_exp_f32 v14, v14
v_exp_f32 v15, v15
v_pk_add_f32 v[12:13], v[12:13], s[66:67]
v_pk_add_f32 v[14:15], v[14:15], s[66:67]
v_rcp_f32 v12, v12
v_rcp_f32 v13, v13
v_rcp_f32 v14, v14
v_rcp_f32 v15, v15
v_pk_mul_f32 v[92:93], v[92:93], v[12:13]
v_pk_mul_f32 v[94:95], v[94:95], v[14:15]
v_cvt_pk_bf16_f32 v88, v88, v89
v_cvt_pk_bf16_f32 v89, v90, v91
v_cvt_pk_bf16_f32 v90, v92, v93
v_cvt_pk_bf16_f32 v91, v94, v95
buffer_store_dwordx4 v[88:91], v10, s[4:7], s62 offen offset:2048 sc1
v_pk_mul_f32 v[12:13], v[112:113], s[64:65]
v_pk_mul_f32 v[14:15], v[114:115], s[64:65]
v_exp_f32 v12, v12
v_exp_f32 v13, v13
v_exp_f32 v14, v14
v_exp_f32 v15, v15
v_pk_add_f32 v[12:13], v[12:13], s[66:67]
v_pk_add_f32 v[14:15], v[14:15], s[66:67]
v_rcp_f32 v12, v12
v_rcp_f32 v13, v13
v_rcp_f32 v14, v14
v_rcp_f32 v15, v15
v_pk_mul_f32 v[112:113], v[112:113], v[12:13]
v_pk_mul_f32 v[114:115], v[114:115], v[14:15]
v_pk_mul_f32 v[12:13], v[116:117], s[64:65]
v_pk_mul_f32 v[14:15], v[118:119], s[64:65]
v_exp_f32 v12, v12
v_exp_f32 v13, v13
v_exp_f32 v14, v14
v_exp_f32 v15, v15
v_pk_add_f32 v[12:13], v[12:13], s[66:67]
v_pk_add_f32 v[14:15], v[14:15], s[66:67]
v_rcp_f32 v12, v12
v_rcp_f32 v13, v13
v_rcp_f32 v14, v14
v_rcp_f32 v15, v15
v_pk_mul_f32 v[116:117], v[116:117], v[12:13]
v_pk_mul_f32 v[118:119], v[118:119], v[14:15]
v_cvt_pk_bf16_f32 v112, v112, v113
v_cvt_pk_bf16_f32 v113, v114, v115
v_cvt_pk_bf16_f32 v114, v116, v117
v_cvt_pk_bf16_f32 v115, v118, v119
buffer_store_dwordx4 v[112:115], v10, s[4:7], s62 offen offset:256 sc1
v_pk_mul_f32 v[12:13], v[120:121], s[64:65]
v_pk_mul_f32 v[14:15], v[122:123], s[64:65]
v_exp_f32 v12, v12
v_exp_f32 v13, v13
v_exp_f32 v14, v14
v_exp_f32 v15, v15
v_pk_add_f32 v[12:13], v[12:13], s[66:67]
v_pk_add_f32 v[14:15], v[14:15], s[66:67]
v_rcp_f32 v12, v12
v_rcp_f32 v13, v13
v_rcp_f32 v14, v14
v_rcp_f32 v15, v15
v_pk_mul_f32 v[120:121], v[120:121], v[12:13]
v_pk_mul_f32 v[122:123], v[122:123], v[14:15]
v_pk_mul_f32 v[12:13], v[124:125], s[64:65]
v_pk_mul_f32 v[14:15], v[126:127], s[64:65]
v_exp_f32 v12, v12
v_exp_f32 v13, v13
v_exp_f32 v14, v14
v_exp_f32 v15, v15
v_pk_add_f32 v[12:13], v[12:13], s[66:67]
v_pk_add_f32 v[14:15], v[14:15], s[66:67]
v_rcp_f32 v12, v12
v_rcp_f32 v13, v13
v_rcp_f32 v14, v14
v_rcp_f32 v15, v15
v_pk_mul_f32 v[124:125], v[124:125], v[12:13]
v_pk_mul_f32 v[126:127], v[126:127], v[14:15]
v_cvt_pk_bf16_f32 v120, v120, v121
v_cvt_pk_bf16_f32 v121, v122, v123
v_cvt_pk_bf16_f32 v122, v124, v125
v_cvt_pk_bf16_f32 v123, v126, v127
buffer_store_dwordx4 v[120:123], v10, s[4:7], s62 offen offset:2304 sc1
s_add_u32 s62, s23, 233472
v_pk_mul_f32 v[12:13], v[96:97], s[64:65]
v_pk_mul_f32 v[14:15], v[98:99], s[64:65]
v_exp_f32 v12, v12
v_exp_f32 v13, v13
v_exp_f32 v14, v14
v_exp_f32 v15, v15
v_pk_add_f32 v[12:13], v[12:13], s[66:67]
v_pk_add_f32 v[14:15], v[14:15], s[66:67]
v_rcp_f32 v12, v12
v_rcp_f32 v13, v13
v_rcp_f32 v14, v14
v_rcp_f32 v15, v15
v_pk_mul_f32 v[96:97], v[96:97], v[12:13]
v_pk_mul_f32 v[98:99], v[98:99], v[14:15]
v_pk_mul_f32 v[12:13], v[100:101], s[64:65]
v_pk_mul_f32 v[14:15], v[102:103], s[64:65]
v_exp_f32 v12, v12
v_exp_f32 v13, v13
v_exp_f32 v14, v14
v_exp_f32 v15, v15
v_pk_add_f32 v[12:13], v[12:13], s[66:67]
v_pk_add_f32 v[14:15], v[14:15], s[66:67]
v_rcp_f32 v12, v12
v_rcp_f32 v13, v13
v_rcp_f32 v14, v14
v_rcp_f32 v15, v15
v_pk_mul_f32 v[100:101], v[100:101], v[12:13]
v_pk_mul_f32 v[102:103], v[102:103], v[14:15]
v_cvt_pk_bf16_f32 v96, v96, v97
v_cvt_pk_bf16_f32 v97, v98, v99
v_cvt_pk_bf16_f32 v98, v100, v101
v_cvt_pk_bf16_f32 v99, v102, v103
buffer_store_dwordx4 v[96:99], v10, s[4:7], s62 offen offset:0 sc1
v_pk_mul_f32 v[12:13], v[104:105], s[64:65]
v_pk_mul_f32 v[14:15], v[106:107], s[64:65]
v_exp_f32 v12, v12
v_exp_f32 v13, v13
v_exp_f32 v14, v14
v_exp_f32 v15, v15
v_pk_add_f32 v[12:13], v[12:13], s[66:67]
v_pk_add_f32 v[14:15], v[14:15], s[66:67]
v_rcp_f32 v12, v12
v_rcp_f32 v13, v13
v_rcp_f32 v14, v14
v_rcp_f32 v15, v15
v_pk_mul_f32 v[104:105], v[104:105], v[12:13]
v_pk_mul_f32 v[106:107], v[106:107], v[14:15]
v_pk_mul_f32 v[12:13], v[108:109], s[64:65]
v_pk_mul_f32 v[14:15], v[110:111], s[64:65]
v_exp_f32 v12, v12
v_exp_f32 v13, v13
v_exp_f32 v14, v14
v_exp_f32 v15, v15
v_pk_add_f32 v[12:13], v[12:13], s[66:67]
v_pk_add_f32 v[14:15], v[14:15], s[66:67]
v_rcp_f32 v12, v12
v_rcp_f32 v13, v13
v_rcp_f32 v14, v14
v_rcp_f32 v15, v15
v_pk_mul_f32 v[108:109], v[108:109], v[12:13]
v_pk_mul_f32 v[110:111], v[110:111], v[14:15]
v_cvt_pk_bf16_f32 v104, v104, v105
v_cvt_pk_bf16_f32 v105, v106, v107
v_cvt_pk_bf16_f32 v106, v108, v109
v_cvt_pk_bf16_f32 v107, v110, v111
buffer_store_dwordx4 v[104:107], v10, s[4:7], s62 offen offset:2048 sc1
v_pk_mul_f32 v[12:13], v[128:129], s[64:65]
v_pk_mul_f32 v[14:15], v[130:131], s[64:65]
v_exp_f32 v12, v12
v_exp_f32 v13, v13
v_exp_f32 v14, v14
v_exp_f32 v15, v15
v_pk_add_f32 v[12:13], v[12:13], s[66:67]
v_pk_add_f32 v[14:15], v[14:15], s[66:67]
v_rcp_f32 v12, v12
v_rcp_f32 v13, v13
v_rcp_f32 v14, v14
v_rcp_f32 v15, v15
v_pk_mul_f32 v[128:129], v[128:129], v[12:13]
v_pk_mul_f32 v[130:131], v[130:131], v[14:15]
v_pk_mul_f32 v[12:13], v[132:133], s[64:65]
v_pk_mul_f32 v[14:15], v[134:135], s[64:65]
v_exp_f32 v12, v12
v_exp_f32 v13, v13
v_exp_f32 v14, v14
v_exp_f32 v15, v15
v_pk_add_f32 v[12:13], v[12:13], s[66:67]
v_pk_add_f32 v[14:15], v[14:15], s[66:67]
v_rcp_f32 v12, v12
v_rcp_f32 v13, v13
v_rcp_f32 v14, v14
v_rcp_f32 v15, v15
v_pk_mul_f32 v[132:133], v[132:133], v[12:13]
v_pk_mul_f32 v[134:135], v[134:135], v[14:15]
v_cvt_pk_bf16_f32 v128, v128, v129
v_cvt_pk_bf16_f32 v129, v130, v131
v_cvt_pk_bf16_f32 v130, v132, v133
v_cvt_pk_bf16_f32 v131, v134, v135
buffer_store_dwordx4 v[128:131], v10, s[4:7], s62 offen offset:256 sc1
v_pk_mul_f32 v[12:13], v[136:137], s[64:65]
v_pk_mul_f32 v[14:15], v[138:139], s[64:65]
v_exp_f32 v12, v12
v_exp_f32 v13, v13
v_exp_f32 v14, v14
v_exp_f32 v15, v15
v_pk_add_f32 v[12:13], v[12:13], s[66:67]
v_pk_add_f32 v[14:15], v[14:15], s[66:67]
v_rcp_f32 v12, v12
v_rcp_f32 v13, v13
v_rcp_f32 v14, v14
v_rcp_f32 v15, v15
v_pk_mul_f32 v[136:137], v[136:137], v[12:13]
v_pk_mul_f32 v[138:139], v[138:139], v[14:15]
v_pk_mul_f32 v[12:13], v[140:141], s[64:65]
v_pk_mul_f32 v[14:15], v[142:143], s[64:65]
v_exp_f32 v12, v12
v_exp_f32 v13, v13
v_exp_f32 v14, v14
v_exp_f32 v15, v15
v_pk_add_f32 v[12:13], v[12:13], s[66:67]
v_pk_add_f32 v[14:15], v[14:15], s[66:67]
v_rcp_f32 v12, v12
v_rcp_f32 v13, v13
v_rcp_f32 v14, v14
v_rcp_f32 v15, v15
v_pk_mul_f32 v[140:141], v[140:141], v[12:13]
v_pk_mul_f32 v[142:143], v[142:143], v[14:15]
v_cvt_pk_bf16_f32 v136, v136, v137
v_cvt_pk_bf16_f32 v137, v138, v139
v_cvt_pk_bf16_f32 v138, v140, v141
v_cvt_pk_bf16_f32 v139, v142, v143
buffer_store_dwordx4 v[136:139], v10, s[4:7], s62 offen offset:2304 sc1
s_add_u32 s62, s23, 458752
v_pk_mul_f32 v[12:13], v[144:145], s[64:65]
v_pk_mul_f32 v[14:15], v[146:147], s[64:65]
v_exp_f32 v12, v12
v_exp_f32 v13, v13
v_exp_f32 v14, v14
v_exp_f32 v15, v15
v_pk_add_f32 v[12:13], v[12:13], s[66:67]
v_pk_add_f32 v[14:15], v[14:15], s[66:67]
v_rcp_f32 v12, v12
v_rcp_f32 v13, v13
v_rcp_f32 v14, v14
v_rcp_f32 v15, v15
v_pk_mul_f32 v[144:145], v[144:145], v[12:13]
v_pk_mul_f32 v[146:147], v[146:147], v[14:15]
v_pk_mul_f32 v[12:13], v[148:149], s[64:65]
v_pk_mul_f32 v[14:15], v[150:151], s[64:65]
v_exp_f32 v12, v12
v_exp_f32 v13, v13
v_exp_f32 v14, v14
v_exp_f32 v15, v15
v_pk_add_f32 v[12:13], v[12:13], s[66:67]
v_pk_add_f32 v[14:15], v[14:15], s[66:67]
v_rcp_f32 v12, v12
v_rcp_f32 v13, v13
v_rcp_f32 v14, v14
v_rcp_f32 v15, v15
v_pk_mul_f32 v[148:149], v[148:149], v[12:13]
v_pk_mul_f32 v[150:151], v[150:151], v[14:15]
v_cvt_pk_bf16_f32 v144, v144, v145
v_cvt_pk_bf16_f32 v145, v146, v147
v_cvt_pk_bf16_f32 v146, v148, v149
v_cvt_pk_bf16_f32 v147, v150, v151
buffer_store_dwordx4 v[144:147], v10, s[4:7], s62 offen offset:0 sc1
v_pk_mul_f32 v[12:13], v[152:153], s[64:65]
v_pk_mul_f32 v[14:15], v[154:155], s[64:65]
v_exp_f32 v12, v12
v_exp_f32 v13, v13
v_exp_f32 v14, v14
v_exp_f32 v15, v15
v_pk_add_f32 v[12:13], v[12:13], s[66:67]
v_pk_add_f32 v[14:15], v[14:15], s[66:67]
v_rcp_f32 v12, v12
v_rcp_f32 v13, v13
v_rcp_f32 v14, v14
v_rcp_f32 v15, v15
v_pk_mul_f32 v[152:153], v[152:153], v[12:13]
v_pk_mul_f32 v[154:155], v[154:155], v[14:15]
v_pk_mul_f32 v[12:13], v[156:157], s[64:65]
v_pk_mul_f32 v[14:15], v[158:159], s[64:65]
v_exp_f32 v12, v12
v_exp_f32 v13, v13
v_exp_f32 v14, v14
v_exp_f32 v15, v15
v_pk_add_f32 v[12:13], v[12:13], s[66:67]
v_pk_add_f32 v[14:15], v[14:15], s[66:67]
v_rcp_f32 v12, v12
v_rcp_f32 v13, v13
v_rcp_f32 v14, v14
v_rcp_f32 v15, v15
v_pk_mul_f32 v[156:157], v[156:157], v[12:13]
v_pk_mul_f32 v[158:159], v[158:159], v[14:15]
v_cvt_pk_bf16_f32 v152, v152, v153
v_cvt_pk_bf16_f32 v153, v154, v155
v_cvt_pk_bf16_f32 v154, v156, v157
v_cvt_pk_bf16_f32 v155, v158, v159
buffer_store_dwordx4 v[152:155], v10, s[4:7], s62 offen offset:2048 sc1
v_pk_mul_f32 v[12:13], v[176:177], s[64:65]
v_pk_mul_f32 v[14:15], v[178:179], s[64:65]
v_exp_f32 v12, v12
v_exp_f32 v13, v13
v_exp_f32 v14, v14
v_exp_f32 v15, v15
v_pk_add_f32 v[12:13], v[12:13], s[66:67]
v_pk_add_f32 v[14:15], v[14:15], s[66:67]
v_rcp_f32 v12, v12
v_rcp_f32 v13, v13
v_rcp_f32 v14, v14
v_rcp_f32 v15, v15
v_pk_mul_f32 v[176:177], v[176:177], v[12:13]
v_pk_mul_f32 v[178:179], v[178:179], v[14:15]
v_pk_mul_f32 v[12:13], v[180:181], s[64:65]
v_pk_mul_f32 v[14:15], v[182:183], s[64:65]
v_exp_f32 v12, v12
v_exp_f32 v13, v13
v_exp_f32 v14, v14
v_exp_f32 v15, v15
v_pk_add_f32 v[12:13], v[12:13], s[66:67]
v_pk_add_f32 v[14:15], v[14:15], s[66:67]
v_rcp_f32 v12, v12
v_rcp_f32 v13, v13
v_rcp_f32 v14, v14
v_rcp_f32 v15, v15
v_pk_mul_f32 v[180:181], v[180:181], v[12:13]
v_pk_mul_f32 v[182:183], v[182:183], v[14:15]
v_cvt_pk_bf16_f32 v176, v176, v177
v_cvt_pk_bf16_f32 v177, v178, v179
v_cvt_pk_bf16_f32 v178, v180, v181
v_cvt_pk_bf16_f32 v179, v182, v183
buffer_store_dwordx4 v[176:179], v10, s[4:7], s62 offen offset:256 sc1
v_pk_mul_f32 v[12:13], v[184:185], s[64:65]
v_pk_mul_f32 v[14:15], v[186:187], s[64:65]
v_exp_f32 v12, v12
v_exp_f32 v13, v13
v_exp_f32 v14, v14
v_exp_f32 v15, v15
v_pk_add_f32 v[12:13], v[12:13], s[66:67]
v_pk_add_f32 v[14:15], v[14:15], s[66:67]
v_rcp_f32 v12, v12
v_rcp_f32 v13, v13
v_rcp_f32 v14, v14
v_rcp_f32 v15, v15
v_pk_mul_f32 v[184:185], v[184:185], v[12:13]
v_pk_mul_f32 v[186:187], v[186:187], v[14:15]
v_pk_mul_f32 v[12:13], v[188:189], s[64:65]
v_pk_mul_f32 v[14:15], v[190:191], s[64:65]
v_exp_f32 v12, v12
v_exp_f32 v13, v13
v_exp_f32 v14, v14
v_exp_f32 v15, v15
v_pk_add_f32 v[12:13], v[12:13], s[66:67]
v_pk_add_f32 v[14:15], v[14:15], s[66:67]
v_rcp_f32 v12, v12
v_rcp_f32 v13, v13
v_rcp_f32 v14, v14
v_rcp_f32 v15, v15
v_pk_mul_f32 v[188:189], v[188:189], v[12:13]
v_pk_mul_f32 v[190:191], v[190:191], v[14:15]
v_cvt_pk_bf16_f32 v184, v184, v185
v_cvt_pk_bf16_f32 v185, v186, v187
v_cvt_pk_bf16_f32 v186, v188, v189
v_cvt_pk_bf16_f32 v187, v190, v191
buffer_store_dwordx4 v[184:187], v10, s[4:7], s62 offen offset:2304 sc1
s_add_u32 s62, s23, 462848
v_pk_mul_f32 v[12:13], v[160:161], s[64:65]
v_pk_mul_f32 v[14:15], v[162:163], s[64:65]
v_exp_f32 v12, v12
v_exp_f32 v13, v13
v_exp_f32 v14, v14
v_exp_f32 v15, v15
v_pk_add_f32 v[12:13], v[12:13], s[66:67]
v_pk_add_f32 v[14:15], v[14:15], s[66:67]
v_rcp_f32 v12, v12
v_rcp_f32 v13, v13
v_rcp_f32 v14, v14
v_rcp_f32 v15, v15
v_pk_mul_f32 v[160:161], v[160:161], v[12:13]
v_pk_mul_f32 v[162:163], v[162:163], v[14:15]
v_pk_mul_f32 v[12:13], v[164:165], s[64:65]
v_pk_mul_f32 v[14:15], v[166:167], s[64:65]
v_exp_f32 v12, v12
v_exp_f32 v13, v13
v_exp_f32 v14, v14
v_exp_f32 v15, v15
v_pk_add_f32 v[12:13], v[12:13], s[66:67]
v_pk_add_f32 v[14:15], v[14:15], s[66:67]
v_rcp_f32 v12, v12
v_rcp_f32 v13, v13
v_rcp_f32 v14, v14
v_rcp_f32 v15, v15
v_pk_mul_f32 v[164:165], v[164:165], v[12:13]
v_pk_mul_f32 v[166:167], v[166:167], v[14:15]
v_cvt_pk_bf16_f32 v160, v160, v161
v_cvt_pk_bf16_f32 v161, v162, v163
v_cvt_pk_bf16_f32 v162, v164, v165
v_cvt_pk_bf16_f32 v163, v166, v167
buffer_store_dwordx4 v[160:163], v10, s[4:7], s62 offen offset:0 sc1
v_pk_mul_f32 v[12:13], v[168:169], s[64:65]
v_pk_mul_f32 v[14:15], v[170:171], s[64:65]
v_exp_f32 v12, v12
v_exp_f32 v13, v13
v_exp_f32 v14, v14
v_exp_f32 v15, v15
v_pk_add_f32 v[12:13], v[12:13], s[66:67]
v_pk_add_f32 v[14:15], v[14:15], s[66:67]
v_rcp_f32 v12, v12
v_rcp_f32 v13, v13
v_rcp_f32 v14, v14
v_rcp_f32 v15, v15
v_pk_mul_f32 v[168:169], v[168:169], v[12:13]
v_pk_mul_f32 v[170:171], v[170:171], v[14:15]
v_pk_mul_f32 v[12:13], v[172:173], s[64:65]
v_pk_mul_f32 v[14:15], v[174:175], s[64:65]
v_exp_f32 v12, v12
v_exp_f32 v13, v13
v_exp_f32 v14, v14
v_exp_f32 v15, v15
v_pk_add_f32 v[12:13], v[12:13], s[66:67]
v_pk_add_f32 v[14:15], v[14:15], s[66:67]
v_rcp_f32 v12, v12
v_rcp_f32 v13, v13
v_rcp_f32 v14, v14
v_rcp_f32 v15, v15
v_pk_mul_f32 v[172:173], v[172:173], v[12:13]
v_pk_mul_f32 v[174:175], v[174:175], v[14:15]
v_cvt_pk_bf16_f32 v168, v168, v169
v_cvt_pk_bf16_f32 v169, v170, v171
v_cvt_pk_bf16_f32 v170, v172, v173
v_cvt_pk_bf16_f32 v171, v174, v175
buffer_store_dwordx4 v[168:171], v10, s[4:7], s62 offen offset:2048 sc1
v_pk_mul_f32 v[12:13], v[192:193], s[64:65]
v_pk_mul_f32 v[14:15], v[194:195], s[64:65]
v_exp_f32 v12, v12
v_exp_f32 v13, v13
v_exp_f32 v14, v14
v_exp_f32 v15, v15
v_pk_add_f32 v[12:13], v[12:13], s[66:67]
v_pk_add_f32 v[14:15], v[14:15], s[66:67]
v_rcp_f32 v12, v12
v_rcp_f32 v13, v13
v_rcp_f32 v14, v14
v_rcp_f32 v15, v15
v_pk_mul_f32 v[192:193], v[192:193], v[12:13]
v_pk_mul_f32 v[194:195], v[194:195], v[14:15]
v_pk_mul_f32 v[12:13], v[196:197], s[64:65]
v_pk_mul_f32 v[14:15], v[198:199], s[64:65]
v_exp_f32 v12, v12
v_exp_f32 v13, v13
v_exp_f32 v14, v14
v_exp_f32 v15, v15
v_pk_add_f32 v[12:13], v[12:13], s[66:67]
v_pk_add_f32 v[14:15], v[14:15], s[66:67]
v_rcp_f32 v12, v12
v_rcp_f32 v13, v13
v_rcp_f32 v14, v14
v_rcp_f32 v15, v15
v_pk_mul_f32 v[196:197], v[196:197], v[12:13]
v_pk_mul_f32 v[198:199], v[198:199], v[14:15]
v_cvt_pk_bf16_f32 v192, v192, v193
v_cvt_pk_bf16_f32 v193, v194, v195
v_cvt_pk_bf16_f32 v194, v196, v197
v_cvt_pk_bf16_f32 v195, v198, v199
buffer_store_dwordx4 v[192:195], v10, s[4:7], s62 offen offset:256 sc1
v_pk_mul_f32 v[12:13], v[200:201], s[64:65]
v_pk_mul_f32 v[14:15], v[202:203], s[64:65]
v_exp_f32 v12, v12
v_exp_f32 v13, v13
v_exp_f32 v14, v14
v_exp_f32 v15, v15
v_pk_add_f32 v[12:13], v[12:13], s[66:67]
v_pk_add_f32 v[14:15], v[14:15], s[66:67]
v_rcp_f32 v12, v12
v_rcp_f32 v13, v13
v_rcp_f32 v14, v14
v_rcp_f32 v15, v15
v_pk_mul_f32 v[200:201], v[200:201], v[12:13]
v_pk_mul_f32 v[202:203], v[202:203], v[14:15]
v_pk_mul_f32 v[12:13], v[204:205], s[64:65]
v_pk_mul_f32 v[14:15], v[206:207], s[64:65]
v_exp_f32 v12, v12
v_exp_f32 v13, v13
v_exp_f32 v14, v14
v_exp_f32 v15, v15
v_pk_add_f32 v[12:13], v[12:13], s[66:67]
v_pk_add_f32 v[14:15], v[14:15], s[66:67]
v_rcp_f32 v12, v12
v_rcp_f32 v13, v13
v_rcp_f32 v14, v14
v_rcp_f32 v15, v15
v_pk_mul_f32 v[204:205], v[204:205], v[12:13]
v_pk_mul_f32 v[206:207], v[206:207], v[14:15]
v_cvt_pk_bf16_f32 v200, v200, v201
v_cvt_pk_bf16_f32 v201, v202, v203
v_cvt_pk_bf16_f32 v202, v204, v205
v_cvt_pk_bf16_f32 v203, v206, v207
buffer_store_dwordx4 v[200:203], v10, s[4:7], s62 offen offset:2304 sc1
s_add_u32 s62, s23, 688128
v_pk_mul_f32 v[12:13], v[208:209], s[64:65]
v_pk_mul_f32 v[14:15], v[210:211], s[64:65]
v_exp_f32 v12, v12
v_exp_f32 v13, v13
v_exp_f32 v14, v14
v_exp_f32 v15, v15
v_pk_add_f32 v[12:13], v[12:13], s[66:67]
v_pk_add_f32 v[14:15], v[14:15], s[66:67]
v_rcp_f32 v12, v12
v_rcp_f32 v13, v13
v_rcp_f32 v14, v14
v_rcp_f32 v15, v15
v_pk_mul_f32 v[208:209], v[208:209], v[12:13]
v_pk_mul_f32 v[210:211], v[210:211], v[14:15]
v_pk_mul_f32 v[12:13], v[212:213], s[64:65]
v_pk_mul_f32 v[14:15], v[214:215], s[64:65]
v_exp_f32 v12, v12
v_exp_f32 v13, v13
v_exp_f32 v14, v14
v_exp_f32 v15, v15
v_pk_add_f32 v[12:13], v[12:13], s[66:67]
v_pk_add_f32 v[14:15], v[14:15], s[66:67]
v_rcp_f32 v12, v12
v_rcp_f32 v13, v13
v_rcp_f32 v14, v14
v_rcp_f32 v15, v15
v_pk_mul_f32 v[212:213], v[212:213], v[12:13]
v_pk_mul_f32 v[214:215], v[214:215], v[14:15]
v_cvt_pk_bf16_f32 v208, v208, v209
v_cvt_pk_bf16_f32 v209, v210, v211
v_cvt_pk_bf16_f32 v210, v212, v213
v_cvt_pk_bf16_f32 v211, v214, v215
buffer_store_dwordx4 v[208:211], v10, s[4:7], s62 offen offset:0 sc1
v_pk_mul_f32 v[12:13], v[216:217], s[64:65]
v_pk_mul_f32 v[14:15], v[218:219], s[64:65]
v_exp_f32 v12, v12
v_exp_f32 v13, v13
v_exp_f32 v14, v14
v_exp_f32 v15, v15
v_pk_add_f32 v[12:13], v[12:13], s[66:67]
v_pk_add_f32 v[14:15], v[14:15], s[66:67]
v_rcp_f32 v12, v12
v_rcp_f32 v13, v13
v_rcp_f32 v14, v14
v_rcp_f32 v15, v15
v_pk_mul_f32 v[216:217], v[216:217], v[12:13]
v_pk_mul_f32 v[218:219], v[218:219], v[14:15]
v_pk_mul_f32 v[12:13], v[220:221], s[64:65]
v_pk_mul_f32 v[14:15], v[222:223], s[64:65]
v_exp_f32 v12, v12
v_exp_f32 v13, v13
v_exp_f32 v14, v14
v_exp_f32 v15, v15
v_pk_add_f32 v[12:13], v[12:13], s[66:67]
v_pk_add_f32 v[14:15], v[14:15], s[66:67]
v_rcp_f32 v12, v12
v_rcp_f32 v13, v13
v_rcp_f32 v14, v14
v_rcp_f32 v15, v15
v_pk_mul_f32 v[220:221], v[220:221], v[12:13]
v_pk_mul_f32 v[222:223], v[222:223], v[14:15]
v_cvt_pk_bf16_f32 v216, v216, v217
v_cvt_pk_bf16_f32 v217, v218, v219
v_cvt_pk_bf16_f32 v218, v220, v221
v_cvt_pk_bf16_f32 v219, v222, v223
buffer_store_dwordx4 v[216:219], v10, s[4:7], s62 offen offset:2048 sc1
v_pk_mul_f32 v[12:13], v[240:241], s[64:65]
v_pk_mul_f32 v[14:15], v[242:243], s[64:65]
v_exp_f32 v12, v12
v_exp_f32 v13, v13
v_exp_f32 v14, v14
v_exp_f32 v15, v15
v_pk_add_f32 v[12:13], v[12:13], s[66:67]
v_pk_add_f32 v[14:15], v[14:15], s[66:67]
v_rcp_f32 v12, v12
v_rcp_f32 v13, v13
v_rcp_f32 v14, v14
v_rcp_f32 v15, v15
v_pk_mul_f32 v[240:241], v[240:241], v[12:13]
v_pk_mul_f32 v[242:243], v[242:243], v[14:15]
v_pk_mul_f32 v[12:13], v[244:245], s[64:65]
v_pk_mul_f32 v[14:15], v[246:247], s[64:65]
v_exp_f32 v12, v12
v_exp_f32 v13, v13
v_exp_f32 v14, v14
v_exp_f32 v15, v15
v_pk_add_f32 v[12:13], v[12:13], s[66:67]
v_pk_add_f32 v[14:15], v[14:15], s[66:67]
v_rcp_f32 v12, v12
v_rcp_f32 v13, v13
v_rcp_f32 v14, v14
v_rcp_f32 v15, v15
v_pk_mul_f32 v[244:245], v[244:245], v[12:13]
v_pk_mul_f32 v[246:247], v[246:247], v[14:15]
v_cvt_pk_bf16_f32 v240, v240, v241
v_cvt_pk_bf16_f32 v241, v242, v243
v_cvt_pk_bf16_f32 v242, v244, v245
v_cvt_pk_bf16_f32 v243, v246, v247
buffer_store_dwordx4 v[240:243], v10, s[4:7], s62 offen offset:256 sc1
v_pk_mul_f32 v[12:13], v[248:249], s[64:65]
v_pk_mul_f32 v[14:15], v[250:251], s[64:65]
v_exp_f32 v12, v12
v_exp_f32 v13, v13
v_exp_f32 v14, v14
v_exp_f32 v15, v15
v_pk_add_f32 v[12:13], v[12:13], s[66:67]
v_pk_add_f32 v[14:15], v[14:15], s[66:67]
v_rcp_f32 v12, v12
v_rcp_f32 v13, v13
v_rcp_f32 v14, v14
v_rcp_f32 v15, v15
v_pk_mul_f32 v[248:249], v[248:249], v[12:13]
v_pk_mul_f32 v[250:251], v[250:251], v[14:15]
v_pk_mul_f32 v[12:13], v[252:253], s[64:65]
v_pk_mul_f32 v[14:15], v[254:255], s[64:65]
v_exp_f32 v12, v12
v_exp_f32 v13, v13
v_exp_f32 v14, v14
v_exp_f32 v15, v15
v_pk_add_f32 v[12:13], v[12:13], s[66:67]
v_pk_add_f32 v[14:15], v[14:15], s[66:67]
v_rcp_f32 v12, v12
v_rcp_f32 v13, v13
v_rcp_f32 v14, v14
v_rcp_f32 v15, v15
v_pk_mul_f32 v[252:253], v[252:253], v[12:13]
v_pk_mul_f32 v[254:255], v[254:255], v[14:15]
v_cvt_pk_bf16_f32 v248, v248, v249
v_cvt_pk_bf16_f32 v249, v250, v251
v_cvt_pk_bf16_f32 v250, v252, v253
v_cvt_pk_bf16_f32 v251, v254, v255
buffer_store_dwordx4 v[248:251], v10, s[4:7], s62 offen offset:2304 sc1
s_add_u32 s62, s23, 692224
v_pk_mul_f32 v[12:13], v[224:225], s[64:65]
v_pk_mul_f32 v[14:15], v[226:227], s[64:65]
v_exp_f32 v12, v12
v_exp_f32 v13, v13
v_exp_f32 v14, v14
v_exp_f32 v15, v15
v_pk_add_f32 v[12:13], v[12:13], s[66:67]
v_pk_add_f32 v[14:15], v[14:15], s[66:67]
v_rcp_f32 v12, v12
v_rcp_f32 v13, v13
v_rcp_f32 v14, v14
v_rcp_f32 v15, v15
v_pk_mul_f32 v[224:225], v[224:225], v[12:13]
v_pk_mul_f32 v[226:227], v[226:227], v[14:15]
v_pk_mul_f32 v[12:13], v[228:229], s[64:65]
v_pk_mul_f32 v[14:15], v[230:231], s[64:65]
v_exp_f32 v12, v12
v_exp_f32 v13, v13
v_exp_f32 v14, v14
v_exp_f32 v15, v15
v_pk_add_f32 v[12:13], v[12:13], s[66:67]
v_pk_add_f32 v[14:15], v[14:15], s[66:67]
v_rcp_f32 v12, v12
v_rcp_f32 v13, v13
v_rcp_f32 v14, v14
v_rcp_f32 v15, v15
v_pk_mul_f32 v[228:229], v[228:229], v[12:13]
v_pk_mul_f32 v[230:231], v[230:231], v[14:15]
v_cvt_pk_bf16_f32 v224, v224, v225
v_cvt_pk_bf16_f32 v225, v226, v227
v_cvt_pk_bf16_f32 v226, v228, v229
v_cvt_pk_bf16_f32 v227, v230, v231
buffer_store_dwordx4 v[224:227], v10, s[4:7], s62 offen offset:0 sc1
v_pk_mul_f32 v[12:13], v[232:233], s[64:65]
v_pk_mul_f32 v[14:15], v[234:235], s[64:65]
v_exp_f32 v12, v12
v_exp_f32 v13, v13
v_exp_f32 v14, v14
v_exp_f32 v15, v15
v_pk_add_f32 v[12:13], v[12:13], s[66:67]
v_pk_add_f32 v[14:15], v[14:15], s[66:67]
v_rcp_f32 v12, v12
v_rcp_f32 v13, v13
v_rcp_f32 v14, v14
v_rcp_f32 v15, v15
v_pk_mul_f32 v[232:233], v[232:233], v[12:13]
v_pk_mul_f32 v[234:235], v[234:235], v[14:15]
v_pk_mul_f32 v[12:13], v[236:237], s[64:65]
v_pk_mul_f32 v[14:15], v[238:239], s[64:65]
v_exp_f32 v12, v12
v_exp_f32 v13, v13
v_exp_f32 v14, v14
v_exp_f32 v15, v15
v_pk_add_f32 v[12:13], v[12:13], s[66:67]
v_pk_add_f32 v[14:15], v[14:15], s[66:67]
v_rcp_f32 v12, v12
v_rcp_f32 v13, v13
v_rcp_f32 v14, v14
v_rcp_f32 v15, v15
v_pk_mul_f32 v[236:237], v[236:237], v[12:13]
v_pk_mul_f32 v[238:239], v[238:239], v[14:15]
v_cvt_pk_bf16_f32 v232, v232, v233
v_cvt_pk_bf16_f32 v233, v234, v235
v_cvt_pk_bf16_f32 v234, v236, v237
v_cvt_pk_bf16_f32 v235, v238, v239
buffer_store_dwordx4 v[232:235], v10, s[4:7], s62 offen offset:2048 sc1
v_accvgpr_read_b32 v16, a128
v_accvgpr_read_b32 v17, a129
v_accvgpr_read_b32 v18, a130
v_accvgpr_read_b32 v19, a131
v_accvgpr_read_b32 v20, a132
v_accvgpr_read_b32 v21, a133
v_accvgpr_read_b32 v22, a134
v_accvgpr_read_b32 v23, a135
v_pk_mul_f32 v[12:13], v[16:17], s[64:65]
v_pk_mul_f32 v[14:15], v[18:19], s[64:65]
v_exp_f32 v12, v12
v_exp_f32 v13, v13
v_exp_f32 v14, v14
v_exp_f32 v15, v15
v_pk_add_f32 v[12:13], v[12:13], s[66:67]
v_pk_add_f32 v[14:15], v[14:15], s[66:67]
v_rcp_f32 v12, v12
v_rcp_f32 v13, v13
v_rcp_f32 v14, v14
v_rcp_f32 v15, v15
v_pk_mul_f32 v[16:17], v[16:17], v[12:13]
v_pk_mul_f32 v[18:19], v[18:19], v[14:15]
v_pk_mul_f32 v[12:13], v[20:21], s[64:65]
v_pk_mul_f32 v[14:15], v[22:23], s[64:65]
v_exp_f32 v12, v12
v_exp_f32 v13, v13
v_exp_f32 v14, v14
v_exp_f32 v15, v15
v_pk_add_f32 v[12:13], v[12:13], s[66:67]
v_pk_add_f32 v[14:15], v[14:15], s[66:67]
v_rcp_f32 v12, v12
v_rcp_f32 v13, v13
v_rcp_f32 v14, v14
v_rcp_f32 v15, v15
v_pk_mul_f32 v[20:21], v[20:21], v[12:13]
v_pk_mul_f32 v[22:23], v[22:23], v[14:15]
v_cvt_pk_bf16_f32 v16, v16, v17
v_cvt_pk_bf16_f32 v17, v18, v19
v_cvt_pk_bf16_f32 v18, v20, v21
v_cvt_pk_bf16_f32 v19, v22, v23
buffer_store_dwordx4 v[16:19], v10, s[4:7], s62 offen offset:256 sc1
s_nop 1
v_accvgpr_read_b32 v16, a136
v_accvgpr_read_b32 v17, a137
v_accvgpr_read_b32 v18, a138
v_accvgpr_read_b32 v19, a139
v_accvgpr_read_b32 v20, a140
v_accvgpr_read_b32 v21, a141
v_accvgpr_read_b32 v22, a142
v_accvgpr_read_b32 v23, a143
v_pk_mul_f32 v[12:13], v[16:17], s[64:65]
v_pk_mul_f32 v[14:15], v[18:19], s[64:65]
v_exp_f32 v12, v12
v_exp_f32 v13, v13
v_exp_f32 v14, v14
v_exp_f32 v15, v15
v_pk_add_f32 v[12:13], v[12:13], s[66:67]
v_pk_add_f32 v[14:15], v[14:15], s[66:67]
v_rcp_f32 v12, v12
v_rcp_f32 v13, v13
v_rcp_f32 v14, v14
v_rcp_f32 v15, v15
v_pk_mul_f32 v[16:17], v[16:17], v[12:13]
v_pk_mul_f32 v[18:19], v[18:19], v[14:15]
v_pk_mul_f32 v[12:13], v[20:21], s[64:65]
v_pk_mul_f32 v[14:15], v[22:23], s[64:65]
v_exp_f32 v12, v12
v_exp_f32 v13, v13
v_exp_f32 v14, v14
v_exp_f32 v15, v15
v_pk_add_f32 v[12:13], v[12:13], s[66:67]
v_pk_add_f32 v[14:15], v[14:15], s[66:67]
v_rcp_f32 v12, v12
v_rcp_f32 v13, v13
v_rcp_f32 v14, v14
v_rcp_f32 v15, v15
v_pk_mul_f32 v[20:21], v[20:21], v[12:13]
v_pk_mul_f32 v[22:23], v[22:23], v[14:15]
v_cvt_pk_bf16_f32 v16, v16, v17
v_cvt_pk_bf16_f32 v17, v18, v19
v_cvt_pk_bf16_f32 v18, v20, v21
v_cvt_pk_bf16_f32 v19, v22, v23
buffer_store_dwordx4 v[16:19], v10, s[4:7], s62 offen offset:2304 sc1
s_branch m_g_nx1
m_g_ek:
s_lshl_b32 s62, s19, 1
s_add_u32 s62, s62, s32
s_mul_i32 s62, s62, 2097152
s_lshl_b32 s63, s20, 1
s_add_u32 s63, s63, s33
s_lshl_b32 s63, s63, 14
s_add_u32 s23, s62, s63
s_add_u32 s23, s23, 25165824
s_lshl_b32 s62, s32, 13
s_xor_b32 s62, s62, s34
s_add_u32 s23, s23, s62
s_lshl_b32 s21, s19, 4
s_add_u32 s21, s21, s20
s_lshl_b32 s21, s21, 6
s_add_u32 s21, s21, 170926080
v_lshrrev_b32 v10, 4, v0
v_lshlrev_b32 v10, 9, v10
v_and_b32 v11, 15, v0
v_lshl_add_u32 v10, v11, 4, v10
s_add_u32 s62, s23, 0
s_xor_b32 s63, s62, 8192
v_cvt_pk_bf16_f32 v16, v16, v17
v_cvt_pk_bf16_f32 v17, v18, v19
v_cvt_pk_bf16_f32 v18, v20, v21
v_cvt_pk_bf16_f32 v19, v22, v23
buffer_store_dwordx4 v[16:19], v10, s[4:7], s62 offen offset:0 sc1
buffer_store_dwordx4 v[16:19], v10, s[4:7], s63 offen offset:0 sc1
v_cvt_pk_bf16_f32 v24, v24, v25
v_cvt_pk_bf16_f32 v25, v26, v27
v_cvt_pk_bf16_f32 v26, v28, v29
v_cvt_pk_bf16_f32 v27, v30, v31
buffer_store_dwordx4 v[24:27], v10, s[4:7], s62 offen offset:2048 sc1
buffer_store_dwordx4 v[24:27], v10, s[4:7], s63 offen offset:2048 sc1
v_cvt_pk_bf16_f32 v48, v48, v49
v_cvt_pk_bf16_f32 v49, v50, v51
v_cvt_pk_bf16_f32 v50, v52, v53
v_cvt_pk_bf16_f32 v51, v54, v55
buffer_store_dwordx4 v[48:51], v10, s[4:7], s62 offen offset:256 sc1
buffer_store_dwordx4 v[48:51], v10, s[4:7], s63 offen offset:256 sc1
v_cvt_pk_bf16_f32 v56, v56, v57
v_cvt_pk_bf16_f32 v57, v58, v59
v_cvt_pk_bf16_f32 v58, v60, v61
v_cvt_pk_bf16_f32 v59, v62, v63
buffer_store_dwordx4 v[56:59], v10, s[4:7], s62 offen offset:2304 sc1
buffer_store_dwordx4 v[56:59], v10, s[4:7], s63 offen offset:2304 sc1
s_add_u32 s62, s23, 4096
s_xor_b32 s63, s62, 8192
v_cvt_pk_bf16_f32 v32, v32, v33
v_cvt_pk_bf16_f32 v33, v34, v35
v_cvt_pk_bf16_f32 v34, v36, v37
v_cvt_pk_bf16_f32 v35, v38, v39
buffer_store_dwordx4 v[32:35], v10, s[4:7], s62 offen offset:0 sc1
buffer_store_dwordx4 v[32:35], v10, s[4:7], s63 offen offset:0 sc1
v_cvt_pk_bf16_f32 v40, v40, v41
v_cvt_pk_bf16_f32 v41, v42, v43
v_cvt_pk_bf16_f32 v42, v44, v45
v_cvt_pk_bf16_f32 v43, v46, v47
buffer_store_dwordx4 v[40:43], v10, s[4:7], s62 offen offset:2048 sc1
buffer_store_dwordx4 v[40:43], v10, s[4:7], s63 offen offset:2048 sc1
v_cvt_pk_bf16_f32 v64, v64, v65
v_cvt_pk_bf16_f32 v65, v66, v67
v_cvt_pk_bf16_f32 v66, v68, v69
v_cvt_pk_bf16_f32 v67, v70, v71
buffer_store_dwordx4 v[64:67], v10, s[4:7], s62 offen offset:256 sc1
buffer_store_dwordx4 v[64:67], v10, s[4:7], s63 offen offset:256 sc1
v_cvt_pk_bf16_f32 v72, v72, v73
v_cvt_pk_bf16_f32 v73, v74, v75
v_cvt_pk_bf16_f32 v74, v76, v77
v_cvt_pk_bf16_f32 v75, v78, v79
buffer_store_dwordx4 v[72:75], v10, s[4:7], s62 offen offset:2304 sc1
buffer_store_dwordx4 v[72:75], v10, s[4:7], s63 offen offset:2304 sc1
s_add_u32 s62, s23, 524288
s_xor_b32 s63, s62, 8192
v_cvt_pk_bf16_f32 v80, v80, v81
v_cvt_pk_bf16_f32 v81, v82, v83
v_cvt_pk_bf16_f32 v82, v84, v85
v_cvt_pk_bf16_f32 v83, v86, v87
buffer_store_dwordx4 v[80:83], v10, s[4:7], s62 offen offset:0 sc1
buffer_store_dwordx4 v[80:83], v10, s[4:7], s63 offen offset:0 sc1
v_cvt_pk_bf16_f32 v88, v88, v89
v_cvt_pk_bf16_f32 v89, v90, v91
v_cvt_pk_bf16_f32 v90, v92, v93
v_cvt_pk_bf16_f32 v91, v94, v95
buffer_store_dwordx4 v[88:91], v10, s[4:7], s62 offen offset:2048 sc1
buffer_store_dwordx4 v[88:91], v10, s[4:7], s63 offen offset:2048 sc1
v_cvt_pk_bf16_f32 v112, v112, v113
v_cvt_pk_bf16_f32 v113, v114, v115
v_cvt_pk_bf16_f32 v114, v116, v117
v_cvt_pk_bf16_f32 v115, v118, v119
buffer_store_dwordx4 v[112:115], v10, s[4:7], s62 offen offset:256 sc1
buffer_store_dwordx4 v[112:115], v10, s[4:7], s63 offen offset:256 sc1
v_cvt_pk_bf16_f32 v120, v120, v121
v_cvt_pk_bf16_f32 v121, v122, v123
v_cvt_pk_bf16_f32 v122, v124, v125
v_cvt_pk_bf16_f32 v123, v126, v127
buffer_store_dwordx4 v[120:123], v10, s[4:7], s62 offen offset:2304 sc1
buffer_store_dwordx4 v[120:123], v10, s[4:7], s63 offen offset:2304 sc1
s_add_u32 s62, s23, 528384
s_xor_b32 s63, s62, 8192
v_cvt_pk_bf16_f32 v96, v96, v97
v_cvt_pk_bf16_f32 v97, v98, v99
v_cvt_pk_bf16_f32 v98, v100, v101
v_cvt_pk_bf16_f32 v99, v102, v103
buffer_store_dwordx4 v[96:99], v10, s[4:7], s62 offen offset:0 sc1
buffer_store_dwordx4 v[96:99], v10, s[4:7], s63 offen offset:0 sc1
v_cvt_pk_bf16_f32 v104, v104, v105
v_cvt_pk_bf16_f32 v105, v106, v107
v_cvt_pk_bf16_f32 v106, v108, v109
v_cvt_pk_bf16_f32 v107, v110, v111
buffer_store_dwordx4 v[104:107], v10, s[4:7], s62 offen offset:2048 sc1
buffer_store_dwordx4 v[104:107], v10, s[4:7], s63 offen offset:2048 sc1
v_cvt_pk_bf16_f32 v128, v128, v129
v_cvt_pk_bf16_f32 v129, v130, v131
v_cvt_pk_bf16_f32 v130, v132, v133
v_cvt_pk_bf16_f32 v131, v134, v135
buffer_store_dwordx4 v[128:131], v10, s[4:7], s62 offen offset:256 sc1
buffer_store_dwordx4 v[128:131], v10, s[4:7], s63 offen offset:256 sc1
v_cvt_pk_bf16_f32 v136, v136, v137
v_cvt_pk_bf16_f32 v137, v138, v139
v_cvt_pk_bf16_f32 v138, v140, v141
v_cvt_pk_bf16_f32 v139, v142, v143
buffer_store_dwordx4 v[136:139], v10, s[4:7], s62 offen offset:2304 sc1
buffer_store_dwordx4 v[136:139], v10, s[4:7], s63 offen offset:2304 sc1
s_add_u32 s62, s23, 1048576
s_xor_b32 s63, s62, 8192
v_cvt_pk_bf16_f32 v144, v144, v145
v_cvt_pk_bf16_f32 v145, v146, v147
v_cvt_pk_bf16_f32 v146, v148, v149
v_cvt_pk_bf16_f32 v147, v150, v151
buffer_store_dwordx4 v[144:147], v10, s[4:7], s62 offen offset:0 sc1
buffer_store_dwordx4 v[144:147], v10, s[4:7], s63 offen offset:0 sc1
v_cvt_pk_bf16_f32 v152, v152, v153
v_cvt_pk_bf16_f32 v153, v154, v155
v_cvt_pk_bf16_f32 v154, v156, v157
v_cvt_pk_bf16_f32 v155, v158, v159
buffer_store_dwordx4 v[152:155], v10, s[4:7], s62 offen offset:2048 sc1
buffer_store_dwordx4 v[152:155], v10, s[4:7], s63 offen offset:2048 sc1
v_cvt_pk_bf16_f32 v176, v176, v177
v_cvt_pk_bf16_f32 v177, v178, v179
v_cvt_pk_bf16_f32 v178, v180, v181
v_cvt_pk_bf16_f32 v179, v182, v183
buffer_store_dwordx4 v[176:179], v10, s[4:7], s62 offen offset:256 sc1
buffer_store_dwordx4 v[176:179], v10, s[4:7], s63 offen offset:256 sc1
v_cvt_pk_bf16_f32 v184, v184, v185
v_cvt_pk_bf16_f32 v185, v186, v187
v_cvt_pk_bf16_f32 v186, v188, v189
v_cvt_pk_bf16_f32 v187, v190, v191
buffer_store_dwordx4 v[184:187], v10, s[4:7], s62 offen offset:2304 sc1
buffer_store_dwordx4 v[184:187], v10, s[4:7], s63 offen offset:2304 sc1
s_add_u32 s62, s23, 1052672
s_xor_b32 s63, s62, 8192
v_cvt_pk_bf16_f32 v160, v160, v161
v_cvt_pk_bf16_f32 v161, v162, v163
v_cvt_pk_bf16_f32 v162, v164, v165
v_cvt_pk_bf16_f32 v163, v166, v167
buffer_store_dwordx4 v[160:163], v10, s[4:7], s62 offen offset:0 sc1
buffer_store_dwordx4 v[160:163], v10, s[4:7], s63 offen offset:0 sc1
v_cvt_pk_bf16_f32 v168, v168, v169
v_cvt_pk_bf16_f32 v169, v170, v171
v_cvt_pk_bf16_f32 v170, v172, v173
v_cvt_pk_bf16_f32 v171, v174, v175
buffer_store_dwordx4 v[168:171], v10, s[4:7], s62 offen offset:2048 sc1
buffer_store_dwordx4 v[168:171], v10, s[4:7], s63 offen offset:2048 sc1
v_cvt_pk_bf16_f32 v192, v192, v193
v_cvt_pk_bf16_f32 v193, v194, v195
v_cvt_pk_bf16_f32 v194, v196, v197
v_cvt_pk_bf16_f32 v195, v198, v199
buffer_store_dwordx4 v[192:195], v10, s[4:7], s62 offen offset:256 sc1
buffer_store_dwordx4 v[192:195], v10, s[4:7], s63 offen offset:256 sc1
v_cvt_pk_bf16_f32 v200, v200, v201
v_cvt_pk_bf16_f32 v201, v202, v203
v_cvt_pk_bf16_f32 v202, v204, v205
v_cvt_pk_bf16_f32 v203, v206, v207
buffer_store_dwordx4 v[200:203], v10, s[4:7], s62 offen offset:2304 sc1
buffer_store_dwordx4 v[200:203], v10, s[4:7], s63 offen offset:2304 sc1
s_add_u32 s62, s23, 1572864
s_xor_b32 s63, s62, 8192
v_cvt_pk_bf16_f32 v208, v208, v209
v_cvt_pk_bf16_f32 v209, v210, v211
v_cvt_pk_bf16_f32 v210, v212, v213
v_cvt_pk_bf16_f32 v211, v214, v215
buffer_store_dwordx4 v[208:211], v10, s[4:7], s62 offen offset:0 sc1
buffer_store_dwordx4 v[208:211], v10, s[4:7], s63 offen offset:0 sc1
v_cvt_pk_bf16_f32 v216, v216, v217
v_cvt_pk_bf16_f32 v217, v218, v219
v_cvt_pk_bf16_f32 v218, v220, v221
v_cvt_pk_bf16_f32 v219, v222, v223
buffer_store_dwordx4 v[216:219], v10, s[4:7], s62 offen offset:2048 sc1
buffer_store_dwordx4 v[216:219], v10, s[4:7], s63 offen offset:2048 sc1
v_cvt_pk_bf16_f32 v240, v240, v241
v_cvt_pk_bf16_f32 v241, v242, v243
v_cvt_pk_bf16_f32 v242, v244, v245
v_cvt_pk_bf16_f32 v243, v246, v247
buffer_store_dwordx4 v[240:243], v10, s[4:7], s62 offen offset:256 sc1
buffer_store_dwordx4 v[240:243], v10, s[4:7], s63 offen offset:256 sc1
v_cvt_pk_bf16_f32 v248, v248, v249
v_cvt_pk_bf16_f32 v249, v250, v251
v_cvt_pk_bf16_f32 v250, v252, v253
v_cvt_pk_bf16_f32 v251, v254, v255
buffer_store_dwordx4 v[248:251], v10, s[4:7], s62 offen offset:2304 sc1
buffer_store_dwordx4 v[248:251], v10, s[4:7], s63 offen offset:2304 sc1
s_add_u32 s62, s23, 1576960
s_xor_b32 s63, s62, 8192
v_cvt_pk_bf16_f32 v224, v224, v225
v_cvt_pk_bf16_f32 v225, v226, v227
v_cvt_pk_bf16_f32 v226, v228, v229
v_cvt_pk_bf16_f32 v227, v230, v231
buffer_store_dwordx4 v[224:227], v10, s[4:7], s62 offen offset:0 sc1
buffer_store_dwordx4 v[224:227], v10, s[4:7], s63 offen offset:0 sc1
v_cvt_pk_bf16_f32 v232, v232, v233
v_cvt_pk_bf16_f32 v233, v234, v235
v_cvt_pk_bf16_f32 v234, v236, v237
v_cvt_pk_bf16_f32 v235, v238, v239
buffer_store_dwordx4 v[232:235], v10, s[4:7], s62 offen offset:2048 sc1
buffer_store_dwordx4 v[232:235], v10, s[4:7], s63 offen offset:2048 sc1
v_accvgpr_read_b32 v16, a128
v_accvgpr_read_b32 v17, a129
v_accvgpr_read_b32 v18, a130
v_accvgpr_read_b32 v19, a131
v_accvgpr_read_b32 v20, a132
v_accvgpr_read_b32 v21, a133
v_accvgpr_read_b32 v22, a134
v_accvgpr_read_b32 v23, a135
v_cvt_pk_bf16_f32 v16, v16, v17
v_cvt_pk_bf16_f32 v17, v18, v19
v_cvt_pk_bf16_f32 v18, v20, v21
v_cvt_pk_bf16_f32 v19, v22, v23
buffer_store_dwordx4 v[16:19], v10, s[4:7], s62 offen offset:256 sc1
buffer_store_dwordx4 v[16:19], v10, s[4:7], s63 offen offset:256 sc1
s_nop 1
v_accvgpr_read_b32 v16, a136
v_accvgpr_read_b32 v17, a137
v_accvgpr_read_b32 v18, a138
v_accvgpr_read_b32 v19, a139
v_accvgpr_read_b32 v20, a140
v_accvgpr_read_b32 v21, a141
v_accvgpr_read_b32 v22, a142
v_accvgpr_read_b32 v23, a143
v_cvt_pk_bf16_f32 v16, v16, v17
v_cvt_pk_bf16_f32 v17, v18, v19
v_cvt_pk_bf16_f32 v18, v20, v21
v_cvt_pk_bf16_f32 v19, v22, v23
buffer_store_dwordx4 v[16:19], v10, s[4:7], s62 offen offset:2304 sc1
buffer_store_dwordx4 v[16:19], v10, s[4:7], s63 offen offset:2304 sc1
m_g_nx0:
s_mov_b32 s61, 2
s_branch m_g_nx3
m_g_nx1:
s_mov_b32 s61, 1
m_g_nx3:
s_bitcmp1_b32 s24, 26
s_cbranch_scc0 m_g_nx4
m_g_sum:
s_bfe_u32 s66, s24, 0x3001b
s_bfe_u32 s67, s24, 0x2001e
s_cmp_ge_u32 s59, 4
s_cbranch_scc1 m_g_sm_k
s_lshl_b32 s62, s66, 2
s_add_u32 s62, s62, s67
s_lshl_b32 s62, s62, 2
s_add_u32 s62, s62, s14
s_lshl_b32 s62, s62, 6
s_add_u32 s62, s62, 170950656
v_mov_b32 v10, 0
m_g_sm_p:
buffer_load_dword v12, v10, s[4:7], s62 offen sc1
s_waitcnt vmcnt(0)
v_readfirstlane_b32 s71, v12
s_cmp_ge_u32 s71, 4
s_cbranch_scc1 m_g_sm_p_d
s_cmp_eq_u32 s17, 0
s_cbranch_scc1 m_g_sm_p_d
s_sub_u32 s17, s17, 1
s_branch m_g_sm_p
m_g_sm_p_d:
m_g_sm_k:
v_lshrrev_b32 v10, 4, v0
v_lshlrev_b32 v10, 9, v10
v_and_b32 v11, 15, v0
v_lshl_add_u32 v10, v11, 4, v10
s_lshl_b32 s68, s66, 1
s_add_u32 s68, s68, s32
s_lshl_b32 s68, s68, 2
s_add_u32 s68, s68, s35
s_lshl_b32 s68, s68, 16
s_lshl_b32 s69, s67, 1
s_add_u32 s69, s69, s33
s_lshl_b32 s62, s69, 13
s_add_u32 s62, s62, s68
v_and_b32 v12, 15, v0
v_lshlrev_b32 v12, 11, v12
v_lshrrev_b32 v11, 4, v0
v_lshl_add_u32 v12, v11, 4, v12
s_lshl_b32 s69, s69, 8
s_add_u32 s68, s68, s69
s_add_u32 s69, s68, 32768
buffer_load_dwordx4 v[16:19], v12, s[8:11], s68 offen offset:0
buffer_load_dwordx4 v[20:23], v12, s[8:11], s68 offen offset:64
buffer_load_dwordx4 v[24:27], v12, s[8:11], s69 offen offset:0
buffer_load_dwordx4 v[28:31], v12, s[8:11], s69 offen offset:64
buffer_load_dwordx4 v[32:35], v12, s[8:11], s68 offen offset:128
buffer_load_dwordx4 v[36:39], v12, s[8:11], s68 offen offset:192
buffer_load_dwordx4 v[40:43], v12, s[8:11], s69 offen offset:128
buffer_load_dwordx4 v[44:47], v12, s[8:11], s69 offen offset:192
s_add_u32 s63, s62, 125829120
buffer_load_dwordx4 v[48:51], v10, s[4:7], s63 offen offset:0
buffer_load_dwordx4 v[52:55], v10, s[4:7], s63 offen offset:2048
buffer_load_dwordx4 v[56:59], v10, s[4:7], s63 offen offset:256
buffer_load_dwordx4 v[60:63], v10, s[4:7], s63 offen offset:2304
s_add_u32 s63, s62, 125833216
buffer_load_dwordx4 v[64:67], v10, s[4:7], s63 offen offset:0
buffer_load_dwordx4 v[68:71], v10, s[4:7], s63 offen offset:2048
buffer_load_dwordx4 v[72:75], v10, s[4:7], s63 offen offset:256
buffer_load_dwordx4 v[76:79], v10, s[4:7], s63 offen offset:2304
s_add_u32 s63, s62, 130023424
buffer_load_dwordx4 v[80:83], v10, s[4:7], s63 offen offset:0
buffer_load_dwordx4 v[84:87], v10, s[4:7], s63 offen offset:2048
buffer_load_dwordx4 v[88:91], v10, s[4:7], s63 offen offset:256
buffer_load_dwordx4 v[92:95], v10, s[4:7], s63 offen offset:2304
s_add_u32 s63, s62, 130027520
buffer_load_dwordx4 v[96:99], v10, s[4:7], s63 offen offset:0
buffer_load_dwordx4 v[100:103], v10, s[4:7], s63 offen offset:2048
buffer_load_dwordx4 v[104:107], v10, s[4:7], s63 offen offset:256
buffer_load_dwordx4 v[108:111], v10, s[4:7], s63 offen offset:2304
s_add_u32 s63, s62, 134217728
buffer_load_dwordx4 v[112:115], v10, s[4:7], s63 offen offset:0
buffer_load_dwordx4 v[116:119], v10, s[4:7], s63 offen offset:2048
buffer_load_dwordx4 v[120:123], v10, s[4:7], s63 offen offset:256
buffer_load_dwordx4 v[124:127], v10, s[4:7], s63 offen offset:2304
s_add_u32 s63, s62, 134221824
buffer_load_dwordx4 v[128:131], v10, s[4:7], s63 offen offset:0
buffer_load_dwordx4 v[132:135], v10, s[4:7], s63 offen offset:2048
buffer_load_dwordx4 v[136:139], v10, s[4:7], s63 offen offset:256
buffer_load_dwordx4 v[140:143], v10, s[4:7], s63 offen offset:2304
s_add_u32 s63, s62, 138412032
buffer_load_dwordx4 v[144:147], v10, s[4:7], s63 offen offset:0
buffer_load_dwordx4 v[148:151], v10, s[4:7], s63 offen offset:2048
buffer_load_dwordx4 v[152:155], v10, s[4:7], s63 offen offset:256
buffer_load_dwordx4 v[156:159], v10, s[4:7], s63 offen offset:2304
s_add_u32 s63, s62, 138416128
buffer_load_dwordx4 v[160:163], v10, s[4:7], s63 offen offset:0
buffer_load_dwordx4 v[164:167], v10, s[4:7], s63 offen offset:2048
buffer_load_dwordx4 v[168:171], v10, s[4:7], s63 offen offset:256
buffer_load_dwordx4 v[172:175], v10, s[4:7], s63 offen offset:2304
s_waitcnt vmcnt(38)
v_permlane16_swap_b32 v16, v18
v_permlane16_swap_b32 v17, v19
v_permlane16_swap_b32 v20, v22
v_permlane16_swap_b32 v21, v23
v_mfma_f32_16x16x32_bf16 v[176:179], a[248:251], v[16:19], 0
v_mfma_f32_16x16x32_bf16 v[180:183], a[252:255], v[16:19], 0
v_mfma_f32_16x16x32_bf16 v[184:187], a[248:251], v[20:23], 0
v_mfma_f32_16x16x32_bf16 v[188:191], a[252:255], v[20:23], 0
s_waitcnt vmcnt(36)
v_permlane16_swap_b32 v24, v26
v_permlane16_swap_b32 v25, v27
v_permlane16_swap_b32 v28, v30
v_permlane16_swap_b32 v29, v31
v_mfma_f32_16x16x32_bf16 v[208:211], a[248:251], v[24:27], 0
v_mfma_f32_16x16x32_bf16 v[212:215], a[252:255], v[24:27], 0
v_mfma_f32_16x16x32_bf16 v[216:219], a[248:251], v[28:31], 0
v_mfma_f32_16x16x32_bf16 v[220:223], a[252:255], v[28:31], 0
s_waitcnt vmcnt(34)
v_permlane16_swap_b32 v32, v34
v_permlane16_swap_b32 v33, v35
v_permlane16_swap_b32 v36, v38
v_permlane16_swap_b32 v37, v39
v_mfma_f32_16x16x32_bf16 v[192:195], a[248:251], v[32:35], 0
v_mfma_f32_16x16x32_bf16 v[196:199], a[252:255], v[32:35], 0
v_mfma_f32_16x16x32_bf16 v[200:203], a[248:251], v[36:39], 0
v_mfma_f32_16x16x32_bf16 v[204:207], a[252:255], v[36:39], 0
s_waitcnt vmcnt(32)
v_permlane16_swap_b32 v40, v42
v_permlane16_swap_b32 v41, v43
v_permlane16_swap_b32 v44, v46
v_permlane16_swap_b32 v45, v47
v_mfma_f32_16x16x32_bf16 v[224:227], a[248:251], v[40:43], 0
v_mfma_f32_16x16x32_bf16 v[228:231], a[252:255], v[40:43], 0
v_mfma_f32_16x16x32_bf16 v[232:235], a[248:251], v[44:47], 0
v_mfma_f32_16x16x32_bf16 v[236:239], a[252:255], v[44:47], 0
s_waitcnt vmcnt(30)
v_mfma_f32_16x16x32_bf16 v[176:179], a[248:251], v[48:51], v[176:179]
v_mfma_f32_16x16x32_bf16 v[180:183], a[252:255], v[48:51], v[180:183]
v_mfma_f32_16x16x32_bf16 v[184:187], a[248:251], v[52:55], v[184:187]
v_mfma_f32_16x16x32_bf16 v[188:191], a[252:255], v[52:55], v[188:191]
s_waitcnt vmcnt(28)
v_mfma_f32_16x16x32_bf16 v[208:211], a[248:251], v[56:59], v[208:211]
v_mfma_f32_16x16x32_bf16 v[212:215], a[252:255], v[56:59], v[212:215]
v_mfma_f32_16x16x32_bf16 v[216:219], a[248:251], v[60:63], v[216:219]
v_mfma_f32_16x16x32_bf16 v[220:223], a[252:255], v[60:63], v[220:223]
s_waitcnt vmcnt(26)
v_mfma_f32_16x16x32_bf16 v[192:195], a[248:251], v[64:67], v[192:195]
v_mfma_f32_16x16x32_bf16 v[196:199], a[252:255], v[64:67], v[196:199]
v_mfma_f32_16x16x32_bf16 v[200:203], a[248:251], v[68:71], v[200:203]
v_mfma_f32_16x16x32_bf16 v[204:207], a[252:255], v[68:71], v[204:207]
s_waitcnt vmcnt(24)
v_mfma_f32_16x16x32_bf16 v[224:227], a[248:251], v[72:75], v[224:227]
v_mfma_f32_16x16x32_bf16 v[228:231], a[252:255], v[72:75], v[228:231]
v_mfma_f32_16x16x32_bf16 v[232:235], a[248:251], v[76:79], v[232:235]
v_mfma_f32_16x16x32_bf16 v[236:239], a[252:255], v[76:79], v[236:239]
s_waitcnt vmcnt(22)
v_mfma_f32_16x16x32_bf16 v[176:179], a[248:251], v[80:83], v[176:179]
v_mfma_f32_16x16x32_bf16 v[180:183], a[252:255], v[80:83], v[180:183]
v_mfma_f32_16x16x32_bf16 v[184:187], a[248:251], v[84:87], v[184:187]
v_mfma_f32_16x16x32_bf16 v[188:191], a[252:255], v[84:87], v[188:191]
s_waitcnt vmcnt(20)
v_mfma_f32_16x16x32_bf16 v[208:211], a[248:251], v[88:91], v[208:211]
v_mfma_f32_16x16x32_bf16 v[212:215], a[252:255], v[88:91], v[212:215]
v_mfma_f32_16x16x32_bf16 v[216:219], a[248:251], v[92:95], v[216:219]
v_mfma_f32_16x16x32_bf16 v[220:223], a[252:255], v[92:95], v[220:223]
s_waitcnt vmcnt(18)
v_mfma_f32_16x16x32_bf16 v[192:195], a[248:251], v[96:99], v[192:195]
v_mfma_f32_16x16x32_bf16 v[196:199], a[252:255], v[96:99], v[196:199]
v_mfma_f32_16x16x32_bf16 v[200:203], a[248:251], v[100:103], v[200:203]
v_mfma_f32_16x16x32_bf16 v[204:207], a[252:255], v[100:103], v[204:207]
s_waitcnt vmcnt(16)
v_mfma_f32_16x16x32_bf16 v[224:227], a[248:251], v[104:107], v[224:227]
v_mfma_f32_16x16x32_bf16 v[228:231], a[252:255], v[104:107], v[228:231]
v_mfma_f32_16x16x32_bf16 v[232:235], a[248:251], v[108:111], v[232:235]
v_mfma_f32_16x16x32_bf16 v[236:239], a[252:255], v[108:111], v[236:239]
s_waitcnt vmcnt(14)
v_mfma_f32_16x16x32_bf16 v[176:179], a[248:251], v[112:115], v[176:179]
v_mfma_f32_16x16x32_bf16 v[180:183], a[252:255], v[112:115], v[180:183]
v_mfma_f32_16x16x32_bf16 v[184:187], a[248:251], v[116:119], v[184:187]
v_mfma_f32_16x16x32_bf16 v[188:191], a[252:255], v[116:119], v[188:191]
s_waitcnt vmcnt(12)
v_mfma_f32_16x16x32_bf16 v[208:211], a[248:251], v[120:123], v[208:211]
v_mfma_f32_16x16x32_bf16 v[212:215], a[252:255], v[120:123], v[212:215]
v_mfma_f32_16x16x32_bf16 v[216:219], a[248:251], v[124:127], v[216:219]
v_mfma_f32_16x16x32_bf16 v[220:223], a[252:255], v[124:127], v[220:223]
s_waitcnt vmcnt(10)
v_mfma_f32_16x16x32_bf16 v[192:195], a[248:251], v[128:131], v[192:195]
v_mfma_f32_16x16x32_bf16 v[196:199], a[252:255], v[128:131], v[196:199]
v_mfma_f32_16x16x32_bf16 v[200:203], a[248:251], v[132:135], v[200:203]
v_mfma_f32_16x16x32_bf16 v[204:207], a[252:255], v[132:135], v[204:207]
s_waitcnt vmcnt(8)
v_mfma_f32_16x16x32_bf16 v[224:227], a[248:251], v[136:139], v[224:227]
v_mfma_f32_16x16x32_bf16 v[228:231], a[252:255], v[136:139], v[228:231]
v_mfma_f32_16x16x32_bf16 v[232:235], a[248:251], v[140:143], v[232:235]
v_mfma_f32_16x16x32_bf16 v[236:239], a[252:255], v[140:143], v[236:239]
s_waitcnt vmcnt(6)
v_mfma_f32_16x16x32_bf16 v[176:179], a[248:251], v[144:147], v[176:179]
v_mfma_f32_16x16x32_bf16 v[180:183], a[252:255], v[144:147], v[180:183]
v_mfma_f32_16x16x32_bf16 v[184:187], a[248:251], v[148:151], v[184:187]
v_mfma_f32_16x16x32_bf16 v[188:191], a[252:255], v[148:151], v[188:191]
s_waitcnt vmcnt(4)
v_mfma_f32_16x16x32_bf16 v[208:211], a[248:251], v[152:155], v[208:211]
v_mfma_f32_16x16x32_bf16 v[212:215], a[252:255], v[152:155], v[212:215]
v_mfma_f32_16x16x32_bf16 v[216:219], a[248:251], v[156:159], v[216:219]
v_mfma_f32_16x16x32_bf16 v[220:223], a[252:255], v[156:159], v[220:223]
s_waitcnt vmcnt(2)
v_mfma_f32_16x16x32_bf16 v[192:195], a[248:251], v[160:163], v[192:195]
v_mfma_f32_16x16x32_bf16 v[196:199], a[252:255], v[160:163], v[196:199]
v_mfma_f32_16x16x32_bf16 v[200:203], a[248:251], v[164:167], v[200:203]
v_mfma_f32_16x16x32_bf16 v[204:207], a[252:255], v[164:167], v[204:207]
s_waitcnt vmcnt(0)
v_mfma_f32_16x16x32_bf16 v[224:227], a[248:251], v[168:171], v[224:227]
v_mfma_f32_16x16x32_bf16 v[228:231], a[252:255], v[168:171], v[228:231]
v_mfma_f32_16x16x32_bf16 v[232:235], a[248:251], v[172:175], v[232:235]
v_mfma_f32_16x16x32_bf16 v[236:239], a[252:255], v[172:175], v[236:239]
v_cvt_pk_bf16_f32 v176, v176, v177
v_cvt_pk_bf16_f32 v177, v178, v179
v_cvt_pk_bf16_f32 v178, v180, v181
v_cvt_pk_bf16_f32 v179, v182, v183
v_cvt_pk_bf16_f32 v184, v184, v185
v_cvt_pk_bf16_f32 v185, v186, v187
v_cvt_pk_bf16_f32 v186, v188, v189
v_cvt_pk_bf16_f32 v187, v190, v191
v_cvt_pk_bf16_f32 v192, v192, v193
v_cvt_pk_bf16_f32 v193, v194, v195
v_cvt_pk_bf16_f32 v194, v196, v197
v_cvt_pk_bf16_f32 v195, v198, v199
v_cvt_pk_bf16_f32 v200, v200, v201
v_cvt_pk_bf16_f32 v201, v202, v203
v_cvt_pk_bf16_f32 v202, v204, v205
v_cvt_pk_bf16_f32 v203, v206, v207
v_permlane16_swap_b32 v176, v178
v_permlane16_swap_b32 v177, v179
v_permlane16_swap_b32 v184, v186
v_permlane16_swap_b32 v185, v187
v_permlane16_swap_b32 v192, v194
v_permlane16_swap_b32 v193, v195
v_permlane16_swap_b32 v200, v202
v_permlane16_swap_b32 v201, v203
buffer_store_dwordx4 v[176:179], v12, s[72:75], s68 offen offset:0
buffer_store_dwordx4 v[184:187], v12, s[72:75], s68 offen offset:64
buffer_store_dwordx4 v[192:195], v12, s[72:75], s68 offen offset:128
buffer_store_dwordx4 v[200:203], v12, s[72:75], s68 offen offset:192
v_cvt_pk_bf16_f32 v208, v208, v209
v_cvt_pk_bf16_f32 v209, v210, v211
v_cvt_pk_bf16_f32 v210, v212, v213
v_cvt_pk_bf16_f32 v211, v214, v215
v_cvt_pk_bf16_f32 v216, v216, v217
v_cvt_pk_bf16_f32 v217, v218, v219
v_cvt_pk_bf16_f32 v218, v220, v221
v_cvt_pk_bf16_f32 v219, v222, v223
v_cvt_pk_bf16_f32 v224, v224, v225
v_cvt_pk_bf16_f32 v225, v226, v227
v_cvt_pk_bf16_f32 v226, v228, v229
v_cvt_pk_bf16_f32 v227, v230, v231
v_cvt_pk_bf16_f32 v232, v232, v233
v_cvt_pk_bf16_f32 v233, v234, v235
v_cvt_pk_bf16_f32 v234, v236, v237
v_cvt_pk_bf16_f32 v235, v238, v239
v_permlane16_swap_b32 v208, v210
v_permlane16_swap_b32 v209, v211
v_permlane16_swap_b32 v216, v218
v_permlane16_swap_b32 v217, v219
v_permlane16_swap_b32 v224, v226
v_permlane16_swap_b32 v225, v227
v_permlane16_swap_b32 v232, v234
v_permlane16_swap_b32 v233, v235
buffer_store_dwordx4 v[208:211], v12, s[72:75], s69 offen offset:0
buffer_store_dwordx4 v[216:219], v12, s[72:75], s69 offen offset:64
buffer_store_dwordx4 v[224:227], v12, s[72:75], s69 offen offset:128
buffer_store_dwordx4 v[232:235], v12, s[72:75], s69 offen offset:192
m_g_nx4:
v_mov_b32 v10, 2147483648
v_mov_b32 v11, 0
v_cmp_eq_u32 s[62:63], 0, v0
s_nop 1
v_cndmask_b32 v10, v10, v11, s[62:63]
s_and_b32 s13, s18, 14
s_cmp_eq_u32 s13, 2
s_cselect_b32 s13, s15, 0
v_mov_b32 v11, s61
s_mov_b32 s29, s21
s_cmp_lg_u32 s61, 0
s_cselect_b64 vcc, -1, 0
m_g_nx2:
s_mov_b32 s70, s18
s_mov_b32 s24, s25
s_mov_b32 s25, s36
s_mov_b32 s36, s37
s_mov_b32 s37, s38
s_mov_b32 s38, s39
s_mov_b32 s39, s40
s_mov_b32 s40, s41
s_mov_b32 s41, s42
s_mov_b32 s42, s43
s_mov_b32 s43, 15
s_and_b32 s18, s24, 15
s_bfe_u32 s19, s24, 0x30004
s_bfe_u32 s20, s24, 0x40007
s_bfe_u32 s56, s24, 0x5000f
s_lshl_b32 s56, s56, 1
s_cmp_eq_u32 s56, 0
s_cselect_b32 s56, 8, s56
s_cmp_eq_u32 s28, 0
s_cbranch_scc1 m_g_warm
s_waitcnt vmcnt(0)
s_cbranch_vccz pb_11
s_mov_b64 vcc, 0
buffer_atomic_add v11, v10, s[4:7], s29 offen sc1
pb_11:
s_cmp_eq_u32 s18, 15
s_cbranch_scc1 m_g_done
s_cmp_eq_u32 s18, 10
s_cbranch_scc1 m_g_tw
s_mov_b32 s61, 0
s_mov_b32 s59, 0
s_cmp_eq_u32 s18, 11
s_cbranch_scc1 m_g_sum
v_lshlrev_b32 v13, 2, v0
v_mov_b32 v14, 2147483648
v_cmp_gt_u32 s[68:69], 4, v0
s_nop 1
v_cndmask_b32 v13, v14, v13, s[68:69]
m_g_dp:
buffer_load_dword v14, v13, s[4:7], s26 offen sc1
s_waitcnt vmcnt(0)
v_cmp_gt_u32 s[62:63], 4, v14
s_and_b32 s62, s62, s27
s_cbranch_scc0 m_g_dpd
s_cmp_eq_u32 s17, 0
s_cbranch_scc1 m_g_dpd
s_sub_u32 s17, s17, 1
s_branch m_g_dp
m_g_dpd:
s_and_b32 s63, s24, 15
s_bfe_u32 s64, s24, 0x30004
s_bfe_u32 s65, s24, 0x40007
s_bfe_u32 s66, s24, 0x4000b
s_mov_b32 s46, 268435456
s_lshl_b32 s53, s65, 9
s_sub_u32 s62, s63, 4
s_cmp_lt_u32 s62, 3
s_cbranch_scc1 m_g_wc_fw
s_lshl_b32 s52, s64, 19
s_mov_b32 s57, 65536
s_mov_b64 s[48:49], s[90:91]
s_cmp_eq_u32 s63, 0
s_cselect_b64 s[48:49], s[86:87], s[48:49]
s_cmp_eq_u32 s63, 1
s_cselect_b64 s[48:49], s[88:89], s[48:49]
s_cmp_eq_u32 s63, 3
s_cselect_b64 s[48:49], s[92:93], s[48:49]
s_cselect_b32 s58, 7168, 0
s_cselect_b32 s62, 0, 8192
s_or_b32 s58, s58, s62
s_lshl_b32 s50, s58, 10
s_branch m_g_wc_l
m_g_wc_fw:
s_lshl_b32 s62, s66, 19
s_add_u32 s53, s53, s62
s_mov_b32 s58, 2048
s_cmp_eq_u32 s63, 5
s_cselect_b64 s[48:49], s[96:97], s[94:95]
s_mov_b32 s50, 7340032
s_cselect_b32 s50, 8388608, s50
s_mov_b32 s57, 229376
s_cselect_b32 s57, 262144, s57
s_mov_b32 s52, 92274688
s_cselect_b32 s52, 109051904, s52
s_mul_i32 s62, s64, s57
s_lshl_b32 s62, s62, 3
s_add_u32 s52, s52, s62
s_lshl_b32 s62, s66, 14
s_add_u32 s52, s52, s62
m_g_wc_l:
s_mul_i32 s62, s14, 2
s_mul_i32 s62, s62, s57
v_lshl_add_u32 v4, v0, 4, s62
s_sub_u32 s62, s57, 2048
v_add_u32 v5, s62, v4
v_lshrrev_b32 v12, 5, v0
v_and_b32 v6, 31, v0
v_xor_b32 v6, v6, v12
v_lshlrev_b32 v6, 4, v6
s_lshl_b32 s62, s14, 3
v_add_u32 v12, s62, v12
v_mad_u32_u24 v6, v12, s58, v6
s_lshl_b32 s62, s58, 1
s_sub_u32 s62, s62, 1088
v_add_u32 v7, s62, v6
v_add_u32 v8, s62, v7
v_add_u32 v9, s62, v8
s_lshl_b32 s55, s58, 5
s_add_u32 m0, s60, 0
s_nop 0
buffer_load_dwordx4 v4, s[44:47], s52 offen offset:0 lds
buffer_load_dwordx4 v4, s[44:47], s52 offen offset:1024 lds
buffer_load_dwordx4 v5, s[44:47], s52 offen offset:2048 lds
buffer_load_dwordx4 v5, s[44:47], s52 offen offset:3072 lds
s_add_u32 s52, s52, 2048
s_add_u32 m0, s54, 0
s_nop 0
buffer_load_dwordx4 v6, s[48:51], s53 offen offset:0 lds
buffer_load_dwordx4 v7, s[48:51], s53 offen offset:1088 lds
buffer_load_dwordx4 v8, s[48:51], s53 offen offset:2176 lds
buffer_load_dwordx4 v9, s[48:51], s53 offen offset:3264 lds
s_add_u32 s53, s53, s55
s_add_u32 m0, s60, 33792
s_nop 0
buffer_load_dwordx4 v4, s[44:47], s52 offen offset:0 lds
buffer_load_dwordx4 v4, s[44:47], s52 offen offset:1024 lds
buffer_load_dwordx4 v5, s[44:47], s52 offen offset:2048 lds
buffer_load_dwordx4 v5, s[44:47], s52 offen offset:3072 lds
s_add_u32 s52, s52, 2048
s_add_u32 m0, s54, 33792
s_nop 0
buffer_load_dwordx4 v6, s[48:51], s53 offen offset:0 lds
buffer_load_dwordx4 v7, s[48:51], s53 offen offset:1088 lds
buffer_load_dwordx4 v8, s[48:51], s53 offen offset:2176 lds
buffer_load_dwordx4 v9, s[48:51], s53 offen offset:3264 lds
s_add_u32 s53, s53, s55
s_add_u32 m0, s60, 67584
s_nop 0
buffer_load_dwordx4 v4, s[44:47], s52 offen offset:0 lds
buffer_load_dwordx4 v4, s[44:47], s52 offen offset:1024 lds
buffer_load_dwordx4 v5, s[44:47], s52 offen offset:2048 lds
buffer_load_dwordx4 v5, s[44:47], s52 offen offset:3072 lds
s_add_u32 s52, s52, 2048
s_add_u32 m0, s54, 67584
s_nop 0
buffer_load_dwordx4 v6, s[48:51], s53 offen offset:0 lds
buffer_load_dwordx4 v7, s[48:51], s53 offen offset:1088 lds
buffer_load_dwordx4 v8, s[48:51], s53 offen offset:2176 lds
buffer_load_dwordx4 v9, s[48:51], s53 offen offset:3264 lds
s_add_u32 s53, s53, s55
s_add_u32 m0, s60, 101376
s_nop 0
buffer_load_dwordx4 v4, s[44:47], s52 offen offset:0 lds
buffer_load_dwordx4 v4, s[44:47], s52 offen offset:1024 lds
buffer_load_dwordx4 v5, s[44:47], s52 offen offset:2048 lds
buffer_load_dwordx4 v5, s[44:47], s52 offen offset:3072 lds
s_add_u32 s52, s52, 2048
s_add_u32 m0, s54, 101376
s_nop 0
buffer_load_dwordx4 v6, s[48:51], s53 offen offset:0 lds
buffer_load_dwordx4 v7, s[48:51], s53 offen offset:1088 lds
buffer_load_dwordx4 v8, s[48:51], s53 offen offset:2176 lds
buffer_load_dwordx4 v9, s[48:51], s53 offen offset:3264 lds
s_add_u32 s53, s53, s55
s_waitcnt vmcnt(24)
m_g_warm:
s_and_b32 s63, s25, 15
s_bfe_u32 s64, s25, 0x30004
s_bfe_u32 s65, s25, 0x4000b
s_bfe_u32 s66, s25, 0x5000f
s_lshl_b32 s64, s64, 4
s_add_u32 s64, s64, s65
s_lshl_b32 s64, s64, 2
s_mov_b32 s26, 170934272
s_cmp_eq_u32 s63, 5
s_cselect_b32 s26, 170936320, s26
s_add_u32 s26, s26, s64
s_lshl_b32 s64, s35, 9
s_add_u32 s26, s26, s64
s_bfm_b32 s27, s66, 0
s_cmp_ge_u32 s63, 10
s_cselect_b32 s28, 1, 0
v_lshlrev_b32 v13, 2, v0
v_mov_b32 v14, 2147483648
v_cmp_gt_u32 s[68:69], 4, v0
s_nop 1
v_cndmask_b32 v13, v14, v13, s[68:69]
s_bfe_u32 s63, s24, 0x3001b
s_bfe_u32 s64, s24, 0x2001e
s_lshl_b32 s62, s63, 2
s_add_u32 s62, s62, s64
s_lshl_b32 s62, s62, 2
s_add_u32 s62, s62, s14
s_lshl_b32 s62, s62, 6
s_add_u32 s62, s62, 170950656
s_sub_u32 s62, s62, s26
v_writelane_b32 v13, s62, 32
s_sub_u32 s62, s18, 4
s_cmp_lt_u32 s62, 3
s_cbranch_scc1 m_g_redo
s_cmp_eq_u32 s70, 2
s_cbranch_scc1 m_g_redo
s_cmp_lt_u32 s70, 7
s_cbranch_scc1 m_g_go
m_g_redo:
s_waitcnt lgkmcnt(0)
s_barrier
ds_read_b64_tr_b16 a[32:33], v2 offset:0
ds_read_b64_tr_b16 a[34:35], v2 offset:4352
ds_read_b128 a[0:3], v1 offset:0
ds_read_b64_tr_b16 a[36:37], v3 offset:0
ds_read_b64_tr_b16 a[38:39], v3 offset:4352
ds_read_b128 a[4:7], v1 offset:256
ds_read_b64_tr_b16 a[40:41], v2 offset:64
ds_read_b64_tr_b16 a[42:43], v2 offset:4416
ds_read_b128 a[8:11], v1 offset:2048
ds_read_b64_tr_b16 a[44:45], v3 offset:64
ds_read_b64_tr_b16 a[46:47], v3 offset:4416
ds_read_b128 a[12:15], v1 offset:2304
ds_read_b64_tr_b16 a[48:49], v2 offset:128
ds_read_b64_tr_b16 a[50:51], v2 offset:4480
ds_read_b128 a[16:19], v1 offset:4096
ds_read_b64_tr_b16 a[52:53], v3 offset:128
ds_read_b64_tr_b16 a[54:55], v3 offset:4480
ds_read_b128 a[20:23], v1 offset:4352
ds_read_b64_tr_b16 a[56:57], v2 offset:192
ds_read_b64_tr_b16 a[58:59], v2 offset:4544
ds_read_b128 a[24:27], v1 offset:6144
ds_read_b64_tr_b16 a[60:61], v3 offset:192
ds_read_b64_tr_b16 a[62:63], v3 offset:4544
ds_read_b128 a[28:31], v1 offset:6400
m_g_go:
s_cmp_eq_u32 s18, 1
s_cbranch_scc1 m_g_N_f
s_cmp_eq_u32 s70, 4
s_cbranch_scc1 m_g_T_c
s_branch m_g_T_f
m_g_tw:
s_bfe_u32 s18, s24, 0x50004
s_bfe_u32 s70, s24, 0x10009
s_bfe_u32 s19, s24, 0x60014
s_mov_b64 s[48:49], s[96:97]
s_mov_b32 s50, 8388608
v_lshrrev_b32 v10, 2, v0
v_and_b32 v11, 3, v0
v_lshlrev_b32 v11, 4, v11
v_lshl_add_u32 v1, v10, 11, v11
s_lshl_b32 s53, s14, 21
s_lshl_b32 s62, s18, 6
s_add_u32 s53, s53, s62
s_lshl_b32 s60, s14, 15
v_lshrrev_b32 v12, 4, v0
v_lshrrev_b32 v13, 5, v0
v_lshlrev_b32 v13, 4, v13
v_and_b32 v14, 1, v12
v_lshl_add_u32 v13, v14, 2, v13
v_and_b32 v10, 3, v10
v_add_u32 v13, v13, v10
v_lshl_add_u32 v5, v13, 6, s60
v_bfe_u32 v13, v0, 1, 1
v_lshl_add_u32 v5, v13, 5, v5
v_and_b32 v13, 1, v0
v_lshl_add_u32 v5, v13, 3, v5
s_waitcnt lgkmcnt(0)
s_bitcmp1_b32 s24, 10
s_cbranch_scc1 m_g_tw_eb
s_barrier
m_g_tw_eb:
s_add_u32 m0, s60, 0
s_nop 0
buffer_load_dwordx4 v1, s[48:51], s53 offen lds
s_add_u32 s53, s53, 32768
s_add_u32 m0, m0, 1024
s_nop 0
buffer_load_dwordx4 v1, s[48:51], s53 offen lds
s_add_u32 s53, s53, 32768
s_add_u32 m0, m0, 1024
s_nop 0
buffer_load_dwordx4 v1, s[48:51], s53 offen lds
s_add_u32 s53, s53, 32768
s_add_u32 m0, m0, 1024
s_nop 0
buffer_load_dwordx4 v1, s[48:51], s53 offen lds
s_add_u32 s53, s53, 32768
s_add_u32 m0, m0, 1024
s_nop 0
buffer_load_dwordx4 v1, s[48:51], s53 offen lds
s_add_u32 s53, s53, 32768
s_add_u32 m0, m0, 1024
s_nop 0
buffer_load_dwordx4 v1, s[48:51], s53 offen lds
s_add_u32 s53, s53, 32768
s_add_u32 m0, m0, 1024
s_nop 0
buffer_load_dwordx4 v1, s[48:51], s53 offen lds
s_add_u32 s53, s53, 32768
s_add_u32 m0, m0, 1024
s_nop 0
buffer_load_dwordx4 v1, s[48:51], s53 offen lds
s_add_u32 s53, s53, 32768
s_add_u32 m0, m0, 1024
s_nop 0
buffer_load_dwordx4 v1, s[48:51], s53 offen lds
s_add_u32 s53, s53, 32768
s_add_u32 m0, m0, 1024
s_nop 0
buffer_load_dwordx4 v1, s[48:51], s53 offen lds
s_add_u32 s53, s53, 32768
s_add_u32 m0, m0, 1024
s_nop 0
buffer_load_dwordx4 v1, s[48:51], s53 offen lds
s_add_u32 s53, s53, 32768
s_add_u32 m0, m0, 1024
s_nop 0
buffer_load_dwordx4 v1, s[48:51], s53 offen lds
s_add_u32 s53, s53, 32768
s_add_u32 m0, m0, 1024
s_nop 0
buffer_load_dwordx4 v1, s[48:51], s53 offen lds
s_add_u32 s53, s53, 32768
s_add_u32 m0, m0, 1024
s_nop 0
buffer_load_dwordx4 v1, s[48:51], s53 offen lds
s_add_u32 s53, s53, 32768
s_add_u32 m0, m0, 1024
s_nop 0
buffer_load_dwordx4 v1, s[48:51], s53 offen lds
s_add_u32 s53, s53, 32768
s_add_u32 m0, m0, 1024
s_nop 0
buffer_load_dwordx4 v1, s[48:51], s53 offen lds
s_add_u32 s53, s53, 32768
s_add_u32 m0, s60, 16384
s_nop 0
buffer_load_dwordx4 v1, s[48:51], s53 offen lds
s_add_u32 s53, s53, 32768
s_add_u32 m0, m0, 1024
s_nop 0
buffer_load_dwordx4 v1, s[48:51], s53 offen lds
s_add_u32 s53, s53, 32768
s_add_u32 m0, m0, 1024
s_nop 0
buffer_load_dwordx4 v1, s[48:51], s53 offen lds
s_add_u32 s53, s53, 32768
s_add_u32 m0, m0, 1024
s_nop 0
buffer_load_dwordx4 v1, s[48:51], s53 offen lds
s_add_u32 s53, s53, 32768
s_add_u32 m0, m0, 1024
s_nop 0
buffer_load_dwordx4 v1, s[48:51], s53 offen lds
s_add_u32 s53, s53, 32768
s_add_u32 m0, m0, 1024
s_nop 0
buffer_load_dwordx4 v1, s[48:51], s53 offen lds
s_add_u32 s53, s53, 32768
s_add_u32 m0, m0, 1024
s_nop 0
buffer_load_dwordx4 v1, s[48:51], s53 offen lds
s_add_u32 s53, s53, 32768
s_add_u32 m0, m0, 1024
s_nop 0
buffer_load_dwordx4 v1, s[48:51], s53 offen lds
s_add_u32 s53, s53, 32768
s_add_u32 m0, m0, 1024
s_nop 0
buffer_load_dwordx4 v1, s[48:51], s53 offen lds
s_add_u32 s53, s53, 32768
s_add_u32 m0, m0, 1024
s_nop 0
buffer_load_dwordx4 v1, s[48:51], s53 offen lds
s_add_u32 s53, s53, 32768
s_add_u32 m0, m0, 1024
s_nop 0
buffer_load_dwordx4 v1, s[48:51], s53 offen lds
s_add_u32 s53, s53, 32768
s_add_u32 m0, m0, 1024
s_nop 0
buffer_load_dwordx4 v1, s[48:51], s53 offen lds
s_add_u32 s53, s53, 32768
s_add_u32 m0, m0, 1024
s_nop 0
buffer_load_dwordx4 v1, s[48:51], s53 offen lds
s_add_u32 s53, s53, 32768
s_add_u32 m0, m0, 1024
s_nop 0
buffer_load_dwordx4 v1, s[48:51], s53 offen lds
s_add_u32 s53, s53, 32768
s_add_u32 m0, m0, 1024
s_nop 0
buffer_load_dwordx4 v1, s[48:51], s53 offen lds
s_add_u32 s53, s53, 32768
s_add_u32 m0, m0, 1024
s_nop 0
buffer_load_dwordx4 v1, s[48:51], s53 offen lds
s_add_u32 s53, s53, 32768
s_waitcnt vmcnt(16)
ds_read_b64_tr_b16 a[0:1], v5 offset:0
ds_read_b64_tr_b16 a[2:3], v5 offset:512
ds_read_b64_tr_b16 a[4:5], v5 offset:16
ds_read_b64_tr_b16 a[6:7], v5 offset:528
ds_read_b64_tr_b16 a[8:9], v5 offset:2048
ds_read_b64_tr_b16 a[10:11], v5 offset:2560
ds_read_b64_tr_b16 a[12:13], v5 offset:2064
ds_read_b64_tr_b16 a[14:15], v5 offset:2576
s_waitcnt lgkmcnt(4)
ds_read_b64_tr_b16 a[16:17], v5 offset:4096
ds_read_b64_tr_b16 a[18:19], v5 offset:4608
ds_read_b64_tr_b16 a[20:21], v5 offset:4112
ds_read_b64_tr_b16 a[22:23], v5 offset:4624
ds_read_b64_tr_b16 a[24:25], v5 offset:6144
ds_read_b64_tr_b16 a[26:27], v5 offset:6656
ds_read_b64_tr_b16 a[28:29], v5 offset:6160
ds_read_b64_tr_b16 a[30:31], v5 offset:6672
s_waitcnt lgkmcnt(4)
ds_read_b64_tr_b16 a[32:33], v5 offset:8192
ds_read_b64_tr_b16 a[34:35], v5 offset:8704
ds_read_b64_tr_b16 a[36:37], v5 offset:8208
ds_read_b64_tr_b16 a[38:39], v5 offset:8720
ds_read_b64_tr_b16 a[40:41], v5 offset:10240
ds_read_b64_tr_b16 a[42:43], v5 offset:10752
ds_read_b64_tr_b16 a[44:45], v5 offset:10256
ds_read_b64_tr_b16 a[46:47], v5 offset:10768
s_waitcnt lgkmcnt(4)
ds_read_b64_tr_b16 a[48:49], v5 offset:12288
ds_read_b64_tr_b16 a[50:51], v5 offset:12800
ds_read_b64_tr_b16 a[52:53], v5 offset:12304
ds_read_b64_tr_b16 a[54:55], v5 offset:12816
ds_read_b64_tr_b16 a[56:57], v5 offset:14336
ds_read_b64_tr_b16 a[58:59], v5 offset:14848
ds_read_b64_tr_b16 a[60:61], v5 offset:14352
ds_read_b64_tr_b16 a[62:63], v5 offset:14864
s_waitcnt lgkmcnt(4)
s_waitcnt lgkmcnt(0)
s_add_u32 m0, s60, 0
s_nop 0
buffer_load_dwordx4 v1, s[48:51], s53 offen lds
s_add_u32 s53, s53, 32768
s_add_u32 m0, m0, 1024
s_nop 0
buffer_load_dwordx4 v1, s[48:51], s53 offen lds
s_add_u32 s53, s53, 32768
s_add_u32 m0, m0, 1024
s_nop 0
buffer_load_dwordx4 v1, s[48:51], s53 offen lds
s_add_u32 s53, s53, 32768
s_add_u32 m0, m0, 1024
s_nop 0
buffer_load_dwordx4 v1, s[48:51], s53 offen lds
s_add_u32 s53, s53, 32768
s_add_u32 m0, m0, 1024
s_nop 0
buffer_load_dwordx4 v1, s[48:51], s53 offen lds
s_add_u32 s53, s53, 32768
s_add_u32 m0, m0, 1024
s_nop 0
buffer_load_dwordx4 v1, s[48:51], s53 offen lds
s_add_u32 s53, s53, 32768
s_add_u32 m0, m0, 1024
s_nop 0
buffer_load_dwordx4 v1, s[48:51], s53 offen lds
s_add_u32 s53, s53, 32768
s_add_u32 m0, m0, 1024
s_nop 0
buffer_load_dwordx4 v1, s[48:51], s53 offen lds
s_add_u32 s53, s53, 32768
s_add_u32 m0, m0, 1024
s_nop 0
buffer_load_dwordx4 v1, s[48:51], s53 offen lds
s_add_u32 s53, s53, 32768
s_add_u32 m0, m0, 1024
s_nop 0
buffer_load_dwordx4 v1, s[48:51], s53 offen lds
s_add_u32 s53, s53, 32768
s_add_u32 m0, m0, 1024
s_nop 0
buffer_load_dwordx4 v1, s[48:51], s53 offen lds
s_add_u32 s53, s53, 32768
s_add_u32 m0, m0, 1024
s_nop 0
buffer_load_dwordx4 v1, s[48:51], s53 offen lds
s_add_u32 s53, s53, 32768
s_add_u32 m0, m0, 1024
s_nop 0
buffer_load_dwordx4 v1, s[48:51], s53 offen lds
s_add_u32 s53, s53, 32768
s_add_u32 m0, m0, 1024
s_nop 0
buffer_load_dwordx4 v1, s[48:51], s53 offen lds
s_add_u32 s53, s53, 32768
s_add_u32 m0, m0, 1024
s_nop 0
buffer_load_dwordx4 v1, s[48:51], s53 offen lds
s_add_u32 s53, s53, 32768
s_add_u32 m0, m0, 1024
s_nop 0
buffer_load_dwordx4 v1, s[48:51], s53 offen lds
s_add_u32 s53, s53, 32768
s_waitcnt vmcnt(16)
ds_read_b64_tr_b16 a[64:65], v5 offset:16384
ds_read_b64_tr_b16 a[66:67], v5 offset:16896
ds_read_b64_tr_b16 a[68:69], v5 offset:16400
ds_read_b64_tr_b16 a[70:71], v5 offset:16912
ds_read_b64_tr_b16 a[72:73], v5 offset:18432
ds_read_b64_tr_b16 a[74:75], v5 offset:18944
ds_read_b64_tr_b16 a[76:77], v5 offset:18448
ds_read_b64_tr_b16 a[78:79], v5 offset:18960
s_waitcnt lgkmcnt(4)
ds_read_b64_tr_b16 a[80:81], v5 offset:20480
ds_read_b64_tr_b16 a[82:83], v5 offset:20992
ds_read_b64_tr_b16 a[84:85], v5 offset:20496
ds_read_b64_tr_b16 a[86:87], v5 offset:21008
ds_read_b64_tr_b16 a[88:89], v5 offset:22528
ds_read_b64_tr_b16 a[90:91], v5 offset:23040
ds_read_b64_tr_b16 a[92:93], v5 offset:22544
ds_read_b64_tr_b16 a[94:95], v5 offset:23056
s_waitcnt lgkmcnt(4)
ds_read_b64_tr_b16 a[96:97], v5 offset:24576
ds_read_b64_tr_b16 a[98:99], v5 offset:25088
ds_read_b64_tr_b16 a[100:101], v5 offset:24592
ds_read_b64_tr_b16 a[102:103], v5 offset:25104
ds_read_b64_tr_b16 a[104:105], v5 offset:26624
ds_read_b64_tr_b16 a[106:107], v5 offset:27136
ds_read_b64_tr_b16 a[108:109], v5 offset:26640
ds_read_b64_tr_b16 a[110:111], v5 offset:27152
s_waitcnt lgkmcnt(4)
ds_read_b64_tr_b16 a[112:113], v5 offset:28672
ds_read_b64_tr_b16 a[114:115], v5 offset:29184
ds_read_b64_tr_b16 a[116:117], v5 offset:28688
ds_read_b64_tr_b16 a[118:119], v5 offset:29200
ds_read_b64_tr_b16 a[120:121], v5 offset:30720
ds_read_b64_tr_b16 a[122:123], v5 offset:31232
ds_read_b64_tr_b16 a[124:125], v5 offset:30736
ds_read_b64_tr_b16 a[126:127], v5 offset:31248
s_waitcnt lgkmcnt(4)
s_waitcnt lgkmcnt(0)
s_add_u32 m0, s60, 16384
s_nop 0
buffer_load_dwordx4 v1, s[48:51], s53 offen lds
s_add_u32 s53, s53, 32768
s_add_u32 m0, m0, 1024
s_nop 0
buffer_load_dwordx4 v1, s[48:51], s53 offen lds
s_add_u32 s53, s53, 32768
s_add_u32 m0, m0, 1024
s_nop 0
buffer_load_dwordx4 v1, s[48:51], s53 offen lds
s_add_u32 s53, s53, 32768
s_add_u32 m0, m0, 1024
s_nop 0
buffer_load_dwordx4 v1, s[48:51], s53 offen lds
s_add_u32 s53, s53, 32768
s_add_u32 m0, m0, 1024
s_nop 0
buffer_load_dwordx4 v1, s[48:51], s53 offen lds
s_add_u32 s53, s53, 32768
s_add_u32 m0, m0, 1024
s_nop 0
buffer_load_dwordx4 v1, s[48:51], s53 offen lds
s_add_u32 s53, s53, 32768
s_add_u32 m0, m0, 1024
s_nop 0
buffer_load_dwordx4 v1, s[48:51], s53 offen lds
s_add_u32 s53, s53, 32768
s_add_u32 m0, m0, 1024
s_nop 0
buffer_load_dwordx4 v1, s[48:51], s53 offen lds
s_add_u32 s53, s53, 32768
s_add_u32 m0, m0, 1024
s_nop 0
buffer_load_dwordx4 v1, s[48:51], s53 offen lds
s_add_u32 s53, s53, 32768
s_add_u32 m0, m0, 1024
s_nop 0
buffer_load_dwordx4 v1, s[48:51], s53 offen lds
s_add_u32 s53, s53, 32768
s_add_u32 m0, m0, 1024
s_nop 0
buffer_load_dwordx4 v1, s[48:51], s53 offen lds
s_add_u32 s53, s53, 32768
s_add_u32 m0, m0, 1024
s_nop 0
buffer_load_dwordx4 v1, s[48:51], s53 offen lds
s_add_u32 s53, s53, 32768
s_add_u32 m0, m0, 1024
s_nop 0
buffer_load_dwordx4 v1, s[48:51], s53 offen lds
s_add_u32 s53, s53, 32768
s_add_u32 m0, m0, 1024
s_nop 0
buffer_load_dwordx4 v1, s[48:51], s53 offen lds
s_add_u32 s53, s53, 32768
s_add_u32 m0, m0, 1024
s_nop 0
buffer_load_dwordx4 v1, s[48:51], s53 offen lds
s_add_u32 s53, s53, 32768
s_add_u32 m0, m0, 1024
s_nop 0
buffer_load_dwordx4 v1, s[48:51], s53 offen lds
s_add_u32 s53, s53, 32768
s_waitcnt vmcnt(16)
ds_read_b64_tr_b16 a[128:129], v5 offset:0
ds_read_b64_tr_b16 a[130:131], v5 offset:512
ds_read_b64_tr_b16 a[132:133], v5 offset:16
ds_read_b64_tr_b16 a[134:135], v5 offset:528
ds_read_b64_tr_b16 a[136:137], v5 offset:2048
ds_read_b64_tr_b16 a[138:139], v5 offset:2560
ds_read_b64_tr_b16 a[140:141], v5 offset:2064
ds_read_b64_tr_b16 a[142:143], v5 offset:2576
s_waitcnt lgkmcnt(4)
ds_read_b64_tr_b16 a[144:145], v5 offset:4096
ds_read_b64_tr_b16 a[146:147], v5 offset:4608
ds_read_b64_tr_b16 a[148:149], v5 offset:4112
ds_read_b64_tr_b16 a[150:151], v5 offset:4624
ds_read_b64_tr_b16 a[152:153], v5 offset:6144
ds_read_b64_tr_b16 a[154:155], v5 offset:6656
ds_read_b64_tr_b16 a[156:157], v5 offset:6160
ds_read_b64_tr_b16 a[158:159], v5 offset:6672
s_waitcnt lgkmcnt(4)
ds_read_b64_tr_b16 a[160:161], v5 offset:8192
ds_read_b64_tr_b16 a[162:163], v5 offset:8704
ds_read_b64_tr_b16 a[164:165], v5 offset:8208
ds_read_b64_tr_b16 a[166:167], v5 offset:8720
ds_read_b64_tr_b16 a[168:169], v5 offset:10240
ds_read_b64_tr_b16 a[170:171], v5 offset:10752
ds_read_b64_tr_b16 a[172:173], v5 offset:10256
ds_read_b64_tr_b16 a[174:175], v5 offset:10768
s_waitcnt lgkmcnt(4)
ds_read_b64_tr_b16 a[176:177], v5 offset:12288
ds_read_b64_tr_b16 a[178:179], v5 offset:12800
ds_read_b64_tr_b16 a[180:181], v5 offset:12304
ds_read_b64_tr_b16 a[182:183], v5 offset:12816
ds_read_b64_tr_b16 a[184:185], v5 offset:14336
ds_read_b64_tr_b16 a[186:187], v5 offset:14848
ds_read_b64_tr_b16 a[188:189], v5 offset:14352
ds_read_b64_tr_b16 a[190:191], v5 offset:14864
s_waitcnt lgkmcnt(4)
s_waitcnt lgkmcnt(0)
s_waitcnt vmcnt(0)
ds_read_b64_tr_b16 a[192:193], v5 offset:16384
ds_read_b64_tr_b16 a[194:195], v5 offset:16896
ds_read_b64_tr_b16 a[196:197], v5 offset:16400
ds_read_b64_tr_b16 a[198:199], v5 offset:16912
ds_read_b64_tr_b16 a[200:201], v5 offset:18432
ds_read_b64_tr_b16 a[202:203], v5 offset:18944
ds_read_b64_tr_b16 a[204:205], v5 offset:18448
ds_read_b64_tr_b16 a[206:207], v5 offset:18960
s_waitcnt lgkmcnt(4)
ds_read_b64_tr_b16 a[208:209], v5 offset:20480
ds_read_b64_tr_b16 a[210:211], v5 offset:20992
ds_read_b64_tr_b16 a[212:213], v5 offset:20496
ds_read_b64_tr_b16 a[214:215], v5 offset:21008
ds_read_b64_tr_b16 a[216:217], v5 offset:22528
ds_read_b64_tr_b16 a[218:219], v5 offset:23040
ds_read_b64_tr_b16 a[220:221], v5 offset:22544
ds_read_b64_tr_b16 a[222:223], v5 offset:23056
s_waitcnt lgkmcnt(4)
ds_read_b64_tr_b16 a[224:225], v5 offset:24576
ds_read_b64_tr_b16 a[226:227], v5 offset:25088
ds_read_b64_tr_b16 a[228:229], v5 offset:24592
ds_read_b64_tr_b16 a[230:231], v5 offset:25104
ds_read_b64_tr_b16 a[232:233], v5 offset:26624
ds_read_b64_tr_b16 a[234:235], v5 offset:27136
ds_read_b64_tr_b16 a[236:237], v5 offset:26640
ds_read_b64_tr_b16 a[238:239], v5 offset:27152
s_waitcnt lgkmcnt(4)
ds_read_b64_tr_b16 a[240:241], v5 offset:28672
ds_read_b64_tr_b16 a[242:243], v5 offset:29184
ds_read_b64_tr_b16 a[244:245], v5 offset:28688
ds_read_b64_tr_b16 a[246:247], v5 offset:29200
ds_read_b64_tr_b16 a[248:249], v5 offset:30720
ds_read_b64_tr_b16 a[250:251], v5 offset:31232
ds_read_b64_tr_b16 a[252:253], v5 offset:30736
ds_read_b64_tr_b16 a[254:255], v5 offset:31248
s_waitcnt lgkmcnt(4)
s_waitcnt lgkmcnt(0)
v_lshrrev_b32 v7, 4, v0
v_lshlrev_b32 v7, 9, v7
v_and_b32 v10, 15, v0
v_lshl_add_u32 v7, v10, 4, v7
s_lshl_b32 s62, s70, 8
v_add_u32 v7, s62, v7
v_and_b32 v10, 15, v0
v_lshlrev_b32 v10, 11, v10
v_lshl_add_u32 v6, v12, 4, v10
s_lshl_b32 s62, s70, 15
s_lshl_b32 s63, s18, 6
s_add_u32 s62, s62, s63
v_add_u32 v6, s62, v6
v_lshlrev_b32 v2, 4, v0
v_add_u32 v5, s60, v2
s_lshr_b32 s62, s18, 3
s_lshl_b32 s62, s62, 8
s_bfe_u32 s63, s18, 0x10002
s_lshl_b32 s63, s63, 6
s_add_u32 s22, s62, s63
s_add_u32 s22, s22, 32768
s_mov_b32 s26, 170917888
s_lshl_b32 s62, s18, 11
s_cmp_eq_u32 s14, 0
s_cselect_b32 s63, 0, 2147483648
v_or_b32 v200, s63, v6
s_lshl_b32 s53, s14, 22
s_add_u32 s53, s53, s62
s_add_u32 s53, s53, 125829120
s_lshl_b32 s55, s14, 16
s_add_u32 s55, s55, 109051904
v_lshrrev_b32 v201, 1, v0
v_lshlrev_b32 v201, 10, v201
v_and_b32 v3, 1, v0
v_lshl_add_u32 v3, v3, 7, v201
s_add_u32 s22, s22, 6144
v_add_u32 v3, s22, v3
v_mov_b32 v13, 2147483648
v_cmp_gt_u32 vcc, 4, v0
s_nop 1
v_cndmask_b32 v3, v13, v3, vcc
v_cndmask_b32 v4, 0, 4, vcc
s_cmp_lg_u32 s14, 0
s_cbranch_scc1 m_g_tw_wf_d
m_g_tw_wf:
buffer_load_dword v12, v3, s[4:7], s26 offen sc1
s_waitcnt vmcnt(0)
v_cmp_gt_u32 vcc, v4, v12
s_cbranch_vccz m_g_tw_wf_d
s_cmp_eq_u32 s17, 0
s_cbranch_scc1 m_g_tw_wf_d
s_sub_u32 s17, s17, 1
s_branch m_g_tw_wf
m_g_tw_wf_d:
s_bfe_u32 s62, s24, 0x60004
s_barrier
s_lshl_b32 s62, s62, 2
s_add_u32 s62, s62, s14
s_lshl_b32 s62, s62, 7
s_add_u32 s62, s62, 98304
v_lshl_add_u32 v3, v0, 2, s62
v_cmp_gt_u32 vcc, 32, v0
s_nop 1
v_cndmask_b32 v3, v13, v3, vcc
v_lshrrev_b32 v201, 3, v0
s_bfe_u32 s62, s19, 0x20002
v_cmp_eq_u32 s[62:63], s62, v201
s_and_b32 s65, s19, 3
s_add_u32 s65, s65, 1
v_mov_b32 v4, s65
v_cndmask_b32 v4, 0, v4, s[62:63]
m_g_tw_w0:
buffer_load_dword v12, v3, s[4:7], s26 offen sc1
s_waitcnt vmcnt(0)
v_cmp_gt_u32 vcc, v4, v12
s_cbranch_vccz m_g_tw_w0_d
s_cmp_eq_u32 s17, 0
s_cbranch_scc1 m_g_tw_w0_d
s_sub_u32 s17, s17, 1
s_branch m_g_tw_w0
m_g_tw_w0_d:
s_add_u32 s64, s19, 1
s_bfe_u32 s62, s64, 0x20002
v_cmp_eq_u32 s[62:63], s62, v201
s_and_b32 s65, s64, 3
s_add_u32 s65, s65, 1
v_mov_b32 v4, s65
v_cndmask_b32 v4, 0, v4, s[62:63]
buffer_load_dword v12, v3, s[4:7], s26 offen sc1
s_lshl_b32 s21, s19, 16
buffer_load_dwordx4 v[196:199], v200, s[8:11], s21 offen
s_add_u32 s62, s21, s53
buffer_load_dwordx4 v[8:11], v7, s[4:7], s62 offen
s_lshl_b32 s20, s19, 18
s_add_u32 s20, s20, s55
buffer_load_dwordx4 v[32:35], v7, s[4:7], s20 offen offset:0
buffer_load_dwordx4 v[36:39], v7, s[4:7], s20 offen offset:2048
s_add_u32 s20, s20, 4096
buffer_load_dwordx4 v[40:43], v7, s[4:7], s20 offen offset:0
buffer_load_dwordx4 v[44:47], v7, s[4:7], s20 offen offset:2048
s_add_u32 s20, s20, 4096
buffer_load_dwordx4 v[48:51], v7, s[4:7], s20 offen offset:0
buffer_load_dwordx4 v[52:55], v7, s[4:7], s20 offen offset:2048
s_add_u32 s20, s20, 4096
buffer_load_dwordx4 v[56:59], v7, s[4:7], s20 offen offset:0
buffer_load_dwordx4 v[60:63], v7, s[4:7], s20 offen offset:2048
s_add_u32 s20, s20, 4096
buffer_load_dwordx4 v[64:67], v7, s[4:7], s20 offen offset:0
buffer_load_dwordx4 v[68:71], v7, s[4:7], s20 offen offset:2048
s_add_u32 s20, s20, 4096
buffer_load_dwordx4 v[72:75], v7, s[4:7], s20 offen offset:0
buffer_load_dwordx4 v[76:79], v7, s[4:7], s20 offen offset:2048
s_add_u32 s20, s20, 4096
buffer_load_dwordx4 v[80:83], v7, s[4:7], s20 offen offset:0
buffer_load_dwordx4 v[84:87], v7, s[4:7], s20 offen offset:2048
s_add_u32 s20, s20, 4096
buffer_load_dwordx4 v[88:91], v7, s[4:7], s20 offen offset:0
buffer_load_dwordx4 v[92:95], v7, s[4:7], s20 offen offset:2048
s_add_u32 s20, s20, 4096
buffer_load_dwordx4 v[96:99], v7, s[4:7], s20 offen offset:0
buffer_load_dwordx4 v[100:103], v7, s[4:7], s20 offen offset:2048
s_add_u32 s20, s20, 4096
buffer_load_dwordx4 v[104:107], v7, s[4:7], s20 offen offset:0
buffer_load_dwordx4 v[108:111], v7, s[4:7], s20 offen offset:2048
s_add_u32 s20, s20, 4096
buffer_load_dwordx4 v[112:115], v7, s[4:7], s20 offen offset:0
buffer_load_dwordx4 v[116:119], v7, s[4:7], s20 offen offset:2048
s_add_u32 s20, s20, 4096
buffer_load_dwordx4 v[120:123], v7, s[4:7], s20 offen offset:0
buffer_load_dwordx4 v[124:127], v7, s[4:7], s20 offen offset:2048
s_add_u32 s20, s20, 4096
buffer_load_dwordx4 v[128:131], v7, s[4:7], s20 offen offset:0
buffer_load_dwordx4 v[132:135], v7, s[4:7], s20 offen offset:2048
s_add_u32 s20, s20, 4096
buffer_load_dwordx4 v[136:139], v7, s[4:7], s20 offen offset:0
buffer_load_dwordx4 v[140:143], v7, s[4:7], s20 offen offset:2048
s_add_u32 s20, s20, 4096
buffer_load_dwordx4 v[144:147], v7, s[4:7], s20 offen offset:0
buffer_load_dwordx4 v[148:151], v7, s[4:7], s20 offen offset:2048
s_add_u32 s20, s20, 4096
buffer_load_dwordx4 v[152:155], v7, s[4:7], s20 offen offset:0
buffer_load_dwordx4 v[156:159], v7, s[4:7], s20 offen offset:2048
buffer_load_dword v14, v3, s[4:7], s26 offen sc1
m_g_tw_top:
s_add_u32 s68, s19, 1
s_waitcnt vmcnt(33)
v_permlane16_swap_b32 v196, v198
v_permlane16_swap_b32 v197, v199
v_lshlrev_b32 v16, 16, v8
v_and_b32 v17, 0xffff0000, v8
v_lshlrev_b32 v18, 16, v9
v_and_b32 v19, 0xffff0000, v9
v_lshlrev_b32 v20, 16, v10
v_and_b32 v21, 0xffff0000, v10
v_lshlrev_b32 v22, 16, v11
v_and_b32 v23, 0xffff0000, v11
v_lshlrev_b32 v24, 16, v196
v_and_b32 v25, 0xffff0000, v196
v_lshlrev_b32 v26, 16, v197
v_and_b32 v27, 0xffff0000, v197
v_lshlrev_b32 v28, 16, v198
v_and_b32 v29, 0xffff0000, v198
v_lshlrev_b32 v30, 16, v199
v_and_b32 v31, 0xffff0000, v199
v_cmp_gt_u32 vcc, v4, v12
s_cmp_eq_u32 s68, 64
s_cselect_b64 vcc, -1, vcc
s_cbranch_vccnz m_g_tw_n
s_add_u32 s64, s68, 1
s_bfe_u32 s62, s64, 0x20002
v_cmp_eq_u32 s[62:63], s62, v201
s_and_b32 s65, s64, 3
s_add_u32 s65, s65, 1
v_mov_b32 v4, s65
v_cndmask_b32 v4, 0, v4, s[62:63]
buffer_load_dword v12, v3, s[4:7], s26 offen sc1
s_lshl_b32 s21, s68, 16
buffer_load_dwordx4 v[196:199], v200, s[8:11], s21 offen
s_add_u32 s62, s21, s53
buffer_load_dwordx4 v[8:11], v7, s[4:7], s62 offen
s_lshl_b32 s20, s68, 18
s_add_u32 s20, s20, s55
s_waitcnt vmcnt(35)
v_mfma_f32_16x16x32_bf16 v[16:19], a[0:3], v[32:35], v[16:19]
v_mfma_f32_16x16x32_bf16 v[20:23], a[4:7], v[32:35], v[20:23]
s_waitcnt vmcnt(34)
v_mfma_f32_16x16x32_bf16 v[24:27], a[8:11], v[36:39], v[24:27]
v_mfma_f32_16x16x32_bf16 v[28:31], a[12:15], v[36:39], v[28:31]
buffer_load_dwordx4 v[32:35], v7, s[4:7], s20 offen offset:0
s_waitcnt vmcnt(34)
v_mfma_f32_16x16x32_bf16 v[16:19], a[16:19], v[40:43], v[16:19]
v_mfma_f32_16x16x32_bf16 v[20:23], a[20:23], v[40:43], v[20:23]
buffer_load_dwordx4 v[36:39], v7, s[4:7], s20 offen offset:2048
s_add_u32 s20, s20, 4096
s_waitcnt vmcnt(34)
v_mfma_f32_16x16x32_bf16 v[24:27], a[24:27], v[44:47], v[24:27]
v_mfma_f32_16x16x32_bf16 v[28:31], a[28:31], v[44:47], v[28:31]
buffer_load_dwordx4 v[40:43], v7, s[4:7], s20 offen offset:0
s_waitcnt vmcnt(34)
v_mfma_f32_16x16x32_bf16 v[16:19], a[32:35], v[48:51], v[16:19]
v_mfma_f32_16x16x32_bf16 v[20:23], a[36:39], v[48:51], v[20:23]
buffer_load_dwordx4 v[44:47], v7, s[4:7], s20 offen offset:2048
s_add_u32 s20, s20, 4096
s_waitcnt vmcnt(34)
v_mfma_f32_16x16x32_bf16 v[24:27], a[40:43], v[52:55], v[24:27]
v_mfma_f32_16x16x32_bf16 v[28:31], a[44:47], v[52:55], v[28:31]
buffer_load_dwordx4 v[48:51], v7, s[4:7], s20 offen offset:0
s_waitcnt vmcnt(34)
v_mfma_f32_16x16x32_bf16 v[16:19], a[48:51], v[56:59], v[16:19]
v_mfma_f32_16x16x32_bf16 v[20:23], a[52:55], v[56:59], v[20:23]
buffer_load_dwordx4 v[52:55], v7, s[4:7], s20 offen offset:2048
s_add_u32 s20, s20, 4096
s_waitcnt vmcnt(34)
v_mfma_f32_16x16x32_bf16 v[24:27], a[56:59], v[60:63], v[24:27]
v_mfma_f32_16x16x32_bf16 v[28:31], a[60:63], v[60:63], v[28:31]
buffer_load_dwordx4 v[56:59], v7, s[4:7], s20 offen offset:0
s_waitcnt vmcnt(34)
v_mfma_f32_16x16x32_bf16 v[16:19], a[64:67], v[64:67], v[16:19]
v_mfma_f32_16x16x32_bf16 v[20:23], a[68:71], v[64:67], v[20:23]
buffer_load_dwordx4 v[60:63], v7, s[4:7], s20 offen offset:2048
s_add_u32 s20, s20, 4096
s_waitcnt vmcnt(34)
v_mfma_f32_16x16x32_bf16 v[24:27], a[72:75], v[68:71], v[24:27]
v_mfma_f32_16x16x32_bf16 v[28:31], a[76:79], v[68:71], v[28:31]
buffer_load_dwordx4 v[64:67], v7, s[4:7], s20 offen offset:0
s_waitcnt vmcnt(34)
v_mfma_f32_16x16x32_bf16 v[16:19], a[80:83], v[72:75], v[16:19]
v_mfma_f32_16x16x32_bf16 v[20:23], a[84:87], v[72:75], v[20:23]
buffer_load_dwordx4 v[68:71], v7, s[4:7], s20 offen offset:2048
s_add_u32 s20, s20, 4096
s_waitcnt vmcnt(34)
v_mfma_f32_16x16x32_bf16 v[24:27], a[88:91], v[76:79], v[24:27]
v_mfma_f32_16x16x32_bf16 v[28:31], a[92:95], v[76:79], v[28:31]
buffer_load_dwordx4 v[72:75], v7, s[4:7], s20 offen offset:0
s_waitcnt vmcnt(34)
v_mfma_f32_16x16x32_bf16 v[16:19], a[96:99], v[80:83], v[16:19]
v_mfma_f32_16x16x32_bf16 v[20:23], a[100:103], v[80:83], v[20:23]
buffer_load_dwordx4 v[76:79], v7, s[4:7], s20 offen offset:2048
s_add_u32 s20, s20, 4096
s_waitcnt vmcnt(34)
v_mfma_f32_16x16x32_bf16 v[24:27], a[104:107], v[84:87], v[24:27]
v_mfma_f32_16x16x32_bf16 v[28:31], a[108:111], v[84:87], v[28:31]
buffer_load_dwordx4 v[80:83], v7, s[4:7], s20 offen offset:0
s_waitcnt vmcnt(34)
v_mfma_f32_16x16x32_bf16 v[16:19], a[112:115], v[88:91], v[16:19]
v_mfma_f32_16x16x32_bf16 v[20:23], a[116:119], v[88:91], v[20:23]
buffer_load_dwordx4 v[84:87], v7, s[4:7], s20 offen offset:2048
s_add_u32 s20, s20, 4096
s_waitcnt vmcnt(34)
v_mfma_f32_16x16x32_bf16 v[24:27], a[120:123], v[92:95], v[24:27]
v_mfma_f32_16x16x32_bf16 v[28:31], a[124:127], v[92:95], v[28:31]
buffer_load_dwordx4 v[88:91], v7, s[4:7], s20 offen offset:0
s_waitcnt vmcnt(34)
v_mfma_f32_16x16x32_bf16 v[16:19], a[128:131], v[96:99], v[16:19]
v_mfma_f32_16x16x32_bf16 v[20:23], a[132:135], v[96:99], v[20:23]
buffer_load_dwordx4 v[92:95], v7, s[4:7], s20 offen offset:2048
s_add_u32 s20, s20, 4096
s_waitcnt vmcnt(34)
v_mfma_f32_16x16x32_bf16 v[24:27], a[136:139], v[100:103], v[24:27]
v_mfma_f32_16x16x32_bf16 v[28:31], a[140:143], v[100:103], v[28:31]
buffer_load_dwordx4 v[96:99], v7, s[4:7], s20 offen offset:0
s_waitcnt vmcnt(34)
v_mfma_f32_16x16x32_bf16 v[16:19], a[144:147], v[104:107], v[16:19]
v_mfma_f32_16x16x32_bf16 v[20:23], a[148:151], v[104:107], v[20:23]
buffer_load_dwordx4 v[100:103], v7, s[4:7], s20 offen offset:2048
s_add_u32 s20, s20, 4096
s_waitcnt vmcnt(34)
v_mfma_f32_16x16x32_bf16 v[24:27], a[152:155], v[108:111], v[24:27]
v_mfma_f32_16x16x32_bf16 v[28:31], a[156:159], v[108:111], v[28:31]
buffer_load_dwordx4 v[104:107], v7, s[4:7], s20 offen offset:0
s_waitcnt vmcnt(34)
v_mfma_f32_16x16x32_bf16 v[16:19], a[160:163], v[112:115], v[16:19]
v_mfma_f32_16x16x32_bf16 v[20:23], a[164:167], v[112:115], v[20:23]
buffer_load_dwordx4 v[108:111], v7, s[4:7], s20 offen offset:2048
s_add_u32 s20, s20, 4096
s_waitcnt vmcnt(34)
v_mfma_f32_16x16x32_bf16 v[24:27], a[168:171], v[116:119], v[24:27]
v_mfma_f32_16x16x32_bf16 v[28:31], a[172:175], v[116:119], v[28:31]
buffer_load_dwordx4 v[112:115], v7, s[4:7], s20 offen offset:0
s_waitcnt vmcnt(34)
v_mfma_f32_16x16x32_bf16 v[16:19], a[176:179], v[120:123], v[16:19]
v_mfma_f32_16x16x32_bf16 v[20:23], a[180:183], v[120:123], v[20:23]
buffer_load_dwordx4 v[116:119], v7, s[4:7], s20 offen offset:2048
s_add_u32 s20, s20, 4096
s_waitcnt vmcnt(34)
v_mfma_f32_16x16x32_bf16 v[24:27], a[184:187], v[124:127], v[24:27]
v_mfma_f32_16x16x32_bf16 v[28:31], a[188:191], v[124:127], v[28:31]
buffer_load_dwordx4 v[120:123], v7, s[4:7], s20 offen offset:0
s_waitcnt vmcnt(34)
v_mfma_f32_16x16x32_bf16 v[16:19], a[192:195], v[128:131], v[16:19]
v_mfma_f32_16x16x32_bf16 v[20:23], a[196:199], v[128:131], v[20:23]
buffer_load_dwordx4 v[124:127], v7, s[4:7], s20 offen offset:2048
s_add_u32 s20, s20, 4096
s_waitcnt vmcnt(34)
v_mfma_f32_16x16x32_bf16 v[24:27], a[200:203], v[132:135], v[24:27]
v_mfma_f32_16x16x32_bf16 v[28:31], a[204:207], v[132:135], v[28:31]
buffer_load_dwordx4 v[128:131], v7, s[4:7], s20 offen offset:0
s_waitcnt vmcnt(34)
v_mfma_f32_16x16x32_bf16 v[16:19], a[208:211], v[136:139], v[16:19]
v_mfma_f32_16x16x32_bf16 v[20:23], a[212:215], v[136:139], v[20:23]
buffer_load_dwordx4 v[132:135], v7, s[4:7], s20 offen offset:2048
s_add_u32 s20, s20, 4096
s_waitcnt vmcnt(34)
v_mfma_f32_16x16x32_bf16 v[24:27], a[216:219], v[140:143], v[24:27]
v_mfma_f32_16x16x32_bf16 v[28:31], a[220:223], v[140:143], v[28:31]
buffer_load_dwordx4 v[136:139], v7, s[4:7], s20 offen offset:0
s_waitcnt vmcnt(34)
v_mfma_f32_16x16x32_bf16 v[16:19], a[224:227], v[144:147], v[16:19]
v_mfma_f32_16x16x32_bf16 v[20:23], a[228:231], v[144:147], v[20:23]
buffer_load_dwordx4 v[140:143], v7, s[4:7], s20 offen offset:2048
s_add_u32 s20, s20, 4096
s_waitcnt vmcnt(34)
v_mfma_f32_16x16x32_bf16 v[24:27], a[232:235], v[148:151], v[24:27]
v_mfma_f32_16x16x32_bf16 v[28:31], a[236:239], v[148:151], v[28:31]
buffer_load_dwordx4 v[144:147], v7, s[4:7], s20 offen offset:0
s_waitcnt vmcnt(34)
v_mfma_f32_16x16x32_bf16 v[16:19], a[240:243], v[152:155], v[16:19]
v_mfma_f32_16x16x32_bf16 v[20:23], a[244:247], v[152:155], v[20:23]
buffer_load_dwordx4 v[148:151], v7, s[4:7], s20 offen offset:2048
s_add_u32 s20, s20, 4096
s_waitcnt vmcnt(34)
v_mfma_f32_16x16x32_bf16 v[24:27], a[248:251], v[156:159], v[24:27]
v_mfma_f32_16x16x32_bf16 v[28:31], a[252:255], v[156:159], v[28:31]
buffer_load_dwordx4 v[152:155], v7, s[4:7], s20 offen offset:0
buffer_load_dwordx4 v[156:159], v7, s[4:7], s20 offen offset:2048
buffer_load_dword v14, v3, s[4:7], s26 offen sc1
s_nop 7
s_branch m_g_tw_r
m_g_tw_n:
s_waitcnt vmcnt(32)
v_mfma_f32_16x16x32_bf16 v[16:19], a[0:3], v[32:35], v[16:19]
v_mfma_f32_16x16x32_bf16 v[20:23], a[4:7], v[32:35], v[20:23]
s_waitcnt vmcnt(31)
v_mfma_f32_16x16x32_bf16 v[24:27], a[8:11], v[36:39], v[24:27]
v_mfma_f32_16x16x32_bf16 v[28:31], a[12:15], v[36:39], v[28:31]
s_waitcnt vmcnt(30)
v_mfma_f32_16x16x32_bf16 v[16:19], a[16:19], v[40:43], v[16:19]
v_mfma_f32_16x16x32_bf16 v[20:23], a[20:23], v[40:43], v[20:23]
s_waitcnt vmcnt(29)
v_mfma_f32_16x16x32_bf16 v[24:27], a[24:27], v[44:47], v[24:27]
v_mfma_f32_16x16x32_bf16 v[28:31], a[28:31], v[44:47], v[28:31]
s_waitcnt vmcnt(28)
v_mfma_f32_16x16x32_bf16 v[16:19], a[32:35], v[48:51], v[16:19]
v_mfma_f32_16x16x32_bf16 v[20:23], a[36:39], v[48:51], v[20:23]
s_waitcnt vmcnt(27)
v_mfma_f32_16x16x32_bf16 v[24:27], a[40:43], v[52:55], v[24:27]
v_mfma_f32_16x16x32_bf16 v[28:31], a[44:47], v[52:55], v[28:31]
s_waitcnt vmcnt(26)
v_mfma_f32_16x16x32_bf16 v[16:19], a[48:51], v[56:59], v[16:19]
v_mfma_f32_16x16x32_bf16 v[20:23], a[52:55], v[56:59], v[20:23]
s_waitcnt vmcnt(25)
v_mfma_f32_16x16x32_bf16 v[24:27], a[56:59], v[60:63], v[24:27]
v_mfma_f32_16x16x32_bf16 v[28:31], a[60:63], v[60:63], v[28:31]
s_waitcnt vmcnt(24)
v_mfma_f32_16x16x32_bf16 v[16:19], a[64:67], v[64:67], v[16:19]
v_mfma_f32_16x16x32_bf16 v[20:23], a[68:71], v[64:67], v[20:23]
s_waitcnt vmcnt(23)
v_mfma_f32_16x16x32_bf16 v[24:27], a[72:75], v[68:71], v[24:27]
v_mfma_f32_16x16x32_bf16 v[28:31], a[76:79], v[68:71], v[28:31]
s_waitcnt vmcnt(22)
v_mfma_f32_16x16x32_bf16 v[16:19], a[80:83], v[72:75], v[16:19]
v_mfma_f32_16x16x32_bf16 v[20:23], a[84:87], v[72:75], v[20:23]
s_waitcnt vmcnt(21)
v_mfma_f32_16x16x32_bf16 v[24:27], a[88:91], v[76:79], v[24:27]
v_mfma_f32_16x16x32_bf16 v[28:31], a[92:95], v[76:79], v[28:31]
s_waitcnt vmcnt(20)
v_mfma_f32_16x16x32_bf16 v[16:19], a[96:99], v[80:83], v[16:19]
v_mfma_f32_16x16x32_bf16 v[20:23], a[100:103], v[80:83], v[20:23]
s_waitcnt vmcnt(19)
v_mfma_f32_16x16x32_bf16 v[24:27], a[104:107], v[84:87], v[24:27]
v_mfma_f32_16x16x32_bf16 v[28:31], a[108:111], v[84:87], v[28:31]
s_waitcnt vmcnt(18)
v_mfma_f32_16x16x32_bf16 v[16:19], a[112:115], v[88:91], v[16:19]
v_mfma_f32_16x16x32_bf16 v[20:23], a[116:119], v[88:91], v[20:23]
s_waitcnt vmcnt(17)
v_mfma_f32_16x16x32_bf16 v[24:27], a[120:123], v[92:95], v[24:27]
v_mfma_f32_16x16x32_bf16 v[28:31], a[124:127], v[92:95], v[28:31]
s_waitcnt vmcnt(16)
v_mfma_f32_16x16x32_bf16 v[16:19], a[128:131], v[96:99], v[16:19]
v_mfma_f32_16x16x32_bf16 v[20:23], a[132:135], v[96:99], v[20:23]
s_waitcnt vmcnt(15)
v_mfma_f32_16x16x32_bf16 v[24:27], a[136:139], v[100:103], v[24:27]
v_mfma_f32_16x16x32_bf16 v[28:31], a[140:143], v[100:103], v[28:31]
s_waitcnt vmcnt(14)
v_mfma_f32_16x16x32_bf16 v[16:19], a[144:147], v[104:107], v[16:19]
v_mfma_f32_16x16x32_bf16 v[20:23], a[148:151], v[104:107], v[20:23]
s_waitcnt vmcnt(13)
v_mfma_f32_16x16x32_bf16 v[24:27], a[152:155], v[108:111], v[24:27]
v_mfma_f32_16x16x32_bf16 v[28:31], a[156:159], v[108:111], v[28:31]
s_waitcnt vmcnt(12)
v_mfma_f32_16x16x32_bf16 v[16:19], a[160:163], v[112:115], v[16:19]
v_mfma_f32_16x16x32_bf16 v[20:23], a[164:167], v[112:115], v[20:23]
s_waitcnt vmcnt(11)
v_mfma_f32_16x16x32_bf16 v[24:27], a[168:171], v[116:119], v[24:27]
v_mfma_f32_16x16x32_bf16 v[28:31], a[172:175], v[116:119], v[28:31]
s_waitcnt vmcnt(10)
v_mfma_f32_16x16x32_bf16 v[16:19], a[176:179], v[120:123], v[16:19]
v_mfma_f32_16x16x32_bf16 v[20:23], a[180:183], v[120:123], v[20:23]
s_waitcnt vmcnt(9)
v_mfma_f32_16x16x32_bf16 v[24:27], a[184:187], v[124:127], v[24:27]
v_mfma_f32_16x16x32_bf16 v[28:31], a[188:191], v[124:127], v[28:31]
s_waitcnt vmcnt(8)
v_mfma_f32_16x16x32_bf16 v[16:19], a[192:195], v[128:131], v[16:19]
v_mfma_f32_16x16x32_bf16 v[20:23], a[196:199], v[128:131], v[20:23]
s_waitcnt vmcnt(7)
v_mfma_f32_16x16x32_bf16 v[24:27], a[200:203], v[132:135], v[24:27]
v_mfma_f32_16x16x32_bf16 v[28:31], a[204:207], v[132:135], v[28:31]
s_waitcnt vmcnt(6)
v_mfma_f32_16x16x32_bf16 v[16:19], a[208:211], v[136:139], v[16:19]
v_mfma_f32_16x16x32_bf16 v[20:23], a[212:215], v[136:139], v[20:23]
s_waitcnt vmcnt(5)
v_mfma_f32_16x16x32_bf16 v[24:27], a[216:219], v[140:143], v[24:27]
v_mfma_f32_16x16x32_bf16 v[28:31], a[220:223], v[140:143], v[28:31]
s_waitcnt vmcnt(4)
v_mfma_f32_16x16x32_bf16 v[16:19], a[224:227], v[144:147], v[16:19]
v_mfma_f32_16x16x32_bf16 v[20:23], a[228:231], v[144:147], v[20:23]
s_waitcnt vmcnt(3)
v_mfma_f32_16x16x32_bf16 v[24:27], a[232:235], v[148:151], v[24:27]
v_mfma_f32_16x16x32_bf16 v[28:31], a[236:239], v[148:151], v[28:31]
s_waitcnt vmcnt(2)
v_mfma_f32_16x16x32_bf16 v[16:19], a[240:243], v[152:155], v[16:19]
v_mfma_f32_16x16x32_bf16 v[20:23], a[244:247], v[152:155], v[20:23]
s_waitcnt vmcnt(1)
v_mfma_f32_16x16x32_bf16 v[24:27], a[248:251], v[156:159], v[24:27]
v_mfma_f32_16x16x32_bf16 v[28:31], a[252:255], v[156:159], v[28:31]
s_waitcnt vmcnt(0)
s_nop 4
v_cmp_gt_u32 vcc, v4, v14
s_cmp_eq_u32 s68, 64
s_cselect_b64 vcc, -1, vcc
s_cbranch_vccnz m_g_tw_r
s_add_u32 s64, s68, 1
s_bfe_u32 s62, s64, 0x20002
v_cmp_eq_u32 s[62:63], s62, v201
s_and_b32 s65, s64, 3
s_add_u32 s65, s65, 1
v_mov_b32 v4, s65
v_cndmask_b32 v4, 0, v4, s[62:63]
buffer_load_dword v12, v3, s[4:7], s26 offen sc1
s_lshl_b32 s21, s68, 16
buffer_load_dwordx4 v[196:199], v200, s[8:11], s21 offen
s_add_u32 s62, s21, s53
buffer_load_dwordx4 v[8:11], v7, s[4:7], s62 offen
s_lshl_b32 s20, s68, 18
s_add_u32 s20, s20, s55
buffer_load_dwordx4 v[32:35], v7, s[4:7], s20 offen offset:0
buffer_load_dwordx4 v[36:39], v7, s[4:7], s20 offen offset:2048
s_add_u32 s20, s20, 4096
buffer_load_dwordx4 v[40:43], v7, s[4:7], s20 offen offset:0
buffer_load_dwordx4 v[44:47], v7, s[4:7], s20 offen offset:2048
s_add_u32 s20, s20, 4096
buffer_load_dwordx4 v[48:51], v7, s[4:7], s20 offen offset:0
buffer_load_dwordx4 v[52:55], v7, s[4:7], s20 offen offset:2048
s_add_u32 s20, s20, 4096
buffer_load_dwordx4 v[56:59], v7, s[4:7], s20 offen offset:0
buffer_load_dwordx4 v[60:63], v7, s[4:7], s20 offen offset:2048
s_add_u32 s20, s20, 4096
buffer_load_dwordx4 v[64:67], v7, s[4:7], s20 offen offset:0
buffer_load_dwordx4 v[68:71], v7, s[4:7], s20 offen offset:2048
s_add_u32 s20, s20, 4096
buffer_load_dwordx4 v[72:75], v7, s[4:7], s20 offen offset:0
buffer_load_dwordx4 v[76:79], v7, s[4:7], s20 offen offset:2048
s_add_u32 s20, s20, 4096
buffer_load_dwordx4 v[80:83], v7, s[4:7], s20 offen offset:0
buffer_load_dwordx4 v[84:87], v7, s[4:7], s20 offen offset:2048
s_add_u32 s20, s20, 4096
buffer_load_dwordx4 v[88:91], v7, s[4:7], s20 offen offset:0
buffer_load_dwordx4 v[92:95], v7, s[4:7], s20 offen offset:2048
s_add_u32 s20, s20, 4096
buffer_load_dwordx4 v[96:99], v7, s[4:7], s20 offen offset:0
buffer_load_dwordx4 v[100:103], v7, s[4:7], s20 offen offset:2048
s_add_u32 s20, s20, 4096
buffer_load_dwordx4 v[104:107], v7, s[4:7], s20 offen offset:0
buffer_load_dwordx4 v[108:111], v7, s[4:7], s20 offen offset:2048
s_add_u32 s20, s20, 4096
buffer_load_dwordx4 v[112:115], v7, s[4:7], s20 offen offset:0
buffer_load_dwordx4 v[116:119], v7, s[4:7], s20 offen offset:2048
s_add_u32 s20, s20, 4096
buffer_load_dwordx4 v[120:123], v7, s[4:7], s20 offen offset:0
buffer_load_dwordx4 v[124:127], v7, s[4:7], s20 offen offset:2048
s_add_u32 s20, s20, 4096
buffer_load_dwordx4 v[128:131], v7, s[4:7], s20 offen offset:0
buffer_load_dwordx4 v[132:135], v7, s[4:7], s20 offen offset:2048
s_add_u32 s20, s20, 4096
buffer_load_dwordx4 v[136:139], v7, s[4:7], s20 offen offset:0
buffer_load_dwordx4 v[140:143], v7, s[4:7], s20 offen offset:2048
s_add_u32 s20, s20, 4096
buffer_load_dwordx4 v[144:147], v7, s[4:7], s20 offen offset:0
buffer_load_dwordx4 v[148:151], v7, s[4:7], s20 offen offset:2048
s_add_u32 s20, s20, 4096
buffer_load_dwordx4 v[152:155], v7, s[4:7], s20 offen offset:0
buffer_load_dwordx4 v[156:159], v7, s[4:7], s20 offen offset:2048
buffer_load_dword v14, v3, s[4:7], s26 offen sc1
m_g_tw_r:
v_pk_add_f32 v[16:17], v[16:17], v[24:25]
v_pk_add_f32 v[18:19], v[18:19], v[26:27]
v_pk_add_f32 v[20:21], v[20:21], v[28:29]
v_pk_add_f32 v[22:23], v[22:23], v[30:31]
ds_write_b128 v5, v[16:19]
ds_write_b128 v5, v[20:23] offset:1024
v_xor_b32 v5, 2048, v5
s_waitcnt lgkmcnt(0)
s_barrier
s_and_b32 s62, s19, 3
s_cmp_lg_u32 s62, s14
s_cbranch_scc1 m_g_tw_s
ds_read_b128 v[164:167], v2 offset:0
ds_read_b128 v[168:171], v2 offset:1024
ds_read_b128 v[172:175], v2 offset:32768
ds_read_b128 v[176:179], v2 offset:33792
v_add_u32 v13, 65536, v2
ds_read_b128 v[180:183], v13 offset:0
ds_read_b128 v[184:187], v13 offset:1024
ds_read_b128 v[188:191], v13 offset:32768
ds_read_b128 v[192:195], v13 offset:33792
s_waitcnt lgkmcnt(4)
v_pk_add_f32 v[164:165], v[164:165], v[172:173]
v_pk_add_f32 v[166:167], v[166:167], v[174:175]
v_pk_add_f32 v[168:169], v[168:169], v[176:177]
v_pk_add_f32 v[170:171], v[170:171], v[178:179]
s_waitcnt lgkmcnt(2)
v_pk_add_f32 v[164:165], v[164:165], v[180:181]
v_pk_add_f32 v[166:167], v[166:167], v[182:183]
v_pk_add_f32 v[168:169], v[168:169], v[184:185]
v_pk_add_f32 v[170:171], v[170:171], v[186:187]
s_waitcnt lgkmcnt(0)
v_pk_add_f32 v[164:165], v[164:165], v[188:189]
v_pk_add_f32 v[166:167], v[166:167], v[190:191]
v_pk_add_f32 v[168:169], v[168:169], v[192:193]
v_pk_add_f32 v[170:171], v[170:171], v[194:195]
v_cvt_pk_bf16_f32 v164, v164, v165
v_cvt_pk_bf16_f32 v165, v166, v167
v_cvt_pk_bf16_f32 v166, v168, v169
v_cvt_pk_bf16_f32 v167, v170, v171
s_nop 0
v_permlane16_swap_b32 v164, v166
v_permlane16_swap_b32 v165, v167
s_lshl_b32 s62, s19, 16
buffer_store_dwordx4 v[164:167], v6, s[72:75], s62 offen
m_g_tw_s:
v_xor_b32 v2, 2048, v2
s_mov_b32 s19, s68
s_cbranch_vccz m_g_tw_top
s_cmp_eq_u32 s19, 64
s_cbranch_scc1 m_g_tw_x
m_g_tw_w1:
buffer_load_dword v12, v3, s[4:7], s26 offen sc1
s_waitcnt vmcnt(0)
v_cmp_gt_u32 vcc, v4, v12
s_cbranch_vccz m_g_tw_w1_d
s_cmp_eq_u32 s17, 0
s_cbranch_scc1 m_g_tw_w1_d
s_sub_u32 s17, s17, 1
s_branch m_g_tw_w1
m_g_tw_w1_d:
s_add_u32 s64, s19, 1
s_bfe_u32 s62, s64, 0x20002
v_cmp_eq_u32 s[62:63], s62, v201
s_and_b32 s65, s64, 3
s_add_u32 s65, s65, 1
v_mov_b32 v4, s65
v_cndmask_b32 v4, 0, v4, s[62:63]
buffer_load_dword v12, v3, s[4:7], s26 offen sc1
s_lshl_b32 s21, s19, 16
buffer_load_dwordx4 v[196:199], v200, s[8:11], s21 offen
s_add_u32 s62, s21, s53
buffer_load_dwordx4 v[8:11], v7, s[4:7], s62 offen
s_lshl_b32 s20, s19, 18
s_add_u32 s20, s20, s55
buffer_load_dwordx4 v[32:35], v7, s[4:7], s20 offen offset:0
buffer_load_dwordx4 v[36:39], v7, s[4:7], s20 offen offset:2048
s_add_u32 s20, s20, 4096
buffer_load_dwordx4 v[40:43], v7, s[4:7], s20 offen offset:0
buffer_load_dwordx4 v[44:47], v7, s[4:7], s20 offen offset:2048
s_add_u32 s20, s20, 4096
buffer_load_dwordx4 v[48:51], v7, s[4:7], s20 offen offset:0
buffer_load_dwordx4 v[52:55], v7, s[4:7], s20 offen offset:2048
s_add_u32 s20, s20, 4096
buffer_load_dwordx4 v[56:59], v7, s[4:7], s20 offen offset:0
buffer_load_dwordx4 v[60:63], v7, s[4:7], s20 offen offset:2048
s_add_u32 s20, s20, 4096
buffer_load_dwordx4 v[64:67], v7, s[4:7], s20 offen offset:0
buffer_load_dwordx4 v[68:71], v7, s[4:7], s20 offen offset:2048
s_add_u32 s20, s20, 4096
buffer_load_dwordx4 v[72:75], v7, s[4:7], s20 offen offset:0
buffer_load_dwordx4 v[76:79], v7, s[4:7], s20 offen offset:2048
s_add_u32 s20, s20, 4096
buffer_load_dwordx4 v[80:83], v7, s[4:7], s20 offen offset:0
buffer_load_dwordx4 v[84:87], v7, s[4:7], s20 offen offset:2048
s_add_u32 s20, s20, 4096
buffer_load_dwordx4 v[88:91], v7, s[4:7], s20 offen offset:0
buffer_load_dwordx4 v[92:95], v7, s[4:7], s20 offen offset:2048
s_add_u32 s20, s20, 4096
buffer_load_dwordx4 v[96:99], v7, s[4:7], s20 offen offset:0
buffer_load_dwordx4 v[100:103], v7, s[4:7], s20 offen offset:2048
s_add_u32 s20, s20, 4096
buffer_load_dwordx4 v[104:107], v7, s[4:7], s20 offen offset:0
buffer_load_dwordx4 v[108:111], v7, s[4:7], s20 offen offset:2048
s_add_u32 s20, s20, 4096
buffer_load_dwordx4 v[112:115], v7, s[4:7], s20 offen offset:0
buffer_load_dwordx4 v[116:119], v7, s[4:7], s20 offen offset:2048
s_add_u32 s20, s20, 4096
buffer_load_dwordx4 v[120:123], v7, s[4:7], s20 offen offset:0
buffer_load_dwordx4 v[124:127], v7, s[4:7], s20 offen offset:2048
s_add_u32 s20, s20, 4096
buffer_load_dwordx4 v[128:131], v7, s[4:7], s20 offen offset:0
buffer_load_dwordx4 v[132:135], v7, s[4:7], s20 offen offset:2048
s_add_u32 s20, s20, 4096
buffer_load_dwordx4 v[136:139], v7, s[4:7], s20 offen offset:0
buffer_load_dwordx4 v[140:143], v7, s[4:7], s20 offen offset:2048
s_add_u32 s20, s20, 4096
buffer_load_dwordx4 v[144:147], v7, s[4:7], s20 offen offset:0
buffer_load_dwordx4 v[148:151], v7, s[4:7], s20 offen offset:2048
s_add_u32 s20, s20, 4096
buffer_load_dwordx4 v[152:155], v7, s[4:7], s20 offen offset:0
buffer_load_dwordx4 v[156:159], v7, s[4:7], s20 offen offset:2048
buffer_load_dword v14, v3, s[4:7], s26 offen sc1
s_branch m_g_tw_top
m_g_tw_x:
m_g_done:
m_recdone:
s_waitcnt vmcnt(0)
m_end:
s_endpgm
.section .rodata,"a"
.p2align 6
.amdhsa_kernel parallel_sum__memory_aug_recurrent_mem_tr__dense_activation_silu__prompt_kernel
  .amdhsa_next_free_vgpr 512
  .amdhsa_next_free_sgpr 102
  .amdhsa_accum_offset 256
  .amdhsa_group_segment_fixed_size 0
  .amdhsa_kernarg_size 104
  .amdhsa_user_sgpr_count 2
  .amdhsa_user_sgpr_kernarg_segment_ptr 1
  .amdhsa_system_sgpr_workgroup_id_x 1
.end_amdhsa_kernel
```
